```python
import torch

def _softmax(x, axis=-1):
    return torch.softmax(x, dim=axis)
def _gelu(x):
    return torch.nn.functional.gelu(x, approximate="tanh")
def _silu(x):
    return torch.nn.functional.silu(x)
def _sigmoid(x):
    return torch.sigmoid(x)
def _layernorm(x, axis=-1, eps=1e-5):
    m = x.mean(dim=axis, keepdim=True)
    v = x.var(dim=axis, keepdim=True, unbiased=False)
    return (x - m) / torch.sqrt(v + eps)
def _scatter_add(tgt, idx, src, axis=0):
    return tgt.clone().index_add_(axis, idx, src)
def _segment_sum(src, seg, n):
    out = torch.zeros((n,) + src.shape[1:], dtype=src.dtype)
    return out.index_add_(0, seg, src)
def _pad(x, pw):
    flat = tuple(v for pair in reversed(pw) for v in pair)
    return torch.nn.functional.pad(x, flat)

kernel_name = 'parallel_sum__spectral_gfnet__dense_activation_mish__prompt'

def setup_inputs():

    _w = (lambda a: (lambda t: t.to(torch.bfloat16) if t.is_floating_point() else t)(torch.as_tensor(a)))
    def _A_setup():
        B, S, D = 1, 2048, 576
        Df = D // 2 + 1
        return {
            "x": _w((lambda *s: torch.randn(*s, dtype=torch.bfloat16) * 0.05)(B, S, D)),
            "w_r": _w((lambda *s: torch.randn(*s, dtype=torch.bfloat16) * 0.8)(S, Df) * 0.02),
            "w_i": _w((lambda *s: torch.randn(*s, dtype=torch.bfloat16) * 0.8)(S, Df) * 0.02),
        }
    _A_in = _A_setup()

    def _B_setup():
        B, S, D, F = 1, 2048, 576, 4608
        return {
            "x": _w((lambda *s: torch.randn(*s, dtype=torch.bfloat16) * 0.05)(B, S, D)),
            "w1": _w((lambda *s: torch.randn(*s, dtype=torch.bfloat16) * 0.8)(D, F) * (D ** -0.5)),
            "b1": _w((lambda *s: torch.randn(*s, dtype=torch.bfloat16) * 0.2)(F)),
            "w2": _w((lambda *s: torch.randn(*s, dtype=torch.bfloat16) * 0.1)(F, D) * (F ** -0.5)),
        }
    _B_in = _B_setup()

    return {
        "A_x": _A_in["x"],
        "A_w_r": _A_in["w_r"],
        "A_w_i": _A_in["w_i"],
        "B_x": _B_in["x"],
        "B_w1": _B_in["w1"],
        "B_b1": _B_in["b1"],
        "B_w2": _B_in["w2"],
    }

def reference(A_x, A_w_r, A_w_i, B_x, B_w1, B_b1, B_w2):
    def _A_ref(x, w_r, w_i):
        B, S, D = x.shape
        X = (lambda x, axes=(-2,-1): torch.fft.rfft2(x.float(), dim=axes))(x, axes=(-2, -1))
        W = w_r + 1j * w_i
        X = X * W
        y = (lambda x, s, axes=(-2,-1): torch.fft.irfft2(x, s=s, dim=axes).to(torch.bfloat16))(X, (S, D), axes=(-2, -1))
        return y

    def _B_ref(x, w1, b1, w2):
        h = torch.einsum("bsd,df->bsf", x, w1) + b1
        sp = torch.log1p(torch.exp(-torch.abs(h))) + torch.where(h > 0, h, torch.zeros_like(h))
        act = h * torch.tanh(sp)
        return torch.einsum("bsf,fd->bsd", act, w2)

    x = A_x
    xn = _layernorm(x, axis=-1)
    return x + _A_ref(xn, A_w_r, A_w_i) + _B_ref(xn, B_w1, B_b1, B_w2)
```

```asm
; @launch grid=(256,1,1) block=(512,1,1) lds=163840
.amdgcn_target "amdgcn-amd-amdhsa--gfx950"
.text
.globl parallel_sum__spectral_gfnet__dense_activation_mish__prompt_kernel
.p2align 8
.type parallel_sum__spectral_gfnet__dense_activation_mish__prompt_kernel,@function
parallel_sum__spectral_gfnet__dense_activation_mish__prompt_kernel:
K1_start:
    s_cmp_ge_u32 s2, 256
    s_cbranch_scc1 K1_end
    s_load_dwordx8 s[4:11], s[0:1], 0
    s_load_dwordx8 s[12:19], s[0:1], 32
    s_load_dwordx2 s[32:33], s[0:1], 72
    s_lshr_b32 s60, s2, 3
    s_getpc_b64 s[80:81]
K1_pc:
    s_mov_b32 s82, code_end-K1_pc
    s_mov_b32 s83, 0x20000
    v_mul_u32_u24 v1, 3, v0
    v_lshrrev_b32 v1, 6, v1
    v_lshlrev_b32 v1, 7, v1
    s_mul_i32 s59, s60, 3072
    s_mov_b32 m0, 157184
    s_nop 0
    buffer_load_dword v1, s[80:83], s59 offen lds
    v_lshrrev_b32 v1, 6, v0
    s_nop 0
    v_readfirstlane_b32 s48, v1
    v_mov_b32 v2, v0
    v_and_b32 v0, 63, v0
    s_and_b32 s49, s2, 1
    s_lshl_b32 s49, s49, 3
    s_and_b32 s61, s60, 7
    s_add_u32 s49, s49, s61
    s_lshr_b32 s3, s60, 3
    s_bfe_u32 s50, s2, 0x20001
    s_lshl_b32 s50, s50, 2
    s_add_u32 s50, s50, s3
    s_add_u32 s71, s3, s49
    s_and_b32 s71, s71, 0
    s_mul_i32 s71, s71, 4
    s_mul_i32 s63, s50, 576
    s_and_b32 s64, s50, 1
    s_mov_b32 s34, 0x10000000
    s_mov_b32 s35, 0x20000
    v_lshlrev_b32 v7, 4, v0
    s_cmp_lt_u32 s48, 4
    s_cbranch_scc1 K1_comp
    s_sub_u32 s51, s48, 4
    v_lshrrev_b32 v8, 3, v0
    v_lshrrev_b32 v9, 4, v0
    v_xor_b32 v9, v9, v0
    v_and_b32 v9, 7, v9
    v_lshlrev_b32 v9, 4, v9
    s_mov_b32 s22, 73728
    v_mad_u32_u24 v3, v8, s22, v9
    v_xor_b32 v4, 64, v3
    v_add_u32 v4, 1178624, v4
    s_lshl_b32 s53, s49, 2
    s_add_u32 s53, s53, s51
    s_mul_i32 s53, s53, 1152
    s_lshl_b32 s20, s71, 7
    s_add_u32 s20, s20, s53
    s_add_u32 s21, s53, 1152
    s_lshl_b32 s57, s51, 12
    s_mov_b32 s26, 2359296
    s_mov_b32 s27, 0x20000
    s_waitcnt lgkmcnt(0)
    s_mov_b64 s[24:25], s[4:5]
    s_add_u32 m0, s57, 73728
    s_mov_b32 s23, s20
    buffer_load_dwordx4 v3, s[24:27], s23 offen lds
    s_add_u32 m0, s57, 73728
    s_nop 0
    buffer_load_dwordx4 v4, s[24:27], s23 offen offset:1024 lds
    s_add_u32 m0, s57, 75776
    s_add_u32 s23, s20, 589824
    buffer_load_dwordx4 v3, s[24:27], s23 offen lds
    s_add_u32 m0, s57, 75776
    s_nop 0
    buffer_load_dwordx4 v4, s[24:27], s23 offen offset:1024 lds
    s_add_u32 s20, s20, 128
    s_cmp_eq_u32 s20, s21
    s_cselect_b32 s20, s53, s20
    v_and_b32 v9, 2, v8
    s_and_b32 s59, s51, 1
    s_lshl_b32 s59, s59, 2
    v_or_b32 v9, s59, v9
    v_xor_b32 v9, v9, v0
    v_and_b32 v9, 7, v9
    v_lshlrev_b32 v9, 4, v9
    v_mul_u32_u24 v5, 9216, v8
    v_add_u32 v5, v5, v9
    v_lshrrev_b32 v8, 2, v0
    v_mul_u32_u24 v6, 9216, v8
    s_lshr_b32 s59, s59, 1
    v_xor_b32 v9, s59, v0
    v_and_b32 v9, 3, v9
    v_lshl_add_u32 v6, v9, 4, v6
    s_mul_i32 s54, s51, 73728
    s_add_u32 s54, s54, s63
    s_mul_i32 s59, s71, 589824
    s_add_u32 s36, s54, s59
    s_add_u32 s37, s54, 5308416
    s_lshl_b32 s38, s64, 6
    s_xor_b32 s39, s64, 1
    s_lshl_b32 s39, s39, 9
    s_lshl_b32 s58, s51, 9
    s_mov_b32 s30, 5308416
    s_mov_b32 s31, 0x20000
    s_mov_b64 s[28:29], s[12:13]
    s_add_u32 m0, s57, 0
    s_add_u32 s40, s36, s38
    buffer_load_dwordx4 v5, s[28:31], s40 offen offset:0 lds
    s_add_u32 m0, s57, 896
    s_nop 0
    buffer_load_dwordx4 v5, s[28:31], s40 offen offset:128 lds
    s_add_u32 m0, s57, 1792
    s_nop 0
    buffer_load_dwordx4 v5, s[28:31], s40 offen offset:256 lds
    s_add_u32 m0, s57, 2688
    s_nop 0
    buffer_load_dwordx4 v5, s[28:31], s40 offen offset:384 lds
    s_add_u32 m0, s58, 16384
    s_add_u32 s41, s36, s39
    s_mov_b32 exec_hi, 0
    buffer_load_dwordx4 v6, s[28:31], s41 offen lds
    s_mov_b32 exec_hi, -1
    s_add_u32 s36, s36, 294912
    s_cmp_eq_u32 s36, s37
    s_cselect_b32 s36, s54, s36
    s_mov_b64 s[44:45], s[14:15]
    s_mov_b32 s46, 9216
    s_mov_b32 s47, 0x20000
    v_subrev_u32 v10, 256, v2
    v_lshlrev_b32 v11, 1, v10
    v_lshlrev_b32 v10, 2, v10
    v_add_u32 v10, 161024, v10
    s_add_u32 m0, s57, 18432
    s_add_u32 s40, s36, s38
    buffer_load_dwordx4 v5, s[28:31], s40 offen offset:0 lds
    s_add_u32 m0, s57, 19328
    s_nop 0
    buffer_load_dwordx4 v5, s[28:31], s40 offen offset:128 lds
    s_add_u32 m0, s57, 20224
    s_nop 0
    buffer_load_dwordx4 v5, s[28:31], s40 offen offset:256 lds
    s_add_u32 m0, s57, 21120
    s_nop 0
    buffer_load_dwordx4 v5, s[28:31], s40 offen offset:384 lds
    s_add_u32 m0, s58, 34816
    s_add_u32 s41, s36, s39
    s_mov_b32 exec_hi, 0
    buffer_load_dwordx4 v6, s[28:31], s41 offen lds
    s_mov_b32 exec_hi, -1
    s_add_u32 s36, s36, 294912
    s_cmp_eq_u32 s36, s37
    s_cselect_b32 s36, s54, s36
    buffer_load_ushort v12, v11, s[44:47], s63 offen
    buffer_load_ushort v13, v11, s[44:47], s63 offen offset:512
    v_and_b32 v8, 31, v0
    v_lshrrev_b32 v9, 5, v0
    v_bfe_u32 v14, v8, 1, 3
    v_xor_b32 v14, v14, v9
    v_lshlrev_b32 v14, 4, v14
    v_lshl_add_u32 v14, v8, 7, v14
    s_add_u32 s59, s57, 73728
    v_add_u32 v24, s59, v14
    v_xor_b32 v25, 32, v24
    v_xor_b32 v26, 64, v24
    v_xor_b32 v27, 0x60, v24
    v_mov_b32 v28, 0
    v_mov_b32 v29, 0
    s_branch K1_hloop
K1_comp:
    s_movk_i32 s72, 256
    s_and_b32 s51, s48, 1
    s_lshr_b32 s52, s48, 1
    v_and_b32 v8, 31, v0
    s_lshl_b32 s61, s50, 5
    s_sub_u32 s60, s61, 287
    s_cmp_lt_u32 s50, 9
    s_cselect_b32 s75, 1.0, -1.0
    s_cselect_b32 s59, s61, s60
    s_cselect_b32 s60, 0, 2
    v_and_b32 v12, 30, v8
    v_add_u32 v12, s59, v12
    v_and_or_b32 v13, v8, 1, s60
    v_add_u32 v18, s61, v8
    v_cmp_eq_u32 vcc, 1, v18
    v_mov_b32 v19, 288
    v_lshrrev_b32 v14, 5, v2
    v_mov_b32 v20, -1
    v_cndmask_b32 v12, v12, v19, vcc
    v_cndmask_b32_e64 v13, v13, 0, vcc
    v_lshrrev_b32 v19, 4, v8
    v_mul_u32_u24 v19, 9216, v19
    v_and_b32 v9, 15, v0
    v_lshl_add_u32 v19, v9, 4, v19
    v_add_u32 v15, 122880, v19
    s_mov_b32 s70, 0
K1_fg0:
    v_mov_b32 v16, v12
    v_mov_b32 v17, v13
    v_mov_b32 v18, v14
    v_lshl_add_u32 v19, v14, 10, v15
K1_fg:
    s_lshl_b32 s59, s71, 6
    v_lshl_add_u32 v18, v18, 5, s59
    v_cvt_f32_u32 v16, v16
    v_cvt_f32_u32 v17, v17
    v_cvt_f32_u32 v18, v18
    v_mul_f32 v16, 0x3ae38e39, v16
    v_mul_f32 v17, 0x3e800000, v17
    v_fma_f32 v17, v18, v16, v17
    v_fract_f32 v17, v17
    v_add_f32 v18, v17, v16
    v_cos_f32 v64, v17
    v_cos_f32 v65, v18
    v_cos_f32 v16, v16
    v_and_b32 v64, v20, v64
    v_and_b32 v65, v20, v65
    v_add_f32 v16, v16, v16
    v_fma_f32 v66, v16, v65, -v64
    v_cvt_pk_bf16_f32 v96, v64, v65
    v_fma_f32 v67, v16, v66, -v65
    v_fma_f32 v68, v16, v67, -v66
    v_cvt_pk_bf16_f32 v97, v66, v67
    v_fma_f32 v69, v16, v68, -v67
    v_fma_f32 v70, v16, v69, -v68
    v_cvt_pk_bf16_f32 v98, v68, v69
    v_fma_f32 v71, v16, v70, -v69
    v_fma_f32 v72, v16, v71, -v70
    v_cvt_pk_bf16_f32 v99, v70, v71
    ds_write_b128 v19, v[96:99]
    v_add_u32 v19, s72, v19
    v_fma_f32 v73, v16, v72, -v71
    v_fma_f32 v74, v16, v73, -v72
    v_cvt_pk_bf16_f32 v100, v72, v73
    v_fma_f32 v75, v16, v74, -v73
    v_fma_f32 v76, v16, v75, -v74
    v_cvt_pk_bf16_f32 v101, v74, v75
    v_fma_f32 v77, v16, v76, -v75
    v_fma_f32 v78, v16, v77, -v76
    v_cvt_pk_bf16_f32 v102, v76, v77
    v_fma_f32 v79, v16, v78, -v77
    v_fma_f32 v80, v16, v79, -v78
    v_cvt_pk_bf16_f32 v103, v78, v79
    ds_write_b128 v19, v[100:103]
    v_add_u32 v19, s72, v19
    v_fma_f32 v81, v16, v80, -v79
    v_fma_f32 v82, v16, v81, -v80
    v_cvt_pk_bf16_f32 v104, v80, v81
    v_fma_f32 v83, v16, v82, -v81
    v_fma_f32 v84, v16, v83, -v82
    v_cvt_pk_bf16_f32 v105, v82, v83
    v_fma_f32 v85, v16, v84, -v83
    v_fma_f32 v86, v16, v85, -v84
    v_cvt_pk_bf16_f32 v106, v84, v85
    v_fma_f32 v87, v16, v86, -v85
    v_fma_f32 v88, v16, v87, -v86
    v_cvt_pk_bf16_f32 v107, v86, v87
    ds_write_b128 v19, v[104:107]
    v_add_u32 v19, s72, v19
    v_fma_f32 v89, v16, v88, -v87
    v_fma_f32 v90, v16, v89, -v88
    v_cvt_pk_bf16_f32 v108, v88, v89
    v_fma_f32 v91, v16, v90, -v89
    v_fma_f32 v92, v16, v91, -v90
    v_cvt_pk_bf16_f32 v109, v90, v91
    v_fma_f32 v93, v16, v92, -v91
    v_fma_f32 v94, v16, v93, -v92
    v_cvt_pk_bf16_f32 v110, v92, v93
    v_fma_f32 v95, v16, v94, -v93
    v_cvt_pk_bf16_f32 v111, v94, v95
    ds_write_b128 v19, v[108:111]
    s_cmp_lg_u32 s70, 0
    s_cbranch_scc1 K1_fgd
    s_mov_b32 s70, 1
    v_mov_b32 v14, 8
    s_cmp_eq_u32 s48, 0
    s_cbranch_scc1 K1_fg0
    s_cmp_eq_u32 s48, 3
    s_cbranch_scc1 K1_fgd
    v_subrev_u32 v18, 64, v2
    v_mul_u32_u24 v21, 3641, v18
    v_lshrrev_b32 v21, 16, v21
    v_mul_u32_u24 v19, 18, v21
    v_sub_u32 v18, v18, v19
    v_mul_u32_u24 v19, 1168, v21
    v_lshl_add_u32 v19, v18, 6, v19
    v_add_u32 v19, 141312, v19
    s_lshl_b32 s59, s50, 2
    s_add_u32 s59, s59, 225
    v_and_b32 v16, 2, v21
    v_add_u32 v16, s59, v16
    v_cmp_gt_u32 vcc, 4, v21
    v_and_b32 v17, 1, v21
    s_movk_i32 s72, 16
    v_cndmask_b32 v16, 0, v16, vcc
    v_cmp_ne_u32 vcc, 5, v21
    s_nop 1
    v_cndmask_b32_e64 v20, 0, -1, vcc
    s_branch K1_fg
K1_fgd:
    v_lshrrev_b32 v10, 4, v0
    v_bfe_u32 v11, v0, 2, 2
    v_and_b32 v12, 3, v0
    v_lshlrev_b32 v13, 12, v10
    v_lshl_add_u32 v13, v11, 7, v13
    v_lshl_add_u32 v13, v12, 3, v13
    s_lshl_b32 s59, s52, 11
    v_add_u32 v13, s59, v13
    v_lshrrev_b32 v14, 1, v11
    v_and_b32 v15, 1, v10
    v_lshl_add_u32 v14, v15, 1, v14
    s_lshl_b32 s59, s51, 1
    v_xor_b32 v14, s59, v14
    v_lshl_add_u32 v1, v14, 5, v13
    v_xor_b32 v2, 32, v1
    v_xor_b32 v3, 64, v1
    v_xor_b32 v4, 0x60, v1
    v_lshrrev_b32 v14, 1, v9
    v_xor_b32 v14, v14, v10
    v_lshlrev_b32 v14, 4, v14
    v_lshl_add_u32 v14, v9, 7, v14
    s_lshl_b32 s59, s51, 13
    s_add_u32 s59, s59, 73728
    v_add_u32 v8, s59, v14
    v_xor_b32 v14, 64, v8
    v_min_u32 v13, 5, v9
    v_mul_u32_u24 v13, 1168, v13
    v_lshl_add_u32 v13, v10, 4, v13
    v_add_u32 v13, 141312, v13
    v_mov_b32 v252, 0x3f803f80
    v_mov_b32 v253, v252
    v_mov_b32 v254, v252
    v_mov_b32 v255, v252
    s_lshl_b32 s73, s49, 2
    s_lshl_b32 s59, s51, 1
    s_add_u32 s73, s73, s59
    s_waitcnt lgkmcnt(0)
    s_cmp_lg_u32 s52, 0
    s_cbranch_scc1 K1_c1
    v_lshlrev_b32 v5, 9, v10
    v_lshl_add_u32 v5, v11, 6, v5
    v_lshl_add_u32 v5, v12, 3, v5
    v_lshl_add_u32 v5, v15, 5, v5
    v_add_u32 v5, 16384, v5
    v_xor_b32 v6, 32, v5
    s_barrier
    ds_read_b128 v[204:207], v8 offset:0
    ds_read_b128 v[208:211], v8 offset:2048
    ds_read_b128 v[212:215], v8 offset:4096
    ds_read_b128 v[216:219], v8 offset:6144
    ds_read_b128 v[236:239], v13 offset:0
    ds_read_b64_tr_b16 v[240:241], v1 offset:0
    ds_read_b64_tr_b16 v[242:243], v1 offset:512
    ds_read_b64_tr_b16 v[244:245], v2 offset:0
    ds_read_b64_tr_b16 v[246:247], v2 offset:512
    s_waitcnt lgkmcnt(4)
    v_mfma_f32_16x16x32_bf16 v[200:203], v[236:239], v[204:207], 0
    ds_read_b64_tr_b16 v[248:249], v1 offset:1024
    ds_read_b64_tr_b16 v[250:251], v1 offset:1536
    s_waitcnt lgkmcnt(4)
    v_mfma_f32_16x16x32_bf16 v[176:179], v[240:243], v[252:255], 0
    ds_read_b64_tr_b16 v[236:237], v2 offset:1024
    v_mfma_f32_16x16x32_bf16 v[16:19], v[240:243], v[204:207], 0
    ds_read_b64_tr_b16 v[238:239], v2 offset:1536
    v_mfma_f32_16x16x32_bf16 v[20:23], v[240:243], v[208:211], 0
    v_mfma_f32_16x16x32_bf16 v[24:27], v[240:243], v[212:215], 0
    v_mfma_f32_16x16x32_bf16 v[28:31], v[240:243], v[216:219], 0
    s_waitcnt lgkmcnt(4)
    v_mfma_f32_16x16x32_bf16 v[180:183], v[244:247], v[252:255], 0
    ds_read_b64_tr_b16 v[240:241], v3 offset:0
    v_mfma_f32_16x16x32_bf16 v[32:35], v[244:247], v[204:207], 0
    ds_read_b64_tr_b16 v[242:243], v3 offset:512
    v_mfma_f32_16x16x32_bf16 v[36:39], v[244:247], v[208:211], 0
    v_mfma_f32_16x16x32_bf16 v[40:43], v[244:247], v[212:215], 0
    v_mfma_f32_16x16x32_bf16 v[44:47], v[244:247], v[216:219], 0
    s_waitcnt lgkmcnt(4)
    v_mfma_f32_16x16x32_bf16 v[184:187], v[248:251], v[252:255], 0
    ds_read_b64_tr_b16 v[244:245], v4 offset:0
    v_mfma_f32_16x16x32_bf16 v[80:83], v[248:251], v[204:207], 0
    ds_read_b64_tr_b16 v[246:247], v4 offset:512
    v_mfma_f32_16x16x32_bf16 v[84:87], v[248:251], v[208:211], 0
    v_mfma_f32_16x16x32_bf16 v[88:91], v[248:251], v[212:215], 0
    v_mfma_f32_16x16x32_bf16 v[92:95], v[248:251], v[216:219], 0
    s_waitcnt lgkmcnt(4)
    v_mfma_f32_16x16x32_bf16 v[188:191], v[236:239], v[252:255], 0
    ds_read_b64_tr_b16 v[248:249], v3 offset:1024
    v_mfma_f32_16x16x32_bf16 v[96:99], v[236:239], v[204:207], 0
    ds_read_b64_tr_b16 v[250:251], v3 offset:1536
    v_mfma_f32_16x16x32_bf16 v[100:103], v[236:239], v[208:211], 0
    v_mfma_f32_16x16x32_bf16 v[104:107], v[236:239], v[212:215], 0
    v_mfma_f32_16x16x32_bf16 v[108:111], v[236:239], v[216:219], 0
    s_waitcnt lgkmcnt(4)
    v_mfma_f32_16x16x32_bf16 v[48:51], v[240:243], v[204:207], 0
    ds_read_b64_tr_b16 v[236:237], v4 offset:1024
    v_mfma_f32_16x16x32_bf16 v[52:55], v[240:243], v[208:211], 0
    ds_read_b64_tr_b16 v[238:239], v4 offset:1536
    v_mfma_f32_16x16x32_bf16 v[56:59], v[240:243], v[212:215], 0
    v_mfma_f32_16x16x32_bf16 v[60:63], v[240:243], v[216:219], 0
    s_waitcnt lgkmcnt(4)
    v_mfma_f32_16x16x32_bf16 v[64:67], v[244:247], v[204:207], 0
    s_barrier
    v_mfma_f32_16x16x32_bf16 v[68:71], v[244:247], v[208:211], 0
    ds_read_b64_tr_b16 v[240:241], v5 offset:0
    v_mfma_f32_16x16x32_bf16 v[72:75], v[244:247], v[212:215], 0
    ds_read_b64_tr_b16 v[242:243], v5 offset:256
    v_mfma_f32_16x16x32_bf16 v[76:79], v[244:247], v[216:219], 0
    ds_read_b128 v[220:223], v14 offset:0
    s_waitcnt lgkmcnt(5)
    v_mfma_f32_16x16x32_bf16 v[112:115], v[248:251], v[204:207], 0
    ds_read_b64_tr_b16 v[244:245], v6 offset:0
    v_mfma_f32_16x16x32_bf16 v[116:119], v[248:251], v[208:211], 0
    ds_read_b64_tr_b16 v[246:247], v6 offset:256
    v_mfma_f32_16x16x32_bf16 v[120:123], v[248:251], v[212:215], 0
    ds_read_b128 v[224:227], v14 offset:2048
    v_mfma_f32_16x16x32_bf16 v[124:127], v[248:251], v[216:219], 0
    ds_read_b128 v[228:231], v14 offset:4096
    s_waitcnt lgkmcnt(7)
    v_mfma_f32_16x16x32_bf16 v[128:131], v[236:239], v[204:207], 0
    ds_read_b128 v[248:251], v13 offset:64
    v_mfma_f32_16x16x32_bf16 v[132:135], v[236:239], v[208:211], 0
    ds_read_b128 v[232:235], v14 offset:6144
    v_mfma_f32_16x16x32_bf16 v[136:139], v[236:239], v[212:215], 0
    v_mfma_f32_16x16x32_bf16 v[140:143], v[236:239], v[216:219], 0
    s_waitcnt lgkmcnt(7)
    v_mfma_f32_16x16x32_bf16 v[192:195], v[240:243], v[252:255], 0
    ds_read_b64_tr_b16 v[236:237], v1 offset:18432
    v_mfma_f32_16x16x32_bf16 v[144:147], v[240:243], v[204:207], 0
    ds_read_b64_tr_b16 v[238:239], v1 offset:18944
    v_mfma_f32_16x16x32_bf16 v[148:151], v[240:243], v[208:211], 0
    v_mfma_f32_16x16x32_bf16 v[152:155], v[240:243], v[212:215], 0
    v_mfma_f32_16x16x32_bf16 v[156:159], v[240:243], v[216:219], 0
    s_waitcnt lgkmcnt(6)
    v_mfma_f32_16x16x32_bf16 v[196:199], v[244:247], v[252:255], 0
    ds_read_b64_tr_b16 v[240:241], v2 offset:18432
    v_mfma_f32_16x16x32_bf16 v[160:163], v[244:247], v[204:207], 0
    ds_read_b64_tr_b16 v[242:243], v2 offset:18944
    v_mfma_f32_16x16x32_bf16 v[164:167], v[244:247], v[208:211], 0
    v_mfma_f32_16x16x32_bf16 v[168:171], v[244:247], v[212:215], 0
    v_mfma_f32_16x16x32_bf16 v[172:175], v[244:247], v[216:219], 0
    s_waitcnt lgkmcnt(4)
    v_mfma_f32_16x16x32_bf16 v[200:203], v[248:251], v[220:223], v[200:203]
    ds_read_b64_tr_b16 v[244:245], v1 offset:19456
    ds_read_b64_tr_b16 v[246:247], v1 offset:19968
    s_waitcnt lgkmcnt(4)
    v_mfma_f32_16x16x32_bf16 v[176:179], v[236:239], v[252:255], v[176:179]
    ds_read_b64_tr_b16 v[248:249], v2 offset:19456
    v_mfma_f32_16x16x32_bf16 v[16:19], v[236:239], v[220:223], v[16:19]
    ds_read_b64_tr_b16 v[250:251], v2 offset:19968
    v_mfma_f32_16x16x32_bf16 v[20:23], v[236:239], v[224:227], v[20:23]
    v_mfma_f32_16x16x32_bf16 v[24:27], v[236:239], v[228:231], v[24:27]
    v_mfma_f32_16x16x32_bf16 v[28:31], v[236:239], v[232:235], v[28:31]
    s_waitcnt lgkmcnt(4)
    v_mfma_f32_16x16x32_bf16 v[180:183], v[240:243], v[252:255], v[180:183]
    ds_read_b64_tr_b16 v[236:237], v3 offset:18432
    v_mfma_f32_16x16x32_bf16 v[32:35], v[240:243], v[220:223], v[32:35]
    ds_read_b64_tr_b16 v[238:239], v3 offset:18944
    v_mfma_f32_16x16x32_bf16 v[36:39], v[240:243], v[224:227], v[36:39]
    v_mfma_f32_16x16x32_bf16 v[40:43], v[240:243], v[228:231], v[40:43]
    v_mfma_f32_16x16x32_bf16 v[44:47], v[240:243], v[232:235], v[44:47]
    s_waitcnt lgkmcnt(4)
    v_mfma_f32_16x16x32_bf16 v[184:187], v[244:247], v[252:255], v[184:187]
    ds_read_b64_tr_b16 v[240:241], v4 offset:18432
    v_mfma_f32_16x16x32_bf16 v[80:83], v[244:247], v[220:223], v[80:83]
    ds_read_b64_tr_b16 v[242:243], v4 offset:18944
    v_mfma_f32_16x16x32_bf16 v[84:87], v[244:247], v[224:227], v[84:87]
    v_mfma_f32_16x16x32_bf16 v[88:91], v[244:247], v[228:231], v[88:91]
    v_mfma_f32_16x16x32_bf16 v[92:95], v[244:247], v[232:235], v[92:95]
    s_waitcnt lgkmcnt(4)
    v_mfma_f32_16x16x32_bf16 v[188:191], v[248:251], v[252:255], v[188:191]
    ds_read_b64_tr_b16 v[244:245], v3 offset:19456
    v_mfma_f32_16x16x32_bf16 v[96:99], v[248:251], v[220:223], v[96:99]
    ds_read_b64_tr_b16 v[246:247], v3 offset:19968
    v_mfma_f32_16x16x32_bf16 v[100:103], v[248:251], v[224:227], v[100:103]
    v_mfma_f32_16x16x32_bf16 v[104:107], v[248:251], v[228:231], v[104:107]
    v_mfma_f32_16x16x32_bf16 v[108:111], v[248:251], v[232:235], v[108:111]
    s_waitcnt lgkmcnt(4)
    v_mfma_f32_16x16x32_bf16 v[48:51], v[236:239], v[220:223], v[48:51]
    ds_read_b64_tr_b16 v[248:249], v4 offset:19456
    v_mfma_f32_16x16x32_bf16 v[52:55], v[236:239], v[224:227], v[52:55]
    ds_read_b64_tr_b16 v[250:251], v4 offset:19968
    v_mfma_f32_16x16x32_bf16 v[56:59], v[236:239], v[228:231], v[56:59]
    v_mfma_f32_16x16x32_bf16 v[60:63], v[236:239], v[232:235], v[60:63]
    s_waitcnt lgkmcnt(4)
    v_mfma_f32_16x16x32_bf16 v[64:67], v[240:243], v[220:223], v[64:67]
    s_barrier
    v_mfma_f32_16x16x32_bf16 v[68:71], v[240:243], v[224:227], v[68:71]
    ds_read_b64_tr_b16 v[236:237], v5 offset:18432
    v_mfma_f32_16x16x32_bf16 v[72:75], v[240:243], v[228:231], v[72:75]
    ds_read_b64_tr_b16 v[238:239], v5 offset:18688
    v_mfma_f32_16x16x32_bf16 v[76:79], v[240:243], v[232:235], v[76:79]
    ds_read_b128 v[204:207], v8 offset:16384
    s_waitcnt lgkmcnt(5)
    v_mfma_f32_16x16x32_bf16 v[112:115], v[244:247], v[220:223], v[112:115]
    ds_read_b64_tr_b16 v[240:241], v6 offset:18432
    v_mfma_f32_16x16x32_bf16 v[116:119], v[244:247], v[224:227], v[116:119]
    ds_read_b64_tr_b16 v[242:243], v6 offset:18688
    v_mfma_f32_16x16x32_bf16 v[120:123], v[244:247], v[228:231], v[120:123]
    ds_read_b128 v[208:211], v8 offset:18432
    v_mfma_f32_16x16x32_bf16 v[124:127], v[244:247], v[232:235], v[124:127]
    ds_read_b128 v[212:215], v8 offset:20480
    s_waitcnt lgkmcnt(7)
    v_mfma_f32_16x16x32_bf16 v[128:131], v[248:251], v[220:223], v[128:131]
    ds_read_b128 v[244:247], v13 offset:128
    v_mfma_f32_16x16x32_bf16 v[132:135], v[248:251], v[224:227], v[132:135]
    ds_read_b128 v[216:219], v8 offset:22528
    v_mfma_f32_16x16x32_bf16 v[136:139], v[248:251], v[228:231], v[136:139]
    v_mfma_f32_16x16x32_bf16 v[140:143], v[248:251], v[232:235], v[140:143]
    s_waitcnt lgkmcnt(7)
    v_mfma_f32_16x16x32_bf16 v[192:195], v[236:239], v[252:255], v[192:195]
    ds_read_b64_tr_b16 v[248:249], v1 offset:36864
    v_mfma_f32_16x16x32_bf16 v[144:147], v[236:239], v[220:223], v[144:147]
    ds_read_b64_tr_b16 v[250:251], v1 offset:37376
    v_mfma_f32_16x16x32_bf16 v[148:151], v[236:239], v[224:227], v[148:151]
    v_mfma_f32_16x16x32_bf16 v[152:155], v[236:239], v[228:231], v[152:155]
    v_mfma_f32_16x16x32_bf16 v[156:159], v[236:239], v[232:235], v[156:159]
    s_waitcnt lgkmcnt(6)
    v_mfma_f32_16x16x32_bf16 v[196:199], v[240:243], v[252:255], v[196:199]
    ds_read_b64_tr_b16 v[236:237], v2 offset:36864
    v_mfma_f32_16x16x32_bf16 v[160:163], v[240:243], v[220:223], v[160:163]
    ds_read_b64_tr_b16 v[238:239], v2 offset:37376
    v_mfma_f32_16x16x32_bf16 v[164:167], v[240:243], v[224:227], v[164:167]
    v_mfma_f32_16x16x32_bf16 v[168:171], v[240:243], v[228:231], v[168:171]
    v_mfma_f32_16x16x32_bf16 v[172:175], v[240:243], v[232:235], v[172:175]
    s_waitcnt lgkmcnt(4)
    v_mfma_f32_16x16x32_bf16 v[200:203], v[244:247], v[204:207], v[200:203]
    ds_read_b64_tr_b16 v[240:241], v1 offset:37888
    ds_read_b64_tr_b16 v[242:243], v1 offset:38400
    s_waitcnt lgkmcnt(4)
    v_mfma_f32_16x16x32_bf16 v[176:179], v[248:251], v[252:255], v[176:179]
    ds_read_b64_tr_b16 v[244:245], v2 offset:37888
    v_mfma_f32_16x16x32_bf16 v[16:19], v[248:251], v[204:207], v[16:19]
    ds_read_b64_tr_b16 v[246:247], v2 offset:38400
    v_mfma_f32_16x16x32_bf16 v[20:23], v[248:251], v[208:211], v[20:23]
    v_mfma_f32_16x16x32_bf16 v[24:27], v[248:251], v[212:215], v[24:27]
    v_mfma_f32_16x16x32_bf16 v[28:31], v[248:251], v[216:219], v[28:31]
    s_waitcnt lgkmcnt(4)
    v_mfma_f32_16x16x32_bf16 v[180:183], v[236:239], v[252:255], v[180:183]
    ds_read_b64_tr_b16 v[248:249], v3 offset:36864
    v_mfma_f32_16x16x32_bf16 v[32:35], v[236:239], v[204:207], v[32:35]
    ds_read_b64_tr_b16 v[250:251], v3 offset:37376
    v_mfma_f32_16x16x32_bf16 v[36:39], v[236:239], v[208:211], v[36:39]
    v_mfma_f32_16x16x32_bf16 v[40:43], v[236:239], v[212:215], v[40:43]
    v_mfma_f32_16x16x32_bf16 v[44:47], v[236:239], v[216:219], v[44:47]
    s_waitcnt lgkmcnt(4)
    v_mfma_f32_16x16x32_bf16 v[184:187], v[240:243], v[252:255], v[184:187]
    ds_read_b64_tr_b16 v[236:237], v4 offset:36864
    v_mfma_f32_16x16x32_bf16 v[80:83], v[240:243], v[204:207], v[80:83]
    ds_read_b64_tr_b16 v[238:239], v4 offset:37376
    v_mfma_f32_16x16x32_bf16 v[84:87], v[240:243], v[208:211], v[84:87]
    v_mfma_f32_16x16x32_bf16 v[88:91], v[240:243], v[212:215], v[88:91]
    v_mfma_f32_16x16x32_bf16 v[92:95], v[240:243], v[216:219], v[92:95]
    s_waitcnt lgkmcnt(4)
    v_mfma_f32_16x16x32_bf16 v[188:191], v[244:247], v[252:255], v[188:191]
    ds_read_b64_tr_b16 v[240:241], v3 offset:37888
    v_mfma_f32_16x16x32_bf16 v[96:99], v[244:247], v[204:207], v[96:99]
    ds_read_b64_tr_b16 v[242:243], v3 offset:38400
    v_mfma_f32_16x16x32_bf16 v[100:103], v[244:247], v[208:211], v[100:103]
    v_mfma_f32_16x16x32_bf16 v[104:107], v[244:247], v[212:215], v[104:107]
    v_mfma_f32_16x16x32_bf16 v[108:111], v[244:247], v[216:219], v[108:111]
    s_waitcnt lgkmcnt(4)
    v_mfma_f32_16x16x32_bf16 v[48:51], v[248:251], v[204:207], v[48:51]
    ds_read_b64_tr_b16 v[244:245], v4 offset:37888
    v_mfma_f32_16x16x32_bf16 v[52:55], v[248:251], v[208:211], v[52:55]
    ds_read_b64_tr_b16 v[246:247], v4 offset:38400
    v_mfma_f32_16x16x32_bf16 v[56:59], v[248:251], v[212:215], v[56:59]
    v_mfma_f32_16x16x32_bf16 v[60:63], v[248:251], v[216:219], v[60:63]
    s_waitcnt lgkmcnt(4)
    v_mfma_f32_16x16x32_bf16 v[64:67], v[236:239], v[204:207], v[64:67]
    s_barrier
    v_mfma_f32_16x16x32_bf16 v[68:71], v[236:239], v[208:211], v[68:71]
    ds_read_b64_tr_b16 v[248:249], v5 offset:36864
    v_mfma_f32_16x16x32_bf16 v[72:75], v[236:239], v[212:215], v[72:75]
    ds_read_b64_tr_b16 v[250:251], v5 offset:37120
    v_mfma_f32_16x16x32_bf16 v[76:79], v[236:239], v[216:219], v[76:79]
    ds_read_b128 v[220:223], v14 offset:16384
    s_waitcnt lgkmcnt(5)
    v_mfma_f32_16x16x32_bf16 v[112:115], v[240:243], v[204:207], v[112:115]
    ds_read_b64_tr_b16 v[236:237], v6 offset:36864
    v_mfma_f32_16x16x32_bf16 v[116:119], v[240:243], v[208:211], v[116:119]
    ds_read_b64_tr_b16 v[238:239], v6 offset:37120
    v_mfma_f32_16x16x32_bf16 v[120:123], v[240:243], v[212:215], v[120:123]
    ds_read_b128 v[224:227], v14 offset:18432
    v_mfma_f32_16x16x32_bf16 v[124:127], v[240:243], v[216:219], v[124:127]
    ds_read_b128 v[228:231], v14 offset:20480
    s_waitcnt lgkmcnt(7)
    v_mfma_f32_16x16x32_bf16 v[128:131], v[244:247], v[204:207], v[128:131]
    ds_read_b128 v[240:243], v13 offset:192
    v_mfma_f32_16x16x32_bf16 v[132:135], v[244:247], v[208:211], v[132:135]
    ds_read_b128 v[232:235], v14 offset:22528
    v_mfma_f32_16x16x32_bf16 v[136:139], v[244:247], v[212:215], v[136:139]
    v_mfma_f32_16x16x32_bf16 v[140:143], v[244:247], v[216:219], v[140:143]
    s_waitcnt lgkmcnt(7)
    v_mfma_f32_16x16x32_bf16 v[192:195], v[248:251], v[252:255], v[192:195]
    ds_read_b64_tr_b16 v[244:245], v1 offset:55296
    v_mfma_f32_16x16x32_bf16 v[144:147], v[248:251], v[204:207], v[144:147]
    ds_read_b64_tr_b16 v[246:247], v1 offset:55808
    v_mfma_f32_16x16x32_bf16 v[148:151], v[248:251], v[208:211], v[148:151]
    v_mfma_f32_16x16x32_bf16 v[152:155], v[248:251], v[212:215], v[152:155]
    v_mfma_f32_16x16x32_bf16 v[156:159], v[248:251], v[216:219], v[156:159]
    s_waitcnt lgkmcnt(6)
    v_mfma_f32_16x16x32_bf16 v[196:199], v[236:239], v[252:255], v[196:199]
    ds_read_b64_tr_b16 v[248:249], v2 offset:55296
    v_mfma_f32_16x16x32_bf16 v[160:163], v[236:239], v[204:207], v[160:163]
    ds_read_b64_tr_b16 v[250:251], v2 offset:55808
    v_mfma_f32_16x16x32_bf16 v[164:167], v[236:239], v[208:211], v[164:167]
    v_mfma_f32_16x16x32_bf16 v[168:171], v[236:239], v[212:215], v[168:171]
    v_mfma_f32_16x16x32_bf16 v[172:175], v[236:239], v[216:219], v[172:175]
    s_waitcnt lgkmcnt(4)
    v_mfma_f32_16x16x32_bf16 v[200:203], v[240:243], v[220:223], v[200:203]
    ds_read_b64_tr_b16 v[236:237], v1 offset:56320
    ds_read_b64_tr_b16 v[238:239], v1 offset:56832
    s_waitcnt lgkmcnt(4)
    v_mfma_f32_16x16x32_bf16 v[176:179], v[244:247], v[252:255], v[176:179]
    ds_read_b64_tr_b16 v[240:241], v2 offset:56320
    v_mfma_f32_16x16x32_bf16 v[16:19], v[244:247], v[220:223], v[16:19]
    ds_read_b64_tr_b16 v[242:243], v2 offset:56832
    v_mfma_f32_16x16x32_bf16 v[20:23], v[244:247], v[224:227], v[20:23]
    v_mfma_f32_16x16x32_bf16 v[24:27], v[244:247], v[228:231], v[24:27]
    v_mfma_f32_16x16x32_bf16 v[28:31], v[244:247], v[232:235], v[28:31]
    s_waitcnt lgkmcnt(4)
    v_mfma_f32_16x16x32_bf16 v[180:183], v[248:251], v[252:255], v[180:183]
    ds_read_b64_tr_b16 v[244:245], v3 offset:55296
    v_mfma_f32_16x16x32_bf16 v[32:35], v[248:251], v[220:223], v[32:35]
    ds_read_b64_tr_b16 v[246:247], v3 offset:55808
    v_mfma_f32_16x16x32_bf16 v[36:39], v[248:251], v[224:227], v[36:39]
    v_mfma_f32_16x16x32_bf16 v[40:43], v[248:251], v[228:231], v[40:43]
    v_mfma_f32_16x16x32_bf16 v[44:47], v[248:251], v[232:235], v[44:47]
    s_waitcnt lgkmcnt(4)
    v_mfma_f32_16x16x32_bf16 v[184:187], v[236:239], v[252:255], v[184:187]
    ds_read_b64_tr_b16 v[248:249], v4 offset:55296
    v_mfma_f32_16x16x32_bf16 v[80:83], v[236:239], v[220:223], v[80:83]
    ds_read_b64_tr_b16 v[250:251], v4 offset:55808
    v_mfma_f32_16x16x32_bf16 v[84:87], v[236:239], v[224:227], v[84:87]
    v_mfma_f32_16x16x32_bf16 v[88:91], v[236:239], v[228:231], v[88:91]
    v_mfma_f32_16x16x32_bf16 v[92:95], v[236:239], v[232:235], v[92:95]
    s_waitcnt lgkmcnt(4)
    v_mfma_f32_16x16x32_bf16 v[188:191], v[240:243], v[252:255], v[188:191]
    ds_read_b64_tr_b16 v[236:237], v3 offset:56320
    v_mfma_f32_16x16x32_bf16 v[96:99], v[240:243], v[220:223], v[96:99]
    ds_read_b64_tr_b16 v[238:239], v3 offset:56832
    v_mfma_f32_16x16x32_bf16 v[100:103], v[240:243], v[224:227], v[100:103]
    v_mfma_f32_16x16x32_bf16 v[104:107], v[240:243], v[228:231], v[104:107]
    v_mfma_f32_16x16x32_bf16 v[108:111], v[240:243], v[232:235], v[108:111]
    s_waitcnt lgkmcnt(4)
    v_mfma_f32_16x16x32_bf16 v[48:51], v[244:247], v[220:223], v[48:51]
    ds_read_b64_tr_b16 v[240:241], v4 offset:56320
    v_mfma_f32_16x16x32_bf16 v[52:55], v[244:247], v[224:227], v[52:55]
    ds_read_b64_tr_b16 v[242:243], v4 offset:56832
    v_mfma_f32_16x16x32_bf16 v[56:59], v[244:247], v[228:231], v[56:59]
    v_mfma_f32_16x16x32_bf16 v[60:63], v[244:247], v[232:235], v[60:63]
    s_waitcnt lgkmcnt(4)
    v_mfma_f32_16x16x32_bf16 v[64:67], v[248:251], v[220:223], v[64:67]
    s_barrier
    v_mfma_f32_16x16x32_bf16 v[68:71], v[248:251], v[224:227], v[68:71]
    ds_read_b64_tr_b16 v[244:245], v5 offset:55296
    v_mfma_f32_16x16x32_bf16 v[72:75], v[248:251], v[228:231], v[72:75]
    ds_read_b64_tr_b16 v[246:247], v5 offset:55552
    v_mfma_f32_16x16x32_bf16 v[76:79], v[248:251], v[232:235], v[76:79]
    ds_read_b128 v[204:207], v8 offset:32768
    s_waitcnt lgkmcnt(5)
    v_mfma_f32_16x16x32_bf16 v[112:115], v[236:239], v[220:223], v[112:115]
    ds_read_b64_tr_b16 v[248:249], v6 offset:55296
    v_mfma_f32_16x16x32_bf16 v[116:119], v[236:239], v[224:227], v[116:119]
    ds_read_b64_tr_b16 v[250:251], v6 offset:55552
    v_mfma_f32_16x16x32_bf16 v[120:123], v[236:239], v[228:231], v[120:123]
    ds_read_b128 v[208:211], v8 offset:34816
    v_mfma_f32_16x16x32_bf16 v[124:127], v[236:239], v[232:235], v[124:127]
    ds_read_b128 v[212:215], v8 offset:36864
    s_waitcnt lgkmcnt(7)
    v_mfma_f32_16x16x32_bf16 v[128:131], v[240:243], v[220:223], v[128:131]
    ds_read_b128 v[236:239], v13 offset:256
    v_mfma_f32_16x16x32_bf16 v[132:135], v[240:243], v[224:227], v[132:135]
    ds_read_b128 v[216:219], v8 offset:38912
    v_mfma_f32_16x16x32_bf16 v[136:139], v[240:243], v[228:231], v[136:139]
    v_mfma_f32_16x16x32_bf16 v[140:143], v[240:243], v[232:235], v[140:143]
    s_waitcnt lgkmcnt(7)
    v_mfma_f32_16x16x32_bf16 v[192:195], v[244:247], v[252:255], v[192:195]
    ds_read_b64_tr_b16 v[240:241], v1 offset:0
    v_mfma_f32_16x16x32_bf16 v[144:147], v[244:247], v[220:223], v[144:147]
    ds_read_b64_tr_b16 v[242:243], v1 offset:512
    v_mfma_f32_16x16x32_bf16 v[148:151], v[244:247], v[224:227], v[148:151]
    v_mfma_f32_16x16x32_bf16 v[152:155], v[244:247], v[228:231], v[152:155]
    v_mfma_f32_16x16x32_bf16 v[156:159], v[244:247], v[232:235], v[156:159]
    s_waitcnt lgkmcnt(6)
    v_mfma_f32_16x16x32_bf16 v[196:199], v[248:251], v[252:255], v[196:199]
    ds_read_b64_tr_b16 v[244:245], v2 offset:0
    v_mfma_f32_16x16x32_bf16 v[160:163], v[248:251], v[220:223], v[160:163]
    ds_read_b64_tr_b16 v[246:247], v2 offset:512
    v_mfma_f32_16x16x32_bf16 v[164:167], v[248:251], v[224:227], v[164:167]
    v_mfma_f32_16x16x32_bf16 v[168:171], v[248:251], v[228:231], v[168:171]
    v_mfma_f32_16x16x32_bf16 v[172:175], v[248:251], v[232:235], v[172:175]
    s_waitcnt lgkmcnt(4)
    v_mfma_f32_16x16x32_bf16 v[200:203], v[236:239], v[204:207], v[200:203]
    ds_read_b64_tr_b16 v[248:249], v1 offset:1024
    ds_read_b64_tr_b16 v[250:251], v1 offset:1536
    s_waitcnt lgkmcnt(4)
    v_mfma_f32_16x16x32_bf16 v[176:179], v[240:243], v[252:255], v[176:179]
    ds_read_b64_tr_b16 v[236:237], v2 offset:1024
    v_mfma_f32_16x16x32_bf16 v[16:19], v[240:243], v[204:207], v[16:19]
    ds_read_b64_tr_b16 v[238:239], v2 offset:1536
    v_mfma_f32_16x16x32_bf16 v[20:23], v[240:243], v[208:211], v[20:23]
    v_mfma_f32_16x16x32_bf16 v[24:27], v[240:243], v[212:215], v[24:27]
    v_mfma_f32_16x16x32_bf16 v[28:31], v[240:243], v[216:219], v[28:31]
    s_waitcnt lgkmcnt(4)
    v_mfma_f32_16x16x32_bf16 v[180:183], v[244:247], v[252:255], v[180:183]
    ds_read_b64_tr_b16 v[240:241], v3 offset:0
    v_mfma_f32_16x16x32_bf16 v[32:35], v[244:247], v[204:207], v[32:35]
    ds_read_b64_tr_b16 v[242:243], v3 offset:512
    v_mfma_f32_16x16x32_bf16 v[36:39], v[244:247], v[208:211], v[36:39]
    v_mfma_f32_16x16x32_bf16 v[40:43], v[244:247], v[212:215], v[40:43]
    v_mfma_f32_16x16x32_bf16 v[44:47], v[244:247], v[216:219], v[44:47]
    s_waitcnt lgkmcnt(4)
    v_mfma_f32_16x16x32_bf16 v[184:187], v[248:251], v[252:255], v[184:187]
    ds_read_b64_tr_b16 v[244:245], v4 offset:0
    v_mfma_f32_16x16x32_bf16 v[80:83], v[248:251], v[204:207], v[80:83]
    ds_read_b64_tr_b16 v[246:247], v4 offset:512
    v_mfma_f32_16x16x32_bf16 v[84:87], v[248:251], v[208:211], v[84:87]
    v_mfma_f32_16x16x32_bf16 v[88:91], v[248:251], v[212:215], v[88:91]
    v_mfma_f32_16x16x32_bf16 v[92:95], v[248:251], v[216:219], v[92:95]
    s_waitcnt lgkmcnt(4)
    v_mfma_f32_16x16x32_bf16 v[188:191], v[236:239], v[252:255], v[188:191]
    ds_read_b64_tr_b16 v[248:249], v3 offset:1024
    v_mfma_f32_16x16x32_bf16 v[96:99], v[236:239], v[204:207], v[96:99]
    ds_read_b64_tr_b16 v[250:251], v3 offset:1536
    v_mfma_f32_16x16x32_bf16 v[100:103], v[236:239], v[208:211], v[100:103]
    v_mfma_f32_16x16x32_bf16 v[104:107], v[236:239], v[212:215], v[104:107]
    v_mfma_f32_16x16x32_bf16 v[108:111], v[236:239], v[216:219], v[108:111]
    s_waitcnt lgkmcnt(4)
    v_mfma_f32_16x16x32_bf16 v[48:51], v[240:243], v[204:207], v[48:51]
    ds_read_b64_tr_b16 v[236:237], v4 offset:1024
    v_mfma_f32_16x16x32_bf16 v[52:55], v[240:243], v[208:211], v[52:55]
    ds_read_b64_tr_b16 v[238:239], v4 offset:1536
    v_mfma_f32_16x16x32_bf16 v[56:59], v[240:243], v[212:215], v[56:59]
    v_mfma_f32_16x16x32_bf16 v[60:63], v[240:243], v[216:219], v[60:63]
    s_waitcnt lgkmcnt(4)
    v_mfma_f32_16x16x32_bf16 v[64:67], v[244:247], v[204:207], v[64:67]
    s_barrier
    v_mfma_f32_16x16x32_bf16 v[68:71], v[244:247], v[208:211], v[68:71]
    ds_read_b64_tr_b16 v[240:241], v5 offset:0
    v_mfma_f32_16x16x32_bf16 v[72:75], v[244:247], v[212:215], v[72:75]
    ds_read_b64_tr_b16 v[242:243], v5 offset:256
    v_mfma_f32_16x16x32_bf16 v[76:79], v[244:247], v[216:219], v[76:79]
    ds_read_b128 v[220:223], v14 offset:32768
    s_waitcnt lgkmcnt(5)
    v_mfma_f32_16x16x32_bf16 v[112:115], v[248:251], v[204:207], v[112:115]
    ds_read_b64_tr_b16 v[244:245], v6 offset:0
    v_mfma_f32_16x16x32_bf16 v[116:119], v[248:251], v[208:211], v[116:119]
    ds_read_b64_tr_b16 v[246:247], v6 offset:256
    v_mfma_f32_16x16x32_bf16 v[120:123], v[248:251], v[212:215], v[120:123]
    ds_read_b128 v[224:227], v14 offset:34816
    v_mfma_f32_16x16x32_bf16 v[124:127], v[248:251], v[216:219], v[124:127]
    ds_read_b128 v[228:231], v14 offset:36864
    s_waitcnt lgkmcnt(7)
    v_mfma_f32_16x16x32_bf16 v[128:131], v[236:239], v[204:207], v[128:131]
    ds_read_b128 v[248:251], v13 offset:320
    v_mfma_f32_16x16x32_bf16 v[132:135], v[236:239], v[208:211], v[132:135]
    ds_read_b128 v[232:235], v14 offset:38912
    v_mfma_f32_16x16x32_bf16 v[136:139], v[236:239], v[212:215], v[136:139]
    v_mfma_f32_16x16x32_bf16 v[140:143], v[236:239], v[216:219], v[140:143]
    s_waitcnt lgkmcnt(7)
    v_mfma_f32_16x16x32_bf16 v[192:195], v[240:243], v[252:255], v[192:195]
    ds_read_b64_tr_b16 v[236:237], v1 offset:18432
    v_mfma_f32_16x16x32_bf16 v[144:147], v[240:243], v[204:207], v[144:147]
    ds_read_b64_tr_b16 v[238:239], v1 offset:18944
    v_mfma_f32_16x16x32_bf16 v[148:151], v[240:243], v[208:211], v[148:151]
    v_mfma_f32_16x16x32_bf16 v[152:155], v[240:243], v[212:215], v[152:155]
    v_mfma_f32_16x16x32_bf16 v[156:159], v[240:243], v[216:219], v[156:159]
    s_waitcnt lgkmcnt(6)
    v_mfma_f32_16x16x32_bf16 v[196:199], v[244:247], v[252:255], v[196:199]
    ds_read_b64_tr_b16 v[240:241], v2 offset:18432
    v_mfma_f32_16x16x32_bf16 v[160:163], v[244:247], v[204:207], v[160:163]
    ds_read_b64_tr_b16 v[242:243], v2 offset:18944
    v_mfma_f32_16x16x32_bf16 v[164:167], v[244:247], v[208:211], v[164:167]
    v_mfma_f32_16x16x32_bf16 v[168:171], v[244:247], v[212:215], v[168:171]
    v_mfma_f32_16x16x32_bf16 v[172:175], v[244:247], v[216:219], v[172:175]
    s_waitcnt lgkmcnt(4)
    v_mfma_f32_16x16x32_bf16 v[200:203], v[248:251], v[220:223], v[200:203]
    ds_read_b64_tr_b16 v[244:245], v1 offset:19456
    ds_read_b64_tr_b16 v[246:247], v1 offset:19968
    s_waitcnt lgkmcnt(4)
    v_mfma_f32_16x16x32_bf16 v[176:179], v[236:239], v[252:255], v[176:179]
    ds_read_b64_tr_b16 v[248:249], v2 offset:19456
    v_mfma_f32_16x16x32_bf16 v[16:19], v[236:239], v[220:223], v[16:19]
    ds_read_b64_tr_b16 v[250:251], v2 offset:19968
    v_mfma_f32_16x16x32_bf16 v[20:23], v[236:239], v[224:227], v[20:23]
    v_mfma_f32_16x16x32_bf16 v[24:27], v[236:239], v[228:231], v[24:27]
    v_mfma_f32_16x16x32_bf16 v[28:31], v[236:239], v[232:235], v[28:31]
    s_waitcnt lgkmcnt(4)
    v_mfma_f32_16x16x32_bf16 v[180:183], v[240:243], v[252:255], v[180:183]
    ds_read_b64_tr_b16 v[236:237], v3 offset:18432
    v_mfma_f32_16x16x32_bf16 v[32:35], v[240:243], v[220:223], v[32:35]
    ds_read_b64_tr_b16 v[238:239], v3 offset:18944
    v_mfma_f32_16x16x32_bf16 v[36:39], v[240:243], v[224:227], v[36:39]
    v_mfma_f32_16x16x32_bf16 v[40:43], v[240:243], v[228:231], v[40:43]
    v_mfma_f32_16x16x32_bf16 v[44:47], v[240:243], v[232:235], v[44:47]
    s_waitcnt lgkmcnt(4)
    v_mfma_f32_16x16x32_bf16 v[184:187], v[244:247], v[252:255], v[184:187]
    ds_read_b64_tr_b16 v[240:241], v4 offset:18432
    v_mfma_f32_16x16x32_bf16 v[80:83], v[244:247], v[220:223], v[80:83]
    ds_read_b64_tr_b16 v[242:243], v4 offset:18944
    v_mfma_f32_16x16x32_bf16 v[84:87], v[244:247], v[224:227], v[84:87]
    v_mfma_f32_16x16x32_bf16 v[88:91], v[244:247], v[228:231], v[88:91]
    v_mfma_f32_16x16x32_bf16 v[92:95], v[244:247], v[232:235], v[92:95]
    s_waitcnt lgkmcnt(4)
    v_mfma_f32_16x16x32_bf16 v[188:191], v[248:251], v[252:255], v[188:191]
    ds_read_b64_tr_b16 v[244:245], v3 offset:19456
    v_mfma_f32_16x16x32_bf16 v[96:99], v[248:251], v[220:223], v[96:99]
    ds_read_b64_tr_b16 v[246:247], v3 offset:19968
    v_mfma_f32_16x16x32_bf16 v[100:103], v[248:251], v[224:227], v[100:103]
    v_mfma_f32_16x16x32_bf16 v[104:107], v[248:251], v[228:231], v[104:107]
    v_mfma_f32_16x16x32_bf16 v[108:111], v[248:251], v[232:235], v[108:111]
    s_waitcnt lgkmcnt(4)
    v_mfma_f32_16x16x32_bf16 v[48:51], v[236:239], v[220:223], v[48:51]
    ds_read_b64_tr_b16 v[248:249], v4 offset:19456
    v_mfma_f32_16x16x32_bf16 v[52:55], v[236:239], v[224:227], v[52:55]
    ds_read_b64_tr_b16 v[250:251], v4 offset:19968
    v_mfma_f32_16x16x32_bf16 v[56:59], v[236:239], v[228:231], v[56:59]
    v_mfma_f32_16x16x32_bf16 v[60:63], v[236:239], v[232:235], v[60:63]
    s_waitcnt lgkmcnt(4)
    v_mfma_f32_16x16x32_bf16 v[64:67], v[240:243], v[220:223], v[64:67]
    s_barrier
    v_mfma_f32_16x16x32_bf16 v[68:71], v[240:243], v[224:227], v[68:71]
    ds_read_b64_tr_b16 v[236:237], v5 offset:18432
    v_mfma_f32_16x16x32_bf16 v[72:75], v[240:243], v[228:231], v[72:75]
    ds_read_b64_tr_b16 v[238:239], v5 offset:18688
    v_mfma_f32_16x16x32_bf16 v[76:79], v[240:243], v[232:235], v[76:79]
    ds_read_b128 v[204:207], v8 offset:0
    s_waitcnt lgkmcnt(5)
    v_mfma_f32_16x16x32_bf16 v[112:115], v[244:247], v[220:223], v[112:115]
    ds_read_b64_tr_b16 v[240:241], v6 offset:18432
    v_mfma_f32_16x16x32_bf16 v[116:119], v[244:247], v[224:227], v[116:119]
    ds_read_b64_tr_b16 v[242:243], v6 offset:18688
    v_mfma_f32_16x16x32_bf16 v[120:123], v[244:247], v[228:231], v[120:123]
    ds_read_b128 v[208:211], v8 offset:2048
    v_mfma_f32_16x16x32_bf16 v[124:127], v[244:247], v[232:235], v[124:127]
    ds_read_b128 v[212:215], v8 offset:4096
    s_waitcnt lgkmcnt(7)
    v_mfma_f32_16x16x32_bf16 v[128:131], v[248:251], v[220:223], v[128:131]
    ds_read_b128 v[244:247], v13 offset:384
    v_mfma_f32_16x16x32_bf16 v[132:135], v[248:251], v[224:227], v[132:135]
    ds_read_b128 v[216:219], v8 offset:6144
    v_mfma_f32_16x16x32_bf16 v[136:139], v[248:251], v[228:231], v[136:139]
    v_mfma_f32_16x16x32_bf16 v[140:143], v[248:251], v[232:235], v[140:143]
    s_waitcnt lgkmcnt(7)
    v_mfma_f32_16x16x32_bf16 v[192:195], v[236:239], v[252:255], v[192:195]
    ds_read_b64_tr_b16 v[248:249], v1 offset:36864
    v_mfma_f32_16x16x32_bf16 v[144:147], v[236:239], v[220:223], v[144:147]
    ds_read_b64_tr_b16 v[250:251], v1 offset:37376
    v_mfma_f32_16x16x32_bf16 v[148:151], v[236:239], v[224:227], v[148:151]
    v_mfma_f32_16x16x32_bf16 v[152:155], v[236:239], v[228:231], v[152:155]
    v_mfma_f32_16x16x32_bf16 v[156:159], v[236:239], v[232:235], v[156:159]
    s_waitcnt lgkmcnt(6)
    v_mfma_f32_16x16x32_bf16 v[196:199], v[240:243], v[252:255], v[196:199]
    ds_read_b64_tr_b16 v[236:237], v2 offset:36864
    v_mfma_f32_16x16x32_bf16 v[160:163], v[240:243], v[220:223], v[160:163]
    ds_read_b64_tr_b16 v[238:239], v2 offset:37376
    v_mfma_f32_16x16x32_bf16 v[164:167], v[240:243], v[224:227], v[164:167]
    v_mfma_f32_16x16x32_bf16 v[168:171], v[240:243], v[228:231], v[168:171]
    v_mfma_f32_16x16x32_bf16 v[172:175], v[240:243], v[232:235], v[172:175]
    s_waitcnt lgkmcnt(4)
    v_mfma_f32_16x16x32_bf16 v[200:203], v[244:247], v[204:207], v[200:203]
    ds_read_b64_tr_b16 v[240:241], v1 offset:37888
    ds_read_b64_tr_b16 v[242:243], v1 offset:38400
    s_waitcnt lgkmcnt(4)
    v_mfma_f32_16x16x32_bf16 v[176:179], v[248:251], v[252:255], v[176:179]
    ds_read_b64_tr_b16 v[244:245], v2 offset:37888
    v_mfma_f32_16x16x32_bf16 v[16:19], v[248:251], v[204:207], v[16:19]
    ds_read_b64_tr_b16 v[246:247], v2 offset:38400
    v_mfma_f32_16x16x32_bf16 v[20:23], v[248:251], v[208:211], v[20:23]
    v_mfma_f32_16x16x32_bf16 v[24:27], v[248:251], v[212:215], v[24:27]
    v_mfma_f32_16x16x32_bf16 v[28:31], v[248:251], v[216:219], v[28:31]
    s_waitcnt lgkmcnt(4)
    v_mfma_f32_16x16x32_bf16 v[180:183], v[236:239], v[252:255], v[180:183]
    ds_read_b64_tr_b16 v[248:249], v3 offset:36864
    v_mfma_f32_16x16x32_bf16 v[32:35], v[236:239], v[204:207], v[32:35]
    ds_read_b64_tr_b16 v[250:251], v3 offset:37376
    v_mfma_f32_16x16x32_bf16 v[36:39], v[236:239], v[208:211], v[36:39]
    v_mfma_f32_16x16x32_bf16 v[40:43], v[236:239], v[212:215], v[40:43]
    v_mfma_f32_16x16x32_bf16 v[44:47], v[236:239], v[216:219], v[44:47]
    s_waitcnt lgkmcnt(4)
    v_mfma_f32_16x16x32_bf16 v[184:187], v[240:243], v[252:255], v[184:187]
    ds_read_b64_tr_b16 v[236:237], v4 offset:36864
    v_mfma_f32_16x16x32_bf16 v[80:83], v[240:243], v[204:207], v[80:83]
    ds_read_b64_tr_b16 v[238:239], v4 offset:37376
    v_mfma_f32_16x16x32_bf16 v[84:87], v[240:243], v[208:211], v[84:87]
    v_mfma_f32_16x16x32_bf16 v[88:91], v[240:243], v[212:215], v[88:91]
    v_mfma_f32_16x16x32_bf16 v[92:95], v[240:243], v[216:219], v[92:95]
    s_waitcnt lgkmcnt(4)
    v_mfma_f32_16x16x32_bf16 v[188:191], v[244:247], v[252:255], v[188:191]
    ds_read_b64_tr_b16 v[240:241], v3 offset:37888
    v_mfma_f32_16x16x32_bf16 v[96:99], v[244:247], v[204:207], v[96:99]
    ds_read_b64_tr_b16 v[242:243], v3 offset:38400
    v_mfma_f32_16x16x32_bf16 v[100:103], v[244:247], v[208:211], v[100:103]
    v_mfma_f32_16x16x32_bf16 v[104:107], v[244:247], v[212:215], v[104:107]
    v_mfma_f32_16x16x32_bf16 v[108:111], v[244:247], v[216:219], v[108:111]
    s_waitcnt lgkmcnt(4)
    v_mfma_f32_16x16x32_bf16 v[48:51], v[248:251], v[204:207], v[48:51]
    ds_read_b64_tr_b16 v[244:245], v4 offset:37888
    v_mfma_f32_16x16x32_bf16 v[52:55], v[248:251], v[208:211], v[52:55]
    ds_read_b64_tr_b16 v[246:247], v4 offset:38400
    v_mfma_f32_16x16x32_bf16 v[56:59], v[248:251], v[212:215], v[56:59]
    v_mfma_f32_16x16x32_bf16 v[60:63], v[248:251], v[216:219], v[60:63]
    s_waitcnt lgkmcnt(4)
    v_mfma_f32_16x16x32_bf16 v[64:67], v[236:239], v[204:207], v[64:67]
    s_barrier
    v_mfma_f32_16x16x32_bf16 v[68:71], v[236:239], v[208:211], v[68:71]
    ds_read_b64_tr_b16 v[248:249], v5 offset:36864
    v_mfma_f32_16x16x32_bf16 v[72:75], v[236:239], v[212:215], v[72:75]
    ds_read_b64_tr_b16 v[250:251], v5 offset:37120
    v_mfma_f32_16x16x32_bf16 v[76:79], v[236:239], v[216:219], v[76:79]
    ds_read_b128 v[220:223], v14 offset:0
    s_waitcnt lgkmcnt(5)
    v_mfma_f32_16x16x32_bf16 v[112:115], v[240:243], v[204:207], v[112:115]
    ds_read_b64_tr_b16 v[236:237], v6 offset:36864
    v_mfma_f32_16x16x32_bf16 v[116:119], v[240:243], v[208:211], v[116:119]
    ds_read_b64_tr_b16 v[238:239], v6 offset:37120
    v_mfma_f32_16x16x32_bf16 v[120:123], v[240:243], v[212:215], v[120:123]
    ds_read_b128 v[224:227], v14 offset:2048
    v_mfma_f32_16x16x32_bf16 v[124:127], v[240:243], v[216:219], v[124:127]
    ds_read_b128 v[228:231], v14 offset:4096
    s_waitcnt lgkmcnt(7)
    v_mfma_f32_16x16x32_bf16 v[128:131], v[244:247], v[204:207], v[128:131]
    ds_read_b128 v[240:243], v13 offset:448
    v_mfma_f32_16x16x32_bf16 v[132:135], v[244:247], v[208:211], v[132:135]
    ds_read_b128 v[232:235], v14 offset:6144
    v_mfma_f32_16x16x32_bf16 v[136:139], v[244:247], v[212:215], v[136:139]
    v_mfma_f32_16x16x32_bf16 v[140:143], v[244:247], v[216:219], v[140:143]
    s_waitcnt lgkmcnt(7)
    v_mfma_f32_16x16x32_bf16 v[192:195], v[248:251], v[252:255], v[192:195]
    ds_read_b64_tr_b16 v[244:245], v1 offset:55296
    v_mfma_f32_16x16x32_bf16 v[144:147], v[248:251], v[204:207], v[144:147]
    ds_read_b64_tr_b16 v[246:247], v1 offset:55808
    v_mfma_f32_16x16x32_bf16 v[148:151], v[248:251], v[208:211], v[148:151]
    v_mfma_f32_16x16x32_bf16 v[152:155], v[248:251], v[212:215], v[152:155]
    v_mfma_f32_16x16x32_bf16 v[156:159], v[248:251], v[216:219], v[156:159]
    s_waitcnt lgkmcnt(6)
    v_mfma_f32_16x16x32_bf16 v[196:199], v[236:239], v[252:255], v[196:199]
    ds_read_b64_tr_b16 v[248:249], v2 offset:55296
    v_mfma_f32_16x16x32_bf16 v[160:163], v[236:239], v[204:207], v[160:163]
    ds_read_b64_tr_b16 v[250:251], v2 offset:55808
    v_mfma_f32_16x16x32_bf16 v[164:167], v[236:239], v[208:211], v[164:167]
    v_mfma_f32_16x16x32_bf16 v[168:171], v[236:239], v[212:215], v[168:171]
    v_mfma_f32_16x16x32_bf16 v[172:175], v[236:239], v[216:219], v[172:175]
    s_waitcnt lgkmcnt(4)
    v_mfma_f32_16x16x32_bf16 v[200:203], v[240:243], v[220:223], v[200:203]
    ds_read_b64_tr_b16 v[236:237], v1 offset:56320
    ds_read_b64_tr_b16 v[238:239], v1 offset:56832
    s_waitcnt lgkmcnt(4)
    v_mfma_f32_16x16x32_bf16 v[176:179], v[244:247], v[252:255], v[176:179]
    ds_read_b64_tr_b16 v[240:241], v2 offset:56320
    v_mfma_f32_16x16x32_bf16 v[16:19], v[244:247], v[220:223], v[16:19]
    ds_read_b64_tr_b16 v[242:243], v2 offset:56832
    v_mfma_f32_16x16x32_bf16 v[20:23], v[244:247], v[224:227], v[20:23]
    v_mfma_f32_16x16x32_bf16 v[24:27], v[244:247], v[228:231], v[24:27]
    v_mfma_f32_16x16x32_bf16 v[28:31], v[244:247], v[232:235], v[28:31]
    s_waitcnt lgkmcnt(4)
    v_mfma_f32_16x16x32_bf16 v[180:183], v[248:251], v[252:255], v[180:183]
    ds_read_b64_tr_b16 v[244:245], v3 offset:55296
    v_mfma_f32_16x16x32_bf16 v[32:35], v[248:251], v[220:223], v[32:35]
    ds_read_b64_tr_b16 v[246:247], v3 offset:55808
    v_mfma_f32_16x16x32_bf16 v[36:39], v[248:251], v[224:227], v[36:39]
    v_mfma_f32_16x16x32_bf16 v[40:43], v[248:251], v[228:231], v[40:43]
    v_mfma_f32_16x16x32_bf16 v[44:47], v[248:251], v[232:235], v[44:47]
    s_waitcnt lgkmcnt(4)
    v_mfma_f32_16x16x32_bf16 v[184:187], v[236:239], v[252:255], v[184:187]
    ds_read_b64_tr_b16 v[248:249], v4 offset:55296
    v_mfma_f32_16x16x32_bf16 v[80:83], v[236:239], v[220:223], v[80:83]
    ds_read_b64_tr_b16 v[250:251], v4 offset:55808
    v_mfma_f32_16x16x32_bf16 v[84:87], v[236:239], v[224:227], v[84:87]
    v_mfma_f32_16x16x32_bf16 v[88:91], v[236:239], v[228:231], v[88:91]
    v_mfma_f32_16x16x32_bf16 v[92:95], v[236:239], v[232:235], v[92:95]
    s_waitcnt lgkmcnt(4)
    v_mfma_f32_16x16x32_bf16 v[188:191], v[240:243], v[252:255], v[188:191]
    ds_read_b64_tr_b16 v[236:237], v3 offset:56320
    v_mfma_f32_16x16x32_bf16 v[96:99], v[240:243], v[220:223], v[96:99]
    ds_read_b64_tr_b16 v[238:239], v3 offset:56832
    v_mfma_f32_16x16x32_bf16 v[100:103], v[240:243], v[224:227], v[100:103]
    v_mfma_f32_16x16x32_bf16 v[104:107], v[240:243], v[228:231], v[104:107]
    v_mfma_f32_16x16x32_bf16 v[108:111], v[240:243], v[232:235], v[108:111]
    s_waitcnt lgkmcnt(4)
    v_mfma_f32_16x16x32_bf16 v[48:51], v[244:247], v[220:223], v[48:51]
    ds_read_b64_tr_b16 v[240:241], v4 offset:56320
    v_mfma_f32_16x16x32_bf16 v[52:55], v[244:247], v[224:227], v[52:55]
    ds_read_b64_tr_b16 v[242:243], v4 offset:56832
    v_mfma_f32_16x16x32_bf16 v[56:59], v[244:247], v[228:231], v[56:59]
    v_mfma_f32_16x16x32_bf16 v[60:63], v[244:247], v[232:235], v[60:63]
    s_waitcnt lgkmcnt(4)
    v_mfma_f32_16x16x32_bf16 v[64:67], v[248:251], v[220:223], v[64:67]
    s_barrier
    v_mfma_f32_16x16x32_bf16 v[68:71], v[248:251], v[224:227], v[68:71]
    ds_read_b64_tr_b16 v[244:245], v5 offset:55296
    v_mfma_f32_16x16x32_bf16 v[72:75], v[248:251], v[228:231], v[72:75]
    ds_read_b64_tr_b16 v[246:247], v5 offset:55552
    v_mfma_f32_16x16x32_bf16 v[76:79], v[248:251], v[232:235], v[76:79]
    ds_read_b128 v[204:207], v8 offset:16384
    s_waitcnt lgkmcnt(5)
    v_mfma_f32_16x16x32_bf16 v[112:115], v[236:239], v[220:223], v[112:115]
    ds_read_b64_tr_b16 v[248:249], v6 offset:55296
    v_mfma_f32_16x16x32_bf16 v[116:119], v[236:239], v[224:227], v[116:119]
    ds_read_b64_tr_b16 v[250:251], v6 offset:55552
    v_mfma_f32_16x16x32_bf16 v[120:123], v[236:239], v[228:231], v[120:123]
    ds_read_b128 v[208:211], v8 offset:18432
    v_mfma_f32_16x16x32_bf16 v[124:127], v[236:239], v[232:235], v[124:127]
    ds_read_b128 v[212:215], v8 offset:20480
    s_waitcnt lgkmcnt(7)
    v_mfma_f32_16x16x32_bf16 v[128:131], v[240:243], v[220:223], v[128:131]
    ds_read_b128 v[236:239], v13 offset:512
    v_mfma_f32_16x16x32_bf16 v[132:135], v[240:243], v[224:227], v[132:135]
    ds_read_b128 v[216:219], v8 offset:22528
    v_mfma_f32_16x16x32_bf16 v[136:139], v[240:243], v[228:231], v[136:139]
    v_mfma_f32_16x16x32_bf16 v[140:143], v[240:243], v[232:235], v[140:143]
    s_waitcnt lgkmcnt(7)
    v_mfma_f32_16x16x32_bf16 v[192:195], v[244:247], v[252:255], v[192:195]
    ds_read_b64_tr_b16 v[240:241], v1 offset:0
    v_mfma_f32_16x16x32_bf16 v[144:147], v[244:247], v[220:223], v[144:147]
    ds_read_b64_tr_b16 v[242:243], v1 offset:512
    v_mfma_f32_16x16x32_bf16 v[148:151], v[244:247], v[224:227], v[148:151]
    v_mfma_f32_16x16x32_bf16 v[152:155], v[244:247], v[228:231], v[152:155]
    v_mfma_f32_16x16x32_bf16 v[156:159], v[244:247], v[232:235], v[156:159]
    s_waitcnt lgkmcnt(6)
    v_mfma_f32_16x16x32_bf16 v[196:199], v[248:251], v[252:255], v[196:199]
    ds_read_b64_tr_b16 v[244:245], v2 offset:0
    v_mfma_f32_16x16x32_bf16 v[160:163], v[248:251], v[220:223], v[160:163]
    ds_read_b64_tr_b16 v[246:247], v2 offset:512
    v_mfma_f32_16x16x32_bf16 v[164:167], v[248:251], v[224:227], v[164:167]
    v_mfma_f32_16x16x32_bf16 v[168:171], v[248:251], v[228:231], v[168:171]
    v_mfma_f32_16x16x32_bf16 v[172:175], v[248:251], v[232:235], v[172:175]
    s_waitcnt lgkmcnt(4)
    v_mfma_f32_16x16x32_bf16 v[200:203], v[236:239], v[204:207], v[200:203]
    ds_read_b64_tr_b16 v[248:249], v1 offset:1024
    ds_read_b64_tr_b16 v[250:251], v1 offset:1536
    s_waitcnt lgkmcnt(4)
    v_mfma_f32_16x16x32_bf16 v[176:179], v[240:243], v[252:255], v[176:179]
    ds_read_b64_tr_b16 v[236:237], v2 offset:1024
    v_mfma_f32_16x16x32_bf16 v[16:19], v[240:243], v[204:207], v[16:19]
    ds_read_b64_tr_b16 v[238:239], v2 offset:1536
    v_mfma_f32_16x16x32_bf16 v[20:23], v[240:243], v[208:211], v[20:23]
    v_mfma_f32_16x16x32_bf16 v[24:27], v[240:243], v[212:215], v[24:27]
    v_mfma_f32_16x16x32_bf16 v[28:31], v[240:243], v[216:219], v[28:31]
    s_waitcnt lgkmcnt(4)
    v_mfma_f32_16x16x32_bf16 v[180:183], v[244:247], v[252:255], v[180:183]
    ds_read_b64_tr_b16 v[240:241], v3 offset:0
    v_mfma_f32_16x16x32_bf16 v[32:35], v[244:247], v[204:207], v[32:35]
    ds_read_b64_tr_b16 v[242:243], v3 offset:512
    v_mfma_f32_16x16x32_bf16 v[36:39], v[244:247], v[208:211], v[36:39]
    v_mfma_f32_16x16x32_bf16 v[40:43], v[244:247], v[212:215], v[40:43]
    v_mfma_f32_16x16x32_bf16 v[44:47], v[244:247], v[216:219], v[44:47]
    s_waitcnt lgkmcnt(4)
    v_mfma_f32_16x16x32_bf16 v[184:187], v[248:251], v[252:255], v[184:187]
    ds_read_b64_tr_b16 v[244:245], v4 offset:0
    v_mfma_f32_16x16x32_bf16 v[80:83], v[248:251], v[204:207], v[80:83]
    ds_read_b64_tr_b16 v[246:247], v4 offset:512
    v_mfma_f32_16x16x32_bf16 v[84:87], v[248:251], v[208:211], v[84:87]
    v_mfma_f32_16x16x32_bf16 v[88:91], v[248:251], v[212:215], v[88:91]
    v_mfma_f32_16x16x32_bf16 v[92:95], v[248:251], v[216:219], v[92:95]
    s_waitcnt lgkmcnt(4)
    v_mfma_f32_16x16x32_bf16 v[188:191], v[236:239], v[252:255], v[188:191]
    ds_read_b64_tr_b16 v[248:249], v3 offset:1024
    v_mfma_f32_16x16x32_bf16 v[96:99], v[236:239], v[204:207], v[96:99]
    ds_read_b64_tr_b16 v[250:251], v3 offset:1536
    v_mfma_f32_16x16x32_bf16 v[100:103], v[236:239], v[208:211], v[100:103]
    v_mfma_f32_16x16x32_bf16 v[104:107], v[236:239], v[212:215], v[104:107]
    v_mfma_f32_16x16x32_bf16 v[108:111], v[236:239], v[216:219], v[108:111]
    s_waitcnt lgkmcnt(4)
    v_mfma_f32_16x16x32_bf16 v[48:51], v[240:243], v[204:207], v[48:51]
    ds_read_b64_tr_b16 v[236:237], v4 offset:1024
    v_mfma_f32_16x16x32_bf16 v[52:55], v[240:243], v[208:211], v[52:55]
    ds_read_b64_tr_b16 v[238:239], v4 offset:1536
    v_mfma_f32_16x16x32_bf16 v[56:59], v[240:243], v[212:215], v[56:59]
    v_mfma_f32_16x16x32_bf16 v[60:63], v[240:243], v[216:219], v[60:63]
    s_waitcnt lgkmcnt(4)
    v_mfma_f32_16x16x32_bf16 v[64:67], v[244:247], v[204:207], v[64:67]
    s_barrier
    v_mfma_f32_16x16x32_bf16 v[68:71], v[244:247], v[208:211], v[68:71]
    ds_read_b64_tr_b16 v[240:241], v5 offset:0
    v_mfma_f32_16x16x32_bf16 v[72:75], v[244:247], v[212:215], v[72:75]
    ds_read_b64_tr_b16 v[242:243], v5 offset:256
    v_mfma_f32_16x16x32_bf16 v[76:79], v[244:247], v[216:219], v[76:79]
    ds_read_b128 v[220:223], v14 offset:16384
    s_waitcnt lgkmcnt(5)
    v_mfma_f32_16x16x32_bf16 v[112:115], v[248:251], v[204:207], v[112:115]
    ds_read_b64_tr_b16 v[244:245], v6 offset:0
    v_mfma_f32_16x16x32_bf16 v[116:119], v[248:251], v[208:211], v[116:119]
    ds_read_b64_tr_b16 v[246:247], v6 offset:256
    v_mfma_f32_16x16x32_bf16 v[120:123], v[248:251], v[212:215], v[120:123]
    ds_read_b128 v[224:227], v14 offset:18432
    v_mfma_f32_16x16x32_bf16 v[124:127], v[248:251], v[216:219], v[124:127]
    ds_read_b128 v[228:231], v14 offset:20480
    s_waitcnt lgkmcnt(7)
    v_mfma_f32_16x16x32_bf16 v[128:131], v[236:239], v[204:207], v[128:131]
    ds_read_b128 v[248:251], v13 offset:576
    v_mfma_f32_16x16x32_bf16 v[132:135], v[236:239], v[208:211], v[132:135]
    ds_read_b128 v[232:235], v14 offset:22528
    v_mfma_f32_16x16x32_bf16 v[136:139], v[236:239], v[212:215], v[136:139]
    v_mfma_f32_16x16x32_bf16 v[140:143], v[236:239], v[216:219], v[140:143]
    s_waitcnt lgkmcnt(7)
    v_mfma_f32_16x16x32_bf16 v[192:195], v[240:243], v[252:255], v[192:195]
    ds_read_b64_tr_b16 v[236:237], v1 offset:18432
    v_mfma_f32_16x16x32_bf16 v[144:147], v[240:243], v[204:207], v[144:147]
    ds_read_b64_tr_b16 v[238:239], v1 offset:18944
    v_mfma_f32_16x16x32_bf16 v[148:151], v[240:243], v[208:211], v[148:151]
    v_mfma_f32_16x16x32_bf16 v[152:155], v[240:243], v[212:215], v[152:155]
    v_mfma_f32_16x16x32_bf16 v[156:159], v[240:243], v[216:219], v[156:159]
    s_waitcnt lgkmcnt(6)
    v_mfma_f32_16x16x32_bf16 v[196:199], v[244:247], v[252:255], v[196:199]
    ds_read_b64_tr_b16 v[240:241], v2 offset:18432
    v_mfma_f32_16x16x32_bf16 v[160:163], v[244:247], v[204:207], v[160:163]
    ds_read_b64_tr_b16 v[242:243], v2 offset:18944
    v_mfma_f32_16x16x32_bf16 v[164:167], v[244:247], v[208:211], v[164:167]
    v_mfma_f32_16x16x32_bf16 v[168:171], v[244:247], v[212:215], v[168:171]
    v_mfma_f32_16x16x32_bf16 v[172:175], v[244:247], v[216:219], v[172:175]
    s_waitcnt lgkmcnt(4)
    v_mfma_f32_16x16x32_bf16 v[200:203], v[248:251], v[220:223], v[200:203]
    ds_read_b64_tr_b16 v[244:245], v1 offset:19456
    ds_read_b64_tr_b16 v[246:247], v1 offset:19968
    s_waitcnt lgkmcnt(4)
    v_mfma_f32_16x16x32_bf16 v[176:179], v[236:239], v[252:255], v[176:179]
    ds_read_b64_tr_b16 v[248:249], v2 offset:19456
    v_mfma_f32_16x16x32_bf16 v[16:19], v[236:239], v[220:223], v[16:19]
    ds_read_b64_tr_b16 v[250:251], v2 offset:19968
    v_mfma_f32_16x16x32_bf16 v[20:23], v[236:239], v[224:227], v[20:23]
    v_mfma_f32_16x16x32_bf16 v[24:27], v[236:239], v[228:231], v[24:27]
    v_mfma_f32_16x16x32_bf16 v[28:31], v[236:239], v[232:235], v[28:31]
    s_waitcnt lgkmcnt(4)
    v_mfma_f32_16x16x32_bf16 v[180:183], v[240:243], v[252:255], v[180:183]
    ds_read_b64_tr_b16 v[236:237], v3 offset:18432
    v_mfma_f32_16x16x32_bf16 v[32:35], v[240:243], v[220:223], v[32:35]
    ds_read_b64_tr_b16 v[238:239], v3 offset:18944
    v_mfma_f32_16x16x32_bf16 v[36:39], v[240:243], v[224:227], v[36:39]
    v_mfma_f32_16x16x32_bf16 v[40:43], v[240:243], v[228:231], v[40:43]
    v_mfma_f32_16x16x32_bf16 v[44:47], v[240:243], v[232:235], v[44:47]
    s_waitcnt lgkmcnt(4)
    v_mfma_f32_16x16x32_bf16 v[184:187], v[244:247], v[252:255], v[184:187]
    ds_read_b64_tr_b16 v[240:241], v4 offset:18432
    v_mfma_f32_16x16x32_bf16 v[80:83], v[244:247], v[220:223], v[80:83]
    ds_read_b64_tr_b16 v[242:243], v4 offset:18944
    v_mfma_f32_16x16x32_bf16 v[84:87], v[244:247], v[224:227], v[84:87]
    v_mfma_f32_16x16x32_bf16 v[88:91], v[244:247], v[228:231], v[88:91]
    v_mfma_f32_16x16x32_bf16 v[92:95], v[244:247], v[232:235], v[92:95]
    s_waitcnt lgkmcnt(4)
    v_mfma_f32_16x16x32_bf16 v[188:191], v[248:251], v[252:255], v[188:191]
    ds_read_b64_tr_b16 v[244:245], v3 offset:19456
    v_mfma_f32_16x16x32_bf16 v[96:99], v[248:251], v[220:223], v[96:99]
    ds_read_b64_tr_b16 v[246:247], v3 offset:19968
    v_mfma_f32_16x16x32_bf16 v[100:103], v[248:251], v[224:227], v[100:103]
    v_mfma_f32_16x16x32_bf16 v[104:107], v[248:251], v[228:231], v[104:107]
    v_mfma_f32_16x16x32_bf16 v[108:111], v[248:251], v[232:235], v[108:111]
    s_waitcnt lgkmcnt(4)
    v_mfma_f32_16x16x32_bf16 v[48:51], v[236:239], v[220:223], v[48:51]
    ds_read_b64_tr_b16 v[248:249], v4 offset:19456
    v_mfma_f32_16x16x32_bf16 v[52:55], v[236:239], v[224:227], v[52:55]
    ds_read_b64_tr_b16 v[250:251], v4 offset:19968
    v_mfma_f32_16x16x32_bf16 v[56:59], v[236:239], v[228:231], v[56:59]
    v_mfma_f32_16x16x32_bf16 v[60:63], v[236:239], v[232:235], v[60:63]
    s_waitcnt lgkmcnt(4)
    v_mfma_f32_16x16x32_bf16 v[64:67], v[240:243], v[220:223], v[64:67]
    s_barrier
    v_mfma_f32_16x16x32_bf16 v[68:71], v[240:243], v[224:227], v[68:71]
    ds_read_b64_tr_b16 v[236:237], v5 offset:18432
    v_mfma_f32_16x16x32_bf16 v[72:75], v[240:243], v[228:231], v[72:75]
    ds_read_b64_tr_b16 v[238:239], v5 offset:18688
    v_mfma_f32_16x16x32_bf16 v[76:79], v[240:243], v[232:235], v[76:79]
    ds_read_b128 v[204:207], v8 offset:32768
    s_waitcnt lgkmcnt(5)
    v_mfma_f32_16x16x32_bf16 v[112:115], v[244:247], v[220:223], v[112:115]
    ds_read_b64_tr_b16 v[240:241], v6 offset:18432
    v_mfma_f32_16x16x32_bf16 v[116:119], v[244:247], v[224:227], v[116:119]
    ds_read_b64_tr_b16 v[242:243], v6 offset:18688
    v_mfma_f32_16x16x32_bf16 v[120:123], v[244:247], v[228:231], v[120:123]
    ds_read_b128 v[208:211], v8 offset:34816
    v_mfma_f32_16x16x32_bf16 v[124:127], v[244:247], v[232:235], v[124:127]
    ds_read_b128 v[212:215], v8 offset:36864
    s_waitcnt lgkmcnt(7)
    v_mfma_f32_16x16x32_bf16 v[128:131], v[248:251], v[220:223], v[128:131]
    ds_read_b128 v[244:247], v13 offset:640
    v_mfma_f32_16x16x32_bf16 v[132:135], v[248:251], v[224:227], v[132:135]
    ds_read_b128 v[216:219], v8 offset:38912
    v_mfma_f32_16x16x32_bf16 v[136:139], v[248:251], v[228:231], v[136:139]
    v_mfma_f32_16x16x32_bf16 v[140:143], v[248:251], v[232:235], v[140:143]
    s_waitcnt lgkmcnt(7)
    v_mfma_f32_16x16x32_bf16 v[192:195], v[236:239], v[252:255], v[192:195]
    ds_read_b64_tr_b16 v[248:249], v1 offset:36864
    v_mfma_f32_16x16x32_bf16 v[144:147], v[236:239], v[220:223], v[144:147]
    ds_read_b64_tr_b16 v[250:251], v1 offset:37376
    v_mfma_f32_16x16x32_bf16 v[148:151], v[236:239], v[224:227], v[148:151]
    v_mfma_f32_16x16x32_bf16 v[152:155], v[236:239], v[228:231], v[152:155]
    v_mfma_f32_16x16x32_bf16 v[156:159], v[236:239], v[232:235], v[156:159]
    s_waitcnt lgkmcnt(6)
    v_mfma_f32_16x16x32_bf16 v[196:199], v[240:243], v[252:255], v[196:199]
    ds_read_b64_tr_b16 v[236:237], v2 offset:36864
    v_mfma_f32_16x16x32_bf16 v[160:163], v[240:243], v[220:223], v[160:163]
    ds_read_b64_tr_b16 v[238:239], v2 offset:37376
    v_mfma_f32_16x16x32_bf16 v[164:167], v[240:243], v[224:227], v[164:167]
    v_mfma_f32_16x16x32_bf16 v[168:171], v[240:243], v[228:231], v[168:171]
    v_mfma_f32_16x16x32_bf16 v[172:175], v[240:243], v[232:235], v[172:175]
    s_waitcnt lgkmcnt(4)
    v_mfma_f32_16x16x32_bf16 v[200:203], v[244:247], v[204:207], v[200:203]
    ds_read_b64_tr_b16 v[240:241], v1 offset:37888
    ds_read_b64_tr_b16 v[242:243], v1 offset:38400
    s_waitcnt lgkmcnt(4)
    v_mfma_f32_16x16x32_bf16 v[176:179], v[248:251], v[252:255], v[176:179]
    ds_read_b64_tr_b16 v[244:245], v2 offset:37888
    v_mfma_f32_16x16x32_bf16 v[16:19], v[248:251], v[204:207], v[16:19]
    ds_read_b64_tr_b16 v[246:247], v2 offset:38400
    v_mfma_f32_16x16x32_bf16 v[20:23], v[248:251], v[208:211], v[20:23]
    v_mfma_f32_16x16x32_bf16 v[24:27], v[248:251], v[212:215], v[24:27]
    v_mfma_f32_16x16x32_bf16 v[28:31], v[248:251], v[216:219], v[28:31]
    s_waitcnt lgkmcnt(4)
    v_mfma_f32_16x16x32_bf16 v[180:183], v[236:239], v[252:255], v[180:183]
    ds_read_b64_tr_b16 v[248:249], v3 offset:36864
    v_mfma_f32_16x16x32_bf16 v[32:35], v[236:239], v[204:207], v[32:35]
    ds_read_b64_tr_b16 v[250:251], v3 offset:37376
    v_mfma_f32_16x16x32_bf16 v[36:39], v[236:239], v[208:211], v[36:39]
    v_mfma_f32_16x16x32_bf16 v[40:43], v[236:239], v[212:215], v[40:43]
    v_mfma_f32_16x16x32_bf16 v[44:47], v[236:239], v[216:219], v[44:47]
    s_waitcnt lgkmcnt(4)
    v_mfma_f32_16x16x32_bf16 v[184:187], v[240:243], v[252:255], v[184:187]
    ds_read_b64_tr_b16 v[236:237], v4 offset:36864
    v_mfma_f32_16x16x32_bf16 v[80:83], v[240:243], v[204:207], v[80:83]
    ds_read_b64_tr_b16 v[238:239], v4 offset:37376
    v_mfma_f32_16x16x32_bf16 v[84:87], v[240:243], v[208:211], v[84:87]
    v_mfma_f32_16x16x32_bf16 v[88:91], v[240:243], v[212:215], v[88:91]
    v_mfma_f32_16x16x32_bf16 v[92:95], v[240:243], v[216:219], v[92:95]
    s_waitcnt lgkmcnt(4)
    v_mfma_f32_16x16x32_bf16 v[188:191], v[244:247], v[252:255], v[188:191]
    ds_read_b64_tr_b16 v[240:241], v3 offset:37888
    v_mfma_f32_16x16x32_bf16 v[96:99], v[244:247], v[204:207], v[96:99]
    ds_read_b64_tr_b16 v[242:243], v3 offset:38400
    v_mfma_f32_16x16x32_bf16 v[100:103], v[244:247], v[208:211], v[100:103]
    v_mfma_f32_16x16x32_bf16 v[104:107], v[244:247], v[212:215], v[104:107]
    v_mfma_f32_16x16x32_bf16 v[108:111], v[244:247], v[216:219], v[108:111]
    s_waitcnt lgkmcnt(4)
    v_mfma_f32_16x16x32_bf16 v[48:51], v[248:251], v[204:207], v[48:51]
    ds_read_b64_tr_b16 v[244:245], v4 offset:37888
    v_mfma_f32_16x16x32_bf16 v[52:55], v[248:251], v[208:211], v[52:55]
    ds_read_b64_tr_b16 v[246:247], v4 offset:38400
    v_mfma_f32_16x16x32_bf16 v[56:59], v[248:251], v[212:215], v[56:59]
    v_mfma_f32_16x16x32_bf16 v[60:63], v[248:251], v[216:219], v[60:63]
    s_waitcnt lgkmcnt(4)
    v_mfma_f32_16x16x32_bf16 v[64:67], v[236:239], v[204:207], v[64:67]
    s_barrier
    v_mfma_f32_16x16x32_bf16 v[68:71], v[236:239], v[208:211], v[68:71]
    ds_read_b64_tr_b16 v[248:249], v5 offset:36864
    v_mfma_f32_16x16x32_bf16 v[72:75], v[236:239], v[212:215], v[72:75]
    ds_read_b64_tr_b16 v[250:251], v5 offset:37120
    v_mfma_f32_16x16x32_bf16 v[76:79], v[236:239], v[216:219], v[76:79]
    ds_read_b128 v[220:223], v14 offset:32768
    s_waitcnt lgkmcnt(5)
    v_mfma_f32_16x16x32_bf16 v[112:115], v[240:243], v[204:207], v[112:115]
    ds_read_b64_tr_b16 v[236:237], v6 offset:36864
    v_mfma_f32_16x16x32_bf16 v[116:119], v[240:243], v[208:211], v[116:119]
    ds_read_b64_tr_b16 v[238:239], v6 offset:37120
    v_mfma_f32_16x16x32_bf16 v[120:123], v[240:243], v[212:215], v[120:123]
    ds_read_b128 v[224:227], v14 offset:34816
    v_mfma_f32_16x16x32_bf16 v[124:127], v[240:243], v[216:219], v[124:127]
    ds_read_b128 v[228:231], v14 offset:36864
    s_waitcnt lgkmcnt(7)
    v_mfma_f32_16x16x32_bf16 v[128:131], v[244:247], v[204:207], v[128:131]
    ds_read_b128 v[240:243], v13 offset:704
    v_mfma_f32_16x16x32_bf16 v[132:135], v[244:247], v[208:211], v[132:135]
    ds_read_b128 v[232:235], v14 offset:38912
    v_mfma_f32_16x16x32_bf16 v[136:139], v[244:247], v[212:215], v[136:139]
    v_mfma_f32_16x16x32_bf16 v[140:143], v[244:247], v[216:219], v[140:143]
    s_waitcnt lgkmcnt(7)
    v_mfma_f32_16x16x32_bf16 v[192:195], v[248:251], v[252:255], v[192:195]
    ds_read_b64_tr_b16 v[244:245], v1 offset:55296
    v_mfma_f32_16x16x32_bf16 v[144:147], v[248:251], v[204:207], v[144:147]
    ds_read_b64_tr_b16 v[246:247], v1 offset:55808
    v_mfma_f32_16x16x32_bf16 v[148:151], v[248:251], v[208:211], v[148:151]
    v_mfma_f32_16x16x32_bf16 v[152:155], v[248:251], v[212:215], v[152:155]
    v_mfma_f32_16x16x32_bf16 v[156:159], v[248:251], v[216:219], v[156:159]
    s_waitcnt lgkmcnt(6)
    v_mfma_f32_16x16x32_bf16 v[196:199], v[236:239], v[252:255], v[196:199]
    ds_read_b64_tr_b16 v[248:249], v2 offset:55296
    v_mfma_f32_16x16x32_bf16 v[160:163], v[236:239], v[204:207], v[160:163]
    ds_read_b64_tr_b16 v[250:251], v2 offset:55808
    v_mfma_f32_16x16x32_bf16 v[164:167], v[236:239], v[208:211], v[164:167]
    v_mfma_f32_16x16x32_bf16 v[168:171], v[236:239], v[212:215], v[168:171]
    v_mfma_f32_16x16x32_bf16 v[172:175], v[236:239], v[216:219], v[172:175]
    s_waitcnt lgkmcnt(4)
    v_mfma_f32_16x16x32_bf16 v[200:203], v[240:243], v[220:223], v[200:203]
    ds_read_b64_tr_b16 v[236:237], v1 offset:56320
    ds_read_b64_tr_b16 v[238:239], v1 offset:56832
    s_waitcnt lgkmcnt(4)
    v_mfma_f32_16x16x32_bf16 v[176:179], v[244:247], v[252:255], v[176:179]
    ds_read_b64_tr_b16 v[240:241], v2 offset:56320
    v_mfma_f32_16x16x32_bf16 v[16:19], v[244:247], v[220:223], v[16:19]
    ds_read_b64_tr_b16 v[242:243], v2 offset:56832
    v_mfma_f32_16x16x32_bf16 v[20:23], v[244:247], v[224:227], v[20:23]
    v_mfma_f32_16x16x32_bf16 v[24:27], v[244:247], v[228:231], v[24:27]
    v_mfma_f32_16x16x32_bf16 v[28:31], v[244:247], v[232:235], v[28:31]
    s_waitcnt lgkmcnt(4)
    v_mfma_f32_16x16x32_bf16 v[180:183], v[248:251], v[252:255], v[180:183]
    ds_read_b64_tr_b16 v[244:245], v3 offset:55296
    v_mfma_f32_16x16x32_bf16 v[32:35], v[248:251], v[220:223], v[32:35]
    ds_read_b64_tr_b16 v[246:247], v3 offset:55808
    v_mfma_f32_16x16x32_bf16 v[36:39], v[248:251], v[224:227], v[36:39]
    v_mfma_f32_16x16x32_bf16 v[40:43], v[248:251], v[228:231], v[40:43]
    v_mfma_f32_16x16x32_bf16 v[44:47], v[248:251], v[232:235], v[44:47]
    s_waitcnt lgkmcnt(4)
    v_mfma_f32_16x16x32_bf16 v[184:187], v[236:239], v[252:255], v[184:187]
    ds_read_b64_tr_b16 v[248:249], v4 offset:55296
    v_mfma_f32_16x16x32_bf16 v[80:83], v[236:239], v[220:223], v[80:83]
    ds_read_b64_tr_b16 v[250:251], v4 offset:55808
    v_mfma_f32_16x16x32_bf16 v[84:87], v[236:239], v[224:227], v[84:87]
    v_mfma_f32_16x16x32_bf16 v[88:91], v[236:239], v[228:231], v[88:91]
    v_mfma_f32_16x16x32_bf16 v[92:95], v[236:239], v[232:235], v[92:95]
    s_waitcnt lgkmcnt(4)
    v_mfma_f32_16x16x32_bf16 v[188:191], v[240:243], v[252:255], v[188:191]
    ds_read_b64_tr_b16 v[236:237], v3 offset:56320
    v_mfma_f32_16x16x32_bf16 v[96:99], v[240:243], v[220:223], v[96:99]
    ds_read_b64_tr_b16 v[238:239], v3 offset:56832
    v_mfma_f32_16x16x32_bf16 v[100:103], v[240:243], v[224:227], v[100:103]
    v_mfma_f32_16x16x32_bf16 v[104:107], v[240:243], v[228:231], v[104:107]
    v_mfma_f32_16x16x32_bf16 v[108:111], v[240:243], v[232:235], v[108:111]
    s_waitcnt lgkmcnt(4)
    v_mfma_f32_16x16x32_bf16 v[48:51], v[244:247], v[220:223], v[48:51]
    ds_read_b64_tr_b16 v[240:241], v4 offset:56320
    v_mfma_f32_16x16x32_bf16 v[52:55], v[244:247], v[224:227], v[52:55]
    ds_read_b64_tr_b16 v[242:243], v4 offset:56832
    v_mfma_f32_16x16x32_bf16 v[56:59], v[244:247], v[228:231], v[56:59]
    v_mfma_f32_16x16x32_bf16 v[60:63], v[244:247], v[232:235], v[60:63]
    s_waitcnt lgkmcnt(4)
    v_mfma_f32_16x16x32_bf16 v[64:67], v[248:251], v[220:223], v[64:67]
    s_barrier
    v_mfma_f32_16x16x32_bf16 v[68:71], v[248:251], v[224:227], v[68:71]
    ds_read_b64_tr_b16 v[244:245], v5 offset:55296
    v_mfma_f32_16x16x32_bf16 v[72:75], v[248:251], v[228:231], v[72:75]
    ds_read_b64_tr_b16 v[246:247], v5 offset:55552
    v_mfma_f32_16x16x32_bf16 v[76:79], v[248:251], v[232:235], v[76:79]
    ds_read_b128 v[204:207], v8 offset:0
    s_waitcnt lgkmcnt(5)
    v_mfma_f32_16x16x32_bf16 v[112:115], v[236:239], v[220:223], v[112:115]
    ds_read_b64_tr_b16 v[248:249], v6 offset:55296
    v_mfma_f32_16x16x32_bf16 v[116:119], v[236:239], v[224:227], v[116:119]
    ds_read_b64_tr_b16 v[250:251], v6 offset:55552
    v_mfma_f32_16x16x32_bf16 v[120:123], v[236:239], v[228:231], v[120:123]
    ds_read_b128 v[208:211], v8 offset:2048
    v_mfma_f32_16x16x32_bf16 v[124:127], v[236:239], v[232:235], v[124:127]
    ds_read_b128 v[212:215], v8 offset:4096
    s_waitcnt lgkmcnt(7)
    v_mfma_f32_16x16x32_bf16 v[128:131], v[240:243], v[220:223], v[128:131]
    ds_read_b128 v[236:239], v13 offset:768
    v_mfma_f32_16x16x32_bf16 v[132:135], v[240:243], v[224:227], v[132:135]
    ds_read_b128 v[216:219], v8 offset:6144
    v_mfma_f32_16x16x32_bf16 v[136:139], v[240:243], v[228:231], v[136:139]
    v_mfma_f32_16x16x32_bf16 v[140:143], v[240:243], v[232:235], v[140:143]
    s_waitcnt lgkmcnt(7)
    v_mfma_f32_16x16x32_bf16 v[192:195], v[244:247], v[252:255], v[192:195]
    ds_read_b64_tr_b16 v[240:241], v1 offset:0
    v_mfma_f32_16x16x32_bf16 v[144:147], v[244:247], v[220:223], v[144:147]
    ds_read_b64_tr_b16 v[242:243], v1 offset:512
    v_mfma_f32_16x16x32_bf16 v[148:151], v[244:247], v[224:227], v[148:151]
    v_mfma_f32_16x16x32_bf16 v[152:155], v[244:247], v[228:231], v[152:155]
    v_mfma_f32_16x16x32_bf16 v[156:159], v[244:247], v[232:235], v[156:159]
    s_waitcnt lgkmcnt(6)
    v_mfma_f32_16x16x32_bf16 v[196:199], v[248:251], v[252:255], v[196:199]
    ds_read_b64_tr_b16 v[244:245], v2 offset:0
    v_mfma_f32_16x16x32_bf16 v[160:163], v[248:251], v[220:223], v[160:163]
    ds_read_b64_tr_b16 v[246:247], v2 offset:512
    v_mfma_f32_16x16x32_bf16 v[164:167], v[248:251], v[224:227], v[164:167]
    v_mfma_f32_16x16x32_bf16 v[168:171], v[248:251], v[228:231], v[168:171]
    v_mfma_f32_16x16x32_bf16 v[172:175], v[248:251], v[232:235], v[172:175]
    s_waitcnt lgkmcnt(4)
    v_mfma_f32_16x16x32_bf16 v[200:203], v[236:239], v[204:207], v[200:203]
    ds_read_b64_tr_b16 v[248:249], v1 offset:1024
    ds_read_b64_tr_b16 v[250:251], v1 offset:1536
    s_waitcnt lgkmcnt(4)
    v_mfma_f32_16x16x32_bf16 v[176:179], v[240:243], v[252:255], v[176:179]
    ds_read_b64_tr_b16 v[236:237], v2 offset:1024
    v_mfma_f32_16x16x32_bf16 v[16:19], v[240:243], v[204:207], v[16:19]
    ds_read_b64_tr_b16 v[238:239], v2 offset:1536
    v_mfma_f32_16x16x32_bf16 v[20:23], v[240:243], v[208:211], v[20:23]
    v_mfma_f32_16x16x32_bf16 v[24:27], v[240:243], v[212:215], v[24:27]
    v_mfma_f32_16x16x32_bf16 v[28:31], v[240:243], v[216:219], v[28:31]
    s_waitcnt lgkmcnt(4)
    v_mfma_f32_16x16x32_bf16 v[180:183], v[244:247], v[252:255], v[180:183]
    ds_read_b64_tr_b16 v[240:241], v3 offset:0
    v_mfma_f32_16x16x32_bf16 v[32:35], v[244:247], v[204:207], v[32:35]
    ds_read_b64_tr_b16 v[242:243], v3 offset:512
    v_mfma_f32_16x16x32_bf16 v[36:39], v[244:247], v[208:211], v[36:39]
    v_mfma_f32_16x16x32_bf16 v[40:43], v[244:247], v[212:215], v[40:43]
    v_mfma_f32_16x16x32_bf16 v[44:47], v[244:247], v[216:219], v[44:47]
    s_waitcnt lgkmcnt(4)
    v_mfma_f32_16x16x32_bf16 v[184:187], v[248:251], v[252:255], v[184:187]
    ds_read_b64_tr_b16 v[244:245], v4 offset:0
    v_mfma_f32_16x16x32_bf16 v[80:83], v[248:251], v[204:207], v[80:83]
    ds_read_b64_tr_b16 v[246:247], v4 offset:512
    v_mfma_f32_16x16x32_bf16 v[84:87], v[248:251], v[208:211], v[84:87]
    v_mfma_f32_16x16x32_bf16 v[88:91], v[248:251], v[212:215], v[88:91]
    v_mfma_f32_16x16x32_bf16 v[92:95], v[248:251], v[216:219], v[92:95]
    s_waitcnt lgkmcnt(4)
    v_mfma_f32_16x16x32_bf16 v[188:191], v[236:239], v[252:255], v[188:191]
    ds_read_b64_tr_b16 v[248:249], v3 offset:1024
    v_mfma_f32_16x16x32_bf16 v[96:99], v[236:239], v[204:207], v[96:99]
    ds_read_b64_tr_b16 v[250:251], v3 offset:1536
    v_mfma_f32_16x16x32_bf16 v[100:103], v[236:239], v[208:211], v[100:103]
    v_mfma_f32_16x16x32_bf16 v[104:107], v[236:239], v[212:215], v[104:107]
    v_mfma_f32_16x16x32_bf16 v[108:111], v[236:239], v[216:219], v[108:111]
    s_waitcnt lgkmcnt(4)
    v_mfma_f32_16x16x32_bf16 v[48:51], v[240:243], v[204:207], v[48:51]
    ds_read_b64_tr_b16 v[236:237], v4 offset:1024
    v_mfma_f32_16x16x32_bf16 v[52:55], v[240:243], v[208:211], v[52:55]
    ds_read_b64_tr_b16 v[238:239], v4 offset:1536
    v_mfma_f32_16x16x32_bf16 v[56:59], v[240:243], v[212:215], v[56:59]
    v_mfma_f32_16x16x32_bf16 v[60:63], v[240:243], v[216:219], v[60:63]
    s_waitcnt lgkmcnt(4)
    v_mfma_f32_16x16x32_bf16 v[64:67], v[244:247], v[204:207], v[64:67]
    s_barrier
    v_mfma_f32_16x16x32_bf16 v[68:71], v[244:247], v[208:211], v[68:71]
    ds_read_b64_tr_b16 v[240:241], v5 offset:0
    v_mfma_f32_16x16x32_bf16 v[72:75], v[244:247], v[212:215], v[72:75]
    ds_read_b64_tr_b16 v[242:243], v5 offset:256
    v_mfma_f32_16x16x32_bf16 v[76:79], v[244:247], v[216:219], v[76:79]
    ds_read_b128 v[220:223], v14 offset:0
    s_waitcnt lgkmcnt(5)
    v_mfma_f32_16x16x32_bf16 v[112:115], v[248:251], v[204:207], v[112:115]
    ds_read_b64_tr_b16 v[244:245], v6 offset:0
    v_mfma_f32_16x16x32_bf16 v[116:119], v[248:251], v[208:211], v[116:119]
    ds_read_b64_tr_b16 v[246:247], v6 offset:256
    v_mfma_f32_16x16x32_bf16 v[120:123], v[248:251], v[212:215], v[120:123]
    ds_read_b128 v[224:227], v14 offset:2048
    v_mfma_f32_16x16x32_bf16 v[124:127], v[248:251], v[216:219], v[124:127]
    ds_read_b128 v[228:231], v14 offset:4096
    s_waitcnt lgkmcnt(7)
    v_mfma_f32_16x16x32_bf16 v[128:131], v[236:239], v[204:207], v[128:131]
    ds_read_b128 v[248:251], v13 offset:832
    v_mfma_f32_16x16x32_bf16 v[132:135], v[236:239], v[208:211], v[132:135]
    ds_read_b128 v[232:235], v14 offset:6144
    v_mfma_f32_16x16x32_bf16 v[136:139], v[236:239], v[212:215], v[136:139]
    v_mfma_f32_16x16x32_bf16 v[140:143], v[236:239], v[216:219], v[140:143]
    s_waitcnt lgkmcnt(7)
    v_mfma_f32_16x16x32_bf16 v[192:195], v[240:243], v[252:255], v[192:195]
    ds_read_b64_tr_b16 v[236:237], v1 offset:18432
    v_mfma_f32_16x16x32_bf16 v[144:147], v[240:243], v[204:207], v[144:147]
    ds_read_b64_tr_b16 v[238:239], v1 offset:18944
    v_mfma_f32_16x16x32_bf16 v[148:151], v[240:243], v[208:211], v[148:151]
    v_mfma_f32_16x16x32_bf16 v[152:155], v[240:243], v[212:215], v[152:155]
    v_mfma_f32_16x16x32_bf16 v[156:159], v[240:243], v[216:219], v[156:159]
    s_waitcnt lgkmcnt(6)
    v_mfma_f32_16x16x32_bf16 v[196:199], v[244:247], v[252:255], v[196:199]
    ds_read_b64_tr_b16 v[240:241], v2 offset:18432
    v_mfma_f32_16x16x32_bf16 v[160:163], v[244:247], v[204:207], v[160:163]
    ds_read_b64_tr_b16 v[242:243], v2 offset:18944
    v_mfma_f32_16x16x32_bf16 v[164:167], v[244:247], v[208:211], v[164:167]
    v_mfma_f32_16x16x32_bf16 v[168:171], v[244:247], v[212:215], v[168:171]
    v_mfma_f32_16x16x32_bf16 v[172:175], v[244:247], v[216:219], v[172:175]
    s_waitcnt lgkmcnt(4)
    v_mfma_f32_16x16x32_bf16 v[200:203], v[248:251], v[220:223], v[200:203]
    ds_read_b64_tr_b16 v[244:245], v1 offset:19456
    ds_read_b64_tr_b16 v[246:247], v1 offset:19968
    s_waitcnt lgkmcnt(4)
    v_mfma_f32_16x16x32_bf16 v[176:179], v[236:239], v[252:255], v[176:179]
    ds_read_b64_tr_b16 v[248:249], v2 offset:19456
    v_mfma_f32_16x16x32_bf16 v[16:19], v[236:239], v[220:223], v[16:19]
    ds_read_b64_tr_b16 v[250:251], v2 offset:19968
    v_mfma_f32_16x16x32_bf16 v[20:23], v[236:239], v[224:227], v[20:23]
    v_mfma_f32_16x16x32_bf16 v[24:27], v[236:239], v[228:231], v[24:27]
    v_mfma_f32_16x16x32_bf16 v[28:31], v[236:239], v[232:235], v[28:31]
    s_waitcnt lgkmcnt(4)
    v_mfma_f32_16x16x32_bf16 v[180:183], v[240:243], v[252:255], v[180:183]
    ds_read_b64_tr_b16 v[236:237], v3 offset:18432
    v_mfma_f32_16x16x32_bf16 v[32:35], v[240:243], v[220:223], v[32:35]
    ds_read_b64_tr_b16 v[238:239], v3 offset:18944
    v_mfma_f32_16x16x32_bf16 v[36:39], v[240:243], v[224:227], v[36:39]
    v_mfma_f32_16x16x32_bf16 v[40:43], v[240:243], v[228:231], v[40:43]
    v_mfma_f32_16x16x32_bf16 v[44:47], v[240:243], v[232:235], v[44:47]
    s_waitcnt lgkmcnt(4)
    v_mfma_f32_16x16x32_bf16 v[184:187], v[244:247], v[252:255], v[184:187]
    ds_read_b64_tr_b16 v[240:241], v4 offset:18432
    v_mfma_f32_16x16x32_bf16 v[80:83], v[244:247], v[220:223], v[80:83]
    ds_read_b64_tr_b16 v[242:243], v4 offset:18944
    v_mfma_f32_16x16x32_bf16 v[84:87], v[244:247], v[224:227], v[84:87]
    v_mfma_f32_16x16x32_bf16 v[88:91], v[244:247], v[228:231], v[88:91]
    v_mfma_f32_16x16x32_bf16 v[92:95], v[244:247], v[232:235], v[92:95]
    s_waitcnt lgkmcnt(4)
    v_mfma_f32_16x16x32_bf16 v[188:191], v[248:251], v[252:255], v[188:191]
    ds_read_b64_tr_b16 v[244:245], v3 offset:19456
    v_mfma_f32_16x16x32_bf16 v[96:99], v[248:251], v[220:223], v[96:99]
    ds_read_b64_tr_b16 v[246:247], v3 offset:19968
    v_mfma_f32_16x16x32_bf16 v[100:103], v[248:251], v[224:227], v[100:103]
    v_mfma_f32_16x16x32_bf16 v[104:107], v[248:251], v[228:231], v[104:107]
    v_mfma_f32_16x16x32_bf16 v[108:111], v[248:251], v[232:235], v[108:111]
    s_waitcnt lgkmcnt(4)
    v_mfma_f32_16x16x32_bf16 v[48:51], v[236:239], v[220:223], v[48:51]
    ds_read_b64_tr_b16 v[248:249], v4 offset:19456
    v_mfma_f32_16x16x32_bf16 v[52:55], v[236:239], v[224:227], v[52:55]
    ds_read_b64_tr_b16 v[250:251], v4 offset:19968
    v_mfma_f32_16x16x32_bf16 v[56:59], v[236:239], v[228:231], v[56:59]
    v_mfma_f32_16x16x32_bf16 v[60:63], v[236:239], v[232:235], v[60:63]
    s_waitcnt lgkmcnt(4)
    v_mfma_f32_16x16x32_bf16 v[64:67], v[240:243], v[220:223], v[64:67]
    s_barrier
    v_mfma_f32_16x16x32_bf16 v[68:71], v[240:243], v[224:227], v[68:71]
    ds_read_b64_tr_b16 v[236:237], v5 offset:18432
    v_mfma_f32_16x16x32_bf16 v[72:75], v[240:243], v[228:231], v[72:75]
    ds_read_b64_tr_b16 v[238:239], v5 offset:18688
    v_mfma_f32_16x16x32_bf16 v[76:79], v[240:243], v[232:235], v[76:79]
    ds_read_b128 v[204:207], v8 offset:16384
    s_waitcnt lgkmcnt(5)
    v_mfma_f32_16x16x32_bf16 v[112:115], v[244:247], v[220:223], v[112:115]
    ds_read_b64_tr_b16 v[240:241], v6 offset:18432
    v_mfma_f32_16x16x32_bf16 v[116:119], v[244:247], v[224:227], v[116:119]
    ds_read_b64_tr_b16 v[242:243], v6 offset:18688
    v_mfma_f32_16x16x32_bf16 v[120:123], v[244:247], v[228:231], v[120:123]
    ds_read_b128 v[208:211], v8 offset:18432
    v_mfma_f32_16x16x32_bf16 v[124:127], v[244:247], v[232:235], v[124:127]
    ds_read_b128 v[212:215], v8 offset:20480
    s_waitcnt lgkmcnt(7)
    v_mfma_f32_16x16x32_bf16 v[128:131], v[248:251], v[220:223], v[128:131]
    ds_read_b128 v[244:247], v13 offset:896
    v_mfma_f32_16x16x32_bf16 v[132:135], v[248:251], v[224:227], v[132:135]
    ds_read_b128 v[216:219], v8 offset:22528
    v_mfma_f32_16x16x32_bf16 v[136:139], v[248:251], v[228:231], v[136:139]
    v_mfma_f32_16x16x32_bf16 v[140:143], v[248:251], v[232:235], v[140:143]
    s_waitcnt lgkmcnt(7)
    v_mfma_f32_16x16x32_bf16 v[192:195], v[236:239], v[252:255], v[192:195]
    ds_read_b64_tr_b16 v[248:249], v1 offset:36864
    v_mfma_f32_16x16x32_bf16 v[144:147], v[236:239], v[220:223], v[144:147]
    ds_read_b64_tr_b16 v[250:251], v1 offset:37376
    v_mfma_f32_16x16x32_bf16 v[148:151], v[236:239], v[224:227], v[148:151]
    v_mfma_f32_16x16x32_bf16 v[152:155], v[236:239], v[228:231], v[152:155]
    v_mfma_f32_16x16x32_bf16 v[156:159], v[236:239], v[232:235], v[156:159]
    s_waitcnt lgkmcnt(6)
    v_mfma_f32_16x16x32_bf16 v[196:199], v[240:243], v[252:255], v[196:199]
    ds_read_b64_tr_b16 v[236:237], v2 offset:36864
    v_mfma_f32_16x16x32_bf16 v[160:163], v[240:243], v[220:223], v[160:163]
    ds_read_b64_tr_b16 v[238:239], v2 offset:37376
    v_mfma_f32_16x16x32_bf16 v[164:167], v[240:243], v[224:227], v[164:167]
    v_mfma_f32_16x16x32_bf16 v[168:171], v[240:243], v[228:231], v[168:171]
    v_mfma_f32_16x16x32_bf16 v[172:175], v[240:243], v[232:235], v[172:175]
    s_waitcnt lgkmcnt(4)
    v_mfma_f32_16x16x32_bf16 v[200:203], v[244:247], v[204:207], v[200:203]
    ds_read_b64_tr_b16 v[240:241], v1 offset:37888
    ds_read_b64_tr_b16 v[242:243], v1 offset:38400
    s_waitcnt lgkmcnt(4)
    v_mfma_f32_16x16x32_bf16 v[176:179], v[248:251], v[252:255], v[176:179]
    ds_read_b64_tr_b16 v[244:245], v2 offset:37888
    v_mfma_f32_16x16x32_bf16 v[16:19], v[248:251], v[204:207], v[16:19]
    ds_read_b64_tr_b16 v[246:247], v2 offset:38400
    v_mfma_f32_16x16x32_bf16 v[20:23], v[248:251], v[208:211], v[20:23]
    v_mfma_f32_16x16x32_bf16 v[24:27], v[248:251], v[212:215], v[24:27]
    v_mfma_f32_16x16x32_bf16 v[28:31], v[248:251], v[216:219], v[28:31]
    s_waitcnt lgkmcnt(4)
    v_mfma_f32_16x16x32_bf16 v[180:183], v[236:239], v[252:255], v[180:183]
    ds_read_b64_tr_b16 v[248:249], v3 offset:36864
    v_mfma_f32_16x16x32_bf16 v[32:35], v[236:239], v[204:207], v[32:35]
    ds_read_b64_tr_b16 v[250:251], v3 offset:37376
    v_mfma_f32_16x16x32_bf16 v[36:39], v[236:239], v[208:211], v[36:39]
    v_mfma_f32_16x16x32_bf16 v[40:43], v[236:239], v[212:215], v[40:43]
    v_mfma_f32_16x16x32_bf16 v[44:47], v[236:239], v[216:219], v[44:47]
    s_waitcnt lgkmcnt(4)
    v_mfma_f32_16x16x32_bf16 v[184:187], v[240:243], v[252:255], v[184:187]
    ds_read_b64_tr_b16 v[236:237], v4 offset:36864
    v_mfma_f32_16x16x32_bf16 v[80:83], v[240:243], v[204:207], v[80:83]
    ds_read_b64_tr_b16 v[238:239], v4 offset:37376
    v_mfma_f32_16x16x32_bf16 v[84:87], v[240:243], v[208:211], v[84:87]
    v_mfma_f32_16x16x32_bf16 v[88:91], v[240:243], v[212:215], v[88:91]
    v_mfma_f32_16x16x32_bf16 v[92:95], v[240:243], v[216:219], v[92:95]
    s_waitcnt lgkmcnt(4)
    v_mfma_f32_16x16x32_bf16 v[188:191], v[244:247], v[252:255], v[188:191]
    ds_read_b64_tr_b16 v[240:241], v3 offset:37888
    v_mfma_f32_16x16x32_bf16 v[96:99], v[244:247], v[204:207], v[96:99]
    ds_read_b64_tr_b16 v[242:243], v3 offset:38400
    v_mfma_f32_16x16x32_bf16 v[100:103], v[244:247], v[208:211], v[100:103]
    v_mfma_f32_16x16x32_bf16 v[104:107], v[244:247], v[212:215], v[104:107]
    v_mfma_f32_16x16x32_bf16 v[108:111], v[244:247], v[216:219], v[108:111]
    s_waitcnt lgkmcnt(4)
    v_mfma_f32_16x16x32_bf16 v[48:51], v[248:251], v[204:207], v[48:51]
    ds_read_b64_tr_b16 v[244:245], v4 offset:37888
    v_mfma_f32_16x16x32_bf16 v[52:55], v[248:251], v[208:211], v[52:55]
    ds_read_b64_tr_b16 v[246:247], v4 offset:38400
    v_mfma_f32_16x16x32_bf16 v[56:59], v[248:251], v[212:215], v[56:59]
    v_mfma_f32_16x16x32_bf16 v[60:63], v[248:251], v[216:219], v[60:63]
    s_waitcnt lgkmcnt(4)
    v_mfma_f32_16x16x32_bf16 v[64:67], v[236:239], v[204:207], v[64:67]
    s_barrier
    v_mfma_f32_16x16x32_bf16 v[68:71], v[236:239], v[208:211], v[68:71]
    ds_read_b64_tr_b16 v[248:249], v5 offset:36864
    v_mfma_f32_16x16x32_bf16 v[72:75], v[236:239], v[212:215], v[72:75]
    ds_read_b64_tr_b16 v[250:251], v5 offset:37120
    v_mfma_f32_16x16x32_bf16 v[76:79], v[236:239], v[216:219], v[76:79]
    ds_read_b128 v[220:223], v14 offset:16384
    s_waitcnt lgkmcnt(5)
    v_mfma_f32_16x16x32_bf16 v[112:115], v[240:243], v[204:207], v[112:115]
    ds_read_b64_tr_b16 v[236:237], v6 offset:36864
    v_mfma_f32_16x16x32_bf16 v[116:119], v[240:243], v[208:211], v[116:119]
    ds_read_b64_tr_b16 v[238:239], v6 offset:37120
    v_mfma_f32_16x16x32_bf16 v[120:123], v[240:243], v[212:215], v[120:123]
    ds_read_b128 v[224:227], v14 offset:18432
    v_mfma_f32_16x16x32_bf16 v[124:127], v[240:243], v[216:219], v[124:127]
    ds_read_b128 v[228:231], v14 offset:20480
    s_waitcnt lgkmcnt(7)
    v_mfma_f32_16x16x32_bf16 v[128:131], v[244:247], v[204:207], v[128:131]
    ds_read_b128 v[240:243], v13 offset:960
    v_mfma_f32_16x16x32_bf16 v[132:135], v[244:247], v[208:211], v[132:135]
    ds_read_b128 v[232:235], v14 offset:22528
    v_mfma_f32_16x16x32_bf16 v[136:139], v[244:247], v[212:215], v[136:139]
    v_mfma_f32_16x16x32_bf16 v[140:143], v[244:247], v[216:219], v[140:143]
    s_waitcnt lgkmcnt(7)
    v_mfma_f32_16x16x32_bf16 v[192:195], v[248:251], v[252:255], v[192:195]
    ds_read_b64_tr_b16 v[244:245], v1 offset:55296
    v_mfma_f32_16x16x32_bf16 v[144:147], v[248:251], v[204:207], v[144:147]
    ds_read_b64_tr_b16 v[246:247], v1 offset:55808
    v_mfma_f32_16x16x32_bf16 v[148:151], v[248:251], v[208:211], v[148:151]
    v_mfma_f32_16x16x32_bf16 v[152:155], v[248:251], v[212:215], v[152:155]
    v_mfma_f32_16x16x32_bf16 v[156:159], v[248:251], v[216:219], v[156:159]
    s_waitcnt lgkmcnt(6)
    v_mfma_f32_16x16x32_bf16 v[196:199], v[236:239], v[252:255], v[196:199]
    ds_read_b64_tr_b16 v[248:249], v2 offset:55296
    v_mfma_f32_16x16x32_bf16 v[160:163], v[236:239], v[204:207], v[160:163]
    ds_read_b64_tr_b16 v[250:251], v2 offset:55808
    v_mfma_f32_16x16x32_bf16 v[164:167], v[236:239], v[208:211], v[164:167]
    v_mfma_f32_16x16x32_bf16 v[168:171], v[236:239], v[212:215], v[168:171]
    v_mfma_f32_16x16x32_bf16 v[172:175], v[236:239], v[216:219], v[172:175]
    s_waitcnt lgkmcnt(4)
    v_mfma_f32_16x16x32_bf16 v[200:203], v[240:243], v[220:223], v[200:203]
    ds_read_b64_tr_b16 v[236:237], v1 offset:56320
    ds_read_b64_tr_b16 v[238:239], v1 offset:56832
    s_waitcnt lgkmcnt(4)
    v_mfma_f32_16x16x32_bf16 v[176:179], v[244:247], v[252:255], v[176:179]
    ds_read_b64_tr_b16 v[240:241], v2 offset:56320
    v_mfma_f32_16x16x32_bf16 v[16:19], v[244:247], v[220:223], v[16:19]
    ds_read_b64_tr_b16 v[242:243], v2 offset:56832
    v_mfma_f32_16x16x32_bf16 v[20:23], v[244:247], v[224:227], v[20:23]
    v_mfma_f32_16x16x32_bf16 v[24:27], v[244:247], v[228:231], v[24:27]
    v_mfma_f32_16x16x32_bf16 v[28:31], v[244:247], v[232:235], v[28:31]
    s_waitcnt lgkmcnt(4)
    v_mfma_f32_16x16x32_bf16 v[180:183], v[248:251], v[252:255], v[180:183]
    ds_read_b64_tr_b16 v[244:245], v3 offset:55296
    v_mfma_f32_16x16x32_bf16 v[32:35], v[248:251], v[220:223], v[32:35]
    ds_read_b64_tr_b16 v[246:247], v3 offset:55808
    v_mfma_f32_16x16x32_bf16 v[36:39], v[248:251], v[224:227], v[36:39]
    v_mfma_f32_16x16x32_bf16 v[40:43], v[248:251], v[228:231], v[40:43]
    v_mfma_f32_16x16x32_bf16 v[44:47], v[248:251], v[232:235], v[44:47]
    s_waitcnt lgkmcnt(4)
    v_mfma_f32_16x16x32_bf16 v[184:187], v[236:239], v[252:255], v[184:187]
    ds_read_b64_tr_b16 v[248:249], v4 offset:55296
    v_mfma_f32_16x16x32_bf16 v[80:83], v[236:239], v[220:223], v[80:83]
    ds_read_b64_tr_b16 v[250:251], v4 offset:55808
    v_mfma_f32_16x16x32_bf16 v[84:87], v[236:239], v[224:227], v[84:87]
    v_mfma_f32_16x16x32_bf16 v[88:91], v[236:239], v[228:231], v[88:91]
    v_mfma_f32_16x16x32_bf16 v[92:95], v[236:239], v[232:235], v[92:95]
    s_waitcnt lgkmcnt(4)
    v_mfma_f32_16x16x32_bf16 v[188:191], v[240:243], v[252:255], v[188:191]
    ds_read_b64_tr_b16 v[236:237], v3 offset:56320
    v_mfma_f32_16x16x32_bf16 v[96:99], v[240:243], v[220:223], v[96:99]
    ds_read_b64_tr_b16 v[238:239], v3 offset:56832
    v_mfma_f32_16x16x32_bf16 v[100:103], v[240:243], v[224:227], v[100:103]
    v_mfma_f32_16x16x32_bf16 v[104:107], v[240:243], v[228:231], v[104:107]
    v_mfma_f32_16x16x32_bf16 v[108:111], v[240:243], v[232:235], v[108:111]
    s_waitcnt lgkmcnt(4)
    v_mfma_f32_16x16x32_bf16 v[48:51], v[244:247], v[220:223], v[48:51]
    ds_read_b64_tr_b16 v[240:241], v4 offset:56320
    v_mfma_f32_16x16x32_bf16 v[52:55], v[244:247], v[224:227], v[52:55]
    ds_read_b64_tr_b16 v[242:243], v4 offset:56832
    v_mfma_f32_16x16x32_bf16 v[56:59], v[244:247], v[228:231], v[56:59]
    v_mfma_f32_16x16x32_bf16 v[60:63], v[244:247], v[232:235], v[60:63]
    s_waitcnt lgkmcnt(4)
    v_mfma_f32_16x16x32_bf16 v[64:67], v[248:251], v[220:223], v[64:67]
    s_barrier
    v_mfma_f32_16x16x32_bf16 v[68:71], v[248:251], v[224:227], v[68:71]
    ds_read_b64_tr_b16 v[244:245], v5 offset:55296
    v_mfma_f32_16x16x32_bf16 v[72:75], v[248:251], v[228:231], v[72:75]
    ds_read_b64_tr_b16 v[246:247], v5 offset:55552
    v_mfma_f32_16x16x32_bf16 v[76:79], v[248:251], v[232:235], v[76:79]
    ds_read_b128 v[204:207], v8 offset:32768
    s_waitcnt lgkmcnt(5)
    v_mfma_f32_16x16x32_bf16 v[112:115], v[236:239], v[220:223], v[112:115]
    ds_read_b64_tr_b16 v[248:249], v6 offset:55296
    v_mfma_f32_16x16x32_bf16 v[116:119], v[236:239], v[224:227], v[116:119]
    ds_read_b64_tr_b16 v[250:251], v6 offset:55552
    v_mfma_f32_16x16x32_bf16 v[120:123], v[236:239], v[228:231], v[120:123]
    ds_read_b128 v[208:211], v8 offset:34816
    v_mfma_f32_16x16x32_bf16 v[124:127], v[236:239], v[232:235], v[124:127]
    ds_read_b128 v[212:215], v8 offset:36864
    s_waitcnt lgkmcnt(7)
    v_mfma_f32_16x16x32_bf16 v[128:131], v[240:243], v[220:223], v[128:131]
    ds_read_b128 v[236:239], v13 offset:1024
    v_mfma_f32_16x16x32_bf16 v[132:135], v[240:243], v[224:227], v[132:135]
    ds_read_b128 v[216:219], v8 offset:38912
    v_mfma_f32_16x16x32_bf16 v[136:139], v[240:243], v[228:231], v[136:139]
    v_mfma_f32_16x16x32_bf16 v[140:143], v[240:243], v[232:235], v[140:143]
    s_waitcnt lgkmcnt(7)
    v_mfma_f32_16x16x32_bf16 v[192:195], v[244:247], v[252:255], v[192:195]
    ds_read_b64_tr_b16 v[240:241], v1 offset:0
    v_mfma_f32_16x16x32_bf16 v[144:147], v[244:247], v[220:223], v[144:147]
    ds_read_b64_tr_b16 v[242:243], v1 offset:512
    v_mfma_f32_16x16x32_bf16 v[148:151], v[244:247], v[224:227], v[148:151]
    v_mfma_f32_16x16x32_bf16 v[152:155], v[244:247], v[228:231], v[152:155]
    v_mfma_f32_16x16x32_bf16 v[156:159], v[244:247], v[232:235], v[156:159]
    s_waitcnt lgkmcnt(6)
    v_mfma_f32_16x16x32_bf16 v[196:199], v[248:251], v[252:255], v[196:199]
    ds_read_b64_tr_b16 v[244:245], v2 offset:0
    v_mfma_f32_16x16x32_bf16 v[160:163], v[248:251], v[220:223], v[160:163]
    ds_read_b64_tr_b16 v[246:247], v2 offset:512
    v_mfma_f32_16x16x32_bf16 v[164:167], v[248:251], v[224:227], v[164:167]
    v_mfma_f32_16x16x32_bf16 v[168:171], v[248:251], v[228:231], v[168:171]
    v_mfma_f32_16x16x32_bf16 v[172:175], v[248:251], v[232:235], v[172:175]
    s_waitcnt lgkmcnt(4)
    v_mfma_f32_16x16x32_bf16 v[200:203], v[236:239], v[204:207], v[200:203]
    ds_read_b64_tr_b16 v[248:249], v1 offset:1024
    ds_read_b64_tr_b16 v[250:251], v1 offset:1536
    s_waitcnt lgkmcnt(4)
    v_mfma_f32_16x16x32_bf16 v[176:179], v[240:243], v[252:255], v[176:179]
    ds_read_b64_tr_b16 v[236:237], v2 offset:1024
    v_mfma_f32_16x16x32_bf16 v[16:19], v[240:243], v[204:207], v[16:19]
    ds_read_b64_tr_b16 v[238:239], v2 offset:1536
    v_mfma_f32_16x16x32_bf16 v[20:23], v[240:243], v[208:211], v[20:23]
    v_mfma_f32_16x16x32_bf16 v[24:27], v[240:243], v[212:215], v[24:27]
    v_mfma_f32_16x16x32_bf16 v[28:31], v[240:243], v[216:219], v[28:31]
    s_waitcnt lgkmcnt(4)
    v_mfma_f32_16x16x32_bf16 v[180:183], v[244:247], v[252:255], v[180:183]
    ds_read_b64_tr_b16 v[240:241], v3 offset:0
    v_mfma_f32_16x16x32_bf16 v[32:35], v[244:247], v[204:207], v[32:35]
    ds_read_b64_tr_b16 v[242:243], v3 offset:512
    v_mfma_f32_16x16x32_bf16 v[36:39], v[244:247], v[208:211], v[36:39]
    v_mfma_f32_16x16x32_bf16 v[40:43], v[244:247], v[212:215], v[40:43]
    v_mfma_f32_16x16x32_bf16 v[44:47], v[244:247], v[216:219], v[44:47]
    s_waitcnt lgkmcnt(4)
    v_mfma_f32_16x16x32_bf16 v[184:187], v[248:251], v[252:255], v[184:187]
    ds_read_b64_tr_b16 v[244:245], v4 offset:0
    v_mfma_f32_16x16x32_bf16 v[80:83], v[248:251], v[204:207], v[80:83]
    ds_read_b64_tr_b16 v[246:247], v4 offset:512
    v_mfma_f32_16x16x32_bf16 v[84:87], v[248:251], v[208:211], v[84:87]
    v_mfma_f32_16x16x32_bf16 v[88:91], v[248:251], v[212:215], v[88:91]
    v_mfma_f32_16x16x32_bf16 v[92:95], v[248:251], v[216:219], v[92:95]
    s_waitcnt lgkmcnt(4)
    v_mfma_f32_16x16x32_bf16 v[188:191], v[236:239], v[252:255], v[188:191]
    ds_read_b64_tr_b16 v[248:249], v3 offset:1024
    v_mfma_f32_16x16x32_bf16 v[96:99], v[236:239], v[204:207], v[96:99]
    ds_read_b64_tr_b16 v[250:251], v3 offset:1536
    v_mfma_f32_16x16x32_bf16 v[100:103], v[236:239], v[208:211], v[100:103]
    v_mfma_f32_16x16x32_bf16 v[104:107], v[236:239], v[212:215], v[104:107]
    v_mfma_f32_16x16x32_bf16 v[108:111], v[236:239], v[216:219], v[108:111]
    s_waitcnt lgkmcnt(4)
    v_mfma_f32_16x16x32_bf16 v[48:51], v[240:243], v[204:207], v[48:51]
    ds_read_b64_tr_b16 v[236:237], v4 offset:1024
    v_mfma_f32_16x16x32_bf16 v[52:55], v[240:243], v[208:211], v[52:55]
    ds_read_b64_tr_b16 v[238:239], v4 offset:1536
    v_mfma_f32_16x16x32_bf16 v[56:59], v[240:243], v[212:215], v[56:59]
    v_mfma_f32_16x16x32_bf16 v[60:63], v[240:243], v[216:219], v[60:63]
    s_waitcnt lgkmcnt(4)
    v_mfma_f32_16x16x32_bf16 v[64:67], v[244:247], v[204:207], v[64:67]
    s_barrier
    v_mfma_f32_16x16x32_bf16 v[68:71], v[244:247], v[208:211], v[68:71]
    ds_read_b64_tr_b16 v[240:241], v5 offset:0
    v_mfma_f32_16x16x32_bf16 v[72:75], v[244:247], v[212:215], v[72:75]
    ds_read_b64_tr_b16 v[242:243], v5 offset:256
    v_mfma_f32_16x16x32_bf16 v[76:79], v[244:247], v[216:219], v[76:79]
    ds_read_b128 v[220:223], v14 offset:32768
    s_waitcnt lgkmcnt(5)
    v_mfma_f32_16x16x32_bf16 v[112:115], v[248:251], v[204:207], v[112:115]
    ds_read_b64_tr_b16 v[244:245], v6 offset:0
    v_mfma_f32_16x16x32_bf16 v[116:119], v[248:251], v[208:211], v[116:119]
    ds_read_b64_tr_b16 v[246:247], v6 offset:256
    v_mfma_f32_16x16x32_bf16 v[120:123], v[248:251], v[212:215], v[120:123]
    ds_read_b128 v[224:227], v14 offset:34816
    v_mfma_f32_16x16x32_bf16 v[124:127], v[248:251], v[216:219], v[124:127]
    ds_read_b128 v[228:231], v14 offset:36864
    s_waitcnt lgkmcnt(7)
    v_mfma_f32_16x16x32_bf16 v[128:131], v[236:239], v[204:207], v[128:131]
    ds_read_b128 v[248:251], v13 offset:1088
    v_mfma_f32_16x16x32_bf16 v[132:135], v[236:239], v[208:211], v[132:135]
    ds_read_b128 v[232:235], v14 offset:38912
    v_mfma_f32_16x16x32_bf16 v[136:139], v[236:239], v[212:215], v[136:139]
    v_mfma_f32_16x16x32_bf16 v[140:143], v[236:239], v[216:219], v[140:143]
    s_waitcnt lgkmcnt(7)
    v_mfma_f32_16x16x32_bf16 v[192:195], v[240:243], v[252:255], v[192:195]
    ds_read_b64_tr_b16 v[236:237], v1 offset:18432
    v_mfma_f32_16x16x32_bf16 v[144:147], v[240:243], v[204:207], v[144:147]
    ds_read_b64_tr_b16 v[238:239], v1 offset:18944
    v_mfma_f32_16x16x32_bf16 v[148:151], v[240:243], v[208:211], v[148:151]
    v_mfma_f32_16x16x32_bf16 v[152:155], v[240:243], v[212:215], v[152:155]
    v_mfma_f32_16x16x32_bf16 v[156:159], v[240:243], v[216:219], v[156:159]
    s_waitcnt lgkmcnt(6)
    v_mfma_f32_16x16x32_bf16 v[196:199], v[244:247], v[252:255], v[196:199]
    ds_read_b64_tr_b16 v[240:241], v2 offset:18432
    v_mfma_f32_16x16x32_bf16 v[160:163], v[244:247], v[204:207], v[160:163]
    ds_read_b64_tr_b16 v[242:243], v2 offset:18944
    v_mfma_f32_16x16x32_bf16 v[164:167], v[244:247], v[208:211], v[164:167]
    v_mfma_f32_16x16x32_bf16 v[168:171], v[244:247], v[212:215], v[168:171]
    v_mfma_f32_16x16x32_bf16 v[172:175], v[244:247], v[216:219], v[172:175]
    s_waitcnt lgkmcnt(4)
    v_mfma_f32_16x16x32_bf16 v[200:203], v[248:251], v[220:223], v[200:203]
    ds_read_b64_tr_b16 v[244:245], v1 offset:19456
    ds_read_b64_tr_b16 v[246:247], v1 offset:19968
    s_waitcnt lgkmcnt(4)
    v_mfma_f32_16x16x32_bf16 v[176:179], v[236:239], v[252:255], v[176:179]
    ds_read_b64_tr_b16 v[248:249], v2 offset:19456
    v_mfma_f32_16x16x32_bf16 v[16:19], v[236:239], v[220:223], v[16:19]
    ds_read_b64_tr_b16 v[250:251], v2 offset:19968
    v_mfma_f32_16x16x32_bf16 v[20:23], v[236:239], v[224:227], v[20:23]
    s_lshl_b32 s59, s52, 9
    s_lshl_b32 s60, s51, 7
    s_add_u32 s59, s59, s60
    s_add_u32 s59, s59, 159744
    v_mfma_f32_16x16x32_bf16 v[24:27], v[236:239], v[228:231], v[24:27]
    v_lshl_add_u32 v208, v10, 4, s59
    v_mfma_f32_16x16x32_bf16 v[28:31], v[236:239], v[232:235], v[28:31]
    s_lshl_b32 s59, s51, 8
    s_add_u32 s59, s59, 162304
    s_waitcnt lgkmcnt(4)
    v_mfma_f32_16x16x32_bf16 v[180:183], v[240:243], v[252:255], v[180:183]
    ds_read_b64_tr_b16 v[236:237], v3 offset:18432
    v_mfma_f32_16x16x32_bf16 v[32:35], v[240:243], v[220:223], v[32:35]
    ds_read_b64_tr_b16 v[238:239], v3 offset:18944
    v_mfma_f32_16x16x32_bf16 v[36:39], v[240:243], v[224:227], v[36:39]
    v_lshl_add_u32 v209, v9, 2, s59
    v_mfma_f32_16x16x32_bf16 v[40:43], v[240:243], v[228:231], v[40:43]
    v_lshl_add_u32 v210, v0, 2, s59
    v_mfma_f32_16x16x32_bf16 v[44:47], v[240:243], v[232:235], v[44:47]
    s_lshl_b32 s59, s48, 10
    s_add_u32 s59, s59, 45056
    s_waitcnt lgkmcnt(4)
    v_mfma_f32_16x16x32_bf16 v[184:187], v[244:247], v[252:255], v[184:187]
    ds_read_b64_tr_b16 v[240:241], v4 offset:18432
    v_mfma_f32_16x16x32_bf16 v[80:83], v[244:247], v[220:223], v[80:83]
    ds_read_b64_tr_b16 v[242:243], v4 offset:18944
    v_mfma_f32_16x16x32_bf16 v[84:87], v[244:247], v[224:227], v[84:87]
    v_lshl_add_u32 v8, v0, 3, s59
    v_mfma_f32_16x16x32_bf16 v[88:91], v[244:247], v[228:231], v[88:91]
    v_lshl_add_u32 v211, v9, 3, s59
    v_mfma_f32_16x16x32_bf16 v[92:95], v[244:247], v[232:235], v[92:95]
    v_lshl_add_u32 v14, v0, 2, s59
    s_waitcnt lgkmcnt(4)
    v_mfma_f32_16x16x32_bf16 v[188:191], v[248:251], v[252:255], v[188:191]
    ds_read_b64_tr_b16 v[244:245], v3 offset:19456
    v_mfma_f32_16x16x32_bf16 v[96:99], v[248:251], v[220:223], v[96:99]
    ds_read_b64_tr_b16 v[246:247], v3 offset:19968
    v_mfma_f32_16x16x32_bf16 v[100:103], v[248:251], v[224:227], v[100:103]
    v_lshl_add_u32 v15, v10, 4, s59
    v_mfma_f32_16x16x32_bf16 v[104:107], v[248:251], v[228:231], v[104:107]
    s_mov_b32 exec_lo, 0xffff0000
    s_mov_b32 exec_hi, 0
    ds_write_b32 v209, v200 offset:0
    s_mov_b64 exec, -1
    v_mfma_f32_16x16x32_bf16 v[108:111], v[248:251], v[232:235], v[108:111]
    s_mov_b32 exec_lo, 0x10001
    s_mov_b32 exec_hi, 0x10001
    ds_write_b128 v208, v[176:179] offset:0
    s_mov_b64 exec, -1
    s_waitcnt lgkmcnt(6)
    v_mfma_f32_16x16x32_bf16 v[48:51], v[236:239], v[220:223], v[48:51]
    ds_read_b64_tr_b16 v[248:249], v4 offset:19456
    v_mfma_f32_16x16x32_bf16 v[52:55], v[236:239], v[224:227], v[52:55]
    ds_read_b64_tr_b16 v[250:251], v4 offset:19968
    v_mfma_f32_16x16x32_bf16 v[56:59], v[236:239], v[228:231], v[56:59]
    s_mov_b32 exec_lo, 0x10001
    s_mov_b32 exec_hi, 0x10001
    ds_write_b128 v208, v[180:183] offset:64
    s_mov_b64 exec, -1
    v_mfma_f32_16x16x32_bf16 v[60:63], v[236:239], v[232:235], v[60:63]
    s_mov_b32 exec_lo, 0x10001
    s_mov_b32 exec_hi, 0x10001
    ds_write_b128 v208, v[184:187] offset:256
    s_mov_b64 exec, -1
    s_mov_b32 exec_lo, 0x10001
    s_mov_b32 exec_hi, 0x10001
    ds_write_b128 v208, v[188:191] offset:320
    s_mov_b64 exec, -1
    s_waitcnt lgkmcnt(9)
    v_mfma_f32_16x16x32_bf16 v[64:67], v[240:243], v[220:223], v[64:67]
    s_waitcnt lgkmcnt(0)
    s_barrier
    v_mfma_f32_16x16x32_bf16 v[68:71], v[240:243], v[224:227], v[68:71]
    ds_read_b64_tr_b16 v[236:237], v5 offset:18432
    v_mfma_f32_16x16x32_bf16 v[72:75], v[240:243], v[228:231], v[72:75]
    ds_read_b64_tr_b16 v[238:239], v5 offset:18688
    v_mfma_f32_16x16x32_bf16 v[76:79], v[240:243], v[232:235], v[76:79]
    ds_read_b32 v204, v210
    v_mfma_f32_16x16x32_bf16 v[112:115], v[244:247], v[220:223], v[112:115]
    ds_read_b64_tr_b16 v[240:241], v6 offset:18432
    v_mfma_f32_16x16x32_bf16 v[116:119], v[244:247], v[224:227], v[116:119]
    ds_read_b64_tr_b16 v[242:243], v6 offset:18688
    ds_read2st64_b32 v[206:207], v210 offset0:2 offset1:4
    v_mfma_f32_16x16x32_bf16 v[120:123], v[244:247], v[228:231], v[120:123]
    s_mul_i32 s58, s73, 294912
    s_mul_i32 s59, s50, 9
    v_mfma_f32_16x16x32_bf16 v[124:127], v[244:247], v[232:235], v[124:127]
    s_xor_b32 s61, s64, 1
    s_lshl_b32 s61, s61, 3
    s_add_u32 s61, s61, s59
    s_lshl_b32 s61, s61, 11
    v_mfma_f32_16x16x32_bf16 v[128:131], v[248:251], v[220:223], v[128:131]
    s_add_u32 s40, s58, s61
    s_add_u32 s59, s59, s64
    v_mfma_f32_16x16x32_bf16 v[132:135], v[248:251], v[224:227], v[132:135]
    s_lshl_b32 s61, s52, 2
    s_add_u32 s59, s59, s61
    s_lshl_b32 s59, s59, 11
    s_add_u32 s58, s58, s59
    v_mfma_f32_16x16x32_bf16 v[136:139], v[248:251], v[228:231], v[136:139]
    s_lshl_b32 s59, s51, 11
    s_add_u32 s36, s58, s59
    v_mfma_f32_16x16x32_bf16 v[140:143], v[248:251], v[232:235], v[140:143]
    s_xor_b32 s59, s59, 2048
    s_add_u32 s37, s58, s59
    s_waitcnt lgkmcnt(0)
    v_mfma_f32_16x16x32_bf16 v[192:195], v[236:239], v[252:255], v[192:195]
    v_add_f32 v206, v206, v207
    v_mul_f32 v204, 0xbae38e39, v204
    v_mfma_f32_16x16x32_bf16 v[144:147], v[236:239], v[220:223], v[144:147]
    v_mul_f32 v206, 0x3ae38e39, v206
    v_fma_f32 v206, -v204, v204, v206
    v_max_f32 v206, 0, v206
    v_cvt_pk_bf16_f32 v204, v204, v206
    v_mfma_f32_16x16x32_bf16 v[148:151], v[236:239], v[224:227], v[148:151]
    v_and_b32 v206, 0xffff0000, v204
    v_lshlrev_b32 v204, 16, v204
    v_mfma_f32_16x16x32_bf16 v[152:155], v[236:239], v[228:231], v[152:155]
    v_add_f32 v206, 0x3727c5ac, v206
    v_cvt_pk_bf16_f32 v206, v206, v206
    v_lshlrev_b32 v206, 16, v206
    v_sqrt_f32 v206, v206
    v_mfma_f32_16x16x32_bf16 v[156:159], v[236:239], v[232:235], v[156:159]
    v_cvt_pk_bf16_f32 v206, v206, v206
    v_lshlrev_b32 v206, 16, v206
    v_mfma_f32_16x16x32_bf16 v[196:199], v[240:243], v[252:255], v[196:199]
    v_rcp_f32 v205, v206
    v_mfma_f32_16x16x32_bf16 v[160:163], v[240:243], v[220:223], v[160:163]
    v_mul_f32 v206, 0x3fb8aa3b, v205
    v_mul_f32 v207, v204, v206
    ds_write_b64 v8, v[206:207]
    ds_write2st64_b32 v14, v205, v204 offset0:2 offset1:3
    v_mfma_f32_16x16x32_bf16 v[164:167], v[240:243], v[224:227], v[164:167]
    ds_read_b64 v[212:213], v211 offset:0
    v_mfma_f32_16x16x32_bf16 v[168:171], v[240:243], v[228:231], v[168:171]
    ds_read_b64 v[214:215], v211 offset:128
    ds_read_b64 v[216:217], v211 offset:256
    v_mfma_f32_16x16x32_bf16 v[172:175], v[240:243], v[232:235], v[172:175]
    ds_read_b64 v[218:219], v211 offset:384
    s_lshl_b32 s59, s52, 9
    s_add_u32 s59, s59, 159744
    v_lshl_add_u32 v4, v10, 4, s59
    v_add_u32 v1, s60, v4
    s_xor_b32 s60, s60, 128
    v_add_u32 v2, s60, v4
    s_lshl_b32 s61, s64, 7
    v_add_u32 v5, s61, v1
    v_add_u32 v6, s61, v2
    s_xor_b32 s61, s64, 1
    s_lshl_b32 s61, s61, 10
    s_add_u32 s61, s61, 161024
    v_lshl_add_u32 v11, v10, 4, s61
    s_add_u32 s38, s36, 4096
    s_add_u32 s39, s37, 4096
    v_mov_b32 v244, -0.5
    v_mov_b32 v245, -0.5
    v_mov_b32 v246, -1.0
    v_mov_b32 v247, -1.0
    ds_read_b128 v[220:223], v1 offset:0
    ds_read_b128 v[224:227], v5 offset:1280
    ds_read_b128 v[228:231], v1 offset:64
    ds_read_b128 v[232:235], v5 offset:1344
    s_waitcnt lgkmcnt(4)
    v_lshrrev_b32 v236, 2, v9
    v_lshlrev_b32 v236, 4, v236
    v_and_b32 v237, 3, v9
    v_lshl_add_u32 v236, v237, 1, v236
    s_lshl_b32 s76, s51, 7
    s_add_u32 s76, s76, 122880
    v_add_u32 v236, s76, v236
    v_mul_f32 v238, 0x3f317218, v212
    v_mul_f32 v200, v200, v238
    v_mul_f32 v201, v201, v238
    v_mul_f32 v202, v202, v238
    v_mul_f32 v203, v203, v238
    v_cvt_pk_bf16_f32 v200, v200, v201
    v_cvt_pk_bf16_f32 v201, v202, v203
    s_barrier
    s_mov_b64 exec, 0xffff
    ds_write_b16 v236, v200 offset:8192
    ds_write_b16_d16_hi v236, v200 offset:8448
    ds_write_b16 v236, v201 offset:8704
    ds_write_b16_d16_hi v236, v201 offset:8960
    s_mov_b64 exec, -1
    s_mul_i32 s59, s51, 0x6000
    s_add_u32 s59, s59, 0
    s_cmp_eq_u32 s3, 0
    s_cselect_b32 s59, 132096, s59
    v_add_u32 v12, s59, v7
    s_waitcnt lgkmcnt(6)
.p2align 3
    v_pk_fma_f32 v[236:237], v[220:221], v[212:213], v[224:225] op_sel:[0,1,0] op_sel_hi:[1,1,1]
    v_pk_fma_f32 v[238:239], v[222:223], v[212:213], v[226:227] op_sel:[0,1,0] op_sel_hi:[1,1,1]
    v_pk_fma_f32 v[16:17], v[16:17], v[212:213], v[236:237] op_sel_hi:[1,0,1]
    v_pk_fma_f32 v[18:19], v[18:19], v[212:213], v[238:239] op_sel_hi:[1,0,1]
    v_pk_fma_f32 v[240:241], v[220:221], v[214:215], v[224:225] op_sel:[0,1,0] op_sel_hi:[1,1,1]
    v_pk_fma_f32 v[242:243], v[222:223], v[214:215], v[226:227] op_sel:[0,1,0] op_sel_hi:[1,1,1]
    v_pk_fma_f32 v[20:21], v[20:21], v[214:215], v[240:241] op_sel_hi:[1,0,1]
    v_pk_fma_f32 v[22:23], v[22:23], v[214:215], v[242:243] op_sel_hi:[1,0,1]
    v_pk_fma_f32 v[236:237], v[220:221], v[216:217], v[224:225] op_sel:[0,1,0] op_sel_hi:[1,1,1]
    v_pk_fma_f32 v[238:239], v[222:223], v[216:217], v[226:227] op_sel:[0,1,0] op_sel_hi:[1,1,1]
    v_pk_fma_f32 v[24:25], v[24:25], v[216:217], v[236:237] op_sel_hi:[1,0,1]
    v_pk_fma_f32 v[26:27], v[26:27], v[216:217], v[238:239] op_sel_hi:[1,0,1]
    v_pk_fma_f32 v[240:241], v[220:221], v[218:219], v[224:225] op_sel:[0,1,0] op_sel_hi:[1,1,1]
    v_pk_fma_f32 v[242:243], v[222:223], v[218:219], v[226:227] op_sel:[0,1,0] op_sel_hi:[1,1,1]
    v_pk_fma_f32 v[28:29], v[28:29], v[218:219], v[240:241] op_sel_hi:[1,0,1]
    v_pk_fma_f32 v[30:31], v[30:31], v[218:219], v[242:243] op_sel_hi:[1,0,1]
    ds_read_b128 v[220:223], v2 offset:0
    ds_read_b128 v[224:227], v6 offset:1280
    s_waitcnt lgkmcnt(6)
.p2align 3
    v_pk_fma_f32 v[236:237], v[228:229], v[212:213], v[232:233] op_sel:[0,1,0] op_sel_hi:[1,1,1]
    v_pk_fma_f32 v[238:239], v[230:231], v[212:213], v[234:235] op_sel:[0,1,0] op_sel_hi:[1,1,1]
    v_pk_fma_f32 v[32:33], v[32:33], v[212:213], v[236:237] op_sel_hi:[1,0,1]
    v_pk_fma_f32 v[34:35], v[34:35], v[212:213], v[238:239] op_sel_hi:[1,0,1]
    v_pk_fma_f32 v[240:241], v[228:229], v[214:215], v[232:233] op_sel:[0,1,0] op_sel_hi:[1,1,1]
    v_pk_fma_f32 v[242:243], v[230:231], v[214:215], v[234:235] op_sel:[0,1,0] op_sel_hi:[1,1,1]
    v_pk_fma_f32 v[36:37], v[36:37], v[214:215], v[240:241] op_sel_hi:[1,0,1]
    v_pk_fma_f32 v[38:39], v[38:39], v[214:215], v[242:243] op_sel_hi:[1,0,1]
    v_pk_fma_f32 v[236:237], v[228:229], v[216:217], v[232:233] op_sel:[0,1,0] op_sel_hi:[1,1,1]
    v_pk_fma_f32 v[238:239], v[230:231], v[216:217], v[234:235] op_sel:[0,1,0] op_sel_hi:[1,1,1]
    v_pk_fma_f32 v[40:41], v[40:41], v[216:217], v[236:237] op_sel_hi:[1,0,1]
    v_pk_fma_f32 v[42:43], v[42:43], v[216:217], v[238:239] op_sel_hi:[1,0,1]
    v_pk_fma_f32 v[240:241], v[228:229], v[218:219], v[232:233] op_sel:[0,1,0] op_sel_hi:[1,1,1]
    v_pk_fma_f32 v[242:243], v[230:231], v[218:219], v[234:235] op_sel:[0,1,0] op_sel_hi:[1,1,1]
    v_pk_fma_f32 v[44:45], v[44:45], v[218:219], v[240:241] op_sel_hi:[1,0,1]
    v_pk_fma_f32 v[46:47], v[46:47], v[218:219], v[242:243] op_sel_hi:[1,0,1]
    ds_read_b128 v[228:231], v2 offset:64
    ds_read_b128 v[232:235], v6 offset:1344
.p2align 3
    v_exp_f32 v236, v16
    v_exp_f32 v237, v17
    v_exp_f32 v238, v18
    v_exp_f32 v239, v19
    v_exp_f32 v240, v32
    v_exp_f32 v241, v33
    v_exp_f32 v242, v34
    v_exp_f32 v243, v35
    v_pk_fma_f32 v[248:249], v[236:237], v[244:245], v[246:247]
    v_pk_fma_f32 v[250:251], v[238:239], v[244:245], v[246:247]
    v_pk_fma_f32 v[252:253], v[240:241], v[244:245], v[246:247]
    v_pk_fma_f32 v[254:255], v[242:243], v[244:245], v[246:247]
    v_pk_fma_f32 v[236:237], v[236:237], v[248:249], v[246:247]
    v_pk_fma_f32 v[238:239], v[238:239], v[250:251], v[246:247]
    v_pk_fma_f32 v[240:241], v[240:241], v[252:253], v[246:247]
    v_pk_fma_f32 v[242:243], v[242:243], v[254:255], v[246:247]
    v_rcp_f32 v236, v236
    v_rcp_f32 v237, v237
    v_rcp_f32 v238, v238
    v_rcp_f32 v239, v239
    v_rcp_f32 v240, v240
    v_rcp_f32 v241, v241
    v_rcp_f32 v242, v242
    v_rcp_f32 v243, v243
    v_pk_fma_f32 v[16:17], v[16:17], v[236:237], v[16:17]
    v_pk_fma_f32 v[18:19], v[18:19], v[238:239], v[18:19]
    v_pk_fma_f32 v[32:33], v[32:33], v[240:241], v[32:33]
    v_pk_fma_f32 v[34:35], v[34:35], v[242:243], v[34:35]
    v_cvt_pk_bf16_f32 v16, v16, v17
    v_cvt_pk_bf16_f32 v17, v18, v19
    v_cvt_pk_bf16_f32 v18, v32, v33
    v_cvt_pk_bf16_f32 v19, v34, v35
    buffer_store_dwordx4 v[16:19], v7, s[32:35], s36 offen offset:0 sc1
    ds_write_b128 v12, v[16:19] offset:0
.p2align 3
    v_exp_f32 v236, v20
    v_exp_f32 v237, v21
    v_exp_f32 v238, v22
    v_exp_f32 v239, v23
    v_exp_f32 v240, v36
    v_exp_f32 v241, v37
    v_exp_f32 v242, v38
    v_exp_f32 v243, v39
    v_pk_fma_f32 v[248:249], v[236:237], v[244:245], v[246:247]
    v_pk_fma_f32 v[250:251], v[238:239], v[244:245], v[246:247]
    v_pk_fma_f32 v[252:253], v[240:241], v[244:245], v[246:247]
    v_pk_fma_f32 v[254:255], v[242:243], v[244:245], v[246:247]
    v_pk_fma_f32 v[236:237], v[236:237], v[248:249], v[246:247]
    v_pk_fma_f32 v[238:239], v[238:239], v[250:251], v[246:247]
    v_pk_fma_f32 v[240:241], v[240:241], v[252:253], v[246:247]
    v_pk_fma_f32 v[242:243], v[242:243], v[254:255], v[246:247]
    v_rcp_f32 v236, v236
    v_rcp_f32 v237, v237
    v_rcp_f32 v238, v238
    v_rcp_f32 v239, v239
    v_rcp_f32 v240, v240
    v_rcp_f32 v241, v241
    v_rcp_f32 v242, v242
    v_rcp_f32 v243, v243
    v_pk_fma_f32 v[20:21], v[20:21], v[236:237], v[20:21]
    v_pk_fma_f32 v[22:23], v[22:23], v[238:239], v[22:23]
    v_pk_fma_f32 v[36:37], v[36:37], v[240:241], v[36:37]
    v_pk_fma_f32 v[38:39], v[38:39], v[242:243], v[38:39]
    v_cvt_pk_bf16_f32 v20, v20, v21
    v_cvt_pk_bf16_f32 v21, v22, v23
    v_cvt_pk_bf16_f32 v22, v36, v37
    v_cvt_pk_bf16_f32 v23, v38, v39
    buffer_store_dwordx4 v[20:23], v7, s[32:35], s36 offen offset:1024 sc1
    ds_write_b128 v12, v[20:23] offset:1024
    s_waitcnt lgkmcnt(6)
    s_barrier
.p2align 3
    v_exp_f32 v236, v24
    v_exp_f32 v237, v25
    v_exp_f32 v238, v26
    v_exp_f32 v239, v27
    v_exp_f32 v240, v40
    v_exp_f32 v241, v41
    v_exp_f32 v242, v42
    v_exp_f32 v243, v43
    v_pk_fma_f32 v[248:249], v[236:237], v[244:245], v[246:247]
    v_pk_fma_f32 v[250:251], v[238:239], v[244:245], v[246:247]
    v_pk_fma_f32 v[252:253], v[240:241], v[244:245], v[246:247]
    v_pk_fma_f32 v[254:255], v[242:243], v[244:245], v[246:247]
    v_pk_fma_f32 v[236:237], v[236:237], v[248:249], v[246:247]
    v_pk_fma_f32 v[238:239], v[238:239], v[250:251], v[246:247]
    v_pk_fma_f32 v[240:241], v[240:241], v[252:253], v[246:247]
    v_pk_fma_f32 v[242:243], v[242:243], v[254:255], v[246:247]
    v_rcp_f32 v236, v236
    v_rcp_f32 v237, v237
    v_rcp_f32 v238, v238
    v_rcp_f32 v239, v239
    v_rcp_f32 v240, v240
    v_rcp_f32 v241, v241
    v_rcp_f32 v242, v242
    v_rcp_f32 v243, v243
    v_pk_fma_f32 v[24:25], v[24:25], v[236:237], v[24:25]
    v_pk_fma_f32 v[26:27], v[26:27], v[238:239], v[26:27]
    v_pk_fma_f32 v[40:41], v[40:41], v[240:241], v[40:41]
    v_pk_fma_f32 v[42:43], v[42:43], v[242:243], v[42:43]
    v_cvt_pk_bf16_f32 v24, v24, v25
    v_cvt_pk_bf16_f32 v25, v26, v27
    v_cvt_pk_bf16_f32 v26, v40, v41
    v_cvt_pk_bf16_f32 v27, v42, v43
    s_add_u32 s36, s36, 294912
    buffer_store_dwordx4 v[24:27], v7, s[32:35], s36 offen offset:0 sc1
    ds_write_b128 v12, v[24:27] offset:2048
.p2align 3
    v_exp_f32 v236, v28
    v_exp_f32 v237, v29
    v_exp_f32 v238, v30
    v_exp_f32 v239, v31
    v_exp_f32 v240, v44
    v_exp_f32 v241, v45
    v_exp_f32 v242, v46
    v_exp_f32 v243, v47
    v_pk_fma_f32 v[248:249], v[236:237], v[244:245], v[246:247]
    v_pk_fma_f32 v[250:251], v[238:239], v[244:245], v[246:247]
    v_pk_fma_f32 v[252:253], v[240:241], v[244:245], v[246:247]
    v_pk_fma_f32 v[254:255], v[242:243], v[244:245], v[246:247]
    v_pk_fma_f32 v[236:237], v[236:237], v[248:249], v[246:247]
    v_pk_fma_f32 v[238:239], v[238:239], v[250:251], v[246:247]
    v_pk_fma_f32 v[240:241], v[240:241], v[252:253], v[246:247]
    v_pk_fma_f32 v[242:243], v[242:243], v[254:255], v[246:247]
    v_rcp_f32 v236, v236
    v_rcp_f32 v237, v237
    v_rcp_f32 v238, v238
    v_rcp_f32 v239, v239
    v_rcp_f32 v240, v240
    v_rcp_f32 v241, v241
    v_rcp_f32 v242, v242
    v_rcp_f32 v243, v243
    v_pk_fma_f32 v[28:29], v[28:29], v[236:237], v[28:29]
    v_pk_fma_f32 v[30:31], v[30:31], v[238:239], v[30:31]
    v_pk_fma_f32 v[44:45], v[44:45], v[240:241], v[44:45]
    v_pk_fma_f32 v[46:47], v[46:47], v[242:243], v[46:47]
    v_cvt_pk_bf16_f32 v28, v28, v29
    v_cvt_pk_bf16_f32 v29, v30, v31
    v_cvt_pk_bf16_f32 v30, v44, v45
    v_cvt_pk_bf16_f32 v31, v46, v47
    buffer_store_dwordx4 v[28:31], v7, s[32:35], s36 offen offset:1024 sc1
    ds_write_b128 v12, v[28:31] offset:3072
    s_mul_i32 s59, s51, 0xffffc000
    s_add_u32 s59, s59, 20480
    s_cmp_eq_u32 s3, 0
    s_cselect_b32 s59, 132096, s59
    v_add_u32 v12, s59, v7
    s_waitcnt lgkmcnt(6)
.p2align 3
    v_pk_fma_f32 v[236:237], v[220:221], v[212:213], v[224:225] op_sel:[0,1,0] op_sel_hi:[1,1,1]
    v_pk_fma_f32 v[238:239], v[222:223], v[212:213], v[226:227] op_sel:[0,1,0] op_sel_hi:[1,1,1]
    v_pk_fma_f32 v[48:49], v[48:49], v[212:213], v[236:237] op_sel_hi:[1,0,1]
    v_pk_fma_f32 v[50:51], v[50:51], v[212:213], v[238:239] op_sel_hi:[1,0,1]
    v_pk_fma_f32 v[240:241], v[220:221], v[214:215], v[224:225] op_sel:[0,1,0] op_sel_hi:[1,1,1]
    v_pk_fma_f32 v[242:243], v[222:223], v[214:215], v[226:227] op_sel:[0,1,0] op_sel_hi:[1,1,1]
    v_pk_fma_f32 v[52:53], v[52:53], v[214:215], v[240:241] op_sel_hi:[1,0,1]
    v_pk_fma_f32 v[54:55], v[54:55], v[214:215], v[242:243] op_sel_hi:[1,0,1]
    v_pk_fma_f32 v[236:237], v[220:221], v[216:217], v[224:225] op_sel:[0,1,0] op_sel_hi:[1,1,1]
    v_pk_fma_f32 v[238:239], v[222:223], v[216:217], v[226:227] op_sel:[0,1,0] op_sel_hi:[1,1,1]
    v_pk_fma_f32 v[56:57], v[56:57], v[216:217], v[236:237] op_sel_hi:[1,0,1]
    v_pk_fma_f32 v[58:59], v[58:59], v[216:217], v[238:239] op_sel_hi:[1,0,1]
    v_pk_fma_f32 v[240:241], v[220:221], v[218:219], v[224:225] op_sel:[0,1,0] op_sel_hi:[1,1,1]
    v_pk_fma_f32 v[242:243], v[222:223], v[218:219], v[226:227] op_sel:[0,1,0] op_sel_hi:[1,1,1]
    v_pk_fma_f32 v[60:61], v[60:61], v[218:219], v[240:241] op_sel_hi:[1,0,1]
    v_pk_fma_f32 v[62:63], v[62:63], v[218:219], v[242:243] op_sel_hi:[1,0,1]
    ds_read_b128 v[220:223], v1 offset:256
    ds_read_b128 v[224:227], v5 offset:1536
    s_waitcnt lgkmcnt(6)
.p2align 3
    v_pk_fma_f32 v[236:237], v[228:229], v[212:213], v[232:233] op_sel:[0,1,0] op_sel_hi:[1,1,1]
    v_pk_fma_f32 v[238:239], v[230:231], v[212:213], v[234:235] op_sel:[0,1,0] op_sel_hi:[1,1,1]
    v_pk_fma_f32 v[64:65], v[64:65], v[212:213], v[236:237] op_sel_hi:[1,0,1]
    v_pk_fma_f32 v[66:67], v[66:67], v[212:213], v[238:239] op_sel_hi:[1,0,1]
    v_pk_fma_f32 v[240:241], v[228:229], v[214:215], v[232:233] op_sel:[0,1,0] op_sel_hi:[1,1,1]
    v_pk_fma_f32 v[242:243], v[230:231], v[214:215], v[234:235] op_sel:[0,1,0] op_sel_hi:[1,1,1]
    v_pk_fma_f32 v[68:69], v[68:69], v[214:215], v[240:241] op_sel_hi:[1,0,1]
    v_pk_fma_f32 v[70:71], v[70:71], v[214:215], v[242:243] op_sel_hi:[1,0,1]
    v_pk_fma_f32 v[236:237], v[228:229], v[216:217], v[232:233] op_sel:[0,1,0] op_sel_hi:[1,1,1]
    v_pk_fma_f32 v[238:239], v[230:231], v[216:217], v[234:235] op_sel:[0,1,0] op_sel_hi:[1,1,1]
    v_pk_fma_f32 v[72:73], v[72:73], v[216:217], v[236:237] op_sel_hi:[1,0,1]
    v_pk_fma_f32 v[74:75], v[74:75], v[216:217], v[238:239] op_sel_hi:[1,0,1]
    v_pk_fma_f32 v[240:241], v[228:229], v[218:219], v[232:233] op_sel:[0,1,0] op_sel_hi:[1,1,1]
    v_pk_fma_f32 v[242:243], v[230:231], v[218:219], v[234:235] op_sel:[0,1,0] op_sel_hi:[1,1,1]
    v_pk_fma_f32 v[76:77], v[76:77], v[218:219], v[240:241] op_sel_hi:[1,0,1]
    v_pk_fma_f32 v[78:79], v[78:79], v[218:219], v[242:243] op_sel_hi:[1,0,1]
    ds_read_b128 v[228:231], v1 offset:320
    ds_read_b128 v[232:235], v5 offset:1600
.p2align 3
    v_exp_f32 v236, v48
    v_exp_f32 v237, v49
    v_exp_f32 v238, v50
    v_exp_f32 v239, v51
    v_exp_f32 v240, v64
    v_exp_f32 v241, v65
    v_exp_f32 v242, v66
    v_exp_f32 v243, v67
    v_pk_fma_f32 v[248:249], v[236:237], v[244:245], v[246:247]
    v_pk_fma_f32 v[250:251], v[238:239], v[244:245], v[246:247]
    v_pk_fma_f32 v[252:253], v[240:241], v[244:245], v[246:247]
    v_pk_fma_f32 v[254:255], v[242:243], v[244:245], v[246:247]
    v_pk_fma_f32 v[236:237], v[236:237], v[248:249], v[246:247]
    v_pk_fma_f32 v[238:239], v[238:239], v[250:251], v[246:247]
    v_pk_fma_f32 v[240:241], v[240:241], v[252:253], v[246:247]
    v_pk_fma_f32 v[242:243], v[242:243], v[254:255], v[246:247]
    v_rcp_f32 v236, v236
    v_rcp_f32 v237, v237
    v_rcp_f32 v238, v238
    v_rcp_f32 v239, v239
    v_rcp_f32 v240, v240
    v_rcp_f32 v241, v241
    v_rcp_f32 v242, v242
    v_rcp_f32 v243, v243
    v_pk_fma_f32 v[48:49], v[48:49], v[236:237], v[48:49]
    v_pk_fma_f32 v[50:51], v[50:51], v[238:239], v[50:51]
    v_pk_fma_f32 v[64:65], v[64:65], v[240:241], v[64:65]
    v_pk_fma_f32 v[66:67], v[66:67], v[242:243], v[66:67]
    v_cvt_pk_bf16_f32 v48, v48, v49
    v_cvt_pk_bf16_f32 v49, v50, v51
    v_cvt_pk_bf16_f32 v50, v64, v65
    v_cvt_pk_bf16_f32 v51, v66, v67
    buffer_store_dwordx4 v[48:51], v7, s[32:35], s37 offen offset:0 sc1
    ds_write_b128 v12, v[48:51] offset:0
.p2align 3
    v_exp_f32 v236, v52
    v_exp_f32 v237, v53
    v_exp_f32 v238, v54
    v_exp_f32 v239, v55
    v_exp_f32 v240, v68
    v_exp_f32 v241, v69
    v_exp_f32 v242, v70
    v_exp_f32 v243, v71
    v_pk_fma_f32 v[248:249], v[236:237], v[244:245], v[246:247]
    v_pk_fma_f32 v[250:251], v[238:239], v[244:245], v[246:247]
    v_pk_fma_f32 v[252:253], v[240:241], v[244:245], v[246:247]
    v_pk_fma_f32 v[254:255], v[242:243], v[244:245], v[246:247]
    v_pk_fma_f32 v[236:237], v[236:237], v[248:249], v[246:247]
    v_pk_fma_f32 v[238:239], v[238:239], v[250:251], v[246:247]
    v_pk_fma_f32 v[240:241], v[240:241], v[252:253], v[246:247]
    v_pk_fma_f32 v[242:243], v[242:243], v[254:255], v[246:247]
    v_rcp_f32 v236, v236
    v_rcp_f32 v237, v237
    v_rcp_f32 v238, v238
    v_rcp_f32 v239, v239
    v_rcp_f32 v240, v240
    v_rcp_f32 v241, v241
    v_rcp_f32 v242, v242
    v_rcp_f32 v243, v243
    v_pk_fma_f32 v[52:53], v[52:53], v[236:237], v[52:53]
    v_pk_fma_f32 v[54:55], v[54:55], v[238:239], v[54:55]
    v_pk_fma_f32 v[68:69], v[68:69], v[240:241], v[68:69]
    v_pk_fma_f32 v[70:71], v[70:71], v[242:243], v[70:71]
    v_cvt_pk_bf16_f32 v52, v52, v53
    v_cvt_pk_bf16_f32 v53, v54, v55
    v_cvt_pk_bf16_f32 v54, v68, v69
    v_cvt_pk_bf16_f32 v55, v70, v71
    buffer_store_dwordx4 v[52:55], v7, s[32:35], s37 offen offset:1024 sc1
    ds_write_b128 v12, v[52:55] offset:1024
.p2align 3
    v_exp_f32 v236, v56
    v_exp_f32 v237, v57
    v_exp_f32 v238, v58
    v_exp_f32 v239, v59
    v_exp_f32 v240, v72
    v_exp_f32 v241, v73
    v_exp_f32 v242, v74
    v_exp_f32 v243, v75
    v_pk_fma_f32 v[248:249], v[236:237], v[244:245], v[246:247]
    v_pk_fma_f32 v[250:251], v[238:239], v[244:245], v[246:247]
    v_pk_fma_f32 v[252:253], v[240:241], v[244:245], v[246:247]
    v_pk_fma_f32 v[254:255], v[242:243], v[244:245], v[246:247]
    v_pk_fma_f32 v[236:237], v[236:237], v[248:249], v[246:247]
    v_pk_fma_f32 v[238:239], v[238:239], v[250:251], v[246:247]
    v_pk_fma_f32 v[240:241], v[240:241], v[252:253], v[246:247]
    v_pk_fma_f32 v[242:243], v[242:243], v[254:255], v[246:247]
    v_rcp_f32 v236, v236
    v_rcp_f32 v237, v237
    v_rcp_f32 v238, v238
    v_rcp_f32 v239, v239
    v_rcp_f32 v240, v240
    v_rcp_f32 v241, v241
    v_rcp_f32 v242, v242
    v_rcp_f32 v243, v243
    v_pk_fma_f32 v[56:57], v[56:57], v[236:237], v[56:57]
    v_pk_fma_f32 v[58:59], v[58:59], v[238:239], v[58:59]
    v_pk_fma_f32 v[72:73], v[72:73], v[240:241], v[72:73]
    v_pk_fma_f32 v[74:75], v[74:75], v[242:243], v[74:75]
    v_cvt_pk_bf16_f32 v56, v56, v57
    v_cvt_pk_bf16_f32 v57, v58, v59
    v_cvt_pk_bf16_f32 v58, v72, v73
    v_cvt_pk_bf16_f32 v59, v74, v75
    s_add_u32 s37, s37, 294912
    buffer_store_dwordx4 v[56:59], v7, s[32:35], s37 offen offset:0 sc1
    ds_write_b128 v12, v[56:59] offset:2048
.p2align 3
    v_exp_f32 v236, v60
    v_exp_f32 v237, v61
    v_exp_f32 v238, v62
    v_exp_f32 v239, v63
    v_exp_f32 v240, v76
    v_exp_f32 v241, v77
    v_exp_f32 v242, v78
    v_exp_f32 v243, v79
    v_pk_fma_f32 v[248:249], v[236:237], v[244:245], v[246:247]
    v_pk_fma_f32 v[250:251], v[238:239], v[244:245], v[246:247]
    v_pk_fma_f32 v[252:253], v[240:241], v[244:245], v[246:247]
    v_pk_fma_f32 v[254:255], v[242:243], v[244:245], v[246:247]
    v_pk_fma_f32 v[236:237], v[236:237], v[248:249], v[246:247]
    v_pk_fma_f32 v[238:239], v[238:239], v[250:251], v[246:247]
    v_pk_fma_f32 v[240:241], v[240:241], v[252:253], v[246:247]
    v_pk_fma_f32 v[242:243], v[242:243], v[254:255], v[246:247]
    v_rcp_f32 v236, v236
    v_rcp_f32 v237, v237
    v_rcp_f32 v238, v238
    v_rcp_f32 v239, v239
    v_rcp_f32 v240, v240
    v_rcp_f32 v241, v241
    v_rcp_f32 v242, v242
    v_rcp_f32 v243, v243
    v_pk_fma_f32 v[60:61], v[60:61], v[236:237], v[60:61]
    v_pk_fma_f32 v[62:63], v[62:63], v[238:239], v[62:63]
    v_pk_fma_f32 v[76:77], v[76:77], v[240:241], v[76:77]
    v_pk_fma_f32 v[78:79], v[78:79], v[242:243], v[78:79]
    v_cvt_pk_bf16_f32 v60, v60, v61
    v_cvt_pk_bf16_f32 v61, v62, v63
    v_cvt_pk_bf16_f32 v62, v76, v77
    v_cvt_pk_bf16_f32 v63, v78, v79
    buffer_store_dwordx4 v[60:63], v7, s[32:35], s37 offen offset:1024 sc1
    ds_write_b128 v12, v[60:63] offset:3072
    s_mul_i32 s59, s51, 0x6000
    s_add_u32 s59, s59, 40960
    s_cmp_eq_u32 s3, 0
    s_cselect_b32 s59, 132096, s59
    v_add_u32 v12, s59, v7
    s_waitcnt lgkmcnt(6)
.p2align 3
    v_pk_fma_f32 v[236:237], v[220:221], v[212:213], v[224:225] op_sel:[0,1,0] op_sel_hi:[1,1,1]
    v_pk_fma_f32 v[238:239], v[222:223], v[212:213], v[226:227] op_sel:[0,1,0] op_sel_hi:[1,1,1]
    v_pk_fma_f32 v[80:81], v[80:81], v[212:213], v[236:237] op_sel_hi:[1,0,1]
    v_pk_fma_f32 v[82:83], v[82:83], v[212:213], v[238:239] op_sel_hi:[1,0,1]
    v_pk_fma_f32 v[240:241], v[220:221], v[214:215], v[224:225] op_sel:[0,1,0] op_sel_hi:[1,1,1]
    v_pk_fma_f32 v[242:243], v[222:223], v[214:215], v[226:227] op_sel:[0,1,0] op_sel_hi:[1,1,1]
    v_pk_fma_f32 v[84:85], v[84:85], v[214:215], v[240:241] op_sel_hi:[1,0,1]
    v_pk_fma_f32 v[86:87], v[86:87], v[214:215], v[242:243] op_sel_hi:[1,0,1]
    v_pk_fma_f32 v[236:237], v[220:221], v[216:217], v[224:225] op_sel:[0,1,0] op_sel_hi:[1,1,1]
    v_pk_fma_f32 v[238:239], v[222:223], v[216:217], v[226:227] op_sel:[0,1,0] op_sel_hi:[1,1,1]
    v_pk_fma_f32 v[88:89], v[88:89], v[216:217], v[236:237] op_sel_hi:[1,0,1]
    v_pk_fma_f32 v[90:91], v[90:91], v[216:217], v[238:239] op_sel_hi:[1,0,1]
    v_pk_fma_f32 v[240:241], v[220:221], v[218:219], v[224:225] op_sel:[0,1,0] op_sel_hi:[1,1,1]
    v_pk_fma_f32 v[242:243], v[222:223], v[218:219], v[226:227] op_sel:[0,1,0] op_sel_hi:[1,1,1]
    v_pk_fma_f32 v[92:93], v[92:93], v[218:219], v[240:241] op_sel_hi:[1,0,1]
    v_pk_fma_f32 v[94:95], v[94:95], v[218:219], v[242:243] op_sel_hi:[1,0,1]
    ds_read_b128 v[220:223], v2 offset:256
    ds_read_b128 v[224:227], v6 offset:1536
    s_waitcnt lgkmcnt(6)
.p2align 3
    v_pk_fma_f32 v[236:237], v[228:229], v[212:213], v[232:233] op_sel:[0,1,0] op_sel_hi:[1,1,1]
    v_pk_fma_f32 v[238:239], v[230:231], v[212:213], v[234:235] op_sel:[0,1,0] op_sel_hi:[1,1,1]
    v_pk_fma_f32 v[96:97], v[96:97], v[212:213], v[236:237] op_sel_hi:[1,0,1]
    v_pk_fma_f32 v[98:99], v[98:99], v[212:213], v[238:239] op_sel_hi:[1,0,1]
    v_pk_fma_f32 v[240:241], v[228:229], v[214:215], v[232:233] op_sel:[0,1,0] op_sel_hi:[1,1,1]
    v_pk_fma_f32 v[242:243], v[230:231], v[214:215], v[234:235] op_sel:[0,1,0] op_sel_hi:[1,1,1]
    v_pk_fma_f32 v[100:101], v[100:101], v[214:215], v[240:241] op_sel_hi:[1,0,1]
    v_pk_fma_f32 v[102:103], v[102:103], v[214:215], v[242:243] op_sel_hi:[1,0,1]
    v_pk_fma_f32 v[236:237], v[228:229], v[216:217], v[232:233] op_sel:[0,1,0] op_sel_hi:[1,1,1]
    v_pk_fma_f32 v[238:239], v[230:231], v[216:217], v[234:235] op_sel:[0,1,0] op_sel_hi:[1,1,1]
    v_pk_fma_f32 v[104:105], v[104:105], v[216:217], v[236:237] op_sel_hi:[1,0,1]
    v_pk_fma_f32 v[106:107], v[106:107], v[216:217], v[238:239] op_sel_hi:[1,0,1]
    v_pk_fma_f32 v[240:241], v[228:229], v[218:219], v[232:233] op_sel:[0,1,0] op_sel_hi:[1,1,1]
    v_pk_fma_f32 v[242:243], v[230:231], v[218:219], v[234:235] op_sel:[0,1,0] op_sel_hi:[1,1,1]
    v_pk_fma_f32 v[108:109], v[108:109], v[218:219], v[240:241] op_sel_hi:[1,0,1]
    v_pk_fma_f32 v[110:111], v[110:111], v[218:219], v[242:243] op_sel_hi:[1,0,1]
    ds_read_b128 v[228:231], v2 offset:320
    ds_read_b128 v[232:235], v6 offset:1600
.p2align 3
    v_exp_f32 v236, v80
    v_exp_f32 v237, v81
    v_exp_f32 v238, v82
    v_exp_f32 v239, v83
    v_exp_f32 v240, v96
    v_exp_f32 v241, v97
    v_exp_f32 v242, v98
    v_exp_f32 v243, v99
    v_pk_fma_f32 v[248:249], v[236:237], v[244:245], v[246:247]
    v_pk_fma_f32 v[250:251], v[238:239], v[244:245], v[246:247]
    v_pk_fma_f32 v[252:253], v[240:241], v[244:245], v[246:247]
    v_pk_fma_f32 v[254:255], v[242:243], v[244:245], v[246:247]
    v_pk_fma_f32 v[236:237], v[236:237], v[248:249], v[246:247]
    v_pk_fma_f32 v[238:239], v[238:239], v[250:251], v[246:247]
    v_pk_fma_f32 v[240:241], v[240:241], v[252:253], v[246:247]
    v_pk_fma_f32 v[242:243], v[242:243], v[254:255], v[246:247]
    v_rcp_f32 v236, v236
    v_rcp_f32 v237, v237
    v_rcp_f32 v238, v238
    v_rcp_f32 v239, v239
    v_rcp_f32 v240, v240
    v_rcp_f32 v241, v241
    v_rcp_f32 v242, v242
    v_rcp_f32 v243, v243
    v_pk_fma_f32 v[80:81], v[80:81], v[236:237], v[80:81]
    v_pk_fma_f32 v[82:83], v[82:83], v[238:239], v[82:83]
    v_pk_fma_f32 v[96:97], v[96:97], v[240:241], v[96:97]
    v_pk_fma_f32 v[98:99], v[98:99], v[242:243], v[98:99]
    v_cvt_pk_bf16_f32 v80, v80, v81
    v_cvt_pk_bf16_f32 v81, v82, v83
    v_cvt_pk_bf16_f32 v82, v96, v97
    v_cvt_pk_bf16_f32 v83, v98, v99
    buffer_store_dwordx4 v[80:83], v7, s[32:35], s38 offen offset:0 sc1
    ds_write_b128 v12, v[80:83] offset:0
.p2align 3
    v_exp_f32 v236, v84
    v_exp_f32 v237, v85
    v_exp_f32 v238, v86
    v_exp_f32 v239, v87
    v_exp_f32 v240, v100
    v_exp_f32 v241, v101
    v_exp_f32 v242, v102
    v_exp_f32 v243, v103
    v_pk_fma_f32 v[248:249], v[236:237], v[244:245], v[246:247]
    v_pk_fma_f32 v[250:251], v[238:239], v[244:245], v[246:247]
    v_pk_fma_f32 v[252:253], v[240:241], v[244:245], v[246:247]
    v_pk_fma_f32 v[254:255], v[242:243], v[244:245], v[246:247]
    v_pk_fma_f32 v[236:237], v[236:237], v[248:249], v[246:247]
    v_pk_fma_f32 v[238:239], v[238:239], v[250:251], v[246:247]
    v_pk_fma_f32 v[240:241], v[240:241], v[252:253], v[246:247]
    v_pk_fma_f32 v[242:243], v[242:243], v[254:255], v[246:247]
    v_rcp_f32 v236, v236
    v_rcp_f32 v237, v237
    v_rcp_f32 v238, v238
    v_rcp_f32 v239, v239
    v_rcp_f32 v240, v240
    v_rcp_f32 v241, v241
    v_rcp_f32 v242, v242
    v_rcp_f32 v243, v243
    v_pk_fma_f32 v[84:85], v[84:85], v[236:237], v[84:85]
    v_pk_fma_f32 v[86:87], v[86:87], v[238:239], v[86:87]
    v_pk_fma_f32 v[100:101], v[100:101], v[240:241], v[100:101]
    v_pk_fma_f32 v[102:103], v[102:103], v[242:243], v[102:103]
    v_cvt_pk_bf16_f32 v84, v84, v85
    v_cvt_pk_bf16_f32 v85, v86, v87
    v_cvt_pk_bf16_f32 v86, v100, v101
    v_cvt_pk_bf16_f32 v87, v102, v103
    buffer_store_dwordx4 v[84:87], v7, s[32:35], s38 offen offset:1024 sc1
    ds_write_b128 v12, v[84:87] offset:1024
.p2align 3
    v_exp_f32 v236, v88
    v_exp_f32 v237, v89
    v_exp_f32 v238, v90
    v_exp_f32 v239, v91
    v_exp_f32 v240, v104
    v_exp_f32 v241, v105
    v_exp_f32 v242, v106
    v_exp_f32 v243, v107
    v_pk_fma_f32 v[248:249], v[236:237], v[244:245], v[246:247]
    v_pk_fma_f32 v[250:251], v[238:239], v[244:245], v[246:247]
    v_pk_fma_f32 v[252:253], v[240:241], v[244:245], v[246:247]
    v_pk_fma_f32 v[254:255], v[242:243], v[244:245], v[246:247]
    v_pk_fma_f32 v[236:237], v[236:237], v[248:249], v[246:247]
    v_pk_fma_f32 v[238:239], v[238:239], v[250:251], v[246:247]
    v_pk_fma_f32 v[240:241], v[240:241], v[252:253], v[246:247]
    v_pk_fma_f32 v[242:243], v[242:243], v[254:255], v[246:247]
    v_rcp_f32 v236, v236
    v_rcp_f32 v237, v237
    v_rcp_f32 v238, v238
    v_rcp_f32 v239, v239
    v_rcp_f32 v240, v240
    v_rcp_f32 v241, v241
    v_rcp_f32 v242, v242
    v_rcp_f32 v243, v243
    v_pk_fma_f32 v[88:89], v[88:89], v[236:237], v[88:89]
    v_pk_fma_f32 v[90:91], v[90:91], v[238:239], v[90:91]
    v_pk_fma_f32 v[104:105], v[104:105], v[240:241], v[104:105]
    v_pk_fma_f32 v[106:107], v[106:107], v[242:243], v[106:107]
    v_cvt_pk_bf16_f32 v88, v88, v89
    v_cvt_pk_bf16_f32 v89, v90, v91
    v_cvt_pk_bf16_f32 v90, v104, v105
    v_cvt_pk_bf16_f32 v91, v106, v107
    s_add_u32 s38, s38, 294912
    buffer_store_dwordx4 v[88:91], v7, s[32:35], s38 offen offset:0 sc1
    ds_write_b128 v12, v[88:91] offset:2048
.p2align 3
    v_exp_f32 v236, v92
    v_exp_f32 v237, v93
    v_exp_f32 v238, v94
    v_exp_f32 v239, v95
    v_exp_f32 v240, v108
    v_exp_f32 v241, v109
    v_exp_f32 v242, v110
    v_exp_f32 v243, v111
    v_pk_fma_f32 v[248:249], v[236:237], v[244:245], v[246:247]
    v_pk_fma_f32 v[250:251], v[238:239], v[244:245], v[246:247]
    v_pk_fma_f32 v[252:253], v[240:241], v[244:245], v[246:247]
    v_pk_fma_f32 v[254:255], v[242:243], v[244:245], v[246:247]
    v_pk_fma_f32 v[236:237], v[236:237], v[248:249], v[246:247]
    v_pk_fma_f32 v[238:239], v[238:239], v[250:251], v[246:247]
    v_pk_fma_f32 v[240:241], v[240:241], v[252:253], v[246:247]
    v_pk_fma_f32 v[242:243], v[242:243], v[254:255], v[246:247]
    v_rcp_f32 v236, v236
    v_rcp_f32 v237, v237
    v_rcp_f32 v238, v238
    v_rcp_f32 v239, v239
    v_rcp_f32 v240, v240
    v_rcp_f32 v241, v241
    v_rcp_f32 v242, v242
    v_rcp_f32 v243, v243
    v_pk_fma_f32 v[92:93], v[92:93], v[236:237], v[92:93]
    v_pk_fma_f32 v[94:95], v[94:95], v[238:239], v[94:95]
    v_pk_fma_f32 v[108:109], v[108:109], v[240:241], v[108:109]
    v_pk_fma_f32 v[110:111], v[110:111], v[242:243], v[110:111]
    v_cvt_pk_bf16_f32 v92, v92, v93
    v_cvt_pk_bf16_f32 v93, v94, v95
    v_cvt_pk_bf16_f32 v94, v108, v109
    v_cvt_pk_bf16_f32 v95, v110, v111
    buffer_store_dwordx4 v[92:95], v7, s[32:35], s38 offen offset:1024 sc1
    ds_write_b128 v12, v[92:95] offset:3072
    s_mul_i32 s59, s51, 0xffffc000
    s_add_u32 s59, s59, 61440
    s_cmp_eq_u32 s3, 0
    s_cselect_b32 s59, 132096, s59
    v_add_u32 v12, s59, v7
    s_waitcnt lgkmcnt(6)
.p2align 3
    v_pk_fma_f32 v[236:237], v[220:221], v[212:213], v[224:225] op_sel:[0,1,0] op_sel_hi:[1,1,1]
    v_pk_fma_f32 v[238:239], v[222:223], v[212:213], v[226:227] op_sel:[0,1,0] op_sel_hi:[1,1,1]
    v_pk_fma_f32 v[112:113], v[112:113], v[212:213], v[236:237] op_sel_hi:[1,0,1]
    v_pk_fma_f32 v[114:115], v[114:115], v[212:213], v[238:239] op_sel_hi:[1,0,1]
    v_pk_fma_f32 v[240:241], v[220:221], v[214:215], v[224:225] op_sel:[0,1,0] op_sel_hi:[1,1,1]
    v_pk_fma_f32 v[242:243], v[222:223], v[214:215], v[226:227] op_sel:[0,1,0] op_sel_hi:[1,1,1]
    v_pk_fma_f32 v[116:117], v[116:117], v[214:215], v[240:241] op_sel_hi:[1,0,1]
    v_pk_fma_f32 v[118:119], v[118:119], v[214:215], v[242:243] op_sel_hi:[1,0,1]
    v_pk_fma_f32 v[236:237], v[220:221], v[216:217], v[224:225] op_sel:[0,1,0] op_sel_hi:[1,1,1]
    v_pk_fma_f32 v[238:239], v[222:223], v[216:217], v[226:227] op_sel:[0,1,0] op_sel_hi:[1,1,1]
    v_pk_fma_f32 v[120:121], v[120:121], v[216:217], v[236:237] op_sel_hi:[1,0,1]
    v_pk_fma_f32 v[122:123], v[122:123], v[216:217], v[238:239] op_sel_hi:[1,0,1]
    v_pk_fma_f32 v[240:241], v[220:221], v[218:219], v[224:225] op_sel:[0,1,0] op_sel_hi:[1,1,1]
    v_pk_fma_f32 v[242:243], v[222:223], v[218:219], v[226:227] op_sel:[0,1,0] op_sel_hi:[1,1,1]
    v_pk_fma_f32 v[124:125], v[124:125], v[218:219], v[240:241] op_sel_hi:[1,0,1]
    v_pk_fma_f32 v[126:127], v[126:127], v[218:219], v[242:243] op_sel_hi:[1,0,1]
    ds_read_b128 v[224:227], v11 offset:0
    s_waitcnt lgkmcnt(5)
.p2align 3
    v_pk_fma_f32 v[236:237], v[228:229], v[212:213], v[232:233] op_sel:[0,1,0] op_sel_hi:[1,1,1]
    v_pk_fma_f32 v[238:239], v[230:231], v[212:213], v[234:235] op_sel:[0,1,0] op_sel_hi:[1,1,1]
    v_pk_fma_f32 v[128:129], v[128:129], v[212:213], v[236:237] op_sel_hi:[1,0,1]
    v_pk_fma_f32 v[130:131], v[130:131], v[212:213], v[238:239] op_sel_hi:[1,0,1]
    v_pk_fma_f32 v[240:241], v[228:229], v[214:215], v[232:233] op_sel:[0,1,0] op_sel_hi:[1,1,1]
    v_pk_fma_f32 v[242:243], v[230:231], v[214:215], v[234:235] op_sel:[0,1,0] op_sel_hi:[1,1,1]
    v_pk_fma_f32 v[132:133], v[132:133], v[214:215], v[240:241] op_sel_hi:[1,0,1]
    v_pk_fma_f32 v[134:135], v[134:135], v[214:215], v[242:243] op_sel_hi:[1,0,1]
    v_pk_fma_f32 v[236:237], v[228:229], v[216:217], v[232:233] op_sel:[0,1,0] op_sel_hi:[1,1,1]
    v_pk_fma_f32 v[238:239], v[230:231], v[216:217], v[234:235] op_sel:[0,1,0] op_sel_hi:[1,1,1]
    v_pk_fma_f32 v[136:137], v[136:137], v[216:217], v[236:237] op_sel_hi:[1,0,1]
    v_pk_fma_f32 v[138:139], v[138:139], v[216:217], v[238:239] op_sel_hi:[1,0,1]
    v_pk_fma_f32 v[240:241], v[228:229], v[218:219], v[232:233] op_sel:[0,1,0] op_sel_hi:[1,1,1]
    v_pk_fma_f32 v[242:243], v[230:231], v[218:219], v[234:235] op_sel:[0,1,0] op_sel_hi:[1,1,1]
    v_pk_fma_f32 v[140:141], v[140:141], v[218:219], v[240:241] op_sel_hi:[1,0,1]
    v_pk_fma_f32 v[142:143], v[142:143], v[218:219], v[242:243] op_sel_hi:[1,0,1]
    ds_read_b128 v[232:235], v11 offset:64
.p2align 3
    v_exp_f32 v236, v112
    v_exp_f32 v237, v113
    v_exp_f32 v238, v114
    v_exp_f32 v239, v115
    v_exp_f32 v240, v128
    v_exp_f32 v241, v129
    v_exp_f32 v242, v130
    v_exp_f32 v243, v131
    v_pk_fma_f32 v[248:249], v[236:237], v[244:245], v[246:247]
    v_pk_fma_f32 v[250:251], v[238:239], v[244:245], v[246:247]
    v_pk_fma_f32 v[252:253], v[240:241], v[244:245], v[246:247]
    v_pk_fma_f32 v[254:255], v[242:243], v[244:245], v[246:247]
    v_pk_fma_f32 v[236:237], v[236:237], v[248:249], v[246:247]
    v_pk_fma_f32 v[238:239], v[238:239], v[250:251], v[246:247]
    v_pk_fma_f32 v[240:241], v[240:241], v[252:253], v[246:247]
    v_pk_fma_f32 v[242:243], v[242:243], v[254:255], v[246:247]
    v_rcp_f32 v236, v236
    v_rcp_f32 v237, v237
    v_rcp_f32 v238, v238
    v_rcp_f32 v239, v239
    v_rcp_f32 v240, v240
    v_rcp_f32 v241, v241
    v_rcp_f32 v242, v242
    v_rcp_f32 v243, v243
    v_pk_fma_f32 v[112:113], v[112:113], v[236:237], v[112:113]
    v_pk_fma_f32 v[114:115], v[114:115], v[238:239], v[114:115]
    v_pk_fma_f32 v[128:129], v[128:129], v[240:241], v[128:129]
    v_pk_fma_f32 v[130:131], v[130:131], v[242:243], v[130:131]
    v_cvt_pk_bf16_f32 v112, v112, v113
    v_cvt_pk_bf16_f32 v113, v114, v115
    v_cvt_pk_bf16_f32 v114, v128, v129
    v_cvt_pk_bf16_f32 v115, v130, v131
    buffer_store_dwordx4 v[112:115], v7, s[32:35], s39 offen offset:0 sc1
    ds_write_b128 v12, v[112:115] offset:0
.p2align 3
    v_exp_f32 v236, v116
    v_exp_f32 v237, v117
    v_exp_f32 v238, v118
    v_exp_f32 v239, v119
    v_exp_f32 v240, v132
    v_exp_f32 v241, v133
    v_exp_f32 v242, v134
    v_exp_f32 v243, v135
    v_pk_fma_f32 v[248:249], v[236:237], v[244:245], v[246:247]
    v_pk_fma_f32 v[250:251], v[238:239], v[244:245], v[246:247]
    v_pk_fma_f32 v[252:253], v[240:241], v[244:245], v[246:247]
    v_pk_fma_f32 v[254:255], v[242:243], v[244:245], v[246:247]
    v_pk_fma_f32 v[236:237], v[236:237], v[248:249], v[246:247]
    v_pk_fma_f32 v[238:239], v[238:239], v[250:251], v[246:247]
    v_pk_fma_f32 v[240:241], v[240:241], v[252:253], v[246:247]
    v_pk_fma_f32 v[242:243], v[242:243], v[254:255], v[246:247]
    v_rcp_f32 v236, v236
    v_rcp_f32 v237, v237
    v_rcp_f32 v238, v238
    v_rcp_f32 v239, v239
    v_rcp_f32 v240, v240
    v_rcp_f32 v241, v241
    v_rcp_f32 v242, v242
    v_rcp_f32 v243, v243
    v_pk_fma_f32 v[116:117], v[116:117], v[236:237], v[116:117]
    v_pk_fma_f32 v[118:119], v[118:119], v[238:239], v[118:119]
    v_pk_fma_f32 v[132:133], v[132:133], v[240:241], v[132:133]
    v_pk_fma_f32 v[134:135], v[134:135], v[242:243], v[134:135]
    v_cvt_pk_bf16_f32 v116, v116, v117
    v_cvt_pk_bf16_f32 v117, v118, v119
    v_cvt_pk_bf16_f32 v118, v132, v133
    v_cvt_pk_bf16_f32 v119, v134, v135
    buffer_store_dwordx4 v[116:119], v7, s[32:35], s39 offen offset:1024 sc1
    ds_write_b128 v12, v[116:119] offset:1024
.p2align 3
    v_exp_f32 v236, v120
    v_exp_f32 v237, v121
    v_exp_f32 v238, v122
    v_exp_f32 v239, v123
    v_exp_f32 v240, v136
    v_exp_f32 v241, v137
    v_exp_f32 v242, v138
    v_exp_f32 v243, v139
    v_pk_fma_f32 v[248:249], v[236:237], v[244:245], v[246:247]
    v_pk_fma_f32 v[250:251], v[238:239], v[244:245], v[246:247]
    v_pk_fma_f32 v[252:253], v[240:241], v[244:245], v[246:247]
    v_pk_fma_f32 v[254:255], v[242:243], v[244:245], v[246:247]
    v_pk_fma_f32 v[236:237], v[236:237], v[248:249], v[246:247]
    v_pk_fma_f32 v[238:239], v[238:239], v[250:251], v[246:247]
    v_pk_fma_f32 v[240:241], v[240:241], v[252:253], v[246:247]
    v_pk_fma_f32 v[242:243], v[242:243], v[254:255], v[246:247]
    v_rcp_f32 v236, v236
    v_rcp_f32 v237, v237
    v_rcp_f32 v238, v238
    v_rcp_f32 v239, v239
    v_rcp_f32 v240, v240
    v_rcp_f32 v241, v241
    v_rcp_f32 v242, v242
    v_rcp_f32 v243, v243
    v_pk_fma_f32 v[120:121], v[120:121], v[236:237], v[120:121]
    v_pk_fma_f32 v[122:123], v[122:123], v[238:239], v[122:123]
    v_pk_fma_f32 v[136:137], v[136:137], v[240:241], v[136:137]
    v_pk_fma_f32 v[138:139], v[138:139], v[242:243], v[138:139]
    v_cvt_pk_bf16_f32 v120, v120, v121
    v_cvt_pk_bf16_f32 v121, v122, v123
    v_cvt_pk_bf16_f32 v122, v136, v137
    v_cvt_pk_bf16_f32 v123, v138, v139
    s_add_u32 s39, s39, 294912
    buffer_store_dwordx4 v[120:123], v7, s[32:35], s39 offen offset:0 sc1
    ds_write_b128 v12, v[120:123] offset:2048
.p2align 3
    v_exp_f32 v236, v124
    v_exp_f32 v237, v125
    v_exp_f32 v238, v126
    v_exp_f32 v239, v127
    v_exp_f32 v240, v140
    v_exp_f32 v241, v141
    v_exp_f32 v242, v142
    v_exp_f32 v243, v143
    v_pk_fma_f32 v[248:249], v[236:237], v[244:245], v[246:247]
    v_pk_fma_f32 v[250:251], v[238:239], v[244:245], v[246:247]
    v_pk_fma_f32 v[252:253], v[240:241], v[244:245], v[246:247]
    v_pk_fma_f32 v[254:255], v[242:243], v[244:245], v[246:247]
    v_pk_fma_f32 v[236:237], v[236:237], v[248:249], v[246:247]
    v_pk_fma_f32 v[238:239], v[238:239], v[250:251], v[246:247]
    v_pk_fma_f32 v[240:241], v[240:241], v[252:253], v[246:247]
    v_pk_fma_f32 v[242:243], v[242:243], v[254:255], v[246:247]
    v_rcp_f32 v236, v236
    v_rcp_f32 v237, v237
    v_rcp_f32 v238, v238
    v_rcp_f32 v239, v239
    v_rcp_f32 v240, v240
    v_rcp_f32 v241, v241
    v_rcp_f32 v242, v242
    v_rcp_f32 v243, v243
    v_pk_fma_f32 v[124:125], v[124:125], v[236:237], v[124:125]
    v_pk_fma_f32 v[126:127], v[126:127], v[238:239], v[126:127]
    v_pk_fma_f32 v[140:141], v[140:141], v[240:241], v[140:141]
    v_pk_fma_f32 v[142:143], v[142:143], v[242:243], v[142:143]
    v_cvt_pk_bf16_f32 v124, v124, v125
    v_cvt_pk_bf16_f32 v125, v126, v127
    v_cvt_pk_bf16_f32 v126, v140, v141
    v_cvt_pk_bf16_f32 v127, v142, v143
    buffer_store_dwordx4 v[124:127], v7, s[32:35], s39 offen offset:1024 sc1
    ds_write_b128 v12, v[124:127] offset:3072
    s_mul_i32 s59, s51, 0x1000
    s_add_u32 s59, s59, 148480
    s_cmp_eq_u32 s3, 0
    s_cselect_b32 s59, 132096, s59
    v_add_u32 v12, s59, v7
    s_waitcnt lgkmcnt(5)
.p2align 3
    v_pk_fma_f32 v[236:237], v[192:193], v[212:213], v[224:225] op_sel:[0,1,0] op_sel_hi:[1,1,1]
    v_pk_fma_f32 v[238:239], v[194:195], v[212:213], v[226:227] op_sel:[0,1,0] op_sel_hi:[1,1,1]
    v_pk_fma_f32 v[144:145], v[144:145], v[212:213], v[236:237] op_sel_hi:[1,0,1]
    v_pk_fma_f32 v[146:147], v[146:147], v[212:213], v[238:239] op_sel_hi:[1,0,1]
    v_pk_fma_f32 v[240:241], v[192:193], v[214:215], v[224:225] op_sel:[0,1,0] op_sel_hi:[1,1,1]
    v_pk_fma_f32 v[242:243], v[194:195], v[214:215], v[226:227] op_sel:[0,1,0] op_sel_hi:[1,1,1]
    v_pk_fma_f32 v[148:149], v[148:149], v[214:215], v[240:241] op_sel_hi:[1,0,1]
    v_pk_fma_f32 v[150:151], v[150:151], v[214:215], v[242:243] op_sel_hi:[1,0,1]
    v_pk_fma_f32 v[236:237], v[192:193], v[216:217], v[224:225] op_sel:[0,1,0] op_sel_hi:[1,1,1]
    v_pk_fma_f32 v[238:239], v[194:195], v[216:217], v[226:227] op_sel:[0,1,0] op_sel_hi:[1,1,1]
    v_pk_fma_f32 v[152:153], v[152:153], v[216:217], v[236:237] op_sel_hi:[1,0,1]
    v_pk_fma_f32 v[154:155], v[154:155], v[216:217], v[238:239] op_sel_hi:[1,0,1]
    v_pk_fma_f32 v[240:241], v[192:193], v[218:219], v[224:225] op_sel:[0,1,0] op_sel_hi:[1,1,1]
    v_pk_fma_f32 v[242:243], v[194:195], v[218:219], v[226:227] op_sel:[0,1,0] op_sel_hi:[1,1,1]
    v_pk_fma_f32 v[156:157], v[156:157], v[218:219], v[240:241] op_sel_hi:[1,0,1]
    v_pk_fma_f32 v[158:159], v[158:159], v[218:219], v[242:243] op_sel_hi:[1,0,1]
    s_waitcnt lgkmcnt(4)
.p2align 3
    v_pk_fma_f32 v[236:237], v[196:197], v[212:213], v[232:233] op_sel:[0,1,0] op_sel_hi:[1,1,1]
    v_pk_fma_f32 v[238:239], v[198:199], v[212:213], v[234:235] op_sel:[0,1,0] op_sel_hi:[1,1,1]
    v_pk_fma_f32 v[160:161], v[160:161], v[212:213], v[236:237] op_sel_hi:[1,0,1]
    v_pk_fma_f32 v[162:163], v[162:163], v[212:213], v[238:239] op_sel_hi:[1,0,1]
    v_pk_fma_f32 v[240:241], v[196:197], v[214:215], v[232:233] op_sel:[0,1,0] op_sel_hi:[1,1,1]
    v_pk_fma_f32 v[242:243], v[198:199], v[214:215], v[234:235] op_sel:[0,1,0] op_sel_hi:[1,1,1]
    v_pk_fma_f32 v[164:165], v[164:165], v[214:215], v[240:241] op_sel_hi:[1,0,1]
    v_pk_fma_f32 v[166:167], v[166:167], v[214:215], v[242:243] op_sel_hi:[1,0,1]
    v_pk_fma_f32 v[236:237], v[196:197], v[216:217], v[232:233] op_sel:[0,1,0] op_sel_hi:[1,1,1]
    v_pk_fma_f32 v[238:239], v[198:199], v[216:217], v[234:235] op_sel:[0,1,0] op_sel_hi:[1,1,1]
    v_pk_fma_f32 v[168:169], v[168:169], v[216:217], v[236:237] op_sel_hi:[1,0,1]
    v_pk_fma_f32 v[170:171], v[170:171], v[216:217], v[238:239] op_sel_hi:[1,0,1]
    v_pk_fma_f32 v[240:241], v[196:197], v[218:219], v[232:233] op_sel:[0,1,0] op_sel_hi:[1,1,1]
    v_pk_fma_f32 v[242:243], v[198:199], v[218:219], v[234:235] op_sel:[0,1,0] op_sel_hi:[1,1,1]
    v_pk_fma_f32 v[172:173], v[172:173], v[218:219], v[240:241] op_sel_hi:[1,0,1]
    v_pk_fma_f32 v[174:175], v[174:175], v[218:219], v[242:243] op_sel_hi:[1,0,1]
.p2align 3
    v_exp_f32 v236, v144
    v_exp_f32 v237, v145
    v_exp_f32 v238, v146
    v_exp_f32 v239, v147
    v_exp_f32 v240, v160
    v_exp_f32 v241, v161
    v_exp_f32 v242, v162
    v_exp_f32 v243, v163
    v_pk_fma_f32 v[248:249], v[236:237], v[244:245], v[246:247]
    v_pk_fma_f32 v[250:251], v[238:239], v[244:245], v[246:247]
    v_pk_fma_f32 v[252:253], v[240:241], v[244:245], v[246:247]
    v_pk_fma_f32 v[254:255], v[242:243], v[244:245], v[246:247]
    v_pk_fma_f32 v[236:237], v[236:237], v[248:249], v[246:247]
    v_pk_fma_f32 v[238:239], v[238:239], v[250:251], v[246:247]
    v_pk_fma_f32 v[240:241], v[240:241], v[252:253], v[246:247]
    v_pk_fma_f32 v[242:243], v[242:243], v[254:255], v[246:247]
    v_rcp_f32 v236, v236
    v_rcp_f32 v237, v237
    v_rcp_f32 v238, v238
    v_rcp_f32 v239, v239
    v_rcp_f32 v240, v240
    v_rcp_f32 v241, v241
    v_rcp_f32 v242, v242
    v_rcp_f32 v243, v243
    v_pk_fma_f32 v[144:145], v[144:145], v[236:237], v[144:145]
    v_pk_fma_f32 v[146:147], v[146:147], v[238:239], v[146:147]
    v_pk_fma_f32 v[160:161], v[160:161], v[240:241], v[160:161]
    v_pk_fma_f32 v[162:163], v[162:163], v[242:243], v[162:163]
    v_cvt_pk_bf16_f32 v144, v144, v145
    v_cvt_pk_bf16_f32 v145, v146, v147
    v_cvt_pk_bf16_f32 v146, v160, v161
    v_cvt_pk_bf16_f32 v147, v162, v163
    buffer_store_dwordx4 v[144:147], v7, s[32:35], s40 offen offset:0 sc1
    ds_write_b128 v12, v[144:147] offset:0
.p2align 3
    v_exp_f32 v236, v148
    v_exp_f32 v237, v149
    v_exp_f32 v238, v150
    v_exp_f32 v239, v151
    v_exp_f32 v240, v164
    v_exp_f32 v241, v165
    v_exp_f32 v242, v166
    v_exp_f32 v243, v167
    v_pk_fma_f32 v[248:249], v[236:237], v[244:245], v[246:247]
    v_pk_fma_f32 v[250:251], v[238:239], v[244:245], v[246:247]
    v_pk_fma_f32 v[252:253], v[240:241], v[244:245], v[246:247]
    v_pk_fma_f32 v[254:255], v[242:243], v[244:245], v[246:247]
    v_pk_fma_f32 v[236:237], v[236:237], v[248:249], v[246:247]
    v_pk_fma_f32 v[238:239], v[238:239], v[250:251], v[246:247]
    v_pk_fma_f32 v[240:241], v[240:241], v[252:253], v[246:247]
    v_pk_fma_f32 v[242:243], v[242:243], v[254:255], v[246:247]
    v_rcp_f32 v236, v236
    v_rcp_f32 v237, v237
    v_rcp_f32 v238, v238
    v_rcp_f32 v239, v239
    v_rcp_f32 v240, v240
    v_rcp_f32 v241, v241
    v_rcp_f32 v242, v242
    v_rcp_f32 v243, v243
    v_pk_fma_f32 v[148:149], v[148:149], v[236:237], v[148:149]
    v_pk_fma_f32 v[150:151], v[150:151], v[238:239], v[150:151]
    v_pk_fma_f32 v[164:165], v[164:165], v[240:241], v[164:165]
    v_pk_fma_f32 v[166:167], v[166:167], v[242:243], v[166:167]
    v_cvt_pk_bf16_f32 v148, v148, v149
    v_cvt_pk_bf16_f32 v149, v150, v151
    v_cvt_pk_bf16_f32 v150, v164, v165
    v_cvt_pk_bf16_f32 v151, v166, v167
    buffer_store_dwordx4 v[148:151], v7, s[32:35], s40 offen offset:1024 sc1
    ds_write_b128 v12, v[148:151] offset:1024
.p2align 3
    v_exp_f32 v236, v152
    v_exp_f32 v237, v153
    v_exp_f32 v238, v154
    v_exp_f32 v239, v155
    v_exp_f32 v240, v168
    v_exp_f32 v241, v169
    v_exp_f32 v242, v170
    v_exp_f32 v243, v171
    v_pk_fma_f32 v[248:249], v[236:237], v[244:245], v[246:247]
    v_pk_fma_f32 v[250:251], v[238:239], v[244:245], v[246:247]
    v_pk_fma_f32 v[252:253], v[240:241], v[244:245], v[246:247]
    v_pk_fma_f32 v[254:255], v[242:243], v[244:245], v[246:247]
    v_pk_fma_f32 v[236:237], v[236:237], v[248:249], v[246:247]
    v_pk_fma_f32 v[238:239], v[238:239], v[250:251], v[246:247]
    v_pk_fma_f32 v[240:241], v[240:241], v[252:253], v[246:247]
    v_pk_fma_f32 v[242:243], v[242:243], v[254:255], v[246:247]
    v_rcp_f32 v236, v236
    v_rcp_f32 v237, v237
    v_rcp_f32 v238, v238
    v_rcp_f32 v239, v239
    v_rcp_f32 v240, v240
    v_rcp_f32 v241, v241
    v_rcp_f32 v242, v242
    v_rcp_f32 v243, v243
    v_pk_fma_f32 v[152:153], v[152:153], v[236:237], v[152:153]
    v_pk_fma_f32 v[154:155], v[154:155], v[238:239], v[154:155]
    v_pk_fma_f32 v[168:169], v[168:169], v[240:241], v[168:169]
    v_pk_fma_f32 v[170:171], v[170:171], v[242:243], v[170:171]
    v_cvt_pk_bf16_f32 v152, v152, v153
    v_cvt_pk_bf16_f32 v153, v154, v155
    v_cvt_pk_bf16_f32 v154, v168, v169
    v_cvt_pk_bf16_f32 v155, v170, v171
    s_add_u32 s40, s40, 294912
    buffer_store_dwordx4 v[152:155], v7, s[32:35], s40 offen offset:0 sc1
    ds_write_b128 v12, v[152:155] offset:2048
.p2align 3
    v_exp_f32 v236, v156
    v_exp_f32 v237, v157
    v_exp_f32 v238, v158
    v_exp_f32 v239, v159
    v_exp_f32 v240, v172
    v_exp_f32 v241, v173
    v_exp_f32 v242, v174
    v_exp_f32 v243, v175
    v_pk_fma_f32 v[248:249], v[236:237], v[244:245], v[246:247]
    v_pk_fma_f32 v[250:251], v[238:239], v[244:245], v[246:247]
    v_pk_fma_f32 v[252:253], v[240:241], v[244:245], v[246:247]
    v_pk_fma_f32 v[254:255], v[242:243], v[244:245], v[246:247]
    v_pk_fma_f32 v[236:237], v[236:237], v[248:249], v[246:247]
    v_pk_fma_f32 v[238:239], v[238:239], v[250:251], v[246:247]
    v_pk_fma_f32 v[240:241], v[240:241], v[252:253], v[246:247]
    v_pk_fma_f32 v[242:243], v[242:243], v[254:255], v[246:247]
    v_rcp_f32 v236, v236
    v_rcp_f32 v237, v237
    v_rcp_f32 v238, v238
    v_rcp_f32 v239, v239
    v_rcp_f32 v240, v240
    v_rcp_f32 v241, v241
    v_rcp_f32 v242, v242
    v_rcp_f32 v243, v243
    v_pk_fma_f32 v[156:157], v[156:157], v[236:237], v[156:157]
    v_pk_fma_f32 v[158:159], v[158:159], v[238:239], v[158:159]
    v_pk_fma_f32 v[172:173], v[172:173], v[240:241], v[172:173]
    v_pk_fma_f32 v[174:175], v[174:175], v[242:243], v[174:175]
    v_cvt_pk_bf16_f32 v156, v156, v157
    v_cvt_pk_bf16_f32 v157, v158, v159
    v_cvt_pk_bf16_f32 v158, v172, v173
    v_cvt_pk_bf16_f32 v159, v174, v175
    buffer_store_dwordx4 v[156:159], v7, s[32:35], s40 offen offset:1024 sc1
    ds_write_b128 v12, v[156:159] offset:3072
    s_lshl_b32 s98, s49, 2
    s_lshr_b32 s59, s50, 2
    s_add_u32 s98, s98, s59
    s_lshl_b32 s98, s98, 7
    s_add_u32 s98, s98, 37568512
    s_branch K2_start
K1_c1:
    v_add_u32 v5, 122880, v7
    s_barrier
    ds_read_b128 v[204:207], v8 offset:0
    ds_read_b128 v[208:211], v8 offset:2048
    ds_read_b128 v[212:215], v8 offset:4096
    ds_read_b128 v[216:219], v8 offset:6144
    ds_read_b128 v[236:239], v13 offset:0
    ds_read_b64_tr_b16 v[240:241], v1 offset:0
    ds_read_b64_tr_b16 v[242:243], v1 offset:512
    ds_read_b64_tr_b16 v[244:245], v2 offset:0
    ds_read_b64_tr_b16 v[246:247], v2 offset:512
    s_waitcnt lgkmcnt(4)
    v_mfma_f32_16x16x32_bf16 v[192:195], v[236:239], v[208:211], 0
    ds_read_b64_tr_b16 v[248:249], v1 offset:1024
    v_mfma_f32_16x16x32_bf16 v[196:199], v[236:239], v[212:215], 0
    ds_read_b64_tr_b16 v[250:251], v1 offset:1536
    v_mfma_f32_16x16x32_bf16 v[200:203], v[236:239], v[216:219], 0
    s_waitcnt lgkmcnt(4)
    v_mfma_f32_16x16x32_bf16 v[176:179], v[240:243], v[252:255], 0
    ds_read_b64_tr_b16 v[236:237], v2 offset:1024
    v_mfma_f32_16x16x32_bf16 v[16:19], v[240:243], v[204:207], 0
    ds_read_b64_tr_b16 v[238:239], v2 offset:1536
    v_mfma_f32_16x16x32_bf16 v[20:23], v[240:243], v[208:211], 0
    v_mfma_f32_16x16x32_bf16 v[24:27], v[240:243], v[212:215], 0
    v_mfma_f32_16x16x32_bf16 v[28:31], v[240:243], v[216:219], 0
    s_waitcnt lgkmcnt(4)
    v_mfma_f32_16x16x32_bf16 v[180:183], v[244:247], v[252:255], 0
    ds_read_b64_tr_b16 v[240:241], v3 offset:0
    v_mfma_f32_16x16x32_bf16 v[32:35], v[244:247], v[204:207], 0
    ds_read_b64_tr_b16 v[242:243], v3 offset:512
    v_mfma_f32_16x16x32_bf16 v[36:39], v[244:247], v[208:211], 0
    v_mfma_f32_16x16x32_bf16 v[40:43], v[244:247], v[212:215], 0
    v_mfma_f32_16x16x32_bf16 v[44:47], v[244:247], v[216:219], 0
    s_waitcnt lgkmcnt(4)
    v_mfma_f32_16x16x32_bf16 v[184:187], v[248:251], v[252:255], 0
    ds_read_b64_tr_b16 v[244:245], v4 offset:0
    v_mfma_f32_16x16x32_bf16 v[80:83], v[248:251], v[204:207], 0
    ds_read_b64_tr_b16 v[246:247], v4 offset:512
    v_mfma_f32_16x16x32_bf16 v[84:87], v[248:251], v[208:211], 0
    v_mfma_f32_16x16x32_bf16 v[88:91], v[248:251], v[212:215], 0
    v_mfma_f32_16x16x32_bf16 v[92:95], v[248:251], v[216:219], 0
    s_waitcnt lgkmcnt(4)
    v_mfma_f32_16x16x32_bf16 v[188:191], v[236:239], v[252:255], 0
    ds_read_b64_tr_b16 v[248:249], v3 offset:1024
    v_mfma_f32_16x16x32_bf16 v[96:99], v[236:239], v[204:207], 0
    ds_read_b64_tr_b16 v[250:251], v3 offset:1536
    v_mfma_f32_16x16x32_bf16 v[100:103], v[236:239], v[208:211], 0
    v_mfma_f32_16x16x32_bf16 v[104:107], v[236:239], v[212:215], 0
    v_mfma_f32_16x16x32_bf16 v[108:111], v[236:239], v[216:219], 0
    s_waitcnt lgkmcnt(4)
    v_mfma_f32_16x16x32_bf16 v[48:51], v[240:243], v[204:207], 0
    ds_read_b64_tr_b16 v[236:237], v4 offset:1024
    v_mfma_f32_16x16x32_bf16 v[52:55], v[240:243], v[208:211], 0
    ds_read_b64_tr_b16 v[238:239], v4 offset:1536
    v_mfma_f32_16x16x32_bf16 v[56:59], v[240:243], v[212:215], 0
    v_mfma_f32_16x16x32_bf16 v[60:63], v[240:243], v[216:219], 0
    s_waitcnt lgkmcnt(4)
    v_mfma_f32_16x16x32_bf16 v[64:67], v[244:247], v[204:207], 0
    s_barrier
    v_mfma_f32_16x16x32_bf16 v[68:71], v[244:247], v[208:211], 0
    ds_read_b128 v[240:243], v5 offset:0
    v_mfma_f32_16x16x32_bf16 v[72:75], v[244:247], v[212:215], 0
    ds_read_b128 v[220:223], v14 offset:0
    v_mfma_f32_16x16x32_bf16 v[76:79], v[244:247], v[216:219], 0
    ds_read_b128 v[224:227], v14 offset:2048
    s_waitcnt lgkmcnt(5)
    v_mfma_f32_16x16x32_bf16 v[112:115], v[248:251], v[204:207], 0
    ds_read_b128 v[244:247], v5 offset:9216
    v_mfma_f32_16x16x32_bf16 v[116:119], v[248:251], v[208:211], 0
    ds_read_b128 v[228:231], v14 offset:4096
    v_mfma_f32_16x16x32_bf16 v[120:123], v[248:251], v[212:215], 0
    ds_read_b128 v[232:235], v14 offset:6144
    v_mfma_f32_16x16x32_bf16 v[124:127], v[248:251], v[216:219], 0
    s_waitcnt lgkmcnt(6)
    v_mfma_f32_16x16x32_bf16 v[128:131], v[236:239], v[204:207], 0
    ds_read_b128 v[248:251], v13 offset:64
    v_mfma_f32_16x16x32_bf16 v[132:135], v[236:239], v[208:211], 0
    v_mfma_f32_16x16x32_bf16 v[136:139], v[236:239], v[212:215], 0
    v_mfma_f32_16x16x32_bf16 v[140:143], v[236:239], v[216:219], 0
    s_waitcnt lgkmcnt(6)
    v_mfma_f32_16x16x32_bf16 v[144:147], v[204:207], v[240:243], 0
    ds_read_b64_tr_b16 v[236:237], v1 offset:18432
    v_mfma_f32_16x16x32_bf16 v[148:151], v[208:211], v[240:243], 0
    ds_read_b64_tr_b16 v[238:239], v1 offset:18944
    v_mfma_f32_16x16x32_bf16 v[152:155], v[212:215], v[240:243], 0
    v_mfma_f32_16x16x32_bf16 v[156:159], v[216:219], v[240:243], 0
    s_waitcnt lgkmcnt(5)
    v_mfma_f32_16x16x32_bf16 v[160:163], v[204:207], v[244:247], 0
    ds_read_b64_tr_b16 v[240:241], v2 offset:18432
    v_mfma_f32_16x16x32_bf16 v[164:167], v[208:211], v[244:247], 0
    ds_read_b64_tr_b16 v[242:243], v2 offset:18944
    v_mfma_f32_16x16x32_bf16 v[168:171], v[212:215], v[244:247], 0
    v_mfma_f32_16x16x32_bf16 v[172:175], v[216:219], v[244:247], 0
    s_waitcnt lgkmcnt(4)
    v_mfma_f32_16x16x32_bf16 v[192:195], v[248:251], v[224:227], v[192:195]
    ds_read_b64_tr_b16 v[244:245], v1 offset:19456
    v_mfma_f32_16x16x32_bf16 v[196:199], v[248:251], v[228:231], v[196:199]
    ds_read_b64_tr_b16 v[246:247], v1 offset:19968
    v_mfma_f32_16x16x32_bf16 v[200:203], v[248:251], v[232:235], v[200:203]
    s_waitcnt lgkmcnt(4)
    v_mfma_f32_16x16x32_bf16 v[176:179], v[236:239], v[252:255], v[176:179]
    ds_read_b64_tr_b16 v[248:249], v2 offset:19456
    v_mfma_f32_16x16x32_bf16 v[16:19], v[236:239], v[220:223], v[16:19]
    ds_read_b64_tr_b16 v[250:251], v2 offset:19968
    v_mfma_f32_16x16x32_bf16 v[20:23], v[236:239], v[224:227], v[20:23]
    v_mfma_f32_16x16x32_bf16 v[24:27], v[236:239], v[228:231], v[24:27]
    v_mfma_f32_16x16x32_bf16 v[28:31], v[236:239], v[232:235], v[28:31]
    s_waitcnt lgkmcnt(4)
    v_mfma_f32_16x16x32_bf16 v[180:183], v[240:243], v[252:255], v[180:183]
    ds_read_b64_tr_b16 v[236:237], v3 offset:18432
    v_mfma_f32_16x16x32_bf16 v[32:35], v[240:243], v[220:223], v[32:35]
    ds_read_b64_tr_b16 v[238:239], v3 offset:18944
    v_mfma_f32_16x16x32_bf16 v[36:39], v[240:243], v[224:227], v[36:39]
    v_mfma_f32_16x16x32_bf16 v[40:43], v[240:243], v[228:231], v[40:43]
    v_mfma_f32_16x16x32_bf16 v[44:47], v[240:243], v[232:235], v[44:47]
    s_waitcnt lgkmcnt(4)
    v_mfma_f32_16x16x32_bf16 v[184:187], v[244:247], v[252:255], v[184:187]
    ds_read_b64_tr_b16 v[240:241], v4 offset:18432
    v_mfma_f32_16x16x32_bf16 v[80:83], v[244:247], v[220:223], v[80:83]
    ds_read_b64_tr_b16 v[242:243], v4 offset:18944
    v_mfma_f32_16x16x32_bf16 v[84:87], v[244:247], v[224:227], v[84:87]
    v_mfma_f32_16x16x32_bf16 v[88:91], v[244:247], v[228:231], v[88:91]
    v_mfma_f32_16x16x32_bf16 v[92:95], v[244:247], v[232:235], v[92:95]
    s_waitcnt lgkmcnt(4)
    v_mfma_f32_16x16x32_bf16 v[188:191], v[248:251], v[252:255], v[188:191]
    ds_read_b64_tr_b16 v[244:245], v3 offset:19456
    v_mfma_f32_16x16x32_bf16 v[96:99], v[248:251], v[220:223], v[96:99]
    ds_read_b64_tr_b16 v[246:247], v3 offset:19968
    v_mfma_f32_16x16x32_bf16 v[100:103], v[248:251], v[224:227], v[100:103]
    v_mfma_f32_16x16x32_bf16 v[104:107], v[248:251], v[228:231], v[104:107]
    v_mfma_f32_16x16x32_bf16 v[108:111], v[248:251], v[232:235], v[108:111]
    s_waitcnt lgkmcnt(4)
    v_mfma_f32_16x16x32_bf16 v[48:51], v[236:239], v[220:223], v[48:51]
    ds_read_b64_tr_b16 v[248:249], v4 offset:19456
    v_mfma_f32_16x16x32_bf16 v[52:55], v[236:239], v[224:227], v[52:55]
    ds_read_b64_tr_b16 v[250:251], v4 offset:19968
    v_mfma_f32_16x16x32_bf16 v[56:59], v[236:239], v[228:231], v[56:59]
    v_mfma_f32_16x16x32_bf16 v[60:63], v[236:239], v[232:235], v[60:63]
    s_waitcnt lgkmcnt(4)
    v_mfma_f32_16x16x32_bf16 v[64:67], v[240:243], v[220:223], v[64:67]
    s_barrier
    v_mfma_f32_16x16x32_bf16 v[68:71], v[240:243], v[224:227], v[68:71]
    ds_read_b128 v[236:239], v5 offset:1024
    v_mfma_f32_16x16x32_bf16 v[72:75], v[240:243], v[228:231], v[72:75]
    ds_read_b128 v[204:207], v8 offset:16384
    v_mfma_f32_16x16x32_bf16 v[76:79], v[240:243], v[232:235], v[76:79]
    ds_read_b128 v[208:211], v8 offset:18432
    s_waitcnt lgkmcnt(5)
    v_mfma_f32_16x16x32_bf16 v[112:115], v[244:247], v[220:223], v[112:115]
    ds_read_b128 v[240:243], v5 offset:10240
    v_mfma_f32_16x16x32_bf16 v[116:119], v[244:247], v[224:227], v[116:119]
    ds_read_b128 v[212:215], v8 offset:20480
    v_mfma_f32_16x16x32_bf16 v[120:123], v[244:247], v[228:231], v[120:123]
    ds_read_b128 v[216:219], v8 offset:22528
    v_mfma_f32_16x16x32_bf16 v[124:127], v[244:247], v[232:235], v[124:127]
    s_waitcnt lgkmcnt(6)
    v_mfma_f32_16x16x32_bf16 v[128:131], v[248:251], v[220:223], v[128:131]
    ds_read_b128 v[244:247], v13 offset:128
    v_mfma_f32_16x16x32_bf16 v[132:135], v[248:251], v[224:227], v[132:135]
    v_mfma_f32_16x16x32_bf16 v[136:139], v[248:251], v[228:231], v[136:139]
    v_mfma_f32_16x16x32_bf16 v[140:143], v[248:251], v[232:235], v[140:143]
    s_waitcnt lgkmcnt(6)
    v_mfma_f32_16x16x32_bf16 v[144:147], v[220:223], v[236:239], v[144:147]
    ds_read_b64_tr_b16 v[248:249], v1 offset:36864
    v_mfma_f32_16x16x32_bf16 v[148:151], v[224:227], v[236:239], v[148:151]
    ds_read_b64_tr_b16 v[250:251], v1 offset:37376
    v_mfma_f32_16x16x32_bf16 v[152:155], v[228:231], v[236:239], v[152:155]
    v_mfma_f32_16x16x32_bf16 v[156:159], v[232:235], v[236:239], v[156:159]
    s_waitcnt lgkmcnt(5)
    v_mfma_f32_16x16x32_bf16 v[160:163], v[220:223], v[240:243], v[160:163]
    ds_read_b64_tr_b16 v[236:237], v2 offset:36864
    v_mfma_f32_16x16x32_bf16 v[164:167], v[224:227], v[240:243], v[164:167]
    ds_read_b64_tr_b16 v[238:239], v2 offset:37376
    v_mfma_f32_16x16x32_bf16 v[168:171], v[228:231], v[240:243], v[168:171]
    v_mfma_f32_16x16x32_bf16 v[172:175], v[232:235], v[240:243], v[172:175]
    s_waitcnt lgkmcnt(4)
    v_mfma_f32_16x16x32_bf16 v[192:195], v[244:247], v[208:211], v[192:195]
    ds_read_b64_tr_b16 v[240:241], v1 offset:37888
    v_mfma_f32_16x16x32_bf16 v[196:199], v[244:247], v[212:215], v[196:199]
    ds_read_b64_tr_b16 v[242:243], v1 offset:38400
    v_mfma_f32_16x16x32_bf16 v[200:203], v[244:247], v[216:219], v[200:203]
    s_waitcnt lgkmcnt(4)
    v_mfma_f32_16x16x32_bf16 v[176:179], v[248:251], v[252:255], v[176:179]
    ds_read_b64_tr_b16 v[244:245], v2 offset:37888
    v_mfma_f32_16x16x32_bf16 v[16:19], v[248:251], v[204:207], v[16:19]
    ds_read_b64_tr_b16 v[246:247], v2 offset:38400
    v_mfma_f32_16x16x32_bf16 v[20:23], v[248:251], v[208:211], v[20:23]
    v_mfma_f32_16x16x32_bf16 v[24:27], v[248:251], v[212:215], v[24:27]
    v_mfma_f32_16x16x32_bf16 v[28:31], v[248:251], v[216:219], v[28:31]
    s_waitcnt lgkmcnt(4)
    v_mfma_f32_16x16x32_bf16 v[180:183], v[236:239], v[252:255], v[180:183]
    ds_read_b64_tr_b16 v[248:249], v3 offset:36864
    v_mfma_f32_16x16x32_bf16 v[32:35], v[236:239], v[204:207], v[32:35]
    ds_read_b64_tr_b16 v[250:251], v3 offset:37376
    v_mfma_f32_16x16x32_bf16 v[36:39], v[236:239], v[208:211], v[36:39]
    v_mfma_f32_16x16x32_bf16 v[40:43], v[236:239], v[212:215], v[40:43]
    v_mfma_f32_16x16x32_bf16 v[44:47], v[236:239], v[216:219], v[44:47]
    s_waitcnt lgkmcnt(4)
    v_mfma_f32_16x16x32_bf16 v[184:187], v[240:243], v[252:255], v[184:187]
    ds_read_b64_tr_b16 v[236:237], v4 offset:36864
    v_mfma_f32_16x16x32_bf16 v[80:83], v[240:243], v[204:207], v[80:83]
    ds_read_b64_tr_b16 v[238:239], v4 offset:37376
    v_mfma_f32_16x16x32_bf16 v[84:87], v[240:243], v[208:211], v[84:87]
    v_mfma_f32_16x16x32_bf16 v[88:91], v[240:243], v[212:215], v[88:91]
    v_mfma_f32_16x16x32_bf16 v[92:95], v[240:243], v[216:219], v[92:95]
    s_waitcnt lgkmcnt(4)
    v_mfma_f32_16x16x32_bf16 v[188:191], v[244:247], v[252:255], v[188:191]
    ds_read_b64_tr_b16 v[240:241], v3 offset:37888
    v_mfma_f32_16x16x32_bf16 v[96:99], v[244:247], v[204:207], v[96:99]
    ds_read_b64_tr_b16 v[242:243], v3 offset:38400
    v_mfma_f32_16x16x32_bf16 v[100:103], v[244:247], v[208:211], v[100:103]
    v_mfma_f32_16x16x32_bf16 v[104:107], v[244:247], v[212:215], v[104:107]
    v_mfma_f32_16x16x32_bf16 v[108:111], v[244:247], v[216:219], v[108:111]
    s_waitcnt lgkmcnt(4)
    v_mfma_f32_16x16x32_bf16 v[48:51], v[248:251], v[204:207], v[48:51]
    ds_read_b64_tr_b16 v[244:245], v4 offset:37888
    v_mfma_f32_16x16x32_bf16 v[52:55], v[248:251], v[208:211], v[52:55]
    ds_read_b64_tr_b16 v[246:247], v4 offset:38400
    v_mfma_f32_16x16x32_bf16 v[56:59], v[248:251], v[212:215], v[56:59]
    v_mfma_f32_16x16x32_bf16 v[60:63], v[248:251], v[216:219], v[60:63]
    s_waitcnt lgkmcnt(4)
    v_mfma_f32_16x16x32_bf16 v[64:67], v[236:239], v[204:207], v[64:67]
    s_barrier
    v_mfma_f32_16x16x32_bf16 v[68:71], v[236:239], v[208:211], v[68:71]
    ds_read_b128 v[248:251], v5 offset:2048
    v_mfma_f32_16x16x32_bf16 v[72:75], v[236:239], v[212:215], v[72:75]
    ds_read_b128 v[220:223], v14 offset:16384
    v_mfma_f32_16x16x32_bf16 v[76:79], v[236:239], v[216:219], v[76:79]
    ds_read_b128 v[224:227], v14 offset:18432
    s_waitcnt lgkmcnt(5)
    v_mfma_f32_16x16x32_bf16 v[112:115], v[240:243], v[204:207], v[112:115]
    ds_read_b128 v[236:239], v5 offset:11264
    v_mfma_f32_16x16x32_bf16 v[116:119], v[240:243], v[208:211], v[116:119]
    ds_read_b128 v[228:231], v14 offset:20480
    v_mfma_f32_16x16x32_bf16 v[120:123], v[240:243], v[212:215], v[120:123]
    ds_read_b128 v[232:235], v14 offset:22528
    v_mfma_f32_16x16x32_bf16 v[124:127], v[240:243], v[216:219], v[124:127]
    s_waitcnt lgkmcnt(6)
    v_mfma_f32_16x16x32_bf16 v[128:131], v[244:247], v[204:207], v[128:131]
    ds_read_b128 v[240:243], v13 offset:192
    v_mfma_f32_16x16x32_bf16 v[132:135], v[244:247], v[208:211], v[132:135]
    v_mfma_f32_16x16x32_bf16 v[136:139], v[244:247], v[212:215], v[136:139]
    v_mfma_f32_16x16x32_bf16 v[140:143], v[244:247], v[216:219], v[140:143]
    s_waitcnt lgkmcnt(6)
    v_mfma_f32_16x16x32_bf16 v[144:147], v[204:207], v[248:251], v[144:147]
    ds_read_b64_tr_b16 v[244:245], v1 offset:55296
    v_mfma_f32_16x16x32_bf16 v[148:151], v[208:211], v[248:251], v[148:151]
    ds_read_b64_tr_b16 v[246:247], v1 offset:55808
    v_mfma_f32_16x16x32_bf16 v[152:155], v[212:215], v[248:251], v[152:155]
    v_mfma_f32_16x16x32_bf16 v[156:159], v[216:219], v[248:251], v[156:159]
    s_waitcnt lgkmcnt(5)
    v_mfma_f32_16x16x32_bf16 v[160:163], v[204:207], v[236:239], v[160:163]
    ds_read_b64_tr_b16 v[248:249], v2 offset:55296
    v_mfma_f32_16x16x32_bf16 v[164:167], v[208:211], v[236:239], v[164:167]
    ds_read_b64_tr_b16 v[250:251], v2 offset:55808
    v_mfma_f32_16x16x32_bf16 v[168:171], v[212:215], v[236:239], v[168:171]
    v_mfma_f32_16x16x32_bf16 v[172:175], v[216:219], v[236:239], v[172:175]
    s_waitcnt lgkmcnt(4)
    v_mfma_f32_16x16x32_bf16 v[192:195], v[240:243], v[224:227], v[192:195]
    ds_read_b64_tr_b16 v[236:237], v1 offset:56320
    v_mfma_f32_16x16x32_bf16 v[196:199], v[240:243], v[228:231], v[196:199]
    ds_read_b64_tr_b16 v[238:239], v1 offset:56832
    v_mfma_f32_16x16x32_bf16 v[200:203], v[240:243], v[232:235], v[200:203]
    s_waitcnt lgkmcnt(4)
    v_mfma_f32_16x16x32_bf16 v[176:179], v[244:247], v[252:255], v[176:179]
    ds_read_b64_tr_b16 v[240:241], v2 offset:56320
    v_mfma_f32_16x16x32_bf16 v[16:19], v[244:247], v[220:223], v[16:19]
    ds_read_b64_tr_b16 v[242:243], v2 offset:56832
    v_mfma_f32_16x16x32_bf16 v[20:23], v[244:247], v[224:227], v[20:23]
    v_mfma_f32_16x16x32_bf16 v[24:27], v[244:247], v[228:231], v[24:27]
    v_mfma_f32_16x16x32_bf16 v[28:31], v[244:247], v[232:235], v[28:31]
    s_waitcnt lgkmcnt(4)
    v_mfma_f32_16x16x32_bf16 v[180:183], v[248:251], v[252:255], v[180:183]
    ds_read_b64_tr_b16 v[244:245], v3 offset:55296
    v_mfma_f32_16x16x32_bf16 v[32:35], v[248:251], v[220:223], v[32:35]
    ds_read_b64_tr_b16 v[246:247], v3 offset:55808
    v_mfma_f32_16x16x32_bf16 v[36:39], v[248:251], v[224:227], v[36:39]
    v_mfma_f32_16x16x32_bf16 v[40:43], v[248:251], v[228:231], v[40:43]
    v_mfma_f32_16x16x32_bf16 v[44:47], v[248:251], v[232:235], v[44:47]
    s_waitcnt lgkmcnt(4)
    v_mfma_f32_16x16x32_bf16 v[184:187], v[236:239], v[252:255], v[184:187]
    ds_read_b64_tr_b16 v[248:249], v4 offset:55296
    v_mfma_f32_16x16x32_bf16 v[80:83], v[236:239], v[220:223], v[80:83]
    ds_read_b64_tr_b16 v[250:251], v4 offset:55808
    v_mfma_f32_16x16x32_bf16 v[84:87], v[236:239], v[224:227], v[84:87]
    v_mfma_f32_16x16x32_bf16 v[88:91], v[236:239], v[228:231], v[88:91]
    v_mfma_f32_16x16x32_bf16 v[92:95], v[236:239], v[232:235], v[92:95]
    s_waitcnt lgkmcnt(4)
    v_mfma_f32_16x16x32_bf16 v[188:191], v[240:243], v[252:255], v[188:191]
    ds_read_b64_tr_b16 v[236:237], v3 offset:56320
    v_mfma_f32_16x16x32_bf16 v[96:99], v[240:243], v[220:223], v[96:99]
    ds_read_b64_tr_b16 v[238:239], v3 offset:56832
    v_mfma_f32_16x16x32_bf16 v[100:103], v[240:243], v[224:227], v[100:103]
    v_mfma_f32_16x16x32_bf16 v[104:107], v[240:243], v[228:231], v[104:107]
    v_mfma_f32_16x16x32_bf16 v[108:111], v[240:243], v[232:235], v[108:111]
    s_waitcnt lgkmcnt(4)
    v_mfma_f32_16x16x32_bf16 v[48:51], v[244:247], v[220:223], v[48:51]
    ds_read_b64_tr_b16 v[240:241], v4 offset:56320
    v_mfma_f32_16x16x32_bf16 v[52:55], v[244:247], v[224:227], v[52:55]
    ds_read_b64_tr_b16 v[242:243], v4 offset:56832
    v_mfma_f32_16x16x32_bf16 v[56:59], v[244:247], v[228:231], v[56:59]
    v_mfma_f32_16x16x32_bf16 v[60:63], v[244:247], v[232:235], v[60:63]
    s_waitcnt lgkmcnt(4)
    v_mfma_f32_16x16x32_bf16 v[64:67], v[248:251], v[220:223], v[64:67]
    s_barrier
    v_mfma_f32_16x16x32_bf16 v[68:71], v[248:251], v[224:227], v[68:71]
    ds_read_b128 v[244:247], v5 offset:3072
    v_mfma_f32_16x16x32_bf16 v[72:75], v[248:251], v[228:231], v[72:75]
    ds_read_b128 v[204:207], v8 offset:32768
    v_mfma_f32_16x16x32_bf16 v[76:79], v[248:251], v[232:235], v[76:79]
    ds_read_b128 v[208:211], v8 offset:34816
    s_waitcnt lgkmcnt(5)
    v_mfma_f32_16x16x32_bf16 v[112:115], v[236:239], v[220:223], v[112:115]
    ds_read_b128 v[248:251], v5 offset:12288
    v_mfma_f32_16x16x32_bf16 v[116:119], v[236:239], v[224:227], v[116:119]
    ds_read_b128 v[212:215], v8 offset:36864
    v_mfma_f32_16x16x32_bf16 v[120:123], v[236:239], v[228:231], v[120:123]
    ds_read_b128 v[216:219], v8 offset:38912
    v_mfma_f32_16x16x32_bf16 v[124:127], v[236:239], v[232:235], v[124:127]
    s_waitcnt lgkmcnt(6)
    v_mfma_f32_16x16x32_bf16 v[128:131], v[240:243], v[220:223], v[128:131]
    ds_read_b128 v[236:239], v13 offset:256
    v_mfma_f32_16x16x32_bf16 v[132:135], v[240:243], v[224:227], v[132:135]
    v_mfma_f32_16x16x32_bf16 v[136:139], v[240:243], v[228:231], v[136:139]
    v_mfma_f32_16x16x32_bf16 v[140:143], v[240:243], v[232:235], v[140:143]
    s_waitcnt lgkmcnt(6)
    v_mfma_f32_16x16x32_bf16 v[144:147], v[220:223], v[244:247], v[144:147]
    ds_read_b64_tr_b16 v[240:241], v1 offset:0
    v_mfma_f32_16x16x32_bf16 v[148:151], v[224:227], v[244:247], v[148:151]
    ds_read_b64_tr_b16 v[242:243], v1 offset:512
    v_mfma_f32_16x16x32_bf16 v[152:155], v[228:231], v[244:247], v[152:155]
    v_mfma_f32_16x16x32_bf16 v[156:159], v[232:235], v[244:247], v[156:159]
    s_waitcnt lgkmcnt(5)
    v_mfma_f32_16x16x32_bf16 v[160:163], v[220:223], v[248:251], v[160:163]
    ds_read_b64_tr_b16 v[244:245], v2 offset:0
    v_mfma_f32_16x16x32_bf16 v[164:167], v[224:227], v[248:251], v[164:167]
    ds_read_b64_tr_b16 v[246:247], v2 offset:512
    v_mfma_f32_16x16x32_bf16 v[168:171], v[228:231], v[248:251], v[168:171]
    v_mfma_f32_16x16x32_bf16 v[172:175], v[232:235], v[248:251], v[172:175]
    s_waitcnt lgkmcnt(4)
    v_mfma_f32_16x16x32_bf16 v[192:195], v[236:239], v[208:211], v[192:195]
    ds_read_b64_tr_b16 v[248:249], v1 offset:1024
    v_mfma_f32_16x16x32_bf16 v[196:199], v[236:239], v[212:215], v[196:199]
    ds_read_b64_tr_b16 v[250:251], v1 offset:1536
    v_mfma_f32_16x16x32_bf16 v[200:203], v[236:239], v[216:219], v[200:203]
    s_waitcnt lgkmcnt(4)
    v_mfma_f32_16x16x32_bf16 v[176:179], v[240:243], v[252:255], v[176:179]
    ds_read_b64_tr_b16 v[236:237], v2 offset:1024
    v_mfma_f32_16x16x32_bf16 v[16:19], v[240:243], v[204:207], v[16:19]
    ds_read_b64_tr_b16 v[238:239], v2 offset:1536
    v_mfma_f32_16x16x32_bf16 v[20:23], v[240:243], v[208:211], v[20:23]
    v_mfma_f32_16x16x32_bf16 v[24:27], v[240:243], v[212:215], v[24:27]
    v_mfma_f32_16x16x32_bf16 v[28:31], v[240:243], v[216:219], v[28:31]
    s_waitcnt lgkmcnt(4)
    v_mfma_f32_16x16x32_bf16 v[180:183], v[244:247], v[252:255], v[180:183]
    ds_read_b64_tr_b16 v[240:241], v3 offset:0
    v_mfma_f32_16x16x32_bf16 v[32:35], v[244:247], v[204:207], v[32:35]
    ds_read_b64_tr_b16 v[242:243], v3 offset:512
    v_mfma_f32_16x16x32_bf16 v[36:39], v[244:247], v[208:211], v[36:39]
    v_mfma_f32_16x16x32_bf16 v[40:43], v[244:247], v[212:215], v[40:43]
    v_mfma_f32_16x16x32_bf16 v[44:47], v[244:247], v[216:219], v[44:47]
    s_waitcnt lgkmcnt(4)
    v_mfma_f32_16x16x32_bf16 v[184:187], v[248:251], v[252:255], v[184:187]
    ds_read_b64_tr_b16 v[244:245], v4 offset:0
    v_mfma_f32_16x16x32_bf16 v[80:83], v[248:251], v[204:207], v[80:83]
    ds_read_b64_tr_b16 v[246:247], v4 offset:512
    v_mfma_f32_16x16x32_bf16 v[84:87], v[248:251], v[208:211], v[84:87]
    v_mfma_f32_16x16x32_bf16 v[88:91], v[248:251], v[212:215], v[88:91]
    v_mfma_f32_16x16x32_bf16 v[92:95], v[248:251], v[216:219], v[92:95]
    s_waitcnt lgkmcnt(4)
    v_mfma_f32_16x16x32_bf16 v[188:191], v[236:239], v[252:255], v[188:191]
    ds_read_b64_tr_b16 v[248:249], v3 offset:1024
    v_mfma_f32_16x16x32_bf16 v[96:99], v[236:239], v[204:207], v[96:99]
    ds_read_b64_tr_b16 v[250:251], v3 offset:1536
    v_mfma_f32_16x16x32_bf16 v[100:103], v[236:239], v[208:211], v[100:103]
    v_mfma_f32_16x16x32_bf16 v[104:107], v[236:239], v[212:215], v[104:107]
    v_mfma_f32_16x16x32_bf16 v[108:111], v[236:239], v[216:219], v[108:111]
    s_waitcnt lgkmcnt(4)
    v_mfma_f32_16x16x32_bf16 v[48:51], v[240:243], v[204:207], v[48:51]
    ds_read_b64_tr_b16 v[236:237], v4 offset:1024
    v_mfma_f32_16x16x32_bf16 v[52:55], v[240:243], v[208:211], v[52:55]
    ds_read_b64_tr_b16 v[238:239], v4 offset:1536
    v_mfma_f32_16x16x32_bf16 v[56:59], v[240:243], v[212:215], v[56:59]
    v_mfma_f32_16x16x32_bf16 v[60:63], v[240:243], v[216:219], v[60:63]
    s_waitcnt lgkmcnt(4)
    v_mfma_f32_16x16x32_bf16 v[64:67], v[244:247], v[204:207], v[64:67]
    s_barrier
    v_mfma_f32_16x16x32_bf16 v[68:71], v[244:247], v[208:211], v[68:71]
    ds_read_b128 v[240:243], v5 offset:4096
    v_mfma_f32_16x16x32_bf16 v[72:75], v[244:247], v[212:215], v[72:75]
    ds_read_b128 v[220:223], v14 offset:32768
    v_mfma_f32_16x16x32_bf16 v[76:79], v[244:247], v[216:219], v[76:79]
    ds_read_b128 v[224:227], v14 offset:34816
    s_waitcnt lgkmcnt(5)
    v_mfma_f32_16x16x32_bf16 v[112:115], v[248:251], v[204:207], v[112:115]
    ds_read_b128 v[244:247], v5 offset:13312
    v_mfma_f32_16x16x32_bf16 v[116:119], v[248:251], v[208:211], v[116:119]
    ds_read_b128 v[228:231], v14 offset:36864
    v_mfma_f32_16x16x32_bf16 v[120:123], v[248:251], v[212:215], v[120:123]
    ds_read_b128 v[232:235], v14 offset:38912
    v_mfma_f32_16x16x32_bf16 v[124:127], v[248:251], v[216:219], v[124:127]
    s_waitcnt lgkmcnt(6)
    v_mfma_f32_16x16x32_bf16 v[128:131], v[236:239], v[204:207], v[128:131]
    ds_read_b128 v[248:251], v13 offset:320
    v_mfma_f32_16x16x32_bf16 v[132:135], v[236:239], v[208:211], v[132:135]
    v_mfma_f32_16x16x32_bf16 v[136:139], v[236:239], v[212:215], v[136:139]
    v_mfma_f32_16x16x32_bf16 v[140:143], v[236:239], v[216:219], v[140:143]
    s_waitcnt lgkmcnt(6)
    v_mfma_f32_16x16x32_bf16 v[144:147], v[204:207], v[240:243], v[144:147]
    ds_read_b64_tr_b16 v[236:237], v1 offset:18432
    v_mfma_f32_16x16x32_bf16 v[148:151], v[208:211], v[240:243], v[148:151]
    ds_read_b64_tr_b16 v[238:239], v1 offset:18944
    v_mfma_f32_16x16x32_bf16 v[152:155], v[212:215], v[240:243], v[152:155]
    v_mfma_f32_16x16x32_bf16 v[156:159], v[216:219], v[240:243], v[156:159]
    s_waitcnt lgkmcnt(5)
    v_mfma_f32_16x16x32_bf16 v[160:163], v[204:207], v[244:247], v[160:163]
    ds_read_b64_tr_b16 v[240:241], v2 offset:18432
    v_mfma_f32_16x16x32_bf16 v[164:167], v[208:211], v[244:247], v[164:167]
    ds_read_b64_tr_b16 v[242:243], v2 offset:18944
    v_mfma_f32_16x16x32_bf16 v[168:171], v[212:215], v[244:247], v[168:171]
    v_mfma_f32_16x16x32_bf16 v[172:175], v[216:219], v[244:247], v[172:175]
    s_waitcnt lgkmcnt(4)
    v_mfma_f32_16x16x32_bf16 v[192:195], v[248:251], v[224:227], v[192:195]
    ds_read_b64_tr_b16 v[244:245], v1 offset:19456
    v_mfma_f32_16x16x32_bf16 v[196:199], v[248:251], v[228:231], v[196:199]
    ds_read_b64_tr_b16 v[246:247], v1 offset:19968
    v_mfma_f32_16x16x32_bf16 v[200:203], v[248:251], v[232:235], v[200:203]
    s_waitcnt lgkmcnt(4)
    v_mfma_f32_16x16x32_bf16 v[176:179], v[236:239], v[252:255], v[176:179]
    ds_read_b64_tr_b16 v[248:249], v2 offset:19456
    v_mfma_f32_16x16x32_bf16 v[16:19], v[236:239], v[220:223], v[16:19]
    ds_read_b64_tr_b16 v[250:251], v2 offset:19968
    v_mfma_f32_16x16x32_bf16 v[20:23], v[236:239], v[224:227], v[20:23]
    v_mfma_f32_16x16x32_bf16 v[24:27], v[236:239], v[228:231], v[24:27]
    v_mfma_f32_16x16x32_bf16 v[28:31], v[236:239], v[232:235], v[28:31]
    s_waitcnt lgkmcnt(4)
    v_mfma_f32_16x16x32_bf16 v[180:183], v[240:243], v[252:255], v[180:183]
    ds_read_b64_tr_b16 v[236:237], v3 offset:18432
    v_mfma_f32_16x16x32_bf16 v[32:35], v[240:243], v[220:223], v[32:35]
    ds_read_b64_tr_b16 v[238:239], v3 offset:18944
    v_mfma_f32_16x16x32_bf16 v[36:39], v[240:243], v[224:227], v[36:39]
    v_mfma_f32_16x16x32_bf16 v[40:43], v[240:243], v[228:231], v[40:43]
    v_mfma_f32_16x16x32_bf16 v[44:47], v[240:243], v[232:235], v[44:47]
    s_waitcnt lgkmcnt(4)
    v_mfma_f32_16x16x32_bf16 v[184:187], v[244:247], v[252:255], v[184:187]
    ds_read_b64_tr_b16 v[240:241], v4 offset:18432
    v_mfma_f32_16x16x32_bf16 v[80:83], v[244:247], v[220:223], v[80:83]
    ds_read_b64_tr_b16 v[242:243], v4 offset:18944
    v_mfma_f32_16x16x32_bf16 v[84:87], v[244:247], v[224:227], v[84:87]
    v_mfma_f32_16x16x32_bf16 v[88:91], v[244:247], v[228:231], v[88:91]
    v_mfma_f32_16x16x32_bf16 v[92:95], v[244:247], v[232:235], v[92:95]
    s_waitcnt lgkmcnt(4)
    v_mfma_f32_16x16x32_bf16 v[188:191], v[248:251], v[252:255], v[188:191]
    ds_read_b64_tr_b16 v[244:245], v3 offset:19456
    v_mfma_f32_16x16x32_bf16 v[96:99], v[248:251], v[220:223], v[96:99]
    ds_read_b64_tr_b16 v[246:247], v3 offset:19968
    v_mfma_f32_16x16x32_bf16 v[100:103], v[248:251], v[224:227], v[100:103]
    v_mfma_f32_16x16x32_bf16 v[104:107], v[248:251], v[228:231], v[104:107]
    v_mfma_f32_16x16x32_bf16 v[108:111], v[248:251], v[232:235], v[108:111]
    s_waitcnt lgkmcnt(4)
    v_mfma_f32_16x16x32_bf16 v[48:51], v[236:239], v[220:223], v[48:51]
    ds_read_b64_tr_b16 v[248:249], v4 offset:19456
    v_mfma_f32_16x16x32_bf16 v[52:55], v[236:239], v[224:227], v[52:55]
    ds_read_b64_tr_b16 v[250:251], v4 offset:19968
    v_mfma_f32_16x16x32_bf16 v[56:59], v[236:239], v[228:231], v[56:59]
    v_mfma_f32_16x16x32_bf16 v[60:63], v[236:239], v[232:235], v[60:63]
    s_waitcnt lgkmcnt(4)
    v_mfma_f32_16x16x32_bf16 v[64:67], v[240:243], v[220:223], v[64:67]
    s_barrier
    v_mfma_f32_16x16x32_bf16 v[68:71], v[240:243], v[224:227], v[68:71]
    ds_read_b128 v[236:239], v5 offset:5120
    v_mfma_f32_16x16x32_bf16 v[72:75], v[240:243], v[228:231], v[72:75]
    ds_read_b128 v[204:207], v8 offset:0
    v_mfma_f32_16x16x32_bf16 v[76:79], v[240:243], v[232:235], v[76:79]
    ds_read_b128 v[208:211], v8 offset:2048
    s_waitcnt lgkmcnt(5)
    v_mfma_f32_16x16x32_bf16 v[112:115], v[244:247], v[220:223], v[112:115]
    ds_read_b128 v[240:243], v5 offset:14336
    v_mfma_f32_16x16x32_bf16 v[116:119], v[244:247], v[224:227], v[116:119]
    ds_read_b128 v[212:215], v8 offset:4096
    v_mfma_f32_16x16x32_bf16 v[120:123], v[244:247], v[228:231], v[120:123]
    ds_read_b128 v[216:219], v8 offset:6144
    v_mfma_f32_16x16x32_bf16 v[124:127], v[244:247], v[232:235], v[124:127]
    s_waitcnt lgkmcnt(6)
    v_mfma_f32_16x16x32_bf16 v[128:131], v[248:251], v[220:223], v[128:131]
    ds_read_b128 v[244:247], v13 offset:384
    v_mfma_f32_16x16x32_bf16 v[132:135], v[248:251], v[224:227], v[132:135]
    v_mfma_f32_16x16x32_bf16 v[136:139], v[248:251], v[228:231], v[136:139]
    v_mfma_f32_16x16x32_bf16 v[140:143], v[248:251], v[232:235], v[140:143]
    s_waitcnt lgkmcnt(6)
    v_mfma_f32_16x16x32_bf16 v[144:147], v[220:223], v[236:239], v[144:147]
    ds_read_b64_tr_b16 v[248:249], v1 offset:36864
    v_mfma_f32_16x16x32_bf16 v[148:151], v[224:227], v[236:239], v[148:151]
    ds_read_b64_tr_b16 v[250:251], v1 offset:37376
    v_mfma_f32_16x16x32_bf16 v[152:155], v[228:231], v[236:239], v[152:155]
    v_mfma_f32_16x16x32_bf16 v[156:159], v[232:235], v[236:239], v[156:159]
    s_waitcnt lgkmcnt(5)
    v_mfma_f32_16x16x32_bf16 v[160:163], v[220:223], v[240:243], v[160:163]
    ds_read_b64_tr_b16 v[236:237], v2 offset:36864
    v_mfma_f32_16x16x32_bf16 v[164:167], v[224:227], v[240:243], v[164:167]
    ds_read_b64_tr_b16 v[238:239], v2 offset:37376
    v_mfma_f32_16x16x32_bf16 v[168:171], v[228:231], v[240:243], v[168:171]
    v_mfma_f32_16x16x32_bf16 v[172:175], v[232:235], v[240:243], v[172:175]
    s_waitcnt lgkmcnt(4)
    v_mfma_f32_16x16x32_bf16 v[192:195], v[244:247], v[208:211], v[192:195]
    ds_read_b64_tr_b16 v[240:241], v1 offset:37888
    v_mfma_f32_16x16x32_bf16 v[196:199], v[244:247], v[212:215], v[196:199]
    ds_read_b64_tr_b16 v[242:243], v1 offset:38400
    v_mfma_f32_16x16x32_bf16 v[200:203], v[244:247], v[216:219], v[200:203]
    s_waitcnt lgkmcnt(4)
    v_mfma_f32_16x16x32_bf16 v[176:179], v[248:251], v[252:255], v[176:179]
    ds_read_b64_tr_b16 v[244:245], v2 offset:37888
    v_mfma_f32_16x16x32_bf16 v[16:19], v[248:251], v[204:207], v[16:19]
    ds_read_b64_tr_b16 v[246:247], v2 offset:38400
    v_mfma_f32_16x16x32_bf16 v[20:23], v[248:251], v[208:211], v[20:23]
    v_mfma_f32_16x16x32_bf16 v[24:27], v[248:251], v[212:215], v[24:27]
    v_mfma_f32_16x16x32_bf16 v[28:31], v[248:251], v[216:219], v[28:31]
    s_waitcnt lgkmcnt(4)
    v_mfma_f32_16x16x32_bf16 v[180:183], v[236:239], v[252:255], v[180:183]
    ds_read_b64_tr_b16 v[248:249], v3 offset:36864
    v_mfma_f32_16x16x32_bf16 v[32:35], v[236:239], v[204:207], v[32:35]
    ds_read_b64_tr_b16 v[250:251], v3 offset:37376
    v_mfma_f32_16x16x32_bf16 v[36:39], v[236:239], v[208:211], v[36:39]
    v_mfma_f32_16x16x32_bf16 v[40:43], v[236:239], v[212:215], v[40:43]
    v_mfma_f32_16x16x32_bf16 v[44:47], v[236:239], v[216:219], v[44:47]
    s_waitcnt lgkmcnt(4)
    v_mfma_f32_16x16x32_bf16 v[184:187], v[240:243], v[252:255], v[184:187]
    ds_read_b64_tr_b16 v[236:237], v4 offset:36864
    v_mfma_f32_16x16x32_bf16 v[80:83], v[240:243], v[204:207], v[80:83]
    ds_read_b64_tr_b16 v[238:239], v4 offset:37376
    v_mfma_f32_16x16x32_bf16 v[84:87], v[240:243], v[208:211], v[84:87]
    v_mfma_f32_16x16x32_bf16 v[88:91], v[240:243], v[212:215], v[88:91]
    v_mfma_f32_16x16x32_bf16 v[92:95], v[240:243], v[216:219], v[92:95]
    s_waitcnt lgkmcnt(4)
    v_mfma_f32_16x16x32_bf16 v[188:191], v[244:247], v[252:255], v[188:191]
    ds_read_b64_tr_b16 v[240:241], v3 offset:37888
    v_mfma_f32_16x16x32_bf16 v[96:99], v[244:247], v[204:207], v[96:99]
    ds_read_b64_tr_b16 v[242:243], v3 offset:38400
    v_mfma_f32_16x16x32_bf16 v[100:103], v[244:247], v[208:211], v[100:103]
    v_mfma_f32_16x16x32_bf16 v[104:107], v[244:247], v[212:215], v[104:107]
    v_mfma_f32_16x16x32_bf16 v[108:111], v[244:247], v[216:219], v[108:111]
    s_waitcnt lgkmcnt(4)
    v_mfma_f32_16x16x32_bf16 v[48:51], v[248:251], v[204:207], v[48:51]
    ds_read_b64_tr_b16 v[244:245], v4 offset:37888
    v_mfma_f32_16x16x32_bf16 v[52:55], v[248:251], v[208:211], v[52:55]
    ds_read_b64_tr_b16 v[246:247], v4 offset:38400
    v_mfma_f32_16x16x32_bf16 v[56:59], v[248:251], v[212:215], v[56:59]
    v_mfma_f32_16x16x32_bf16 v[60:63], v[248:251], v[216:219], v[60:63]
    s_waitcnt lgkmcnt(4)
    v_mfma_f32_16x16x32_bf16 v[64:67], v[236:239], v[204:207], v[64:67]
    s_barrier
    v_mfma_f32_16x16x32_bf16 v[68:71], v[236:239], v[208:211], v[68:71]
    ds_read_b128 v[248:251], v5 offset:6144
    v_mfma_f32_16x16x32_bf16 v[72:75], v[236:239], v[212:215], v[72:75]
    ds_read_b128 v[220:223], v14 offset:0
    v_mfma_f32_16x16x32_bf16 v[76:79], v[236:239], v[216:219], v[76:79]
    ds_read_b128 v[224:227], v14 offset:2048
    s_waitcnt lgkmcnt(5)
    v_mfma_f32_16x16x32_bf16 v[112:115], v[240:243], v[204:207], v[112:115]
    ds_read_b128 v[236:239], v5 offset:15360
    v_mfma_f32_16x16x32_bf16 v[116:119], v[240:243], v[208:211], v[116:119]
    ds_read_b128 v[228:231], v14 offset:4096
    v_mfma_f32_16x16x32_bf16 v[120:123], v[240:243], v[212:215], v[120:123]
    ds_read_b128 v[232:235], v14 offset:6144
    v_mfma_f32_16x16x32_bf16 v[124:127], v[240:243], v[216:219], v[124:127]
    s_waitcnt lgkmcnt(6)
    v_mfma_f32_16x16x32_bf16 v[128:131], v[244:247], v[204:207], v[128:131]
    ds_read_b128 v[240:243], v13 offset:448
    v_mfma_f32_16x16x32_bf16 v[132:135], v[244:247], v[208:211], v[132:135]
    v_mfma_f32_16x16x32_bf16 v[136:139], v[244:247], v[212:215], v[136:139]
    v_mfma_f32_16x16x32_bf16 v[140:143], v[244:247], v[216:219], v[140:143]
    s_waitcnt lgkmcnt(6)
    v_mfma_f32_16x16x32_bf16 v[144:147], v[204:207], v[248:251], v[144:147]
    ds_read_b64_tr_b16 v[244:245], v1 offset:55296
    v_mfma_f32_16x16x32_bf16 v[148:151], v[208:211], v[248:251], v[148:151]
    ds_read_b64_tr_b16 v[246:247], v1 offset:55808
    v_mfma_f32_16x16x32_bf16 v[152:155], v[212:215], v[248:251], v[152:155]
    v_mfma_f32_16x16x32_bf16 v[156:159], v[216:219], v[248:251], v[156:159]
    s_waitcnt lgkmcnt(5)
    v_mfma_f32_16x16x32_bf16 v[160:163], v[204:207], v[236:239], v[160:163]
    ds_read_b64_tr_b16 v[248:249], v2 offset:55296
    v_mfma_f32_16x16x32_bf16 v[164:167], v[208:211], v[236:239], v[164:167]
    ds_read_b64_tr_b16 v[250:251], v2 offset:55808
    v_mfma_f32_16x16x32_bf16 v[168:171], v[212:215], v[236:239], v[168:171]
    v_mfma_f32_16x16x32_bf16 v[172:175], v[216:219], v[236:239], v[172:175]
    s_waitcnt lgkmcnt(4)
    v_mfma_f32_16x16x32_bf16 v[192:195], v[240:243], v[224:227], v[192:195]
    ds_read_b64_tr_b16 v[236:237], v1 offset:56320
    v_mfma_f32_16x16x32_bf16 v[196:199], v[240:243], v[228:231], v[196:199]
    ds_read_b64_tr_b16 v[238:239], v1 offset:56832
    v_mfma_f32_16x16x32_bf16 v[200:203], v[240:243], v[232:235], v[200:203]
    s_waitcnt lgkmcnt(4)
    v_mfma_f32_16x16x32_bf16 v[176:179], v[244:247], v[252:255], v[176:179]
    ds_read_b64_tr_b16 v[240:241], v2 offset:56320
    v_mfma_f32_16x16x32_bf16 v[16:19], v[244:247], v[220:223], v[16:19]
    ds_read_b64_tr_b16 v[242:243], v2 offset:56832
    v_mfma_f32_16x16x32_bf16 v[20:23], v[244:247], v[224:227], v[20:23]
    v_mfma_f32_16x16x32_bf16 v[24:27], v[244:247], v[228:231], v[24:27]
    v_mfma_f32_16x16x32_bf16 v[28:31], v[244:247], v[232:235], v[28:31]
    s_waitcnt lgkmcnt(4)
    v_mfma_f32_16x16x32_bf16 v[180:183], v[248:251], v[252:255], v[180:183]
    ds_read_b64_tr_b16 v[244:245], v3 offset:55296
    v_mfma_f32_16x16x32_bf16 v[32:35], v[248:251], v[220:223], v[32:35]
    ds_read_b64_tr_b16 v[246:247], v3 offset:55808
    v_mfma_f32_16x16x32_bf16 v[36:39], v[248:251], v[224:227], v[36:39]
    v_mfma_f32_16x16x32_bf16 v[40:43], v[248:251], v[228:231], v[40:43]
    v_mfma_f32_16x16x32_bf16 v[44:47], v[248:251], v[232:235], v[44:47]
    s_waitcnt lgkmcnt(4)
    v_mfma_f32_16x16x32_bf16 v[184:187], v[236:239], v[252:255], v[184:187]
    ds_read_b64_tr_b16 v[248:249], v4 offset:55296
    v_mfma_f32_16x16x32_bf16 v[80:83], v[236:239], v[220:223], v[80:83]
    ds_read_b64_tr_b16 v[250:251], v4 offset:55808
    v_mfma_f32_16x16x32_bf16 v[84:87], v[236:239], v[224:227], v[84:87]
    v_mfma_f32_16x16x32_bf16 v[88:91], v[236:239], v[228:231], v[88:91]
    v_mfma_f32_16x16x32_bf16 v[92:95], v[236:239], v[232:235], v[92:95]
    s_waitcnt lgkmcnt(4)
    v_mfma_f32_16x16x32_bf16 v[188:191], v[240:243], v[252:255], v[188:191]
    ds_read_b64_tr_b16 v[236:237], v3 offset:56320
    v_mfma_f32_16x16x32_bf16 v[96:99], v[240:243], v[220:223], v[96:99]
    ds_read_b64_tr_b16 v[238:239], v3 offset:56832
    v_mfma_f32_16x16x32_bf16 v[100:103], v[240:243], v[224:227], v[100:103]
    v_mfma_f32_16x16x32_bf16 v[104:107], v[240:243], v[228:231], v[104:107]
    v_mfma_f32_16x16x32_bf16 v[108:111], v[240:243], v[232:235], v[108:111]
    s_waitcnt lgkmcnt(4)
    v_mfma_f32_16x16x32_bf16 v[48:51], v[244:247], v[220:223], v[48:51]
    ds_read_b64_tr_b16 v[240:241], v4 offset:56320
    v_mfma_f32_16x16x32_bf16 v[52:55], v[244:247], v[224:227], v[52:55]
    ds_read_b64_tr_b16 v[242:243], v4 offset:56832
    v_mfma_f32_16x16x32_bf16 v[56:59], v[244:247], v[228:231], v[56:59]
    v_mfma_f32_16x16x32_bf16 v[60:63], v[244:247], v[232:235], v[60:63]
    s_waitcnt lgkmcnt(4)
    v_mfma_f32_16x16x32_bf16 v[64:67], v[248:251], v[220:223], v[64:67]
    s_barrier
    v_mfma_f32_16x16x32_bf16 v[68:71], v[248:251], v[224:227], v[68:71]
    ds_read_b128 v[244:247], v5 offset:7168
    v_mfma_f32_16x16x32_bf16 v[72:75], v[248:251], v[228:231], v[72:75]
    ds_read_b128 v[204:207], v8 offset:16384
    v_mfma_f32_16x16x32_bf16 v[76:79], v[248:251], v[232:235], v[76:79]
    ds_read_b128 v[208:211], v8 offset:18432
    s_waitcnt lgkmcnt(5)
    v_mfma_f32_16x16x32_bf16 v[112:115], v[236:239], v[220:223], v[112:115]
    ds_read_b128 v[248:251], v5 offset:16384
    v_mfma_f32_16x16x32_bf16 v[116:119], v[236:239], v[224:227], v[116:119]
    ds_read_b128 v[212:215], v8 offset:20480
    v_mfma_f32_16x16x32_bf16 v[120:123], v[236:239], v[228:231], v[120:123]
    ds_read_b128 v[216:219], v8 offset:22528
    v_mfma_f32_16x16x32_bf16 v[124:127], v[236:239], v[232:235], v[124:127]
    s_waitcnt lgkmcnt(6)
    v_mfma_f32_16x16x32_bf16 v[128:131], v[240:243], v[220:223], v[128:131]
    ds_read_b128 v[236:239], v13 offset:512
    v_mfma_f32_16x16x32_bf16 v[132:135], v[240:243], v[224:227], v[132:135]
    v_mfma_f32_16x16x32_bf16 v[136:139], v[240:243], v[228:231], v[136:139]
    v_mfma_f32_16x16x32_bf16 v[140:143], v[240:243], v[232:235], v[140:143]
    s_waitcnt lgkmcnt(6)
    v_mfma_f32_16x16x32_bf16 v[144:147], v[220:223], v[244:247], v[144:147]
    ds_read_b64_tr_b16 v[240:241], v1 offset:0
    v_mfma_f32_16x16x32_bf16 v[148:151], v[224:227], v[244:247], v[148:151]
    ds_read_b64_tr_b16 v[242:243], v1 offset:512
    v_mfma_f32_16x16x32_bf16 v[152:155], v[228:231], v[244:247], v[152:155]
    v_mfma_f32_16x16x32_bf16 v[156:159], v[232:235], v[244:247], v[156:159]
    s_waitcnt lgkmcnt(5)
    v_mfma_f32_16x16x32_bf16 v[160:163], v[220:223], v[248:251], v[160:163]
    ds_read_b64_tr_b16 v[244:245], v2 offset:0
    v_mfma_f32_16x16x32_bf16 v[164:167], v[224:227], v[248:251], v[164:167]
    ds_read_b64_tr_b16 v[246:247], v2 offset:512
    v_mfma_f32_16x16x32_bf16 v[168:171], v[228:231], v[248:251], v[168:171]
    v_mfma_f32_16x16x32_bf16 v[172:175], v[232:235], v[248:251], v[172:175]
    s_waitcnt lgkmcnt(4)
    v_mfma_f32_16x16x32_bf16 v[192:195], v[236:239], v[208:211], v[192:195]
    ds_read_b64_tr_b16 v[248:249], v1 offset:1024
    v_mfma_f32_16x16x32_bf16 v[196:199], v[236:239], v[212:215], v[196:199]
    ds_read_b64_tr_b16 v[250:251], v1 offset:1536
    v_mfma_f32_16x16x32_bf16 v[200:203], v[236:239], v[216:219], v[200:203]
    s_waitcnt lgkmcnt(4)
    v_mfma_f32_16x16x32_bf16 v[176:179], v[240:243], v[252:255], v[176:179]
    ds_read_b64_tr_b16 v[236:237], v2 offset:1024
    v_mfma_f32_16x16x32_bf16 v[16:19], v[240:243], v[204:207], v[16:19]
    ds_read_b64_tr_b16 v[238:239], v2 offset:1536
    v_mfma_f32_16x16x32_bf16 v[20:23], v[240:243], v[208:211], v[20:23]
    v_mfma_f32_16x16x32_bf16 v[24:27], v[240:243], v[212:215], v[24:27]
    v_mfma_f32_16x16x32_bf16 v[28:31], v[240:243], v[216:219], v[28:31]
    s_waitcnt lgkmcnt(4)
    v_mfma_f32_16x16x32_bf16 v[180:183], v[244:247], v[252:255], v[180:183]
    ds_read_b64_tr_b16 v[240:241], v3 offset:0
    v_mfma_f32_16x16x32_bf16 v[32:35], v[244:247], v[204:207], v[32:35]
    ds_read_b64_tr_b16 v[242:243], v3 offset:512
    v_mfma_f32_16x16x32_bf16 v[36:39], v[244:247], v[208:211], v[36:39]
    v_mfma_f32_16x16x32_bf16 v[40:43], v[244:247], v[212:215], v[40:43]
    v_mfma_f32_16x16x32_bf16 v[44:47], v[244:247], v[216:219], v[44:47]
    s_waitcnt lgkmcnt(4)
    v_mfma_f32_16x16x32_bf16 v[184:187], v[248:251], v[252:255], v[184:187]
    ds_read_b64_tr_b16 v[244:245], v4 offset:0
    v_mfma_f32_16x16x32_bf16 v[80:83], v[248:251], v[204:207], v[80:83]
    ds_read_b64_tr_b16 v[246:247], v4 offset:512
    v_mfma_f32_16x16x32_bf16 v[84:87], v[248:251], v[208:211], v[84:87]
    v_mfma_f32_16x16x32_bf16 v[88:91], v[248:251], v[212:215], v[88:91]
    v_mfma_f32_16x16x32_bf16 v[92:95], v[248:251], v[216:219], v[92:95]
    s_waitcnt lgkmcnt(4)
    v_mfma_f32_16x16x32_bf16 v[188:191], v[236:239], v[252:255], v[188:191]
    ds_read_b64_tr_b16 v[248:249], v3 offset:1024
    v_mfma_f32_16x16x32_bf16 v[96:99], v[236:239], v[204:207], v[96:99]
    ds_read_b64_tr_b16 v[250:251], v3 offset:1536
    v_mfma_f32_16x16x32_bf16 v[100:103], v[236:239], v[208:211], v[100:103]
    v_mfma_f32_16x16x32_bf16 v[104:107], v[236:239], v[212:215], v[104:107]
    v_mfma_f32_16x16x32_bf16 v[108:111], v[236:239], v[216:219], v[108:111]
    s_waitcnt lgkmcnt(4)
    v_mfma_f32_16x16x32_bf16 v[48:51], v[240:243], v[204:207], v[48:51]
    ds_read_b64_tr_b16 v[236:237], v4 offset:1024
    v_mfma_f32_16x16x32_bf16 v[52:55], v[240:243], v[208:211], v[52:55]
    ds_read_b64_tr_b16 v[238:239], v4 offset:1536
    v_mfma_f32_16x16x32_bf16 v[56:59], v[240:243], v[212:215], v[56:59]
    v_mfma_f32_16x16x32_bf16 v[60:63], v[240:243], v[216:219], v[60:63]
    s_waitcnt lgkmcnt(4)
    v_mfma_f32_16x16x32_bf16 v[64:67], v[244:247], v[204:207], v[64:67]
    s_barrier
    v_mfma_f32_16x16x32_bf16 v[68:71], v[244:247], v[208:211], v[68:71]
    ds_read_b128 v[240:243], v5 offset:8192
    v_mfma_f32_16x16x32_bf16 v[72:75], v[244:247], v[212:215], v[72:75]
    ds_read_b128 v[220:223], v14 offset:16384
    v_mfma_f32_16x16x32_bf16 v[76:79], v[244:247], v[216:219], v[76:79]
    ds_read_b128 v[224:227], v14 offset:18432
    s_waitcnt lgkmcnt(5)
    v_mfma_f32_16x16x32_bf16 v[112:115], v[248:251], v[204:207], v[112:115]
    ds_read_b128 v[244:247], v5 offset:17408
    v_mfma_f32_16x16x32_bf16 v[116:119], v[248:251], v[208:211], v[116:119]
    ds_read_b128 v[228:231], v14 offset:20480
    v_mfma_f32_16x16x32_bf16 v[120:123], v[248:251], v[212:215], v[120:123]
    ds_read_b128 v[232:235], v14 offset:22528
    v_mfma_f32_16x16x32_bf16 v[124:127], v[248:251], v[216:219], v[124:127]
    s_waitcnt lgkmcnt(6)
    v_mfma_f32_16x16x32_bf16 v[128:131], v[236:239], v[204:207], v[128:131]
    ds_read_b128 v[248:251], v13 offset:576
    v_mfma_f32_16x16x32_bf16 v[132:135], v[236:239], v[208:211], v[132:135]
    v_mfma_f32_16x16x32_bf16 v[136:139], v[236:239], v[212:215], v[136:139]
    v_mfma_f32_16x16x32_bf16 v[140:143], v[236:239], v[216:219], v[140:143]
    s_waitcnt lgkmcnt(6)
    v_mfma_f32_16x16x32_bf16 v[144:147], v[204:207], v[240:243], v[144:147]
    ds_read_b64_tr_b16 v[236:237], v1 offset:18432
    v_mfma_f32_16x16x32_bf16 v[148:151], v[208:211], v[240:243], v[148:151]
    ds_read_b64_tr_b16 v[238:239], v1 offset:18944
    v_mfma_f32_16x16x32_bf16 v[152:155], v[212:215], v[240:243], v[152:155]
    v_mfma_f32_16x16x32_bf16 v[156:159], v[216:219], v[240:243], v[156:159]
    s_waitcnt lgkmcnt(5)
    v_mfma_f32_16x16x32_bf16 v[160:163], v[204:207], v[244:247], v[160:163]
    ds_read_b64_tr_b16 v[240:241], v2 offset:18432
    v_mfma_f32_16x16x32_bf16 v[164:167], v[208:211], v[244:247], v[164:167]
    ds_read_b64_tr_b16 v[242:243], v2 offset:18944
    v_mfma_f32_16x16x32_bf16 v[168:171], v[212:215], v[244:247], v[168:171]
    v_mfma_f32_16x16x32_bf16 v[172:175], v[216:219], v[244:247], v[172:175]
    s_waitcnt lgkmcnt(4)
    v_mfma_f32_16x16x32_bf16 v[192:195], v[248:251], v[224:227], v[192:195]
    ds_read_b64_tr_b16 v[244:245], v1 offset:19456
    v_mfma_f32_16x16x32_bf16 v[196:199], v[248:251], v[228:231], v[196:199]
    ds_read_b64_tr_b16 v[246:247], v1 offset:19968
    v_mfma_f32_16x16x32_bf16 v[200:203], v[248:251], v[232:235], v[200:203]
    s_waitcnt lgkmcnt(4)
    v_mfma_f32_16x16x32_bf16 v[176:179], v[236:239], v[252:255], v[176:179]
    ds_read_b64_tr_b16 v[248:249], v2 offset:19456
    v_mfma_f32_16x16x32_bf16 v[16:19], v[236:239], v[220:223], v[16:19]
    ds_read_b64_tr_b16 v[250:251], v2 offset:19968
    v_mfma_f32_16x16x32_bf16 v[20:23], v[236:239], v[224:227], v[20:23]
    v_mfma_f32_16x16x32_bf16 v[24:27], v[236:239], v[228:231], v[24:27]
    v_mfma_f32_16x16x32_bf16 v[28:31], v[236:239], v[232:235], v[28:31]
    s_waitcnt lgkmcnt(4)
    v_mfma_f32_16x16x32_bf16 v[180:183], v[240:243], v[252:255], v[180:183]
    ds_read_b64_tr_b16 v[236:237], v3 offset:18432
    v_mfma_f32_16x16x32_bf16 v[32:35], v[240:243], v[220:223], v[32:35]
    ds_read_b64_tr_b16 v[238:239], v3 offset:18944
    v_mfma_f32_16x16x32_bf16 v[36:39], v[240:243], v[224:227], v[36:39]
    v_mfma_f32_16x16x32_bf16 v[40:43], v[240:243], v[228:231], v[40:43]
    v_mfma_f32_16x16x32_bf16 v[44:47], v[240:243], v[232:235], v[44:47]
    s_waitcnt lgkmcnt(4)
    v_mfma_f32_16x16x32_bf16 v[184:187], v[244:247], v[252:255], v[184:187]
    ds_read_b64_tr_b16 v[240:241], v4 offset:18432
    v_mfma_f32_16x16x32_bf16 v[80:83], v[244:247], v[220:223], v[80:83]
    ds_read_b64_tr_b16 v[242:243], v4 offset:18944
    v_mfma_f32_16x16x32_bf16 v[84:87], v[244:247], v[224:227], v[84:87]
    v_mfma_f32_16x16x32_bf16 v[88:91], v[244:247], v[228:231], v[88:91]
    v_mfma_f32_16x16x32_bf16 v[92:95], v[244:247], v[232:235], v[92:95]
    s_waitcnt lgkmcnt(4)
    v_mfma_f32_16x16x32_bf16 v[188:191], v[248:251], v[252:255], v[188:191]
    ds_read_b64_tr_b16 v[244:245], v3 offset:19456
    v_mfma_f32_16x16x32_bf16 v[96:99], v[248:251], v[220:223], v[96:99]
    ds_read_b64_tr_b16 v[246:247], v3 offset:19968
    v_mfma_f32_16x16x32_bf16 v[100:103], v[248:251], v[224:227], v[100:103]
    v_mfma_f32_16x16x32_bf16 v[104:107], v[248:251], v[228:231], v[104:107]
    v_mfma_f32_16x16x32_bf16 v[108:111], v[248:251], v[232:235], v[108:111]
    s_waitcnt lgkmcnt(4)
    v_mfma_f32_16x16x32_bf16 v[48:51], v[236:239], v[220:223], v[48:51]
    ds_read_b64_tr_b16 v[248:249], v4 offset:19456
    v_mfma_f32_16x16x32_bf16 v[52:55], v[236:239], v[224:227], v[52:55]
    ds_read_b64_tr_b16 v[250:251], v4 offset:19968
    v_mfma_f32_16x16x32_bf16 v[56:59], v[236:239], v[228:231], v[56:59]
    v_mfma_f32_16x16x32_bf16 v[60:63], v[236:239], v[232:235], v[60:63]
    s_waitcnt lgkmcnt(4)
    v_mfma_f32_16x16x32_bf16 v[64:67], v[240:243], v[220:223], v[64:67]
    s_barrier
    v_mfma_f32_16x16x32_bf16 v[68:71], v[240:243], v[224:227], v[68:71]
    ds_read_b128 v[236:239], v5 offset:0
    v_mfma_f32_16x16x32_bf16 v[72:75], v[240:243], v[228:231], v[72:75]
    ds_read_b128 v[204:207], v8 offset:32768
    v_mfma_f32_16x16x32_bf16 v[76:79], v[240:243], v[232:235], v[76:79]
    ds_read_b128 v[208:211], v8 offset:34816
    s_waitcnt lgkmcnt(5)
    v_mfma_f32_16x16x32_bf16 v[112:115], v[244:247], v[220:223], v[112:115]
    ds_read_b128 v[240:243], v5 offset:9216
    v_mfma_f32_16x16x32_bf16 v[116:119], v[244:247], v[224:227], v[116:119]
    ds_read_b128 v[212:215], v8 offset:36864
    v_mfma_f32_16x16x32_bf16 v[120:123], v[244:247], v[228:231], v[120:123]
    ds_read_b128 v[216:219], v8 offset:38912
    v_mfma_f32_16x16x32_bf16 v[124:127], v[244:247], v[232:235], v[124:127]
    s_waitcnt lgkmcnt(6)
    v_mfma_f32_16x16x32_bf16 v[128:131], v[248:251], v[220:223], v[128:131]
    ds_read_b128 v[244:247], v13 offset:640
    v_mfma_f32_16x16x32_bf16 v[132:135], v[248:251], v[224:227], v[132:135]
    v_mfma_f32_16x16x32_bf16 v[136:139], v[248:251], v[228:231], v[136:139]
    v_mfma_f32_16x16x32_bf16 v[140:143], v[248:251], v[232:235], v[140:143]
    s_waitcnt lgkmcnt(6)
    v_mul_f32 v144, s75, v144
    v_mul_f32 v145, s75, v145
    v_mul_f32 v146, s75, v146
    v_mul_f32 v147, s75, v147
    v_mul_f32 v148, s75, v148
    v_mul_f32 v149, s75, v149
    v_mul_f32 v150, s75, v150
    v_mul_f32 v151, s75, v151
    v_mul_f32 v152, s75, v152
    v_mul_f32 v153, s75, v153
    v_mul_f32 v154, s75, v154
    v_mul_f32 v155, s75, v155
    v_mul_f32 v156, s75, v156
    v_mul_f32 v157, s75, v157
    v_mul_f32 v158, s75, v158
    v_mul_f32 v159, s75, v159
    v_mfma_f32_16x16x32_bf16 v[144:147], v[220:223], v[236:239], v[144:147]
    ds_read_b64_tr_b16 v[248:249], v1 offset:36864
    v_mfma_f32_16x16x32_bf16 v[148:151], v[224:227], v[236:239], v[148:151]
    ds_read_b64_tr_b16 v[250:251], v1 offset:37376
    v_mfma_f32_16x16x32_bf16 v[152:155], v[228:231], v[236:239], v[152:155]
    v_mfma_f32_16x16x32_bf16 v[156:159], v[232:235], v[236:239], v[156:159]
    s_waitcnt lgkmcnt(5)
    v_mul_f32 v160, s75, v160
    v_mul_f32 v161, s75, v161
    v_mul_f32 v162, s75, v162
    v_mul_f32 v163, s75, v163
    v_mul_f32 v164, s75, v164
    v_mul_f32 v165, s75, v165
    v_mul_f32 v166, s75, v166
    v_mul_f32 v167, s75, v167
    v_mul_f32 v168, s75, v168
    v_mul_f32 v169, s75, v169
    v_mul_f32 v170, s75, v170
    v_mul_f32 v171, s75, v171
    v_mul_f32 v172, s75, v172
    v_mul_f32 v173, s75, v173
    v_mul_f32 v174, s75, v174
    v_mul_f32 v175, s75, v175
    v_mfma_f32_16x16x32_bf16 v[160:163], v[220:223], v[240:243], v[160:163]
    ds_read_b64_tr_b16 v[236:237], v2 offset:36864
    v_mfma_f32_16x16x32_bf16 v[164:167], v[224:227], v[240:243], v[164:167]
    ds_read_b64_tr_b16 v[238:239], v2 offset:37376
    v_mfma_f32_16x16x32_bf16 v[168:171], v[228:231], v[240:243], v[168:171]
    v_mfma_f32_16x16x32_bf16 v[172:175], v[232:235], v[240:243], v[172:175]
    s_waitcnt lgkmcnt(4)
    v_mfma_f32_16x16x32_bf16 v[192:195], v[244:247], v[208:211], v[192:195]
    ds_read_b64_tr_b16 v[240:241], v1 offset:37888
    v_mfma_f32_16x16x32_bf16 v[196:199], v[244:247], v[212:215], v[196:199]
    ds_read_b64_tr_b16 v[242:243], v1 offset:38400
    v_mfma_f32_16x16x32_bf16 v[200:203], v[244:247], v[216:219], v[200:203]
    s_waitcnt lgkmcnt(4)
    v_mfma_f32_16x16x32_bf16 v[176:179], v[248:251], v[252:255], v[176:179]
    ds_read_b64_tr_b16 v[244:245], v2 offset:37888
    v_mfma_f32_16x16x32_bf16 v[16:19], v[248:251], v[204:207], v[16:19]
    ds_read_b64_tr_b16 v[246:247], v2 offset:38400
    v_mfma_f32_16x16x32_bf16 v[20:23], v[248:251], v[208:211], v[20:23]
    v_mfma_f32_16x16x32_bf16 v[24:27], v[248:251], v[212:215], v[24:27]
    v_mfma_f32_16x16x32_bf16 v[28:31], v[248:251], v[216:219], v[28:31]
    s_waitcnt lgkmcnt(4)
    v_mfma_f32_16x16x32_bf16 v[180:183], v[236:239], v[252:255], v[180:183]
    ds_read_b64_tr_b16 v[248:249], v3 offset:36864
    v_mfma_f32_16x16x32_bf16 v[32:35], v[236:239], v[204:207], v[32:35]
    ds_read_b64_tr_b16 v[250:251], v3 offset:37376
    v_mfma_f32_16x16x32_bf16 v[36:39], v[236:239], v[208:211], v[36:39]
    v_mfma_f32_16x16x32_bf16 v[40:43], v[236:239], v[212:215], v[40:43]
    v_mfma_f32_16x16x32_bf16 v[44:47], v[236:239], v[216:219], v[44:47]
    s_waitcnt lgkmcnt(4)
    v_mfma_f32_16x16x32_bf16 v[184:187], v[240:243], v[252:255], v[184:187]
    ds_read_b64_tr_b16 v[236:237], v4 offset:36864
    v_mfma_f32_16x16x32_bf16 v[80:83], v[240:243], v[204:207], v[80:83]
    ds_read_b64_tr_b16 v[238:239], v4 offset:37376
    v_mfma_f32_16x16x32_bf16 v[84:87], v[240:243], v[208:211], v[84:87]
    v_mfma_f32_16x16x32_bf16 v[88:91], v[240:243], v[212:215], v[88:91]
    v_mfma_f32_16x16x32_bf16 v[92:95], v[240:243], v[216:219], v[92:95]
    s_waitcnt lgkmcnt(4)
    v_mfma_f32_16x16x32_bf16 v[188:191], v[244:247], v[252:255], v[188:191]
    ds_read_b64_tr_b16 v[240:241], v3 offset:37888
    v_mfma_f32_16x16x32_bf16 v[96:99], v[244:247], v[204:207], v[96:99]
    ds_read_b64_tr_b16 v[242:243], v3 offset:38400
    v_mfma_f32_16x16x32_bf16 v[100:103], v[244:247], v[208:211], v[100:103]
    v_mfma_f32_16x16x32_bf16 v[104:107], v[244:247], v[212:215], v[104:107]
    v_mfma_f32_16x16x32_bf16 v[108:111], v[244:247], v[216:219], v[108:111]
    s_waitcnt lgkmcnt(4)
    v_mfma_f32_16x16x32_bf16 v[48:51], v[248:251], v[204:207], v[48:51]
    ds_read_b64_tr_b16 v[244:245], v4 offset:37888
    v_mfma_f32_16x16x32_bf16 v[52:55], v[248:251], v[208:211], v[52:55]
    ds_read_b64_tr_b16 v[246:247], v4 offset:38400
    v_mfma_f32_16x16x32_bf16 v[56:59], v[248:251], v[212:215], v[56:59]
    v_mfma_f32_16x16x32_bf16 v[60:63], v[248:251], v[216:219], v[60:63]
    s_waitcnt lgkmcnt(4)
    v_mfma_f32_16x16x32_bf16 v[64:67], v[236:239], v[204:207], v[64:67]
    s_barrier
    v_mfma_f32_16x16x32_bf16 v[68:71], v[236:239], v[208:211], v[68:71]
    ds_read_b128 v[248:251], v5 offset:1024
    v_mfma_f32_16x16x32_bf16 v[72:75], v[236:239], v[212:215], v[72:75]
    ds_read_b128 v[220:223], v14 offset:32768
    v_mfma_f32_16x16x32_bf16 v[76:79], v[236:239], v[216:219], v[76:79]
    ds_read_b128 v[224:227], v14 offset:34816
    s_waitcnt lgkmcnt(5)
    v_mfma_f32_16x16x32_bf16 v[112:115], v[240:243], v[204:207], v[112:115]
    ds_read_b128 v[236:239], v5 offset:10240
    v_mfma_f32_16x16x32_bf16 v[116:119], v[240:243], v[208:211], v[116:119]
    ds_read_b128 v[228:231], v14 offset:36864
    v_mfma_f32_16x16x32_bf16 v[120:123], v[240:243], v[212:215], v[120:123]
    ds_read_b128 v[232:235], v14 offset:38912
    v_mfma_f32_16x16x32_bf16 v[124:127], v[240:243], v[216:219], v[124:127]
    s_waitcnt lgkmcnt(6)
    v_mfma_f32_16x16x32_bf16 v[128:131], v[244:247], v[204:207], v[128:131]
    ds_read_b128 v[240:243], v13 offset:704
    v_mfma_f32_16x16x32_bf16 v[132:135], v[244:247], v[208:211], v[132:135]
    v_mfma_f32_16x16x32_bf16 v[136:139], v[244:247], v[212:215], v[136:139]
    v_mfma_f32_16x16x32_bf16 v[140:143], v[244:247], v[216:219], v[140:143]
    s_waitcnt lgkmcnt(6)
    v_mfma_f32_16x16x32_bf16 v[144:147], v[204:207], v[248:251], v[144:147]
    ds_read_b64_tr_b16 v[244:245], v1 offset:55296
    v_mfma_f32_16x16x32_bf16 v[148:151], v[208:211], v[248:251], v[148:151]
    ds_read_b64_tr_b16 v[246:247], v1 offset:55808
    v_mfma_f32_16x16x32_bf16 v[152:155], v[212:215], v[248:251], v[152:155]
    v_mfma_f32_16x16x32_bf16 v[156:159], v[216:219], v[248:251], v[156:159]
    s_waitcnt lgkmcnt(5)
    v_mfma_f32_16x16x32_bf16 v[160:163], v[204:207], v[236:239], v[160:163]
    ds_read_b64_tr_b16 v[248:249], v2 offset:55296
    v_mfma_f32_16x16x32_bf16 v[164:167], v[208:211], v[236:239], v[164:167]
    ds_read_b64_tr_b16 v[250:251], v2 offset:55808
    v_mfma_f32_16x16x32_bf16 v[168:171], v[212:215], v[236:239], v[168:171]
    v_mfma_f32_16x16x32_bf16 v[172:175], v[216:219], v[236:239], v[172:175]
    s_waitcnt lgkmcnt(4)
    v_mfma_f32_16x16x32_bf16 v[192:195], v[240:243], v[224:227], v[192:195]
    ds_read_b64_tr_b16 v[236:237], v1 offset:56320
    v_mfma_f32_16x16x32_bf16 v[196:199], v[240:243], v[228:231], v[196:199]
    ds_read_b64_tr_b16 v[238:239], v1 offset:56832
    v_mfma_f32_16x16x32_bf16 v[200:203], v[240:243], v[232:235], v[200:203]
    s_waitcnt lgkmcnt(4)
    v_mfma_f32_16x16x32_bf16 v[176:179], v[244:247], v[252:255], v[176:179]
    ds_read_b64_tr_b16 v[240:241], v2 offset:56320
    v_mfma_f32_16x16x32_bf16 v[16:19], v[244:247], v[220:223], v[16:19]
    ds_read_b64_tr_b16 v[242:243], v2 offset:56832
    v_mfma_f32_16x16x32_bf16 v[20:23], v[244:247], v[224:227], v[20:23]
    v_mfma_f32_16x16x32_bf16 v[24:27], v[244:247], v[228:231], v[24:27]
    v_mfma_f32_16x16x32_bf16 v[28:31], v[244:247], v[232:235], v[28:31]
    s_waitcnt lgkmcnt(4)
    v_mfma_f32_16x16x32_bf16 v[180:183], v[248:251], v[252:255], v[180:183]
    ds_read_b64_tr_b16 v[244:245], v3 offset:55296
    v_mfma_f32_16x16x32_bf16 v[32:35], v[248:251], v[220:223], v[32:35]
    ds_read_b64_tr_b16 v[246:247], v3 offset:55808
    v_mfma_f32_16x16x32_bf16 v[36:39], v[248:251], v[224:227], v[36:39]
    v_mfma_f32_16x16x32_bf16 v[40:43], v[248:251], v[228:231], v[40:43]
    v_mfma_f32_16x16x32_bf16 v[44:47], v[248:251], v[232:235], v[44:47]
    s_waitcnt lgkmcnt(4)
    v_mfma_f32_16x16x32_bf16 v[184:187], v[236:239], v[252:255], v[184:187]
    ds_read_b64_tr_b16 v[248:249], v4 offset:55296
    v_mfma_f32_16x16x32_bf16 v[80:83], v[236:239], v[220:223], v[80:83]
    ds_read_b64_tr_b16 v[250:251], v4 offset:55808
    v_mfma_f32_16x16x32_bf16 v[84:87], v[236:239], v[224:227], v[84:87]
    v_mfma_f32_16x16x32_bf16 v[88:91], v[236:239], v[228:231], v[88:91]
    v_mfma_f32_16x16x32_bf16 v[92:95], v[236:239], v[232:235], v[92:95]
    s_waitcnt lgkmcnt(4)
    v_mfma_f32_16x16x32_bf16 v[188:191], v[240:243], v[252:255], v[188:191]
    ds_read_b64_tr_b16 v[236:237], v3 offset:56320
    v_mfma_f32_16x16x32_bf16 v[96:99], v[240:243], v[220:223], v[96:99]
    ds_read_b64_tr_b16 v[238:239], v3 offset:56832
    v_mfma_f32_16x16x32_bf16 v[100:103], v[240:243], v[224:227], v[100:103]
    v_mfma_f32_16x16x32_bf16 v[104:107], v[240:243], v[228:231], v[104:107]
    v_mfma_f32_16x16x32_bf16 v[108:111], v[240:243], v[232:235], v[108:111]
    s_waitcnt lgkmcnt(4)
    v_mfma_f32_16x16x32_bf16 v[48:51], v[244:247], v[220:223], v[48:51]
    ds_read_b64_tr_b16 v[240:241], v4 offset:56320
    v_mfma_f32_16x16x32_bf16 v[52:55], v[244:247], v[224:227], v[52:55]
    ds_read_b64_tr_b16 v[242:243], v4 offset:56832
    v_mfma_f32_16x16x32_bf16 v[56:59], v[244:247], v[228:231], v[56:59]
    v_mfma_f32_16x16x32_bf16 v[60:63], v[244:247], v[232:235], v[60:63]
    s_waitcnt lgkmcnt(4)
    v_mfma_f32_16x16x32_bf16 v[64:67], v[248:251], v[220:223], v[64:67]
    s_barrier
    v_mfma_f32_16x16x32_bf16 v[68:71], v[248:251], v[224:227], v[68:71]
    ds_read_b128 v[244:247], v5 offset:2048
    v_mfma_f32_16x16x32_bf16 v[72:75], v[248:251], v[228:231], v[72:75]
    ds_read_b128 v[204:207], v8 offset:0
    v_mfma_f32_16x16x32_bf16 v[76:79], v[248:251], v[232:235], v[76:79]
    ds_read_b128 v[208:211], v8 offset:2048
    s_waitcnt lgkmcnt(5)
    v_mfma_f32_16x16x32_bf16 v[112:115], v[236:239], v[220:223], v[112:115]
    ds_read_b128 v[248:251], v5 offset:11264
    v_mfma_f32_16x16x32_bf16 v[116:119], v[236:239], v[224:227], v[116:119]
    ds_read_b128 v[212:215], v8 offset:4096
    v_mfma_f32_16x16x32_bf16 v[120:123], v[236:239], v[228:231], v[120:123]
    ds_read_b128 v[216:219], v8 offset:6144
    v_mfma_f32_16x16x32_bf16 v[124:127], v[236:239], v[232:235], v[124:127]
    s_waitcnt lgkmcnt(6)
    v_mfma_f32_16x16x32_bf16 v[128:131], v[240:243], v[220:223], v[128:131]
    ds_read_b128 v[236:239], v13 offset:768
    v_mfma_f32_16x16x32_bf16 v[132:135], v[240:243], v[224:227], v[132:135]
    v_mfma_f32_16x16x32_bf16 v[136:139], v[240:243], v[228:231], v[136:139]
    v_mfma_f32_16x16x32_bf16 v[140:143], v[240:243], v[232:235], v[140:143]
    s_waitcnt lgkmcnt(6)
    v_mfma_f32_16x16x32_bf16 v[144:147], v[220:223], v[244:247], v[144:147]
    ds_read_b64_tr_b16 v[240:241], v1 offset:0
    v_mfma_f32_16x16x32_bf16 v[148:151], v[224:227], v[244:247], v[148:151]
    ds_read_b64_tr_b16 v[242:243], v1 offset:512
    v_mfma_f32_16x16x32_bf16 v[152:155], v[228:231], v[244:247], v[152:155]
    v_mfma_f32_16x16x32_bf16 v[156:159], v[232:235], v[244:247], v[156:159]
    s_waitcnt lgkmcnt(5)
    v_mfma_f32_16x16x32_bf16 v[160:163], v[220:223], v[248:251], v[160:163]
    ds_read_b64_tr_b16 v[244:245], v2 offset:0
    v_mfma_f32_16x16x32_bf16 v[164:167], v[224:227], v[248:251], v[164:167]
    ds_read_b64_tr_b16 v[246:247], v2 offset:512
    v_mfma_f32_16x16x32_bf16 v[168:171], v[228:231], v[248:251], v[168:171]
    v_mfma_f32_16x16x32_bf16 v[172:175], v[232:235], v[248:251], v[172:175]
    s_waitcnt lgkmcnt(4)
    v_mfma_f32_16x16x32_bf16 v[192:195], v[236:239], v[208:211], v[192:195]
    ds_read_b64_tr_b16 v[248:249], v1 offset:1024
    v_mfma_f32_16x16x32_bf16 v[196:199], v[236:239], v[212:215], v[196:199]
    ds_read_b64_tr_b16 v[250:251], v1 offset:1536
    v_mfma_f32_16x16x32_bf16 v[200:203], v[236:239], v[216:219], v[200:203]
    s_waitcnt lgkmcnt(4)
    v_mfma_f32_16x16x32_bf16 v[176:179], v[240:243], v[252:255], v[176:179]
    ds_read_b64_tr_b16 v[236:237], v2 offset:1024
    v_mfma_f32_16x16x32_bf16 v[16:19], v[240:243], v[204:207], v[16:19]
    ds_read_b64_tr_b16 v[238:239], v2 offset:1536
    v_mfma_f32_16x16x32_bf16 v[20:23], v[240:243], v[208:211], v[20:23]
    v_mfma_f32_16x16x32_bf16 v[24:27], v[240:243], v[212:215], v[24:27]
    v_mfma_f32_16x16x32_bf16 v[28:31], v[240:243], v[216:219], v[28:31]
    s_waitcnt lgkmcnt(4)
    v_mfma_f32_16x16x32_bf16 v[180:183], v[244:247], v[252:255], v[180:183]
    ds_read_b64_tr_b16 v[240:241], v3 offset:0
    v_mfma_f32_16x16x32_bf16 v[32:35], v[244:247], v[204:207], v[32:35]
    ds_read_b64_tr_b16 v[242:243], v3 offset:512
    v_mfma_f32_16x16x32_bf16 v[36:39], v[244:247], v[208:211], v[36:39]
    v_mfma_f32_16x16x32_bf16 v[40:43], v[244:247], v[212:215], v[40:43]
    v_mfma_f32_16x16x32_bf16 v[44:47], v[244:247], v[216:219], v[44:47]
    s_waitcnt lgkmcnt(4)
    v_mfma_f32_16x16x32_bf16 v[184:187], v[248:251], v[252:255], v[184:187]
    ds_read_b64_tr_b16 v[244:245], v4 offset:0
    v_mfma_f32_16x16x32_bf16 v[80:83], v[248:251], v[204:207], v[80:83]
    ds_read_b64_tr_b16 v[246:247], v4 offset:512
    v_mfma_f32_16x16x32_bf16 v[84:87], v[248:251], v[208:211], v[84:87]
    v_mfma_f32_16x16x32_bf16 v[88:91], v[248:251], v[212:215], v[88:91]
    v_mfma_f32_16x16x32_bf16 v[92:95], v[248:251], v[216:219], v[92:95]
    s_waitcnt lgkmcnt(4)
    v_mfma_f32_16x16x32_bf16 v[188:191], v[236:239], v[252:255], v[188:191]
    ds_read_b64_tr_b16 v[248:249], v3 offset:1024
    v_mfma_f32_16x16x32_bf16 v[96:99], v[236:239], v[204:207], v[96:99]
    ds_read_b64_tr_b16 v[250:251], v3 offset:1536
    v_mfma_f32_16x16x32_bf16 v[100:103], v[236:239], v[208:211], v[100:103]
    v_mfma_f32_16x16x32_bf16 v[104:107], v[236:239], v[212:215], v[104:107]
    v_mfma_f32_16x16x32_bf16 v[108:111], v[236:239], v[216:219], v[108:111]
    s_waitcnt lgkmcnt(4)
    v_mfma_f32_16x16x32_bf16 v[48:51], v[240:243], v[204:207], v[48:51]
    ds_read_b64_tr_b16 v[236:237], v4 offset:1024
    v_mfma_f32_16x16x32_bf16 v[52:55], v[240:243], v[208:211], v[52:55]
    ds_read_b64_tr_b16 v[238:239], v4 offset:1536
    v_mfma_f32_16x16x32_bf16 v[56:59], v[240:243], v[212:215], v[56:59]
    v_mfma_f32_16x16x32_bf16 v[60:63], v[240:243], v[216:219], v[60:63]
    s_waitcnt lgkmcnt(4)
    v_mfma_f32_16x16x32_bf16 v[64:67], v[244:247], v[204:207], v[64:67]
    s_barrier
    v_mfma_f32_16x16x32_bf16 v[68:71], v[244:247], v[208:211], v[68:71]
    ds_read_b128 v[240:243], v5 offset:3072
    v_mfma_f32_16x16x32_bf16 v[72:75], v[244:247], v[212:215], v[72:75]
    ds_read_b128 v[220:223], v14 offset:0
    v_mfma_f32_16x16x32_bf16 v[76:79], v[244:247], v[216:219], v[76:79]
    ds_read_b128 v[224:227], v14 offset:2048
    s_waitcnt lgkmcnt(5)
    v_mfma_f32_16x16x32_bf16 v[112:115], v[248:251], v[204:207], v[112:115]
    ds_read_b128 v[244:247], v5 offset:12288
    v_mfma_f32_16x16x32_bf16 v[116:119], v[248:251], v[208:211], v[116:119]
    ds_read_b128 v[228:231], v14 offset:4096
    v_mfma_f32_16x16x32_bf16 v[120:123], v[248:251], v[212:215], v[120:123]
    ds_read_b128 v[232:235], v14 offset:6144
    v_mfma_f32_16x16x32_bf16 v[124:127], v[248:251], v[216:219], v[124:127]
    s_waitcnt lgkmcnt(6)
    v_mfma_f32_16x16x32_bf16 v[128:131], v[236:239], v[204:207], v[128:131]
    ds_read_b128 v[248:251], v13 offset:832
    v_mfma_f32_16x16x32_bf16 v[132:135], v[236:239], v[208:211], v[132:135]
    v_mfma_f32_16x16x32_bf16 v[136:139], v[236:239], v[212:215], v[136:139]
    v_mfma_f32_16x16x32_bf16 v[140:143], v[236:239], v[216:219], v[140:143]
    s_waitcnt lgkmcnt(6)
    v_mfma_f32_16x16x32_bf16 v[144:147], v[204:207], v[240:243], v[144:147]
    ds_read_b64_tr_b16 v[236:237], v1 offset:18432
    v_mfma_f32_16x16x32_bf16 v[148:151], v[208:211], v[240:243], v[148:151]
    ds_read_b64_tr_b16 v[238:239], v1 offset:18944
    v_mfma_f32_16x16x32_bf16 v[152:155], v[212:215], v[240:243], v[152:155]
    v_mfma_f32_16x16x32_bf16 v[156:159], v[216:219], v[240:243], v[156:159]
    s_waitcnt lgkmcnt(5)
    v_mfma_f32_16x16x32_bf16 v[160:163], v[204:207], v[244:247], v[160:163]
    ds_read_b64_tr_b16 v[240:241], v2 offset:18432
    v_mfma_f32_16x16x32_bf16 v[164:167], v[208:211], v[244:247], v[164:167]
    ds_read_b64_tr_b16 v[242:243], v2 offset:18944
    v_mfma_f32_16x16x32_bf16 v[168:171], v[212:215], v[244:247], v[168:171]
    v_mfma_f32_16x16x32_bf16 v[172:175], v[216:219], v[244:247], v[172:175]
    s_waitcnt lgkmcnt(4)
    v_mfma_f32_16x16x32_bf16 v[192:195], v[248:251], v[224:227], v[192:195]
    ds_read_b64_tr_b16 v[244:245], v1 offset:19456
    v_mfma_f32_16x16x32_bf16 v[196:199], v[248:251], v[228:231], v[196:199]
    ds_read_b64_tr_b16 v[246:247], v1 offset:19968
    v_mfma_f32_16x16x32_bf16 v[200:203], v[248:251], v[232:235], v[200:203]
    s_waitcnt lgkmcnt(4)
    v_mfma_f32_16x16x32_bf16 v[176:179], v[236:239], v[252:255], v[176:179]
    ds_read_b64_tr_b16 v[248:249], v2 offset:19456
    v_mfma_f32_16x16x32_bf16 v[16:19], v[236:239], v[220:223], v[16:19]
    ds_read_b64_tr_b16 v[250:251], v2 offset:19968
    v_mfma_f32_16x16x32_bf16 v[20:23], v[236:239], v[224:227], v[20:23]
    v_mfma_f32_16x16x32_bf16 v[24:27], v[236:239], v[228:231], v[24:27]
    v_mfma_f32_16x16x32_bf16 v[28:31], v[236:239], v[232:235], v[28:31]
    s_waitcnt lgkmcnt(4)
    v_mfma_f32_16x16x32_bf16 v[180:183], v[240:243], v[252:255], v[180:183]
    ds_read_b64_tr_b16 v[236:237], v3 offset:18432
    v_mfma_f32_16x16x32_bf16 v[32:35], v[240:243], v[220:223], v[32:35]
    ds_read_b64_tr_b16 v[238:239], v3 offset:18944
    v_mfma_f32_16x16x32_bf16 v[36:39], v[240:243], v[224:227], v[36:39]
    v_mfma_f32_16x16x32_bf16 v[40:43], v[240:243], v[228:231], v[40:43]
    v_mfma_f32_16x16x32_bf16 v[44:47], v[240:243], v[232:235], v[44:47]
    s_waitcnt lgkmcnt(4)
    v_mfma_f32_16x16x32_bf16 v[184:187], v[244:247], v[252:255], v[184:187]
    ds_read_b64_tr_b16 v[240:241], v4 offset:18432
    v_mfma_f32_16x16x32_bf16 v[80:83], v[244:247], v[220:223], v[80:83]
    ds_read_b64_tr_b16 v[242:243], v4 offset:18944
    v_mfma_f32_16x16x32_bf16 v[84:87], v[244:247], v[224:227], v[84:87]
    v_mfma_f32_16x16x32_bf16 v[88:91], v[244:247], v[228:231], v[88:91]
    v_mfma_f32_16x16x32_bf16 v[92:95], v[244:247], v[232:235], v[92:95]
    s_waitcnt lgkmcnt(4)
    v_mfma_f32_16x16x32_bf16 v[188:191], v[248:251], v[252:255], v[188:191]
    ds_read_b64_tr_b16 v[244:245], v3 offset:19456
    v_mfma_f32_16x16x32_bf16 v[96:99], v[248:251], v[220:223], v[96:99]
    ds_read_b64_tr_b16 v[246:247], v3 offset:19968
    v_mfma_f32_16x16x32_bf16 v[100:103], v[248:251], v[224:227], v[100:103]
    v_mfma_f32_16x16x32_bf16 v[104:107], v[248:251], v[228:231], v[104:107]
    v_mfma_f32_16x16x32_bf16 v[108:111], v[248:251], v[232:235], v[108:111]
    s_waitcnt lgkmcnt(4)
    v_mfma_f32_16x16x32_bf16 v[48:51], v[236:239], v[220:223], v[48:51]
    ds_read_b64_tr_b16 v[248:249], v4 offset:19456
    v_mfma_f32_16x16x32_bf16 v[52:55], v[236:239], v[224:227], v[52:55]
    ds_read_b64_tr_b16 v[250:251], v4 offset:19968
    v_mfma_f32_16x16x32_bf16 v[56:59], v[236:239], v[228:231], v[56:59]
    v_mfma_f32_16x16x32_bf16 v[60:63], v[236:239], v[232:235], v[60:63]
    s_waitcnt lgkmcnt(4)
    v_mfma_f32_16x16x32_bf16 v[64:67], v[240:243], v[220:223], v[64:67]
    s_barrier
    v_mfma_f32_16x16x32_bf16 v[68:71], v[240:243], v[224:227], v[68:71]
    ds_read_b128 v[236:239], v5 offset:4096
    v_mfma_f32_16x16x32_bf16 v[72:75], v[240:243], v[228:231], v[72:75]
    ds_read_b128 v[204:207], v8 offset:16384
    v_mfma_f32_16x16x32_bf16 v[76:79], v[240:243], v[232:235], v[76:79]
    ds_read_b128 v[208:211], v8 offset:18432
    s_waitcnt lgkmcnt(5)
    v_mfma_f32_16x16x32_bf16 v[112:115], v[244:247], v[220:223], v[112:115]
    ds_read_b128 v[240:243], v5 offset:13312
    v_mfma_f32_16x16x32_bf16 v[116:119], v[244:247], v[224:227], v[116:119]
    ds_read_b128 v[212:215], v8 offset:20480
    v_mfma_f32_16x16x32_bf16 v[120:123], v[244:247], v[228:231], v[120:123]
    ds_read_b128 v[216:219], v8 offset:22528
    v_mfma_f32_16x16x32_bf16 v[124:127], v[244:247], v[232:235], v[124:127]
    s_waitcnt lgkmcnt(6)
    v_mfma_f32_16x16x32_bf16 v[128:131], v[248:251], v[220:223], v[128:131]
    ds_read_b128 v[244:247], v13 offset:896
    v_mfma_f32_16x16x32_bf16 v[132:135], v[248:251], v[224:227], v[132:135]
    v_mfma_f32_16x16x32_bf16 v[136:139], v[248:251], v[228:231], v[136:139]
    v_mfma_f32_16x16x32_bf16 v[140:143], v[248:251], v[232:235], v[140:143]
    s_waitcnt lgkmcnt(6)
    v_mfma_f32_16x16x32_bf16 v[144:147], v[220:223], v[236:239], v[144:147]
    ds_read_b64_tr_b16 v[248:249], v1 offset:36864
    v_mfma_f32_16x16x32_bf16 v[148:151], v[224:227], v[236:239], v[148:151]
    ds_read_b64_tr_b16 v[250:251], v1 offset:37376
    v_mfma_f32_16x16x32_bf16 v[152:155], v[228:231], v[236:239], v[152:155]
    v_mfma_f32_16x16x32_bf16 v[156:159], v[232:235], v[236:239], v[156:159]
    s_waitcnt lgkmcnt(5)
    v_mfma_f32_16x16x32_bf16 v[160:163], v[220:223], v[240:243], v[160:163]
    ds_read_b64_tr_b16 v[236:237], v2 offset:36864
    v_mfma_f32_16x16x32_bf16 v[164:167], v[224:227], v[240:243], v[164:167]
    ds_read_b64_tr_b16 v[238:239], v2 offset:37376
    v_mfma_f32_16x16x32_bf16 v[168:171], v[228:231], v[240:243], v[168:171]
    v_mfma_f32_16x16x32_bf16 v[172:175], v[232:235], v[240:243], v[172:175]
    s_waitcnt lgkmcnt(4)
    v_mfma_f32_16x16x32_bf16 v[192:195], v[244:247], v[208:211], v[192:195]
    ds_read_b64_tr_b16 v[240:241], v1 offset:37888
    v_mfma_f32_16x16x32_bf16 v[196:199], v[244:247], v[212:215], v[196:199]
    ds_read_b64_tr_b16 v[242:243], v1 offset:38400
    v_mfma_f32_16x16x32_bf16 v[200:203], v[244:247], v[216:219], v[200:203]
    s_waitcnt lgkmcnt(4)
    v_mfma_f32_16x16x32_bf16 v[176:179], v[248:251], v[252:255], v[176:179]
    ds_read_b64_tr_b16 v[244:245], v2 offset:37888
    v_mfma_f32_16x16x32_bf16 v[16:19], v[248:251], v[204:207], v[16:19]
    ds_read_b64_tr_b16 v[246:247], v2 offset:38400
    v_mfma_f32_16x16x32_bf16 v[20:23], v[248:251], v[208:211], v[20:23]
    v_mfma_f32_16x16x32_bf16 v[24:27], v[248:251], v[212:215], v[24:27]
    v_mfma_f32_16x16x32_bf16 v[28:31], v[248:251], v[216:219], v[28:31]
    s_waitcnt lgkmcnt(4)
    v_mfma_f32_16x16x32_bf16 v[180:183], v[236:239], v[252:255], v[180:183]
    ds_read_b64_tr_b16 v[248:249], v3 offset:36864
    v_mfma_f32_16x16x32_bf16 v[32:35], v[236:239], v[204:207], v[32:35]
    ds_read_b64_tr_b16 v[250:251], v3 offset:37376
    v_mfma_f32_16x16x32_bf16 v[36:39], v[236:239], v[208:211], v[36:39]
    v_mfma_f32_16x16x32_bf16 v[40:43], v[236:239], v[212:215], v[40:43]
    v_mfma_f32_16x16x32_bf16 v[44:47], v[236:239], v[216:219], v[44:47]
    s_waitcnt lgkmcnt(4)
    v_mfma_f32_16x16x32_bf16 v[184:187], v[240:243], v[252:255], v[184:187]
    ds_read_b64_tr_b16 v[236:237], v4 offset:36864
    v_mfma_f32_16x16x32_bf16 v[80:83], v[240:243], v[204:207], v[80:83]
    ds_read_b64_tr_b16 v[238:239], v4 offset:37376
    v_mfma_f32_16x16x32_bf16 v[84:87], v[240:243], v[208:211], v[84:87]
    v_mfma_f32_16x16x32_bf16 v[88:91], v[240:243], v[212:215], v[88:91]
    v_mfma_f32_16x16x32_bf16 v[92:95], v[240:243], v[216:219], v[92:95]
    s_waitcnt lgkmcnt(4)
    v_mfma_f32_16x16x32_bf16 v[188:191], v[244:247], v[252:255], v[188:191]
    ds_read_b64_tr_b16 v[240:241], v3 offset:37888
    v_mfma_f32_16x16x32_bf16 v[96:99], v[244:247], v[204:207], v[96:99]
    ds_read_b64_tr_b16 v[242:243], v3 offset:38400
    v_mfma_f32_16x16x32_bf16 v[100:103], v[244:247], v[208:211], v[100:103]
    v_mfma_f32_16x16x32_bf16 v[104:107], v[244:247], v[212:215], v[104:107]
    v_mfma_f32_16x16x32_bf16 v[108:111], v[244:247], v[216:219], v[108:111]
    s_waitcnt lgkmcnt(4)
    v_mfma_f32_16x16x32_bf16 v[48:51], v[248:251], v[204:207], v[48:51]
    ds_read_b64_tr_b16 v[244:245], v4 offset:37888
    v_mfma_f32_16x16x32_bf16 v[52:55], v[248:251], v[208:211], v[52:55]
    ds_read_b64_tr_b16 v[246:247], v4 offset:38400
    v_mfma_f32_16x16x32_bf16 v[56:59], v[248:251], v[212:215], v[56:59]
    v_mfma_f32_16x16x32_bf16 v[60:63], v[248:251], v[216:219], v[60:63]
    s_waitcnt lgkmcnt(4)
    v_mfma_f32_16x16x32_bf16 v[64:67], v[236:239], v[204:207], v[64:67]
    s_barrier
    v_mfma_f32_16x16x32_bf16 v[68:71], v[236:239], v[208:211], v[68:71]
    ds_read_b128 v[248:251], v5 offset:5120
    v_mfma_f32_16x16x32_bf16 v[72:75], v[236:239], v[212:215], v[72:75]
    ds_read_b128 v[220:223], v14 offset:16384
    v_mfma_f32_16x16x32_bf16 v[76:79], v[236:239], v[216:219], v[76:79]
    ds_read_b128 v[224:227], v14 offset:18432
    s_waitcnt lgkmcnt(5)
    v_mfma_f32_16x16x32_bf16 v[112:115], v[240:243], v[204:207], v[112:115]
    ds_read_b128 v[236:239], v5 offset:14336
    v_mfma_f32_16x16x32_bf16 v[116:119], v[240:243], v[208:211], v[116:119]
    ds_read_b128 v[228:231], v14 offset:20480
    v_mfma_f32_16x16x32_bf16 v[120:123], v[240:243], v[212:215], v[120:123]
    ds_read_b128 v[232:235], v14 offset:22528
    v_mfma_f32_16x16x32_bf16 v[124:127], v[240:243], v[216:219], v[124:127]
    s_waitcnt lgkmcnt(6)
    v_mfma_f32_16x16x32_bf16 v[128:131], v[244:247], v[204:207], v[128:131]
    ds_read_b128 v[240:243], v13 offset:960
    v_mfma_f32_16x16x32_bf16 v[132:135], v[244:247], v[208:211], v[132:135]
    v_mfma_f32_16x16x32_bf16 v[136:139], v[244:247], v[212:215], v[136:139]
    v_mfma_f32_16x16x32_bf16 v[140:143], v[244:247], v[216:219], v[140:143]
    s_waitcnt lgkmcnt(6)
    v_mfma_f32_16x16x32_bf16 v[144:147], v[204:207], v[248:251], v[144:147]
    ds_read_b64_tr_b16 v[244:245], v1 offset:55296
    v_mfma_f32_16x16x32_bf16 v[148:151], v[208:211], v[248:251], v[148:151]
    ds_read_b64_tr_b16 v[246:247], v1 offset:55808
    v_mfma_f32_16x16x32_bf16 v[152:155], v[212:215], v[248:251], v[152:155]
    v_mfma_f32_16x16x32_bf16 v[156:159], v[216:219], v[248:251], v[156:159]
    s_waitcnt lgkmcnt(5)
    v_mfma_f32_16x16x32_bf16 v[160:163], v[204:207], v[236:239], v[160:163]
    ds_read_b64_tr_b16 v[248:249], v2 offset:55296
    v_mfma_f32_16x16x32_bf16 v[164:167], v[208:211], v[236:239], v[164:167]
    ds_read_b64_tr_b16 v[250:251], v2 offset:55808
    v_mfma_f32_16x16x32_bf16 v[168:171], v[212:215], v[236:239], v[168:171]
    v_mfma_f32_16x16x32_bf16 v[172:175], v[216:219], v[236:239], v[172:175]
    s_waitcnt lgkmcnt(4)
    v_mfma_f32_16x16x32_bf16 v[192:195], v[240:243], v[224:227], v[192:195]
    ds_read_b64_tr_b16 v[236:237], v1 offset:56320
    v_mfma_f32_16x16x32_bf16 v[196:199], v[240:243], v[228:231], v[196:199]
    ds_read_b64_tr_b16 v[238:239], v1 offset:56832
    v_mfma_f32_16x16x32_bf16 v[200:203], v[240:243], v[232:235], v[200:203]
    s_waitcnt lgkmcnt(4)
    v_mfma_f32_16x16x32_bf16 v[176:179], v[244:247], v[252:255], v[176:179]
    ds_read_b64_tr_b16 v[240:241], v2 offset:56320
    v_mfma_f32_16x16x32_bf16 v[16:19], v[244:247], v[220:223], v[16:19]
    ds_read_b64_tr_b16 v[242:243], v2 offset:56832
    v_mfma_f32_16x16x32_bf16 v[20:23], v[244:247], v[224:227], v[20:23]
    v_mfma_f32_16x16x32_bf16 v[24:27], v[244:247], v[228:231], v[24:27]
    v_mfma_f32_16x16x32_bf16 v[28:31], v[244:247], v[232:235], v[28:31]
    s_waitcnt lgkmcnt(4)
    v_mfma_f32_16x16x32_bf16 v[180:183], v[248:251], v[252:255], v[180:183]
    ds_read_b64_tr_b16 v[244:245], v3 offset:55296
    v_mfma_f32_16x16x32_bf16 v[32:35], v[248:251], v[220:223], v[32:35]
    ds_read_b64_tr_b16 v[246:247], v3 offset:55808
    v_mfma_f32_16x16x32_bf16 v[36:39], v[248:251], v[224:227], v[36:39]
    v_mfma_f32_16x16x32_bf16 v[40:43], v[248:251], v[228:231], v[40:43]
    v_mfma_f32_16x16x32_bf16 v[44:47], v[248:251], v[232:235], v[44:47]
    s_waitcnt lgkmcnt(4)
    v_mfma_f32_16x16x32_bf16 v[184:187], v[236:239], v[252:255], v[184:187]
    ds_read_b64_tr_b16 v[248:249], v4 offset:55296
    v_mfma_f32_16x16x32_bf16 v[80:83], v[236:239], v[220:223], v[80:83]
    ds_read_b64_tr_b16 v[250:251], v4 offset:55808
    v_mfma_f32_16x16x32_bf16 v[84:87], v[236:239], v[224:227], v[84:87]
    v_mfma_f32_16x16x32_bf16 v[88:91], v[236:239], v[228:231], v[88:91]
    v_mfma_f32_16x16x32_bf16 v[92:95], v[236:239], v[232:235], v[92:95]
    s_waitcnt lgkmcnt(4)
    v_mfma_f32_16x16x32_bf16 v[188:191], v[240:243], v[252:255], v[188:191]
    ds_read_b64_tr_b16 v[236:237], v3 offset:56320
    v_mfma_f32_16x16x32_bf16 v[96:99], v[240:243], v[220:223], v[96:99]
    ds_read_b64_tr_b16 v[238:239], v3 offset:56832
    v_mfma_f32_16x16x32_bf16 v[100:103], v[240:243], v[224:227], v[100:103]
    v_mfma_f32_16x16x32_bf16 v[104:107], v[240:243], v[228:231], v[104:107]
    v_mfma_f32_16x16x32_bf16 v[108:111], v[240:243], v[232:235], v[108:111]
    s_waitcnt lgkmcnt(4)
    v_mfma_f32_16x16x32_bf16 v[48:51], v[244:247], v[220:223], v[48:51]
    ds_read_b64_tr_b16 v[240:241], v4 offset:56320
    v_mfma_f32_16x16x32_bf16 v[52:55], v[244:247], v[224:227], v[52:55]
    ds_read_b64_tr_b16 v[242:243], v4 offset:56832
    v_mfma_f32_16x16x32_bf16 v[56:59], v[244:247], v[228:231], v[56:59]
    v_mfma_f32_16x16x32_bf16 v[60:63], v[244:247], v[232:235], v[60:63]
    s_waitcnt lgkmcnt(4)
    v_mfma_f32_16x16x32_bf16 v[64:67], v[248:251], v[220:223], v[64:67]
    s_barrier
    v_mfma_f32_16x16x32_bf16 v[68:71], v[248:251], v[224:227], v[68:71]
    ds_read_b128 v[244:247], v5 offset:6144
    v_mfma_f32_16x16x32_bf16 v[72:75], v[248:251], v[228:231], v[72:75]
    ds_read_b128 v[204:207], v8 offset:32768
    v_mfma_f32_16x16x32_bf16 v[76:79], v[248:251], v[232:235], v[76:79]
    ds_read_b128 v[208:211], v8 offset:34816
    s_waitcnt lgkmcnt(5)
    v_mfma_f32_16x16x32_bf16 v[112:115], v[236:239], v[220:223], v[112:115]
    ds_read_b128 v[248:251], v5 offset:15360
    v_mfma_f32_16x16x32_bf16 v[116:119], v[236:239], v[224:227], v[116:119]
    ds_read_b128 v[212:215], v8 offset:36864
    v_mfma_f32_16x16x32_bf16 v[120:123], v[236:239], v[228:231], v[120:123]
    ds_read_b128 v[216:219], v8 offset:38912
    v_mfma_f32_16x16x32_bf16 v[124:127], v[236:239], v[232:235], v[124:127]
    s_waitcnt lgkmcnt(6)
    v_mfma_f32_16x16x32_bf16 v[128:131], v[240:243], v[220:223], v[128:131]
    ds_read_b128 v[236:239], v13 offset:1024
    v_mfma_f32_16x16x32_bf16 v[132:135], v[240:243], v[224:227], v[132:135]
    v_mfma_f32_16x16x32_bf16 v[136:139], v[240:243], v[228:231], v[136:139]
    v_mfma_f32_16x16x32_bf16 v[140:143], v[240:243], v[232:235], v[140:143]
    s_waitcnt lgkmcnt(6)
    v_mfma_f32_16x16x32_bf16 v[144:147], v[220:223], v[244:247], v[144:147]
    ds_read_b64_tr_b16 v[240:241], v1 offset:0
    v_mfma_f32_16x16x32_bf16 v[148:151], v[224:227], v[244:247], v[148:151]
    ds_read_b64_tr_b16 v[242:243], v1 offset:512
    v_mfma_f32_16x16x32_bf16 v[152:155], v[228:231], v[244:247], v[152:155]
    v_mfma_f32_16x16x32_bf16 v[156:159], v[232:235], v[244:247], v[156:159]
    s_waitcnt lgkmcnt(5)
    v_mfma_f32_16x16x32_bf16 v[160:163], v[220:223], v[248:251], v[160:163]
    ds_read_b64_tr_b16 v[244:245], v2 offset:0
    v_mfma_f32_16x16x32_bf16 v[164:167], v[224:227], v[248:251], v[164:167]
    ds_read_b64_tr_b16 v[246:247], v2 offset:512
    v_mfma_f32_16x16x32_bf16 v[168:171], v[228:231], v[248:251], v[168:171]
    v_mfma_f32_16x16x32_bf16 v[172:175], v[232:235], v[248:251], v[172:175]
    s_waitcnt lgkmcnt(4)
    v_mfma_f32_16x16x32_bf16 v[192:195], v[236:239], v[208:211], v[192:195]
    ds_read_b64_tr_b16 v[248:249], v1 offset:1024
    v_mfma_f32_16x16x32_bf16 v[196:199], v[236:239], v[212:215], v[196:199]
    ds_read_b64_tr_b16 v[250:251], v1 offset:1536
    v_mfma_f32_16x16x32_bf16 v[200:203], v[236:239], v[216:219], v[200:203]
    s_waitcnt lgkmcnt(4)
    v_mfma_f32_16x16x32_bf16 v[176:179], v[240:243], v[252:255], v[176:179]
    ds_read_b64_tr_b16 v[236:237], v2 offset:1024
    v_mfma_f32_16x16x32_bf16 v[16:19], v[240:243], v[204:207], v[16:19]
    ds_read_b64_tr_b16 v[238:239], v2 offset:1536
    v_mfma_f32_16x16x32_bf16 v[20:23], v[240:243], v[208:211], v[20:23]
    v_mfma_f32_16x16x32_bf16 v[24:27], v[240:243], v[212:215], v[24:27]
    v_mfma_f32_16x16x32_bf16 v[28:31], v[240:243], v[216:219], v[28:31]
    s_waitcnt lgkmcnt(4)
    v_mfma_f32_16x16x32_bf16 v[180:183], v[244:247], v[252:255], v[180:183]
    ds_read_b64_tr_b16 v[240:241], v3 offset:0
    v_mfma_f32_16x16x32_bf16 v[32:35], v[244:247], v[204:207], v[32:35]
    ds_read_b64_tr_b16 v[242:243], v3 offset:512
    v_mfma_f32_16x16x32_bf16 v[36:39], v[244:247], v[208:211], v[36:39]
    v_mfma_f32_16x16x32_bf16 v[40:43], v[244:247], v[212:215], v[40:43]
    v_mfma_f32_16x16x32_bf16 v[44:47], v[244:247], v[216:219], v[44:47]
    s_waitcnt lgkmcnt(4)
    v_mfma_f32_16x16x32_bf16 v[184:187], v[248:251], v[252:255], v[184:187]
    ds_read_b64_tr_b16 v[244:245], v4 offset:0
    v_mfma_f32_16x16x32_bf16 v[80:83], v[248:251], v[204:207], v[80:83]
    ds_read_b64_tr_b16 v[246:247], v4 offset:512
    v_mfma_f32_16x16x32_bf16 v[84:87], v[248:251], v[208:211], v[84:87]
    v_mfma_f32_16x16x32_bf16 v[88:91], v[248:251], v[212:215], v[88:91]
    v_mfma_f32_16x16x32_bf16 v[92:95], v[248:251], v[216:219], v[92:95]
    s_waitcnt lgkmcnt(4)
    v_mfma_f32_16x16x32_bf16 v[188:191], v[236:239], v[252:255], v[188:191]
    ds_read_b64_tr_b16 v[248:249], v3 offset:1024
    v_mfma_f32_16x16x32_bf16 v[96:99], v[236:239], v[204:207], v[96:99]
    ds_read_b64_tr_b16 v[250:251], v3 offset:1536
    v_mfma_f32_16x16x32_bf16 v[100:103], v[236:239], v[208:211], v[100:103]
    v_mfma_f32_16x16x32_bf16 v[104:107], v[236:239], v[212:215], v[104:107]
    v_mfma_f32_16x16x32_bf16 v[108:111], v[236:239], v[216:219], v[108:111]
    s_waitcnt lgkmcnt(4)
    v_mfma_f32_16x16x32_bf16 v[48:51], v[240:243], v[204:207], v[48:51]
    ds_read_b64_tr_b16 v[236:237], v4 offset:1024
    v_mfma_f32_16x16x32_bf16 v[52:55], v[240:243], v[208:211], v[52:55]
    ds_read_b64_tr_b16 v[238:239], v4 offset:1536
    v_mfma_f32_16x16x32_bf16 v[56:59], v[240:243], v[212:215], v[56:59]
    v_mfma_f32_16x16x32_bf16 v[60:63], v[240:243], v[216:219], v[60:63]
    s_waitcnt lgkmcnt(4)
    v_mfma_f32_16x16x32_bf16 v[64:67], v[244:247], v[204:207], v[64:67]
    s_barrier
    v_mfma_f32_16x16x32_bf16 v[68:71], v[244:247], v[208:211], v[68:71]
    ds_read_b128 v[240:243], v5 offset:7168
    v_mfma_f32_16x16x32_bf16 v[72:75], v[244:247], v[212:215], v[72:75]
    ds_read_b128 v[220:223], v14 offset:32768
    v_mfma_f32_16x16x32_bf16 v[76:79], v[244:247], v[216:219], v[76:79]
    ds_read_b128 v[224:227], v14 offset:34816
    s_waitcnt lgkmcnt(5)
    v_mfma_f32_16x16x32_bf16 v[112:115], v[248:251], v[204:207], v[112:115]
    ds_read_b128 v[244:247], v5 offset:16384
    v_mfma_f32_16x16x32_bf16 v[116:119], v[248:251], v[208:211], v[116:119]
    ds_read_b128 v[228:231], v14 offset:36864
    v_mfma_f32_16x16x32_bf16 v[120:123], v[248:251], v[212:215], v[120:123]
    ds_read_b128 v[232:235], v14 offset:38912
    v_mfma_f32_16x16x32_bf16 v[124:127], v[248:251], v[216:219], v[124:127]
    s_waitcnt lgkmcnt(6)
    v_mfma_f32_16x16x32_bf16 v[128:131], v[236:239], v[204:207], v[128:131]
    ds_read_b128 v[248:251], v13 offset:1088
    v_mfma_f32_16x16x32_bf16 v[132:135], v[236:239], v[208:211], v[132:135]
    v_mfma_f32_16x16x32_bf16 v[136:139], v[236:239], v[212:215], v[136:139]
    v_mfma_f32_16x16x32_bf16 v[140:143], v[236:239], v[216:219], v[140:143]
    s_waitcnt lgkmcnt(6)
    v_mfma_f32_16x16x32_bf16 v[144:147], v[204:207], v[240:243], v[144:147]
    ds_read_b64_tr_b16 v[236:237], v1 offset:18432
    v_mfma_f32_16x16x32_bf16 v[148:151], v[208:211], v[240:243], v[148:151]
    ds_read_b64_tr_b16 v[238:239], v1 offset:18944
    v_mfma_f32_16x16x32_bf16 v[152:155], v[212:215], v[240:243], v[152:155]
    v_mfma_f32_16x16x32_bf16 v[156:159], v[216:219], v[240:243], v[156:159]
    s_waitcnt lgkmcnt(5)
    v_mfma_f32_16x16x32_bf16 v[160:163], v[204:207], v[244:247], v[160:163]
    ds_read_b64_tr_b16 v[240:241], v2 offset:18432
    v_mfma_f32_16x16x32_bf16 v[164:167], v[208:211], v[244:247], v[164:167]
    ds_read_b64_tr_b16 v[242:243], v2 offset:18944
    v_mfma_f32_16x16x32_bf16 v[168:171], v[212:215], v[244:247], v[168:171]
    v_mfma_f32_16x16x32_bf16 v[172:175], v[216:219], v[244:247], v[172:175]
    s_waitcnt lgkmcnt(4)
    v_mfma_f32_16x16x32_bf16 v[192:195], v[248:251], v[224:227], v[192:195]
    ds_read_b64_tr_b16 v[244:245], v1 offset:19456
    v_mfma_f32_16x16x32_bf16 v[196:199], v[248:251], v[228:231], v[196:199]
    ds_read_b64_tr_b16 v[246:247], v1 offset:19968
    v_mfma_f32_16x16x32_bf16 v[200:203], v[248:251], v[232:235], v[200:203]
    s_lshl_b32 s59, s52, 9
    s_lshl_b32 s60, s51, 7
    s_add_u32 s59, s59, s60
    s_add_u32 s59, s59, 159744
    s_waitcnt lgkmcnt(4)
    v_mfma_f32_16x16x32_bf16 v[176:179], v[236:239], v[252:255], v[176:179]
    ds_read_b64_tr_b16 v[248:249], v2 offset:19456
    v_mfma_f32_16x16x32_bf16 v[16:19], v[236:239], v[220:223], v[16:19]
    ds_read_b64_tr_b16 v[250:251], v2 offset:19968
    v_mfma_f32_16x16x32_bf16 v[20:23], v[236:239], v[224:227], v[20:23]
    v_lshl_add_u32 v208, v10, 4, s59
    v_mfma_f32_16x16x32_bf16 v[24:27], v[236:239], v[228:231], v[24:27]
    s_lshl_b32 s59, s51, 8
    s_add_u32 s59, s59, 162304
    v_mfma_f32_16x16x32_bf16 v[28:31], v[236:239], v[232:235], v[28:31]
    v_lshl_add_u32 v209, v9, 2, s59
    s_waitcnt lgkmcnt(4)
    v_mfma_f32_16x16x32_bf16 v[180:183], v[240:243], v[252:255], v[180:183]
    ds_read_b64_tr_b16 v[236:237], v3 offset:18432
    v_mfma_f32_16x16x32_bf16 v[32:35], v[240:243], v[220:223], v[32:35]
    ds_read_b64_tr_b16 v[238:239], v3 offset:18944
    v_mfma_f32_16x16x32_bf16 v[36:39], v[240:243], v[224:227], v[36:39]
    v_lshl_add_u32 v210, v0, 2, s59
    v_mfma_f32_16x16x32_bf16 v[40:43], v[240:243], v[228:231], v[40:43]
    s_lshl_b32 s59, s48, 10
    s_add_u32 s59, s59, 45056
    v_mfma_f32_16x16x32_bf16 v[44:47], v[240:243], v[232:235], v[44:47]
    v_lshl_add_u32 v8, v0, 3, s59
    s_waitcnt lgkmcnt(4)
    v_mfma_f32_16x16x32_bf16 v[184:187], v[244:247], v[252:255], v[184:187]
    ds_read_b64_tr_b16 v[240:241], v4 offset:18432
    v_mfma_f32_16x16x32_bf16 v[80:83], v[244:247], v[220:223], v[80:83]
    ds_read_b64_tr_b16 v[242:243], v4 offset:18944
    v_mfma_f32_16x16x32_bf16 v[84:87], v[244:247], v[224:227], v[84:87]
    v_lshl_add_u32 v211, v9, 3, s59
    v_mfma_f32_16x16x32_bf16 v[88:91], v[244:247], v[228:231], v[88:91]
    v_lshl_add_u32 v14, v0, 2, s59
    v_mfma_f32_16x16x32_bf16 v[92:95], v[244:247], v[232:235], v[92:95]
    v_lshl_add_u32 v15, v10, 4, s59
    s_waitcnt lgkmcnt(4)
    v_mfma_f32_16x16x32_bf16 v[188:191], v[248:251], v[252:255], v[188:191]
    ds_read_b64_tr_b16 v[244:245], v3 offset:19456
    v_mfma_f32_16x16x32_bf16 v[96:99], v[248:251], v[220:223], v[96:99]
    ds_read_b64_tr_b16 v[246:247], v3 offset:19968
    v_mfma_f32_16x16x32_bf16 v[100:103], v[248:251], v[224:227], v[100:103]
    s_mov_b32 exec_lo, 0xffff0000
    s_mov_b32 exec_hi, 0
    ds_write_b32 v209, v192 offset:64
    ds_write_b32 v209, v196 offset:128
    ds_write_b32 v209, v200 offset:192
    s_mov_b64 exec, -1
    v_mfma_f32_16x16x32_bf16 v[104:107], v[248:251], v[228:231], v[104:107]
    s_mov_b32 exec_lo, 0x10001
    s_mov_b32 exec_hi, 0x10001
    ds_write_b128 v208, v[176:179] offset:0
    s_mov_b64 exec, -1
    v_mfma_f32_16x16x32_bf16 v[108:111], v[248:251], v[232:235], v[108:111]
    s_mov_b32 exec_lo, 0x10001
    s_mov_b32 exec_hi, 0x10001
    ds_write_b128 v208, v[180:183] offset:64
    s_mov_b64 exec, -1
    s_waitcnt lgkmcnt(9)
    v_mfma_f32_16x16x32_bf16 v[48:51], v[236:239], v[220:223], v[48:51]
    ds_read_b64_tr_b16 v[248:249], v4 offset:19456
    v_mfma_f32_16x16x32_bf16 v[52:55], v[236:239], v[224:227], v[52:55]
    ds_read_b64_tr_b16 v[250:251], v4 offset:19968
    v_mfma_f32_16x16x32_bf16 v[56:59], v[236:239], v[228:231], v[56:59]
    s_mov_b32 exec_lo, 0x10001
    s_mov_b32 exec_hi, 0x10001
    ds_write_b128 v208, v[184:187] offset:256
    s_mov_b64 exec, -1
    v_mfma_f32_16x16x32_bf16 v[60:63], v[236:239], v[232:235], v[60:63]
    s_mov_b32 exec_lo, 0x10001
    s_mov_b32 exec_hi, 0x10001
    ds_write_b128 v208, v[188:191] offset:320
    s_mov_b64 exec, -1
    s_waitcnt lgkmcnt(11)
    v_mfma_f32_16x16x32_bf16 v[64:67], v[240:243], v[220:223], v[64:67]
    s_waitcnt lgkmcnt(0)
    s_barrier
    v_mfma_f32_16x16x32_bf16 v[68:71], v[240:243], v[224:227], v[68:71]
    ds_read_b128 v[236:239], v5 offset:8192
    v_mfma_f32_16x16x32_bf16 v[72:75], v[240:243], v[228:231], v[72:75]
    ds_read_b32 v204, v210
    v_mfma_f32_16x16x32_bf16 v[76:79], v[240:243], v[232:235], v[76:79]
    ds_read2st64_b32 v[206:207], v210 offset0:2 offset1:4
    v_mfma_f32_16x16x32_bf16 v[112:115], v[244:247], v[220:223], v[112:115]
    ds_read_b128 v[240:243], v5 offset:17408
    v_mfma_f32_16x16x32_bf16 v[116:119], v[244:247], v[224:227], v[116:119]
    s_mul_i32 s58, s73, 294912
    s_mul_i32 s59, s50, 9
    s_xor_b32 s61, s64, 1
    s_lshl_b32 s61, s61, 3
    v_mfma_f32_16x16x32_bf16 v[120:123], v[244:247], v[228:231], v[120:123]
    s_add_u32 s61, s61, s59
    s_lshl_b32 s61, s61, 11
    v_mfma_f32_16x16x32_bf16 v[124:127], v[244:247], v[232:235], v[124:127]
    s_add_u32 s40, s58, s61
    s_add_u32 s59, s59, s64
    s_lshl_b32 s61, s52, 2
    s_add_u32 s59, s59, s61
    v_mfma_f32_16x16x32_bf16 v[128:131], v[248:251], v[220:223], v[128:131]
    s_lshl_b32 s59, s59, 11
    s_add_u32 s58, s58, s59
    v_mfma_f32_16x16x32_bf16 v[132:135], v[248:251], v[224:227], v[132:135]
    s_lshl_b32 s59, s51, 11
    s_add_u32 s36, s58, s59
    s_xor_b32 s59, s59, 2048
    s_add_u32 s37, s58, s59
    v_mfma_f32_16x16x32_bf16 v[136:139], v[248:251], v[228:231], v[136:139]
    s_waitcnt lgkmcnt(1)
    v_mfma_f32_16x16x32_bf16 v[140:143], v[248:251], v[232:235], v[140:143]
    v_add_f32 v206, v206, v207
    v_mul_f32 v204, 0xbae38e39, v204
    v_mul_f32 v206, 0x3ae38e39, v206
    v_fma_f32 v206, -v204, v204, v206
    v_mfma_f32_16x16x32_bf16 v[144:147], v[220:223], v[236:239], v[144:147]
    v_max_f32 v206, 0, v206
    v_cvt_pk_bf16_f32 v204, v204, v206
    v_mfma_f32_16x16x32_bf16 v[148:151], v[224:227], v[236:239], v[148:151]
    v_and_b32 v206, 0xffff0000, v204
    v_lshlrev_b32 v204, 16, v204
    v_add_f32 v206, 0x3727c5ac, v206
    v_cvt_pk_bf16_f32 v206, v206, v206
    v_mfma_f32_16x16x32_bf16 v[152:155], v[228:231], v[236:239], v[152:155]
    v_lshlrev_b32 v206, 16, v206
    v_sqrt_f32 v206, v206
    v_mfma_f32_16x16x32_bf16 v[156:159], v[232:235], v[236:239], v[156:159]
    v_cvt_pk_bf16_f32 v206, v206, v206
    v_lshlrev_b32 v206, 16, v206
    v_rcp_f32 v205, v206
    s_waitcnt lgkmcnt(0)
    v_mfma_f32_16x16x32_bf16 v[160:163], v[220:223], v[240:243], v[160:163]
    v_mul_f32 v206, 0x3fb8aa3b, v205
    v_mul_f32 v207, v204, v206
    v_mfma_f32_16x16x32_bf16 v[164:167], v[224:227], v[240:243], v[164:167]
    ds_write_b64 v8, v[206:207]
    ds_write2st64_b32 v14, v205, v204 offset0:2 offset1:3
    ds_read_b64 v[212:213], v211 offset:0
    v_mfma_f32_16x16x32_bf16 v[168:171], v[228:231], v[240:243], v[168:171]
    ds_read_b64 v[214:215], v211 offset:128
    v_mfma_f32_16x16x32_bf16 v[172:175], v[232:235], v[240:243], v[172:175]
    ds_read_b64 v[216:217], v211 offset:256
    ds_read_b64 v[218:219], v211 offset:384
    s_lshl_b32 s59, s52, 9
    s_add_u32 s59, s59, 159744
    v_lshl_add_u32 v4, v10, 4, s59
    v_add_u32 v1, s60, v4
    s_xor_b32 s60, s60, 128
    v_add_u32 v2, s60, v4
    s_lshl_b32 s61, s64, 7
    v_add_u32 v5, s61, v1
    v_add_u32 v6, s61, v2
    s_xor_b32 s61, s64, 1
    s_lshl_b32 s61, s61, 10
    s_add_u32 s61, s61, 161024
    v_lshl_add_u32 v11, v10, 4, s61
    s_add_u32 s38, s36, 4096
    s_add_u32 s39, s37, 4096
    v_mov_b32 v244, -0.5
    v_mov_b32 v245, -0.5
    v_mov_b32 v246, -1.0
    v_mov_b32 v247, -1.0
    ds_read_b128 v[220:223], v1 offset:0
    ds_read_b128 v[224:227], v5 offset:1280
    ds_read_b128 v[228:231], v1 offset:64
    ds_read_b128 v[232:235], v5 offset:1344
    s_waitcnt lgkmcnt(4)
    v_lshrrev_b32 v236, 2, v9
    v_lshlrev_b32 v236, 4, v236
    v_and_b32 v237, 3, v9
    v_lshl_add_u32 v236, v237, 1, v236
    s_lshl_b32 s76, s51, 7
    s_add_u32 s76, s76, 122880
    v_add_u32 v236, s76, v236
    ds_read_b128 v[176:179], v15 offset:512
    ds_read_b128 v[180:183], v15 offset:768
    ds_read_b128 v[184:187], v15 offset:576
    ds_read_b128 v[188:191], v15 offset:832
    v_mul_f32 v238, 0x3f317218, v214
    v_mul_f32 v192, v192, v238
    v_mul_f32 v193, v193, v238
    v_mul_f32 v194, v194, v238
    v_mul_f32 v195, v195, v238
    v_cvt_pk_bf16_f32 v192, v192, v193
    v_cvt_pk_bf16_f32 v193, v194, v195
    v_mul_f32 v238, 0x3f317218, v216
    v_mul_f32 v196, v196, v238
    v_mul_f32 v197, v197, v238
    v_mul_f32 v198, v198, v238
    v_mul_f32 v199, v199, v238
    v_cvt_pk_bf16_f32 v196, v196, v197
    v_cvt_pk_bf16_f32 v197, v198, v199
    v_mul_f32 v238, 0x3f317218, v218
    v_mul_f32 v200, v200, v238
    v_mul_f32 v201, v201, v238
    v_mul_f32 v202, v202, v238
    v_mul_f32 v203, v203, v238
    v_cvt_pk_bf16_f32 v200, v200, v201
    v_cvt_pk_bf16_f32 v201, v202, v203
    s_barrier
    s_mov_b64 exec, 0xffff
    ds_write_b16 v236, v192 offset:8200
    ds_write_b16 v236, v196 offset:8256
    ds_write_b16 v236, v200 offset:8264
    ds_write_b16_d16_hi v236, v192 offset:8456
    ds_write_b16_d16_hi v236, v196 offset:8512
    ds_write_b16_d16_hi v236, v200 offset:8520
    ds_write_b16 v236, v193 offset:8712
    ds_write_b16 v236, v197 offset:8768
    ds_write_b16 v236, v201 offset:8776
    ds_write_b16_d16_hi v236, v193 offset:8968
    ds_write_b16_d16_hi v236, v197 offset:9024
    ds_write_b16_d16_hi v236, v201 offset:9032
    s_mov_b64 exec, -1
    s_mov_b32 s78, 0
    s_cmp_eq_u32 s50, 0
    s_cselect_b32 s78, 0x44100000, s78
    s_cmp_eq_u32 s50, 2
    s_cselect_b32 s78, 0xbe800000, s78
    s_cmp_eq_u32 s50, 4
    s_cselect_b32 s78, 0xbe800000, s78
    s_cmp_eq_u32 s50, 8
    s_cselect_b32 s78, 0xbe800000, s78
    v_cmp_eq_u32 vcc, 0, v9
    v_mov_b32 v237, s78
    v_lshlrev_b32 v238, 4, v10
    v_lshl_add_u32 v238, v9, 8, v238
    v_cndmask_b32 v237, 0, v237, vcc
    v_add_u32 v238, s76, v238
    s_waitcnt lgkmcnt(14)
    v_fmac_f32 v144, v180, v237
    v_fmac_f32 v145, v181, v237
    v_fmac_f32 v146, v182, v237
    v_fmac_f32 v147, v183, v237
    v_pk_mul_f32 v[144:145], v[144:145], v[176:177]
    v_pk_mul_f32 v[146:147], v[146:147], v[178:179]
    v_cvt_pk_bf16_f32 v144, v144, v145
    v_cvt_pk_bf16_f32 v145, v146, v147
    v_pk_mul_f32 v[160:161], v[160:161], v[176:177]
    v_pk_mul_f32 v[162:163], v[162:163], v[178:179]
    v_cvt_pk_bf16_f32 v160, v160, v161
    v_cvt_pk_bf16_f32 v161, v162, v163
    ds_read_b128 v[176:179], v15 offset:640
    ds_read_b128 v[180:183], v15 offset:896
    s_waitcnt lgkmcnt(14)
    v_fmac_f32 v148, v188, v237
    v_fmac_f32 v149, v189, v237
    v_fmac_f32 v150, v190, v237
    v_fmac_f32 v151, v191, v237
    v_pk_mul_f32 v[148:149], v[148:149], v[184:185]
    v_pk_mul_f32 v[150:151], v[150:151], v[186:187]
    v_cvt_pk_bf16_f32 v146, v148, v149
    v_cvt_pk_bf16_f32 v147, v150, v151
    ds_write_b128 v238, v[144:147] offset:0
    v_pk_mul_f32 v[164:165], v[164:165], v[184:185]
    v_pk_mul_f32 v[166:167], v[166:167], v[186:187]
    v_cvt_pk_bf16_f32 v162, v164, v165
    v_cvt_pk_bf16_f32 v163, v166, v167
    ds_write_b128 v238, v[160:163] offset:4096
    ds_read_b128 v[184:187], v15 offset:704
    ds_read_b128 v[188:191], v15 offset:960
    s_waitcnt lgkmcnt(4)
    v_fmac_f32 v152, v180, v237
    v_fmac_f32 v153, v181, v237
    v_fmac_f32 v154, v182, v237
    v_fmac_f32 v155, v183, v237
    v_pk_mul_f32 v[152:153], v[152:153], v[176:177]
    v_pk_mul_f32 v[154:155], v[154:155], v[178:179]
    v_cvt_pk_bf16_f32 v152, v152, v153
    v_cvt_pk_bf16_f32 v153, v154, v155
    v_pk_mul_f32 v[168:169], v[168:169], v[176:177]
    v_pk_mul_f32 v[170:171], v[170:171], v[178:179]
    v_cvt_pk_bf16_f32 v168, v168, v169
    v_cvt_pk_bf16_f32 v169, v170, v171
    s_waitcnt lgkmcnt(0)
    v_fmac_f32 v156, v188, v237
    v_fmac_f32 v157, v189, v237
    v_fmac_f32 v158, v190, v237
    v_fmac_f32 v159, v191, v237
    v_pk_mul_f32 v[156:157], v[156:157], v[184:185]
    v_pk_mul_f32 v[158:159], v[158:159], v[186:187]
    v_cvt_pk_bf16_f32 v154, v156, v157
    v_cvt_pk_bf16_f32 v155, v158, v159
    ds_write_b128 v238, v[152:155] offset:64
    v_pk_mul_f32 v[172:173], v[172:173], v[184:185]
    v_pk_mul_f32 v[174:175], v[174:175], v[186:187]
    v_cvt_pk_bf16_f32 v170, v172, v173
    v_cvt_pk_bf16_f32 v171, v174, v175
    ds_write_b128 v238, v[168:171] offset:4160
    s_waitcnt lgkmcnt(0)
    s_barrier
    s_mul_i32 s59, s51, 0x6000
    s_add_u32 s59, s59, 81920
    s_cmp_eq_u32 s3, 0
    s_cselect_b32 s59, 132096, s59
    v_add_u32 v12, s59, v7
.p2align 3
    v_pk_fma_f32 v[236:237], v[220:221], v[212:213], v[224:225] op_sel:[0,1,0] op_sel_hi:[1,1,1]
    v_pk_fma_f32 v[238:239], v[222:223], v[212:213], v[226:227] op_sel:[0,1,0] op_sel_hi:[1,1,1]
    v_pk_fma_f32 v[16:17], v[16:17], v[212:213], v[236:237] op_sel_hi:[1,0,1]
    v_pk_fma_f32 v[18:19], v[18:19], v[212:213], v[238:239] op_sel_hi:[1,0,1]
    v_pk_fma_f32 v[240:241], v[220:221], v[214:215], v[224:225] op_sel:[0,1,0] op_sel_hi:[1,1,1]
    v_pk_fma_f32 v[242:243], v[222:223], v[214:215], v[226:227] op_sel:[0,1,0] op_sel_hi:[1,1,1]
    v_pk_fma_f32 v[20:21], v[20:21], v[214:215], v[240:241] op_sel_hi:[1,0,1]
    v_pk_fma_f32 v[22:23], v[22:23], v[214:215], v[242:243] op_sel_hi:[1,0,1]
    v_pk_fma_f32 v[236:237], v[220:221], v[216:217], v[224:225] op_sel:[0,1,0] op_sel_hi:[1,1,1]
    v_pk_fma_f32 v[238:239], v[222:223], v[216:217], v[226:227] op_sel:[0,1,0] op_sel_hi:[1,1,1]
    v_pk_fma_f32 v[24:25], v[24:25], v[216:217], v[236:237] op_sel_hi:[1,0,1]
    v_pk_fma_f32 v[26:27], v[26:27], v[216:217], v[238:239] op_sel_hi:[1,0,1]
    v_pk_fma_f32 v[240:241], v[220:221], v[218:219], v[224:225] op_sel:[0,1,0] op_sel_hi:[1,1,1]
    v_pk_fma_f32 v[242:243], v[222:223], v[218:219], v[226:227] op_sel:[0,1,0] op_sel_hi:[1,1,1]
    v_pk_fma_f32 v[28:29], v[28:29], v[218:219], v[240:241] op_sel_hi:[1,0,1]
    v_pk_fma_f32 v[30:31], v[30:31], v[218:219], v[242:243] op_sel_hi:[1,0,1]
    ds_read_b128 v[220:223], v2 offset:0
    ds_read_b128 v[224:227], v6 offset:1280
.p2align 3
    v_pk_fma_f32 v[236:237], v[228:229], v[212:213], v[232:233] op_sel:[0,1,0] op_sel_hi:[1,1,1]
    v_pk_fma_f32 v[238:239], v[230:231], v[212:213], v[234:235] op_sel:[0,1,0] op_sel_hi:[1,1,1]
    v_pk_fma_f32 v[32:33], v[32:33], v[212:213], v[236:237] op_sel_hi:[1,0,1]
    v_pk_fma_f32 v[34:35], v[34:35], v[212:213], v[238:239] op_sel_hi:[1,0,1]
    v_pk_fma_f32 v[240:241], v[228:229], v[214:215], v[232:233] op_sel:[0,1,0] op_sel_hi:[1,1,1]
    v_pk_fma_f32 v[242:243], v[230:231], v[214:215], v[234:235] op_sel:[0,1,0] op_sel_hi:[1,1,1]
    v_pk_fma_f32 v[36:37], v[36:37], v[214:215], v[240:241] op_sel_hi:[1,0,1]
    v_pk_fma_f32 v[38:39], v[38:39], v[214:215], v[242:243] op_sel_hi:[1,0,1]
    v_pk_fma_f32 v[236:237], v[228:229], v[216:217], v[232:233] op_sel:[0,1,0] op_sel_hi:[1,1,1]
    v_pk_fma_f32 v[238:239], v[230:231], v[216:217], v[234:235] op_sel:[0,1,0] op_sel_hi:[1,1,1]
    v_pk_fma_f32 v[40:41], v[40:41], v[216:217], v[236:237] op_sel_hi:[1,0,1]
    v_pk_fma_f32 v[42:43], v[42:43], v[216:217], v[238:239] op_sel_hi:[1,0,1]
    v_pk_fma_f32 v[240:241], v[228:229], v[218:219], v[232:233] op_sel:[0,1,0] op_sel_hi:[1,1,1]
    v_pk_fma_f32 v[242:243], v[230:231], v[218:219], v[234:235] op_sel:[0,1,0] op_sel_hi:[1,1,1]
    v_pk_fma_f32 v[44:45], v[44:45], v[218:219], v[240:241] op_sel_hi:[1,0,1]
    v_pk_fma_f32 v[46:47], v[46:47], v[218:219], v[242:243] op_sel_hi:[1,0,1]
    ds_read_b128 v[228:231], v2 offset:64
    ds_read_b128 v[232:235], v6 offset:1344
.p2align 3
    v_exp_f32 v236, v16
    v_exp_f32 v237, v17
    v_exp_f32 v238, v18
    v_exp_f32 v239, v19
    v_exp_f32 v240, v32
    v_exp_f32 v241, v33
    v_exp_f32 v242, v34
    v_exp_f32 v243, v35
    v_pk_fma_f32 v[248:249], v[236:237], v[244:245], v[246:247]
    v_pk_fma_f32 v[250:251], v[238:239], v[244:245], v[246:247]
    v_pk_fma_f32 v[252:253], v[240:241], v[244:245], v[246:247]
    v_pk_fma_f32 v[254:255], v[242:243], v[244:245], v[246:247]
    v_pk_fma_f32 v[236:237], v[236:237], v[248:249], v[246:247]
    v_pk_fma_f32 v[238:239], v[238:239], v[250:251], v[246:247]
    v_pk_fma_f32 v[240:241], v[240:241], v[252:253], v[246:247]
    v_pk_fma_f32 v[242:243], v[242:243], v[254:255], v[246:247]
    v_rcp_f32 v236, v236
    v_rcp_f32 v237, v237
    v_rcp_f32 v238, v238
    v_rcp_f32 v239, v239
    v_rcp_f32 v240, v240
    v_rcp_f32 v241, v241
    v_rcp_f32 v242, v242
    v_rcp_f32 v243, v243
    v_pk_fma_f32 v[16:17], v[16:17], v[236:237], v[16:17]
    v_pk_fma_f32 v[18:19], v[18:19], v[238:239], v[18:19]
    v_pk_fma_f32 v[32:33], v[32:33], v[240:241], v[32:33]
    v_pk_fma_f32 v[34:35], v[34:35], v[242:243], v[34:35]
    v_cvt_pk_bf16_f32 v16, v16, v17
    v_cvt_pk_bf16_f32 v17, v18, v19
    v_cvt_pk_bf16_f32 v18, v32, v33
    v_cvt_pk_bf16_f32 v19, v34, v35
    buffer_store_dwordx4 v[16:19], v7, s[32:35], s36 offen offset:0 sc1
    ds_write_b128 v12, v[16:19] offset:0
.p2align 3
    v_exp_f32 v236, v20
    v_exp_f32 v237, v21
    v_exp_f32 v238, v22
    v_exp_f32 v239, v23
    v_exp_f32 v240, v36
    v_exp_f32 v241, v37
    v_exp_f32 v242, v38
    v_exp_f32 v243, v39
    v_pk_fma_f32 v[248:249], v[236:237], v[244:245], v[246:247]
    v_pk_fma_f32 v[250:251], v[238:239], v[244:245], v[246:247]
    v_pk_fma_f32 v[252:253], v[240:241], v[244:245], v[246:247]
    v_pk_fma_f32 v[254:255], v[242:243], v[244:245], v[246:247]
    v_pk_fma_f32 v[236:237], v[236:237], v[248:249], v[246:247]
    v_pk_fma_f32 v[238:239], v[238:239], v[250:251], v[246:247]
    v_pk_fma_f32 v[240:241], v[240:241], v[252:253], v[246:247]
    v_pk_fma_f32 v[242:243], v[242:243], v[254:255], v[246:247]
    v_rcp_f32 v236, v236
    v_rcp_f32 v237, v237
    v_rcp_f32 v238, v238
    v_rcp_f32 v239, v239
    v_rcp_f32 v240, v240
    v_rcp_f32 v241, v241
    v_rcp_f32 v242, v242
    v_rcp_f32 v243, v243
    v_pk_fma_f32 v[20:21], v[20:21], v[236:237], v[20:21]
    v_pk_fma_f32 v[22:23], v[22:23], v[238:239], v[22:23]
    v_pk_fma_f32 v[36:37], v[36:37], v[240:241], v[36:37]
    v_pk_fma_f32 v[38:39], v[38:39], v[242:243], v[38:39]
    v_cvt_pk_bf16_f32 v20, v20, v21
    v_cvt_pk_bf16_f32 v21, v22, v23
    v_cvt_pk_bf16_f32 v22, v36, v37
    v_cvt_pk_bf16_f32 v23, v38, v39
    buffer_store_dwordx4 v[20:23], v7, s[32:35], s36 offen offset:1024 sc1
    ds_write_b128 v12, v[20:23] offset:1024
.p2align 3
    v_exp_f32 v236, v24
    v_exp_f32 v237, v25
    v_exp_f32 v238, v26
    v_exp_f32 v239, v27
    v_exp_f32 v240, v40
    v_exp_f32 v241, v41
    v_exp_f32 v242, v42
    v_exp_f32 v243, v43
    v_pk_fma_f32 v[248:249], v[236:237], v[244:245], v[246:247]
    v_pk_fma_f32 v[250:251], v[238:239], v[244:245], v[246:247]
    v_pk_fma_f32 v[252:253], v[240:241], v[244:245], v[246:247]
    v_pk_fma_f32 v[254:255], v[242:243], v[244:245], v[246:247]
    v_pk_fma_f32 v[236:237], v[236:237], v[248:249], v[246:247]
    v_pk_fma_f32 v[238:239], v[238:239], v[250:251], v[246:247]
    v_pk_fma_f32 v[240:241], v[240:241], v[252:253], v[246:247]
    v_pk_fma_f32 v[242:243], v[242:243], v[254:255], v[246:247]
    v_rcp_f32 v236, v236
    v_rcp_f32 v237, v237
    v_rcp_f32 v238, v238
    v_rcp_f32 v239, v239
    v_rcp_f32 v240, v240
    v_rcp_f32 v241, v241
    v_rcp_f32 v242, v242
    v_rcp_f32 v243, v243
    v_pk_fma_f32 v[24:25], v[24:25], v[236:237], v[24:25]
    v_pk_fma_f32 v[26:27], v[26:27], v[238:239], v[26:27]
    v_pk_fma_f32 v[40:41], v[40:41], v[240:241], v[40:41]
    v_pk_fma_f32 v[42:43], v[42:43], v[242:243], v[42:43]
    v_cvt_pk_bf16_f32 v24, v24, v25
    v_cvt_pk_bf16_f32 v25, v26, v27
    v_cvt_pk_bf16_f32 v26, v40, v41
    v_cvt_pk_bf16_f32 v27, v42, v43
    s_add_u32 s36, s36, 294912
    buffer_store_dwordx4 v[24:27], v7, s[32:35], s36 offen offset:0 sc1
    ds_write_b128 v12, v[24:27] offset:2048
.p2align 3
    v_exp_f32 v236, v28
    v_exp_f32 v237, v29
    v_exp_f32 v238, v30
    v_exp_f32 v239, v31
    v_exp_f32 v240, v44
    v_exp_f32 v241, v45
    v_exp_f32 v242, v46
    v_exp_f32 v243, v47
    v_pk_fma_f32 v[248:249], v[236:237], v[244:245], v[246:247]
    v_pk_fma_f32 v[250:251], v[238:239], v[244:245], v[246:247]
    v_pk_fma_f32 v[252:253], v[240:241], v[244:245], v[246:247]
    v_pk_fma_f32 v[254:255], v[242:243], v[244:245], v[246:247]
    v_pk_fma_f32 v[236:237], v[236:237], v[248:249], v[246:247]
    v_pk_fma_f32 v[238:239], v[238:239], v[250:251], v[246:247]
    v_pk_fma_f32 v[240:241], v[240:241], v[252:253], v[246:247]
    v_pk_fma_f32 v[242:243], v[242:243], v[254:255], v[246:247]
    v_rcp_f32 v236, v236
    v_rcp_f32 v237, v237
    v_rcp_f32 v238, v238
    v_rcp_f32 v239, v239
    v_rcp_f32 v240, v240
    v_rcp_f32 v241, v241
    v_rcp_f32 v242, v242
    v_rcp_f32 v243, v243
    v_pk_fma_f32 v[28:29], v[28:29], v[236:237], v[28:29]
    v_pk_fma_f32 v[30:31], v[30:31], v[238:239], v[30:31]
    v_pk_fma_f32 v[44:45], v[44:45], v[240:241], v[44:45]
    v_pk_fma_f32 v[46:47], v[46:47], v[242:243], v[46:47]
    v_cvt_pk_bf16_f32 v28, v28, v29
    v_cvt_pk_bf16_f32 v29, v30, v31
    v_cvt_pk_bf16_f32 v30, v44, v45
    v_cvt_pk_bf16_f32 v31, v46, v47
    buffer_store_dwordx4 v[28:31], v7, s[32:35], s36 offen offset:1024 sc1
    ds_write_b128 v12, v[28:31] offset:3072
    s_mul_i32 s59, s51, 0xffffc000
    s_add_u32 s59, s59, 102400
    s_cmp_eq_u32 s3, 0
    s_cselect_b32 s59, 132096, s59
    v_add_u32 v12, s59, v7
    s_waitcnt lgkmcnt(6)
.p2align 3
    v_pk_fma_f32 v[236:237], v[220:221], v[212:213], v[224:225] op_sel:[0,1,0] op_sel_hi:[1,1,1]
    v_pk_fma_f32 v[238:239], v[222:223], v[212:213], v[226:227] op_sel:[0,1,0] op_sel_hi:[1,1,1]
    v_pk_fma_f32 v[48:49], v[48:49], v[212:213], v[236:237] op_sel_hi:[1,0,1]
    v_pk_fma_f32 v[50:51], v[50:51], v[212:213], v[238:239] op_sel_hi:[1,0,1]
    v_pk_fma_f32 v[240:241], v[220:221], v[214:215], v[224:225] op_sel:[0,1,0] op_sel_hi:[1,1,1]
    v_pk_fma_f32 v[242:243], v[222:223], v[214:215], v[226:227] op_sel:[0,1,0] op_sel_hi:[1,1,1]
    v_pk_fma_f32 v[52:53], v[52:53], v[214:215], v[240:241] op_sel_hi:[1,0,1]
    v_pk_fma_f32 v[54:55], v[54:55], v[214:215], v[242:243] op_sel_hi:[1,0,1]
    v_pk_fma_f32 v[236:237], v[220:221], v[216:217], v[224:225] op_sel:[0,1,0] op_sel_hi:[1,1,1]
    v_pk_fma_f32 v[238:239], v[222:223], v[216:217], v[226:227] op_sel:[0,1,0] op_sel_hi:[1,1,1]
    v_pk_fma_f32 v[56:57], v[56:57], v[216:217], v[236:237] op_sel_hi:[1,0,1]
    v_pk_fma_f32 v[58:59], v[58:59], v[216:217], v[238:239] op_sel_hi:[1,0,1]
    v_pk_fma_f32 v[240:241], v[220:221], v[218:219], v[224:225] op_sel:[0,1,0] op_sel_hi:[1,1,1]
    v_pk_fma_f32 v[242:243], v[222:223], v[218:219], v[226:227] op_sel:[0,1,0] op_sel_hi:[1,1,1]
    v_pk_fma_f32 v[60:61], v[60:61], v[218:219], v[240:241] op_sel_hi:[1,0,1]
    v_pk_fma_f32 v[62:63], v[62:63], v[218:219], v[242:243] op_sel_hi:[1,0,1]
    ds_read_b128 v[220:223], v1 offset:256
    ds_read_b128 v[224:227], v5 offset:1536
    s_waitcnt lgkmcnt(6)
.p2align 3
    v_pk_fma_f32 v[236:237], v[228:229], v[212:213], v[232:233] op_sel:[0,1,0] op_sel_hi:[1,1,1]
    v_pk_fma_f32 v[238:239], v[230:231], v[212:213], v[234:235] op_sel:[0,1,0] op_sel_hi:[1,1,1]
    v_pk_fma_f32 v[64:65], v[64:65], v[212:213], v[236:237] op_sel_hi:[1,0,1]
    v_pk_fma_f32 v[66:67], v[66:67], v[212:213], v[238:239] op_sel_hi:[1,0,1]
    v_pk_fma_f32 v[240:241], v[228:229], v[214:215], v[232:233] op_sel:[0,1,0] op_sel_hi:[1,1,1]
    v_pk_fma_f32 v[242:243], v[230:231], v[214:215], v[234:235] op_sel:[0,1,0] op_sel_hi:[1,1,1]
    v_pk_fma_f32 v[68:69], v[68:69], v[214:215], v[240:241] op_sel_hi:[1,0,1]
    v_pk_fma_f32 v[70:71], v[70:71], v[214:215], v[242:243] op_sel_hi:[1,0,1]
    v_pk_fma_f32 v[236:237], v[228:229], v[216:217], v[232:233] op_sel:[0,1,0] op_sel_hi:[1,1,1]
    v_pk_fma_f32 v[238:239], v[230:231], v[216:217], v[234:235] op_sel:[0,1,0] op_sel_hi:[1,1,1]
    v_pk_fma_f32 v[72:73], v[72:73], v[216:217], v[236:237] op_sel_hi:[1,0,1]
    v_pk_fma_f32 v[74:75], v[74:75], v[216:217], v[238:239] op_sel_hi:[1,0,1]
    v_pk_fma_f32 v[240:241], v[228:229], v[218:219], v[232:233] op_sel:[0,1,0] op_sel_hi:[1,1,1]
    v_pk_fma_f32 v[242:243], v[230:231], v[218:219], v[234:235] op_sel:[0,1,0] op_sel_hi:[1,1,1]
    v_pk_fma_f32 v[76:77], v[76:77], v[218:219], v[240:241] op_sel_hi:[1,0,1]
    v_pk_fma_f32 v[78:79], v[78:79], v[218:219], v[242:243] op_sel_hi:[1,0,1]
    ds_read_b128 v[228:231], v1 offset:320
    ds_read_b128 v[232:235], v5 offset:1600
.p2align 3
    v_exp_f32 v236, v48
    v_exp_f32 v237, v49
    v_exp_f32 v238, v50
    v_exp_f32 v239, v51
    v_exp_f32 v240, v64
    v_exp_f32 v241, v65
    v_exp_f32 v242, v66
    v_exp_f32 v243, v67
    v_pk_fma_f32 v[248:249], v[236:237], v[244:245], v[246:247]
    v_pk_fma_f32 v[250:251], v[238:239], v[244:245], v[246:247]
    v_pk_fma_f32 v[252:253], v[240:241], v[244:245], v[246:247]
    v_pk_fma_f32 v[254:255], v[242:243], v[244:245], v[246:247]
    v_pk_fma_f32 v[236:237], v[236:237], v[248:249], v[246:247]
    v_pk_fma_f32 v[238:239], v[238:239], v[250:251], v[246:247]
    v_pk_fma_f32 v[240:241], v[240:241], v[252:253], v[246:247]
    v_pk_fma_f32 v[242:243], v[242:243], v[254:255], v[246:247]
    v_rcp_f32 v236, v236
    v_rcp_f32 v237, v237
    v_rcp_f32 v238, v238
    v_rcp_f32 v239, v239
    v_rcp_f32 v240, v240
    v_rcp_f32 v241, v241
    v_rcp_f32 v242, v242
    v_rcp_f32 v243, v243
    v_pk_fma_f32 v[48:49], v[48:49], v[236:237], v[48:49]
    v_pk_fma_f32 v[50:51], v[50:51], v[238:239], v[50:51]
    v_pk_fma_f32 v[64:65], v[64:65], v[240:241], v[64:65]
    v_pk_fma_f32 v[66:67], v[66:67], v[242:243], v[66:67]
    v_cvt_pk_bf16_f32 v48, v48, v49
    v_cvt_pk_bf16_f32 v49, v50, v51
    v_cvt_pk_bf16_f32 v50, v64, v65
    v_cvt_pk_bf16_f32 v51, v66, v67
    buffer_store_dwordx4 v[48:51], v7, s[32:35], s37 offen offset:0 sc1
    ds_write_b128 v12, v[48:51] offset:0
.p2align 3
    v_exp_f32 v236, v52
    v_exp_f32 v237, v53
    v_exp_f32 v238, v54
    v_exp_f32 v239, v55
    v_exp_f32 v240, v68
    v_exp_f32 v241, v69
    v_exp_f32 v242, v70
    v_exp_f32 v243, v71
    v_pk_fma_f32 v[248:249], v[236:237], v[244:245], v[246:247]
    v_pk_fma_f32 v[250:251], v[238:239], v[244:245], v[246:247]
    v_pk_fma_f32 v[252:253], v[240:241], v[244:245], v[246:247]
    v_pk_fma_f32 v[254:255], v[242:243], v[244:245], v[246:247]
    v_pk_fma_f32 v[236:237], v[236:237], v[248:249], v[246:247]
    v_pk_fma_f32 v[238:239], v[238:239], v[250:251], v[246:247]
    v_pk_fma_f32 v[240:241], v[240:241], v[252:253], v[246:247]
    v_pk_fma_f32 v[242:243], v[242:243], v[254:255], v[246:247]
    v_rcp_f32 v236, v236
    v_rcp_f32 v237, v237
    v_rcp_f32 v238, v238
    v_rcp_f32 v239, v239
    v_rcp_f32 v240, v240
    v_rcp_f32 v241, v241
    v_rcp_f32 v242, v242
    v_rcp_f32 v243, v243
    v_pk_fma_f32 v[52:53], v[52:53], v[236:237], v[52:53]
    v_pk_fma_f32 v[54:55], v[54:55], v[238:239], v[54:55]
    v_pk_fma_f32 v[68:69], v[68:69], v[240:241], v[68:69]
    v_pk_fma_f32 v[70:71], v[70:71], v[242:243], v[70:71]
    v_cvt_pk_bf16_f32 v52, v52, v53
    v_cvt_pk_bf16_f32 v53, v54, v55
    v_cvt_pk_bf16_f32 v54, v68, v69
    v_cvt_pk_bf16_f32 v55, v70, v71
    buffer_store_dwordx4 v[52:55], v7, s[32:35], s37 offen offset:1024 sc1
    ds_write_b128 v12, v[52:55] offset:1024
.p2align 3
    v_exp_f32 v236, v56
    v_exp_f32 v237, v57
    v_exp_f32 v238, v58
    v_exp_f32 v239, v59
    v_exp_f32 v240, v72
    v_exp_f32 v241, v73
    v_exp_f32 v242, v74
    v_exp_f32 v243, v75
    v_pk_fma_f32 v[248:249], v[236:237], v[244:245], v[246:247]
    v_pk_fma_f32 v[250:251], v[238:239], v[244:245], v[246:247]
    v_pk_fma_f32 v[252:253], v[240:241], v[244:245], v[246:247]
    v_pk_fma_f32 v[254:255], v[242:243], v[244:245], v[246:247]
    v_pk_fma_f32 v[236:237], v[236:237], v[248:249], v[246:247]
    v_pk_fma_f32 v[238:239], v[238:239], v[250:251], v[246:247]
    v_pk_fma_f32 v[240:241], v[240:241], v[252:253], v[246:247]
    v_pk_fma_f32 v[242:243], v[242:243], v[254:255], v[246:247]
    v_rcp_f32 v236, v236
    v_rcp_f32 v237, v237
    v_rcp_f32 v238, v238
    v_rcp_f32 v239, v239
    v_rcp_f32 v240, v240
    v_rcp_f32 v241, v241
    v_rcp_f32 v242, v242
    v_rcp_f32 v243, v243
    v_pk_fma_f32 v[56:57], v[56:57], v[236:237], v[56:57]
    v_pk_fma_f32 v[58:59], v[58:59], v[238:239], v[58:59]
    v_pk_fma_f32 v[72:73], v[72:73], v[240:241], v[72:73]
    v_pk_fma_f32 v[74:75], v[74:75], v[242:243], v[74:75]
    v_cvt_pk_bf16_f32 v56, v56, v57
    v_cvt_pk_bf16_f32 v57, v58, v59
    v_cvt_pk_bf16_f32 v58, v72, v73
    v_cvt_pk_bf16_f32 v59, v74, v75
    s_add_u32 s37, s37, 294912
    buffer_store_dwordx4 v[56:59], v7, s[32:35], s37 offen offset:0 sc1
    ds_write_b128 v12, v[56:59] offset:2048
.p2align 3
    v_exp_f32 v236, v60
    v_exp_f32 v237, v61
    v_exp_f32 v238, v62
    v_exp_f32 v239, v63
    v_exp_f32 v240, v76
    v_exp_f32 v241, v77
    v_exp_f32 v242, v78
    v_exp_f32 v243, v79
    v_pk_fma_f32 v[248:249], v[236:237], v[244:245], v[246:247]
    v_pk_fma_f32 v[250:251], v[238:239], v[244:245], v[246:247]
    v_pk_fma_f32 v[252:253], v[240:241], v[244:245], v[246:247]
    v_pk_fma_f32 v[254:255], v[242:243], v[244:245], v[246:247]
    v_pk_fma_f32 v[236:237], v[236:237], v[248:249], v[246:247]
    v_pk_fma_f32 v[238:239], v[238:239], v[250:251], v[246:247]
    v_pk_fma_f32 v[240:241], v[240:241], v[252:253], v[246:247]
    v_pk_fma_f32 v[242:243], v[242:243], v[254:255], v[246:247]
    v_rcp_f32 v236, v236
    v_rcp_f32 v237, v237
    v_rcp_f32 v238, v238
    v_rcp_f32 v239, v239
    v_rcp_f32 v240, v240
    v_rcp_f32 v241, v241
    v_rcp_f32 v242, v242
    v_rcp_f32 v243, v243
    v_pk_fma_f32 v[60:61], v[60:61], v[236:237], v[60:61]
    v_pk_fma_f32 v[62:63], v[62:63], v[238:239], v[62:63]
    v_pk_fma_f32 v[76:77], v[76:77], v[240:241], v[76:77]
    v_pk_fma_f32 v[78:79], v[78:79], v[242:243], v[78:79]
    v_cvt_pk_bf16_f32 v60, v60, v61
    v_cvt_pk_bf16_f32 v61, v62, v63
    v_cvt_pk_bf16_f32 v62, v76, v77
    v_cvt_pk_bf16_f32 v63, v78, v79
    buffer_store_dwordx4 v[60:63], v7, s[32:35], s37 offen offset:1024 sc1
    ds_write_b128 v12, v[60:63] offset:3072
    s_mul_i32 s59, s51, 0x3000
    s_add_u32 s59, s59, 132096
    s_cmp_eq_u32 s3, 0
    s_cselect_b32 s59, 132096, s59
    v_add_u32 v12, s59, v7
    s_waitcnt lgkmcnt(6)
.p2align 3
    v_pk_fma_f32 v[236:237], v[220:221], v[212:213], v[224:225] op_sel:[0,1,0] op_sel_hi:[1,1,1]
    v_pk_fma_f32 v[238:239], v[222:223], v[212:213], v[226:227] op_sel:[0,1,0] op_sel_hi:[1,1,1]
    v_pk_fma_f32 v[80:81], v[80:81], v[212:213], v[236:237] op_sel_hi:[1,0,1]
    v_pk_fma_f32 v[82:83], v[82:83], v[212:213], v[238:239] op_sel_hi:[1,0,1]
    v_pk_fma_f32 v[240:241], v[220:221], v[214:215], v[224:225] op_sel:[0,1,0] op_sel_hi:[1,1,1]
    v_pk_fma_f32 v[242:243], v[222:223], v[214:215], v[226:227] op_sel:[0,1,0] op_sel_hi:[1,1,1]
    v_pk_fma_f32 v[84:85], v[84:85], v[214:215], v[240:241] op_sel_hi:[1,0,1]
    v_pk_fma_f32 v[86:87], v[86:87], v[214:215], v[242:243] op_sel_hi:[1,0,1]
    v_pk_fma_f32 v[236:237], v[220:221], v[216:217], v[224:225] op_sel:[0,1,0] op_sel_hi:[1,1,1]
    v_pk_fma_f32 v[238:239], v[222:223], v[216:217], v[226:227] op_sel:[0,1,0] op_sel_hi:[1,1,1]
    v_pk_fma_f32 v[88:89], v[88:89], v[216:217], v[236:237] op_sel_hi:[1,0,1]
    v_pk_fma_f32 v[90:91], v[90:91], v[216:217], v[238:239] op_sel_hi:[1,0,1]
    v_pk_fma_f32 v[240:241], v[220:221], v[218:219], v[224:225] op_sel:[0,1,0] op_sel_hi:[1,1,1]
    v_pk_fma_f32 v[242:243], v[222:223], v[218:219], v[226:227] op_sel:[0,1,0] op_sel_hi:[1,1,1]
    v_pk_fma_f32 v[92:93], v[92:93], v[218:219], v[240:241] op_sel_hi:[1,0,1]
    v_pk_fma_f32 v[94:95], v[94:95], v[218:219], v[242:243] op_sel_hi:[1,0,1]
    ds_read_b128 v[220:223], v2 offset:256
    ds_read_b128 v[224:227], v6 offset:1536
    s_waitcnt lgkmcnt(6)
.p2align 3
    v_pk_fma_f32 v[236:237], v[228:229], v[212:213], v[232:233] op_sel:[0,1,0] op_sel_hi:[1,1,1]
    v_pk_fma_f32 v[238:239], v[230:231], v[212:213], v[234:235] op_sel:[0,1,0] op_sel_hi:[1,1,1]
    v_pk_fma_f32 v[96:97], v[96:97], v[212:213], v[236:237] op_sel_hi:[1,0,1]
    v_pk_fma_f32 v[98:99], v[98:99], v[212:213], v[238:239] op_sel_hi:[1,0,1]
    v_pk_fma_f32 v[240:241], v[228:229], v[214:215], v[232:233] op_sel:[0,1,0] op_sel_hi:[1,1,1]
    v_pk_fma_f32 v[242:243], v[230:231], v[214:215], v[234:235] op_sel:[0,1,0] op_sel_hi:[1,1,1]
    v_pk_fma_f32 v[100:101], v[100:101], v[214:215], v[240:241] op_sel_hi:[1,0,1]
    v_pk_fma_f32 v[102:103], v[102:103], v[214:215], v[242:243] op_sel_hi:[1,0,1]
    v_pk_fma_f32 v[236:237], v[228:229], v[216:217], v[232:233] op_sel:[0,1,0] op_sel_hi:[1,1,1]
    v_pk_fma_f32 v[238:239], v[230:231], v[216:217], v[234:235] op_sel:[0,1,0] op_sel_hi:[1,1,1]
    v_pk_fma_f32 v[104:105], v[104:105], v[216:217], v[236:237] op_sel_hi:[1,0,1]
    v_pk_fma_f32 v[106:107], v[106:107], v[216:217], v[238:239] op_sel_hi:[1,0,1]
    v_pk_fma_f32 v[240:241], v[228:229], v[218:219], v[232:233] op_sel:[0,1,0] op_sel_hi:[1,1,1]
    v_pk_fma_f32 v[242:243], v[230:231], v[218:219], v[234:235] op_sel:[0,1,0] op_sel_hi:[1,1,1]
    v_pk_fma_f32 v[108:109], v[108:109], v[218:219], v[240:241] op_sel_hi:[1,0,1]
    v_pk_fma_f32 v[110:111], v[110:111], v[218:219], v[242:243] op_sel_hi:[1,0,1]
    ds_read_b128 v[228:231], v2 offset:320
    ds_read_b128 v[232:235], v6 offset:1600
.p2align 3
    v_exp_f32 v236, v80
    v_exp_f32 v237, v81
    v_exp_f32 v238, v82
    v_exp_f32 v239, v83
    v_exp_f32 v240, v96
    v_exp_f32 v241, v97
    v_exp_f32 v242, v98
    v_exp_f32 v243, v99
    v_pk_fma_f32 v[248:249], v[236:237], v[244:245], v[246:247]
    v_pk_fma_f32 v[250:251], v[238:239], v[244:245], v[246:247]
    v_pk_fma_f32 v[252:253], v[240:241], v[244:245], v[246:247]
    v_pk_fma_f32 v[254:255], v[242:243], v[244:245], v[246:247]
    v_pk_fma_f32 v[236:237], v[236:237], v[248:249], v[246:247]
    v_pk_fma_f32 v[238:239], v[238:239], v[250:251], v[246:247]
    v_pk_fma_f32 v[240:241], v[240:241], v[252:253], v[246:247]
    v_pk_fma_f32 v[242:243], v[242:243], v[254:255], v[246:247]
    v_rcp_f32 v236, v236
    v_rcp_f32 v237, v237
    v_rcp_f32 v238, v238
    v_rcp_f32 v239, v239
    v_rcp_f32 v240, v240
    v_rcp_f32 v241, v241
    v_rcp_f32 v242, v242
    v_rcp_f32 v243, v243
    v_pk_fma_f32 v[80:81], v[80:81], v[236:237], v[80:81]
    v_pk_fma_f32 v[82:83], v[82:83], v[238:239], v[82:83]
    v_pk_fma_f32 v[96:97], v[96:97], v[240:241], v[96:97]
    v_pk_fma_f32 v[98:99], v[98:99], v[242:243], v[98:99]
    v_cvt_pk_bf16_f32 v80, v80, v81
    v_cvt_pk_bf16_f32 v81, v82, v83
    v_cvt_pk_bf16_f32 v82, v96, v97
    v_cvt_pk_bf16_f32 v83, v98, v99
    buffer_store_dwordx4 v[80:83], v7, s[32:35], s38 offen offset:0 sc1
    ds_write_b128 v12, v[80:83] offset:0
.p2align 3
    v_exp_f32 v236, v84
    v_exp_f32 v237, v85
    v_exp_f32 v238, v86
    v_exp_f32 v239, v87
    v_exp_f32 v240, v100
    v_exp_f32 v241, v101
    v_exp_f32 v242, v102
    v_exp_f32 v243, v103
    v_pk_fma_f32 v[248:249], v[236:237], v[244:245], v[246:247]
    v_pk_fma_f32 v[250:251], v[238:239], v[244:245], v[246:247]
    v_pk_fma_f32 v[252:253], v[240:241], v[244:245], v[246:247]
    v_pk_fma_f32 v[254:255], v[242:243], v[244:245], v[246:247]
    v_pk_fma_f32 v[236:237], v[236:237], v[248:249], v[246:247]
    v_pk_fma_f32 v[238:239], v[238:239], v[250:251], v[246:247]
    v_pk_fma_f32 v[240:241], v[240:241], v[252:253], v[246:247]
    v_pk_fma_f32 v[242:243], v[242:243], v[254:255], v[246:247]
    v_rcp_f32 v236, v236
    v_rcp_f32 v237, v237
    v_rcp_f32 v238, v238
    v_rcp_f32 v239, v239
    v_rcp_f32 v240, v240
    v_rcp_f32 v241, v241
    v_rcp_f32 v242, v242
    v_rcp_f32 v243, v243
    v_pk_fma_f32 v[84:85], v[84:85], v[236:237], v[84:85]
    v_pk_fma_f32 v[86:87], v[86:87], v[238:239], v[86:87]
    v_pk_fma_f32 v[100:101], v[100:101], v[240:241], v[100:101]
    v_pk_fma_f32 v[102:103], v[102:103], v[242:243], v[102:103]
    v_cvt_pk_bf16_f32 v84, v84, v85
    v_cvt_pk_bf16_f32 v85, v86, v87
    v_cvt_pk_bf16_f32 v86, v100, v101
    v_cvt_pk_bf16_f32 v87, v102, v103
    buffer_store_dwordx4 v[84:87], v7, s[32:35], s38 offen offset:1024 sc1
    ds_write_b128 v12, v[84:87] offset:1024
.p2align 3
    v_exp_f32 v236, v88
    v_exp_f32 v237, v89
    v_exp_f32 v238, v90
    v_exp_f32 v239, v91
    v_exp_f32 v240, v104
    v_exp_f32 v241, v105
    v_exp_f32 v242, v106
    v_exp_f32 v243, v107
    v_pk_fma_f32 v[248:249], v[236:237], v[244:245], v[246:247]
    v_pk_fma_f32 v[250:251], v[238:239], v[244:245], v[246:247]
    v_pk_fma_f32 v[252:253], v[240:241], v[244:245], v[246:247]
    v_pk_fma_f32 v[254:255], v[242:243], v[244:245], v[246:247]
    v_pk_fma_f32 v[236:237], v[236:237], v[248:249], v[246:247]
    v_pk_fma_f32 v[238:239], v[238:239], v[250:251], v[246:247]
    v_pk_fma_f32 v[240:241], v[240:241], v[252:253], v[246:247]
    v_pk_fma_f32 v[242:243], v[242:243], v[254:255], v[246:247]
    v_rcp_f32 v236, v236
    v_rcp_f32 v237, v237
    v_rcp_f32 v238, v238
    v_rcp_f32 v239, v239
    v_rcp_f32 v240, v240
    v_rcp_f32 v241, v241
    v_rcp_f32 v242, v242
    v_rcp_f32 v243, v243
    v_pk_fma_f32 v[88:89], v[88:89], v[236:237], v[88:89]
    v_pk_fma_f32 v[90:91], v[90:91], v[238:239], v[90:91]
    v_pk_fma_f32 v[104:105], v[104:105], v[240:241], v[104:105]
    v_pk_fma_f32 v[106:107], v[106:107], v[242:243], v[106:107]
    v_cvt_pk_bf16_f32 v88, v88, v89
    v_cvt_pk_bf16_f32 v89, v90, v91
    v_cvt_pk_bf16_f32 v90, v104, v105
    v_cvt_pk_bf16_f32 v91, v106, v107
    s_add_u32 s38, s38, 294912
    buffer_store_dwordx4 v[88:91], v7, s[32:35], s38 offen offset:0 sc1
    ds_write_b128 v12, v[88:91] offset:2048
.p2align 3
    v_exp_f32 v236, v92
    v_exp_f32 v237, v93
    v_exp_f32 v238, v94
    v_exp_f32 v239, v95
    v_exp_f32 v240, v108
    v_exp_f32 v241, v109
    v_exp_f32 v242, v110
    v_exp_f32 v243, v111
    v_pk_fma_f32 v[248:249], v[236:237], v[244:245], v[246:247]
    v_pk_fma_f32 v[250:251], v[238:239], v[244:245], v[246:247]
    v_pk_fma_f32 v[252:253], v[240:241], v[244:245], v[246:247]
    v_pk_fma_f32 v[254:255], v[242:243], v[244:245], v[246:247]
    v_pk_fma_f32 v[236:237], v[236:237], v[248:249], v[246:247]
    v_pk_fma_f32 v[238:239], v[238:239], v[250:251], v[246:247]
    v_pk_fma_f32 v[240:241], v[240:241], v[252:253], v[246:247]
    v_pk_fma_f32 v[242:243], v[242:243], v[254:255], v[246:247]
    v_rcp_f32 v236, v236
    v_rcp_f32 v237, v237
    v_rcp_f32 v238, v238
    v_rcp_f32 v239, v239
    v_rcp_f32 v240, v240
    v_rcp_f32 v241, v241
    v_rcp_f32 v242, v242
    v_rcp_f32 v243, v243
    v_pk_fma_f32 v[92:93], v[92:93], v[236:237], v[92:93]
    v_pk_fma_f32 v[94:95], v[94:95], v[238:239], v[94:95]
    v_pk_fma_f32 v[108:109], v[108:109], v[240:241], v[108:109]
    v_pk_fma_f32 v[110:111], v[110:111], v[242:243], v[110:111]
    v_cvt_pk_bf16_f32 v92, v92, v93
    v_cvt_pk_bf16_f32 v93, v94, v95
    v_cvt_pk_bf16_f32 v94, v108, v109
    v_cvt_pk_bf16_f32 v95, v110, v111
    buffer_store_dwordx4 v[92:95], v7, s[32:35], s38 offen offset:1024 sc1
    ds_write_b128 v12, v[92:95] offset:3072
    s_mul_i32 s59, s51, 0xfffff000
    s_add_u32 s59, s59, 140288
    s_cmp_eq_u32 s3, 0
    s_cselect_b32 s59, 132096, s59
    v_add_u32 v12, s59, v7
    s_waitcnt lgkmcnt(6)
.p2align 3
    v_pk_fma_f32 v[236:237], v[220:221], v[212:213], v[224:225] op_sel:[0,1,0] op_sel_hi:[1,1,1]
    v_pk_fma_f32 v[238:239], v[222:223], v[212:213], v[226:227] op_sel:[0,1,0] op_sel_hi:[1,1,1]
    v_pk_fma_f32 v[112:113], v[112:113], v[212:213], v[236:237] op_sel_hi:[1,0,1]
    v_pk_fma_f32 v[114:115], v[114:115], v[212:213], v[238:239] op_sel_hi:[1,0,1]
    v_pk_fma_f32 v[240:241], v[220:221], v[214:215], v[224:225] op_sel:[0,1,0] op_sel_hi:[1,1,1]
    v_pk_fma_f32 v[242:243], v[222:223], v[214:215], v[226:227] op_sel:[0,1,0] op_sel_hi:[1,1,1]
    v_pk_fma_f32 v[116:117], v[116:117], v[214:215], v[240:241] op_sel_hi:[1,0,1]
    v_pk_fma_f32 v[118:119], v[118:119], v[214:215], v[242:243] op_sel_hi:[1,0,1]
    v_pk_fma_f32 v[236:237], v[220:221], v[216:217], v[224:225] op_sel:[0,1,0] op_sel_hi:[1,1,1]
    v_pk_fma_f32 v[238:239], v[222:223], v[216:217], v[226:227] op_sel:[0,1,0] op_sel_hi:[1,1,1]
    v_pk_fma_f32 v[120:121], v[120:121], v[216:217], v[236:237] op_sel_hi:[1,0,1]
    v_pk_fma_f32 v[122:123], v[122:123], v[216:217], v[238:239] op_sel_hi:[1,0,1]
    v_pk_fma_f32 v[240:241], v[220:221], v[218:219], v[224:225] op_sel:[0,1,0] op_sel_hi:[1,1,1]
    v_pk_fma_f32 v[242:243], v[222:223], v[218:219], v[226:227] op_sel:[0,1,0] op_sel_hi:[1,1,1]
    v_pk_fma_f32 v[124:125], v[124:125], v[218:219], v[240:241] op_sel_hi:[1,0,1]
    v_pk_fma_f32 v[126:127], v[126:127], v[218:219], v[242:243] op_sel_hi:[1,0,1]
    s_waitcnt lgkmcnt(4)
.p2align 3
    v_pk_fma_f32 v[236:237], v[228:229], v[212:213], v[232:233] op_sel:[0,1,0] op_sel_hi:[1,1,1]
    v_pk_fma_f32 v[238:239], v[230:231], v[212:213], v[234:235] op_sel:[0,1,0] op_sel_hi:[1,1,1]
    v_pk_fma_f32 v[128:129], v[128:129], v[212:213], v[236:237] op_sel_hi:[1,0,1]
    v_pk_fma_f32 v[130:131], v[130:131], v[212:213], v[238:239] op_sel_hi:[1,0,1]
    v_pk_fma_f32 v[240:241], v[228:229], v[214:215], v[232:233] op_sel:[0,1,0] op_sel_hi:[1,1,1]
    v_pk_fma_f32 v[242:243], v[230:231], v[214:215], v[234:235] op_sel:[0,1,0] op_sel_hi:[1,1,1]
    v_pk_fma_f32 v[132:133], v[132:133], v[214:215], v[240:241] op_sel_hi:[1,0,1]
    v_pk_fma_f32 v[134:135], v[134:135], v[214:215], v[242:243] op_sel_hi:[1,0,1]
    v_pk_fma_f32 v[236:237], v[228:229], v[216:217], v[232:233] op_sel:[0,1,0] op_sel_hi:[1,1,1]
    v_pk_fma_f32 v[238:239], v[230:231], v[216:217], v[234:235] op_sel:[0,1,0] op_sel_hi:[1,1,1]
    v_pk_fma_f32 v[136:137], v[136:137], v[216:217], v[236:237] op_sel_hi:[1,0,1]
    v_pk_fma_f32 v[138:139], v[138:139], v[216:217], v[238:239] op_sel_hi:[1,0,1]
    v_pk_fma_f32 v[240:241], v[228:229], v[218:219], v[232:233] op_sel:[0,1,0] op_sel_hi:[1,1,1]
    v_pk_fma_f32 v[242:243], v[230:231], v[218:219], v[234:235] op_sel:[0,1,0] op_sel_hi:[1,1,1]
    v_pk_fma_f32 v[140:141], v[140:141], v[218:219], v[240:241] op_sel_hi:[1,0,1]
    v_pk_fma_f32 v[142:143], v[142:143], v[218:219], v[242:243] op_sel_hi:[1,0,1]
.p2align 3
    v_exp_f32 v236, v112
    v_exp_f32 v237, v113
    v_exp_f32 v238, v114
    v_exp_f32 v239, v115
    v_exp_f32 v240, v128
    v_exp_f32 v241, v129
    v_exp_f32 v242, v130
    v_exp_f32 v243, v131
    v_pk_fma_f32 v[248:249], v[236:237], v[244:245], v[246:247]
    v_pk_fma_f32 v[250:251], v[238:239], v[244:245], v[246:247]
    v_pk_fma_f32 v[252:253], v[240:241], v[244:245], v[246:247]
    v_pk_fma_f32 v[254:255], v[242:243], v[244:245], v[246:247]
    v_pk_fma_f32 v[236:237], v[236:237], v[248:249], v[246:247]
    v_pk_fma_f32 v[238:239], v[238:239], v[250:251], v[246:247]
    v_pk_fma_f32 v[240:241], v[240:241], v[252:253], v[246:247]
    v_pk_fma_f32 v[242:243], v[242:243], v[254:255], v[246:247]
    v_rcp_f32 v236, v236
    v_rcp_f32 v237, v237
    v_rcp_f32 v238, v238
    v_rcp_f32 v239, v239
    v_rcp_f32 v240, v240
    v_rcp_f32 v241, v241
    v_rcp_f32 v242, v242
    v_rcp_f32 v243, v243
    v_pk_fma_f32 v[112:113], v[112:113], v[236:237], v[112:113]
    v_pk_fma_f32 v[114:115], v[114:115], v[238:239], v[114:115]
    v_pk_fma_f32 v[128:129], v[128:129], v[240:241], v[128:129]
    v_pk_fma_f32 v[130:131], v[130:131], v[242:243], v[130:131]
    v_cvt_pk_bf16_f32 v112, v112, v113
    v_cvt_pk_bf16_f32 v113, v114, v115
    v_cvt_pk_bf16_f32 v114, v128, v129
    v_cvt_pk_bf16_f32 v115, v130, v131
    buffer_store_dwordx4 v[112:115], v7, s[32:35], s39 offen offset:0 sc1
    ds_write_b128 v12, v[112:115] offset:0
.p2align 3
    v_exp_f32 v236, v116
    v_exp_f32 v237, v117
    v_exp_f32 v238, v118
    v_exp_f32 v239, v119
    v_exp_f32 v240, v132
    v_exp_f32 v241, v133
    v_exp_f32 v242, v134
    v_exp_f32 v243, v135
    v_pk_fma_f32 v[248:249], v[236:237], v[244:245], v[246:247]
    v_pk_fma_f32 v[250:251], v[238:239], v[244:245], v[246:247]
    v_pk_fma_f32 v[252:253], v[240:241], v[244:245], v[246:247]
    v_pk_fma_f32 v[254:255], v[242:243], v[244:245], v[246:247]
    v_pk_fma_f32 v[236:237], v[236:237], v[248:249], v[246:247]
    v_pk_fma_f32 v[238:239], v[238:239], v[250:251], v[246:247]
    v_pk_fma_f32 v[240:241], v[240:241], v[252:253], v[246:247]
    v_pk_fma_f32 v[242:243], v[242:243], v[254:255], v[246:247]
    v_rcp_f32 v236, v236
    v_rcp_f32 v237, v237
    v_rcp_f32 v238, v238
    v_rcp_f32 v239, v239
    v_rcp_f32 v240, v240
    v_rcp_f32 v241, v241
    v_rcp_f32 v242, v242
    v_rcp_f32 v243, v243
    v_pk_fma_f32 v[116:117], v[116:117], v[236:237], v[116:117]
    v_pk_fma_f32 v[118:119], v[118:119], v[238:239], v[118:119]
    v_pk_fma_f32 v[132:133], v[132:133], v[240:241], v[132:133]
    v_pk_fma_f32 v[134:135], v[134:135], v[242:243], v[134:135]
    v_cvt_pk_bf16_f32 v116, v116, v117
    v_cvt_pk_bf16_f32 v117, v118, v119
    v_cvt_pk_bf16_f32 v118, v132, v133
    v_cvt_pk_bf16_f32 v119, v134, v135
    buffer_store_dwordx4 v[116:119], v7, s[32:35], s39 offen offset:1024 sc1
    ds_write_b128 v12, v[116:119] offset:1024
.p2align 3
    v_exp_f32 v236, v120
    v_exp_f32 v237, v121
    v_exp_f32 v238, v122
    v_exp_f32 v239, v123
    v_exp_f32 v240, v136
    v_exp_f32 v241, v137
    v_exp_f32 v242, v138
    v_exp_f32 v243, v139
    v_pk_fma_f32 v[248:249], v[236:237], v[244:245], v[246:247]
    v_pk_fma_f32 v[250:251], v[238:239], v[244:245], v[246:247]
    v_pk_fma_f32 v[252:253], v[240:241], v[244:245], v[246:247]
    v_pk_fma_f32 v[254:255], v[242:243], v[244:245], v[246:247]
    v_pk_fma_f32 v[236:237], v[236:237], v[248:249], v[246:247]
    v_pk_fma_f32 v[238:239], v[238:239], v[250:251], v[246:247]
    v_pk_fma_f32 v[240:241], v[240:241], v[252:253], v[246:247]
    v_pk_fma_f32 v[242:243], v[242:243], v[254:255], v[246:247]
    v_rcp_f32 v236, v236
    v_rcp_f32 v237, v237
    v_rcp_f32 v238, v238
    v_rcp_f32 v239, v239
    v_rcp_f32 v240, v240
    v_rcp_f32 v241, v241
    v_rcp_f32 v242, v242
    v_rcp_f32 v243, v243
    v_pk_fma_f32 v[120:121], v[120:121], v[236:237], v[120:121]
    v_pk_fma_f32 v[122:123], v[122:123], v[238:239], v[122:123]
    v_pk_fma_f32 v[136:137], v[136:137], v[240:241], v[136:137]
    v_pk_fma_f32 v[138:139], v[138:139], v[242:243], v[138:139]
    v_cvt_pk_bf16_f32 v120, v120, v121
    v_cvt_pk_bf16_f32 v121, v122, v123
    v_cvt_pk_bf16_f32 v122, v136, v137
    v_cvt_pk_bf16_f32 v123, v138, v139
    s_add_u32 s39, s39, 294912
    buffer_store_dwordx4 v[120:123], v7, s[32:35], s39 offen offset:0 sc1
    ds_write_b128 v12, v[120:123] offset:2048
.p2align 3
    v_exp_f32 v236, v124
    v_exp_f32 v237, v125
    v_exp_f32 v238, v126
    v_exp_f32 v239, v127
    v_exp_f32 v240, v140
    v_exp_f32 v241, v141
    v_exp_f32 v242, v142
    v_exp_f32 v243, v143
    v_pk_fma_f32 v[248:249], v[236:237], v[244:245], v[246:247]
    v_pk_fma_f32 v[250:251], v[238:239], v[244:245], v[246:247]
    v_pk_fma_f32 v[252:253], v[240:241], v[244:245], v[246:247]
    v_pk_fma_f32 v[254:255], v[242:243], v[244:245], v[246:247]
    v_pk_fma_f32 v[236:237], v[236:237], v[248:249], v[246:247]
    v_pk_fma_f32 v[238:239], v[238:239], v[250:251], v[246:247]
    v_pk_fma_f32 v[240:241], v[240:241], v[252:253], v[246:247]
    v_pk_fma_f32 v[242:243], v[242:243], v[254:255], v[246:247]
    v_rcp_f32 v236, v236
    v_rcp_f32 v237, v237
    v_rcp_f32 v238, v238
    v_rcp_f32 v239, v239
    v_rcp_f32 v240, v240
    v_rcp_f32 v241, v241
    v_rcp_f32 v242, v242
    v_rcp_f32 v243, v243
    v_pk_fma_f32 v[124:125], v[124:125], v[236:237], v[124:125]
    v_pk_fma_f32 v[126:127], v[126:127], v[238:239], v[126:127]
    v_pk_fma_f32 v[140:141], v[140:141], v[240:241], v[140:141]
    v_pk_fma_f32 v[142:143], v[142:143], v[242:243], v[142:143]
    v_cvt_pk_bf16_f32 v124, v124, v125
    v_cvt_pk_bf16_f32 v125, v126, v127
    v_cvt_pk_bf16_f32 v126, v140, v141
    v_cvt_pk_bf16_f32 v127, v142, v143
    buffer_store_dwordx4 v[124:127], v7, s[32:35], s39 offen offset:1024 sc1
    ds_write_b128 v12, v[124:127] offset:3072
    s_lshl_b32 s98, s49, 2
    s_lshr_b32 s59, s50, 2
    s_add_u32 s98, s98, s59
    s_lshl_b32 s98, s98, 7
    s_add_u32 s98, s98, 37568512
    s_branch K2_start
K1_hloop:
    s_mov_b32 s18, 5308416
    s_mov_b32 s19, 0x20000
    s_bfe_u32 s65, s2, 0x20001
    s_mul_i32 s65, s65, 1327104
    s_mul_i32 s66, s60, 41472
    s_add_u32 s65, s65, s66
    s_lshl_b32 s66, s51, 1
    s_and_b32 s67, s2, 1
    s_add_u32 s66, s66, s67
    s_mul_i32 s66, s66, 5248
    s_add_u32 s95, s65, s66
    v_min_u32 v52, 40, v0
    v_lshlrev_b32 v52, 7, v52
    v_lshrrev_b32 v56, 3, v0
    v_lshlrev_b32 v56, 7, v56
    v_min_u32 v57, 5, v0
    v_lshlrev_b32 v57, 7, v57
    s_mul_i32 s65, s50, 331776
    s_mul_i32 s66, s64, 36864
    s_add_u32 s65, s65, s66
    s_and_b32 s66, s49, 7
    s_lshl_b32 s66, s66, 2
    s_add_u32 s66, s66, s51
    s_mul_i32 s66, s66, 4608
    s_add_u32 s65, s65, s66
    s_add_u32 s66, s3, 2
    s_mul_i32 s66, s66, 192
    s_cmp_ge_u32 s66, 576
    s_cselect_b32 s67, 576, 0
    s_sub_u32 s66, s66, s67
    s_add_u32 s96, s65, s66
    v_lshrrev_b32 v58, 2, v0
    v_min_u32 v58, 3, v58
    v_mul_u32_u24 v58, 1152, v58
    v_and_b32 v9, 1, v0
    v_lshl_add_u32 v58, v9, 7, v58
    v_bfe_u32 v9, v0, 1, 1
    v_mul_u32_u24 v9, 576, v9
    v_add_u32 v58, v58, v9
    v_and_b32 v8, 7, v0
    v_lshrrev_b32 v9, 3, v0
    v_mul_u32_u24 v30, 289, v8
    v_lshl_add_u32 v30, v9, 2, v30
    v_and_b32 v30, -2, v30
    v_lshlrev_b32 v30, 1, v30
    v_lshlrev_b32 v253, 4, v8
    v_lshl_add_u32 v31, v9, 15, v253
    v_and_b32 v253, 16, v253
    v_mov_b32 v53, 0
    v_and_b32 v8, 31, v0
    v_lshrrev_b32 v9, 5, v0
    v_lshlrev_b32 v8, 2, v8
    v_lshl_add_u32 v8, v9, 9, v8
    s_lshl_b32 s59, s51, 7
    s_add_u32 s59, s59, 162816
    v_add_u32 v59, s59, v8
    s_lshl_b32 s59, s51, 11
    s_add_u32 s59, s59, 122880
    v_add_u32 v250, s59, v7
    v_lshrrev_b32 v8, 4, v0
    v_and_b32 v9, 15, v0
    v_lshlrev_b32 v9, 4, v9
    v_lshl_add_u32 v251, v8, 12, v9
    s_lshl_b32 s14, s50, 17
    s_lshl_b32 s66, s49, 8
    s_lshl_b32 s67, s51, 15
    s_add_u32 s14, s14, s67
    s_add_u32 s14, s14, s66
    s_add_u32 s14, s14, 18874368
    s_add_u32 s15, s14, 16384
    s_lshl_b32 s10, s50, 14
    s_add_u32 s10, s10, s66
    s_add_u32 s10, s10, 20971520
    s_lshl_b32 s59, s51, 2
    s_add_u32 s59, s59, 160912
    v_mov_b32 v237, s59
    s_waitcnt vmcnt(7)
    s_barrier
    ds_read_b128 v[32:35], v24 offset:0
    ds_read_b128 v[36:39], v25 offset:0
    ds_read_b128 v[40:43], v26 offset:0
    ds_read_b128 v[44:47], v27 offset:0
    s_add_u32 m0, s57, 90112
    s_mov_b32 s23, s20
    buffer_load_dwordx4 v3, s[24:27], s23 offen lds
    s_add_u32 m0, s57, 90112
    s_nop 0
    buffer_load_dwordx4 v4, s[24:27], s23 offen offset:1024 lds
    s_add_u32 m0, s57, 92160
    s_add_u32 s23, s20, 589824
    buffer_load_dwordx4 v3, s[24:27], s23 offen lds
    s_waitcnt lgkmcnt(3)
    v_lshlrev_b32 v48, 16, v32
    v_and_b32 v49, 0xffff0000, v32
    v_lshlrev_b32 v50, 16, v33
    v_and_b32 v51, 0xffff0000, v33
    v_fmac_f32 v28, v48, v48
    v_fmac_f32 v29, v49, v49
    v_fmac_f32 v28, v50, v50
    v_fmac_f32 v29, v51, v51
    v_lshlrev_b32 v48, 16, v34
    v_and_b32 v49, 0xffff0000, v34
    v_lshlrev_b32 v50, 16, v35
    v_and_b32 v51, 0xffff0000, v35
    v_fmac_f32 v28, v48, v48
    v_fmac_f32 v29, v49, v49
    v_fmac_f32 v28, v50, v50
    v_fmac_f32 v29, v51, v51
    s_add_u32 m0, s57, 92160
    s_nop 0
    buffer_load_dwordx4 v4, s[24:27], s23 offen offset:1024 lds
    s_add_u32 s20, s20, 128
    s_cmp_eq_u32 s20, s21
    s_cselect_b32 s20, s53, s20
    s_add_u32 m0, s57, 36864
    s_add_u32 s40, s36, s38
    buffer_load_dwordx4 v5, s[28:31], s40 offen offset:0 lds
    s_add_u32 m0, s57, 37760
    s_nop 0
    buffer_load_dwordx4 v5, s[28:31], s40 offen offset:128 lds
    s_waitcnt lgkmcnt(2)
    v_lshlrev_b32 v48, 16, v36
    v_and_b32 v49, 0xffff0000, v36
    v_lshlrev_b32 v50, 16, v37
    v_and_b32 v51, 0xffff0000, v37
    v_fmac_f32 v28, v48, v48
    v_fmac_f32 v29, v49, v49
    v_fmac_f32 v28, v50, v50
    v_fmac_f32 v29, v51, v51
    v_lshlrev_b32 v48, 16, v38
    v_and_b32 v49, 0xffff0000, v38
    v_lshlrev_b32 v50, 16, v39
    v_and_b32 v51, 0xffff0000, v39
    v_fmac_f32 v28, v48, v48
    v_fmac_f32 v29, v49, v49
    v_fmac_f32 v28, v50, v50
    v_fmac_f32 v29, v51, v51
    s_add_u32 m0, s57, 38656
    s_nop 0
    buffer_load_dwordx4 v5, s[28:31], s40 offen offset:256 lds
    s_add_u32 m0, s57, 39552
    s_nop 0
    buffer_load_dwordx4 v5, s[28:31], s40 offen offset:384 lds
    s_add_u32 m0, s58, 53248
    s_add_u32 s41, s36, s39
    s_mov_b32 exec_hi, 0
    buffer_load_dwordx4 v6, s[28:31], s41 offen lds
    s_mov_b32 exec_hi, -1
    s_add_u32 s36, s36, 294912
    s_cmp_eq_u32 s36, s37
    s_cselect_b32 s36, s54, s36
    s_waitcnt vmcnt(11) lgkmcnt(0)
    s_barrier
    s_add_u32 m0, s57, 106496
    s_mov_b32 s23, s20
    buffer_load_dwordx4 v3, s[24:27], s23 offen lds
    s_add_u32 m0, s57, 106496
    s_nop 0
    buffer_load_dwordx4 v4, s[24:27], s23 offen offset:1024 lds
    s_add_u32 m0, s57, 55296
    s_add_u32 s40, s36, s38
    buffer_load_dwordx4 v5, s[28:31], s40 offen offset:0 lds
    v_lshlrev_b32 v48, 16, v40
    v_and_b32 v49, 0xffff0000, v40
    v_lshlrev_b32 v50, 16, v41
    v_and_b32 v51, 0xffff0000, v41
    v_fmac_f32 v28, v48, v48
    v_fmac_f32 v29, v49, v49
    v_fmac_f32 v28, v50, v50
    v_fmac_f32 v29, v51, v51
    v_lshlrev_b32 v48, 16, v42
    v_and_b32 v49, 0xffff0000, v42
    v_lshlrev_b32 v50, 16, v43
    v_and_b32 v51, 0xffff0000, v43
    v_fmac_f32 v28, v48, v48
    v_fmac_f32 v29, v49, v49
    v_fmac_f32 v28, v50, v50
    v_fmac_f32 v29, v51, v51
    s_add_u32 m0, s57, 56192
    s_nop 0
    buffer_load_dwordx4 v5, s[28:31], s40 offen offset:128 lds
    s_add_u32 m0, s57, 57088
    s_nop 0
    buffer_load_dwordx4 v5, s[28:31], s40 offen offset:256 lds
    s_add_u32 m0, s57, 57984
    s_nop 0
    buffer_load_dwordx4 v5, s[28:31], s40 offen offset:384 lds
    v_lshlrev_b32 v48, 16, v44
    v_and_b32 v49, 0xffff0000, v44
    v_lshlrev_b32 v50, 16, v45
    v_and_b32 v51, 0xffff0000, v45
    v_fmac_f32 v28, v48, v48
    v_fmac_f32 v29, v49, v49
    v_fmac_f32 v28, v50, v50
    v_fmac_f32 v29, v51, v51
    v_lshlrev_b32 v48, 16, v46
    v_and_b32 v49, 0xffff0000, v46
    v_lshlrev_b32 v50, 16, v47
    v_and_b32 v51, 0xffff0000, v47
    v_fmac_f32 v28, v48, v48
    v_fmac_f32 v29, v49, v49
    v_fmac_f32 v28, v50, v50
    v_fmac_f32 v29, v51, v51
    s_add_u32 m0, s58, 71680
    s_add_u32 s41, s36, s39
    s_mov_b32 exec_hi, 0
    buffer_load_dwordx4 v6, s[28:31], s41 offen lds
    s_mov_b32 exec_hi, -1
    s_add_u32 s36, s36, 294912
    s_cmp_eq_u32 s36, s37
    s_cselect_b32 s36, s54, s36
    s_waitcnt vmcnt(16)
    v_lshlrev_b32 v12, 16, v12
    v_lshlrev_b32 v13, 16, v13
    v_mul_f32 v12, 0x3fb8aa3b, v12
    v_mul_f32 v13, 0x3fb8aa3b, v13
    ds_write_b32 v10, v12
    v_mov_b32 v8, 160896
    v_mov_b32 v9, 0
    ds_write_b32 v8, v9
    ds_write_b32 v237, v9
    s_cmp_lg_u32 s51, 0
    s_cbranch_scc1 K1_nb
    ds_write_b32 v10, v13 offset:1024
K1_nb:
    s_waitcnt vmcnt(7) lgkmcnt(0)
    s_barrier
    ds_read_b128 v[32:35], v24 offset:16384
    ds_read_b128 v[36:39], v25 offset:16384
    ds_read_b128 v[40:43], v26 offset:16384
    ds_read_b128 v[44:47], v27 offset:16384
    s_add_u32 m0, s57, 108544
    s_add_u32 s23, s20, 589824
    buffer_load_dwordx4 v3, s[24:27], s23 offen lds
    s_add_u32 m0, s57, 108544
    s_nop 0
    buffer_load_dwordx4 v4, s[24:27], s23 offen offset:1024 lds
    s_add_u32 s20, s20, 128
    s_cmp_eq_u32 s20, s21
    s_cselect_b32 s20, s53, s20
    s_add_u32 m0, s57, 0
    s_add_u32 s40, s36, s38
    buffer_load_dwordx4 v5, s[28:31], s40 offen offset:0 lds
    s_waitcnt lgkmcnt(3)
    v_lshlrev_b32 v48, 16, v32
    v_and_b32 v49, 0xffff0000, v32
    v_lshlrev_b32 v50, 16, v33
    v_and_b32 v51, 0xffff0000, v33
    v_fmac_f32 v28, v48, v48
    v_fmac_f32 v29, v49, v49
    v_fmac_f32 v28, v50, v50
    v_fmac_f32 v29, v51, v51
    v_lshlrev_b32 v48, 16, v34
    v_and_b32 v49, 0xffff0000, v34
    v_lshlrev_b32 v50, 16, v35
    v_and_b32 v51, 0xffff0000, v35
    v_fmac_f32 v28, v48, v48
    v_fmac_f32 v29, v49, v49
    v_fmac_f32 v28, v50, v50
    v_fmac_f32 v29, v51, v51
    s_add_u32 m0, s57, 896
    s_nop 0
    buffer_load_dwordx4 v5, s[28:31], s40 offen offset:128 lds
    s_add_u32 m0, s57, 1792
    s_nop 0
    buffer_load_dwordx4 v5, s[28:31], s40 offen offset:256 lds
    s_add_u32 m0, s57, 2688
    s_nop 0
    buffer_load_dwordx4 v5, s[28:31], s40 offen offset:384 lds
    s_waitcnt lgkmcnt(2)
    v_lshlrev_b32 v48, 16, v36
    v_and_b32 v49, 0xffff0000, v36
    v_lshlrev_b32 v50, 16, v37
    v_and_b32 v51, 0xffff0000, v37
    v_fmac_f32 v28, v48, v48
    v_fmac_f32 v29, v49, v49
    v_fmac_f32 v28, v50, v50
    v_fmac_f32 v29, v51, v51
    v_lshlrev_b32 v48, 16, v38
    v_and_b32 v49, 0xffff0000, v38
    v_lshlrev_b32 v50, 16, v39
    v_and_b32 v51, 0xffff0000, v39
    v_fmac_f32 v28, v48, v48
    v_fmac_f32 v29, v49, v49
    v_fmac_f32 v28, v50, v50
    v_fmac_f32 v29, v51, v51
    s_add_u32 m0, s58, 16384
    s_add_u32 s41, s36, s39
    s_mov_b32 exec_hi, 0
    buffer_load_dwordx4 v6, s[28:31], s41 offen lds
    s_mov_b32 exec_hi, -1
    s_add_u32 s36, s36, 294912
    s_cmp_eq_u32 s36, s37
    s_cselect_b32 s36, s54, s36
    s_load_dwordx2 s[44:45], s[0:1], 64
    s_mov_b32 s46, 256
    s_waitcnt lgkmcnt(0)
    s_lshl_b32 s59, s2, 2
    s_or_b32 s59, s59, s51
    s_cmp_lg_u32 s59, 0
    s_cbranch_scc1 K1_nz
    v_lshlrev_b32 v8, 7, v0
    v_mov_b32 v9, 0
    s_mov_b32 s59, 37560320
    buffer_store_dword v9, v8, s[32:35], s59 offen sc1
    s_add_u32 s59, s59, 8192
    buffer_store_dword v9, v8, s[32:35], s59 offen sc1
    s_add_u32 s59, s59, 8192
    buffer_store_dword v9, v8, s[32:35], s59 offen sc1
    s_add_u32 s59, s59, 8192
    buffer_store_dword v9, v8, s[32:35], s59 offen sc1
K1_nz:
    s_waitcnt vmcnt(7)
    s_barrier
    s_add_u32 m0, s57, 73728
    s_mov_b32 s23, s20
    buffer_load_dwordx4 v3, s[24:27], s23 offen lds
    s_add_u32 m0, s57, 73728
    s_nop 0
    buffer_load_dwordx4 v4, s[24:27], s23 offen offset:1024 lds
    s_add_u32 m0, s57, 18432
    s_add_u32 s40, s36, s38
    buffer_load_dwordx4 v5, s[28:31], s40 offen offset:0 lds
    v_lshlrev_b32 v48, 16, v40
    v_and_b32 v49, 0xffff0000, v40
    v_lshlrev_b32 v50, 16, v41
    v_and_b32 v51, 0xffff0000, v41
    v_fmac_f32 v28, v48, v48
    v_fmac_f32 v29, v49, v49
    v_fmac_f32 v28, v50, v50
    v_fmac_f32 v29, v51, v51
    v_lshlrev_b32 v48, 16, v42
    v_and_b32 v49, 0xffff0000, v42
    v_lshlrev_b32 v50, 16, v43
    v_and_b32 v51, 0xffff0000, v43
    v_fmac_f32 v28, v48, v48
    v_fmac_f32 v29, v49, v49
    v_fmac_f32 v28, v50, v50
    v_fmac_f32 v29, v51, v51
    s_add_u32 m0, s57, 19328
    s_nop 0
    buffer_load_dwordx4 v5, s[28:31], s40 offen offset:128 lds
    s_add_u32 m0, s57, 20224
    s_nop 0
    buffer_load_dwordx4 v5, s[28:31], s40 offen offset:256 lds
    s_add_u32 m0, s57, 21120
    s_nop 0
    buffer_load_dwordx4 v5, s[28:31], s40 offen offset:384 lds
    v_lshlrev_b32 v48, 16, v44
    v_and_b32 v49, 0xffff0000, v44
    v_lshlrev_b32 v50, 16, v45
    v_and_b32 v51, 0xffff0000, v45
    v_fmac_f32 v28, v48, v48
    v_fmac_f32 v29, v49, v49
    v_fmac_f32 v28, v50, v50
    v_fmac_f32 v29, v51, v51
    v_lshlrev_b32 v48, 16, v46
    v_and_b32 v49, 0xffff0000, v46
    v_lshlrev_b32 v50, 16, v47
    v_and_b32 v51, 0xffff0000, v47
    v_fmac_f32 v28, v48, v48
    v_fmac_f32 v29, v49, v49
    v_fmac_f32 v28, v50, v50
    v_fmac_f32 v29, v51, v51
    s_add_u32 m0, s58, 34816
    s_add_u32 s41, s36, s39
    s_mov_b32 exec_hi, 0
    buffer_load_dwordx4 v6, s[28:31], s41 offen lds
    s_mov_b32 exec_hi, -1
    s_add_u32 s36, s36, 294912
    s_cmp_eq_u32 s36, s37
    s_cselect_b32 s36, s54, s36
    s_waitcnt vmcnt(7)
    s_barrier
    ds_read_b128 v[32:35], v24 offset:32768
    ds_read_b128 v[36:39], v25 offset:32768
    ds_read_b128 v[40:43], v26 offset:32768
    ds_read_b128 v[44:47], v27 offset:32768
    s_add_u32 m0, s57, 75776
    s_add_u32 s23, s20, 589824
    buffer_load_dwordx4 v3, s[24:27], s23 offen lds
    s_add_u32 m0, s57, 75776
    s_nop 0
    buffer_load_dwordx4 v4, s[24:27], s23 offen offset:1024 lds
    s_add_u32 s20, s20, 128
    s_cmp_eq_u32 s20, s21
    s_cselect_b32 s20, s53, s20
    s_add_u32 m0, s57, 36864
    s_add_u32 s40, s36, s38
    buffer_load_dwordx4 v5, s[28:31], s40 offen offset:0 lds
    s_waitcnt lgkmcnt(3)
    v_lshlrev_b32 v48, 16, v32
    v_and_b32 v49, 0xffff0000, v32
    v_lshlrev_b32 v50, 16, v33
    v_and_b32 v51, 0xffff0000, v33
    v_fmac_f32 v28, v48, v48
    v_fmac_f32 v29, v49, v49
    v_fmac_f32 v28, v50, v50
    v_fmac_f32 v29, v51, v51
    v_lshlrev_b32 v48, 16, v34
    v_and_b32 v49, 0xffff0000, v34
    v_lshlrev_b32 v50, 16, v35
    v_and_b32 v51, 0xffff0000, v35
    v_fmac_f32 v28, v48, v48
    v_fmac_f32 v29, v49, v49
    v_fmac_f32 v28, v50, v50
    v_fmac_f32 v29, v51, v51
    s_add_u32 m0, s57, 37760
    s_nop 0
    buffer_load_dwordx4 v5, s[28:31], s40 offen offset:128 lds
    s_add_u32 m0, s57, 38656
    s_nop 0
    buffer_load_dwordx4 v5, s[28:31], s40 offen offset:256 lds
    s_add_u32 m0, s57, 39552
    s_nop 0
    buffer_load_dwordx4 v5, s[28:31], s40 offen offset:384 lds
    s_waitcnt lgkmcnt(2)
    v_lshlrev_b32 v48, 16, v36
    v_and_b32 v49, 0xffff0000, v36
    v_lshlrev_b32 v50, 16, v37
    v_and_b32 v51, 0xffff0000, v37
    v_fmac_f32 v28, v48, v48
    v_fmac_f32 v29, v49, v49
    v_fmac_f32 v28, v50, v50
    v_fmac_f32 v29, v51, v51
    v_lshlrev_b32 v48, 16, v38
    v_and_b32 v49, 0xffff0000, v38
    v_lshlrev_b32 v50, 16, v39
    v_and_b32 v51, 0xffff0000, v39
    v_fmac_f32 v28, v48, v48
    v_fmac_f32 v29, v49, v49
    v_fmac_f32 v28, v50, v50
    v_fmac_f32 v29, v51, v51
    s_add_u32 m0, s58, 53248
    s_add_u32 s41, s36, s39
    s_mov_b32 exec_hi, 0
    buffer_load_dwordx4 v6, s[28:31], s41 offen lds
    s_mov_b32 exec_hi, -1
    s_add_u32 s36, s36, 294912
    s_cmp_eq_u32 s36, s37
    s_cselect_b32 s36, s54, s36
    s_waitcnt vmcnt(7) lgkmcnt(0)
    s_barrier
    s_add_u32 m0, s57, 90112
    s_mov_b32 s23, s20
    buffer_load_dwordx4 v3, s[24:27], s23 offen lds
    s_add_u32 m0, s57, 90112
    s_nop 0
    buffer_load_dwordx4 v4, s[24:27], s23 offen offset:1024 lds
    s_add_u32 m0, s57, 55296
    s_add_u32 s40, s36, s38
    buffer_load_dwordx4 v5, s[28:31], s40 offen offset:0 lds
    v_lshlrev_b32 v48, 16, v40
    v_and_b32 v49, 0xffff0000, v40
    v_lshlrev_b32 v50, 16, v41
    v_and_b32 v51, 0xffff0000, v41
    v_fmac_f32 v28, v48, v48
    v_fmac_f32 v29, v49, v49
    v_fmac_f32 v28, v50, v50
    v_fmac_f32 v29, v51, v51
    v_lshlrev_b32 v48, 16, v42
    v_and_b32 v49, 0xffff0000, v42
    v_lshlrev_b32 v50, 16, v43
    v_and_b32 v51, 0xffff0000, v43
    v_fmac_f32 v28, v48, v48
    v_fmac_f32 v29, v49, v49
    v_fmac_f32 v28, v50, v50
    v_fmac_f32 v29, v51, v51
    s_add_u32 m0, s57, 56192
    s_nop 0
    buffer_load_dwordx4 v5, s[28:31], s40 offen offset:128 lds
    s_add_u32 m0, s57, 57088
    s_nop 0
    buffer_load_dwordx4 v5, s[28:31], s40 offen offset:256 lds
    s_add_u32 m0, s57, 57984
    s_nop 0
    buffer_load_dwordx4 v5, s[28:31], s40 offen offset:384 lds
    v_lshlrev_b32 v48, 16, v44
    v_and_b32 v49, 0xffff0000, v44
    v_lshlrev_b32 v50, 16, v45
    v_and_b32 v51, 0xffff0000, v45
    v_fmac_f32 v28, v48, v48
    v_fmac_f32 v29, v49, v49
    v_fmac_f32 v28, v50, v50
    v_fmac_f32 v29, v51, v51
    v_lshlrev_b32 v48, 16, v46
    v_and_b32 v49, 0xffff0000, v46
    v_lshlrev_b32 v50, 16, v47
    v_and_b32 v51, 0xffff0000, v47
    v_fmac_f32 v28, v48, v48
    v_fmac_f32 v29, v49, v49
    v_fmac_f32 v28, v50, v50
    v_fmac_f32 v29, v51, v51
    s_add_u32 m0, s58, 71680
    s_add_u32 s41, s36, s39
    s_mov_b32 exec_hi, 0
    buffer_load_dwordx4 v6, s[28:31], s41 offen lds
    s_mov_b32 exec_hi, -1
    s_add_u32 s36, s36, 294912
    s_cmp_eq_u32 s36, s37
    s_cselect_b32 s36, s54, s36
    s_waitcnt vmcnt(7)
    s_barrier
    ds_read_b128 v[32:35], v24 offset:0
    ds_read_b128 v[36:39], v25 offset:0
    ds_read_b128 v[40:43], v26 offset:0
    ds_read_b128 v[44:47], v27 offset:0
    s_add_u32 m0, s57, 92160
    s_add_u32 s23, s20, 589824
    buffer_load_dwordx4 v3, s[24:27], s23 offen lds
    s_add_u32 m0, s57, 92160
    s_nop 0
    buffer_load_dwordx4 v4, s[24:27], s23 offen offset:1024 lds
    s_add_u32 s20, s20, 128
    s_cmp_eq_u32 s20, s21
    s_cselect_b32 s20, s53, s20
    s_add_u32 m0, s57, 0
    s_add_u32 s40, s36, s38
    buffer_load_dwordx4 v5, s[28:31], s40 offen offset:0 lds
    s_waitcnt lgkmcnt(3)
    v_lshlrev_b32 v48, 16, v32
    v_and_b32 v49, 0xffff0000, v32
    v_lshlrev_b32 v50, 16, v33
    v_and_b32 v51, 0xffff0000, v33
    v_fmac_f32 v28, v48, v48
    v_fmac_f32 v29, v49, v49
    v_fmac_f32 v28, v50, v50
    v_fmac_f32 v29, v51, v51
    v_lshlrev_b32 v48, 16, v34
    v_and_b32 v49, 0xffff0000, v34
    v_lshlrev_b32 v50, 16, v35
    v_and_b32 v51, 0xffff0000, v35
    v_fmac_f32 v28, v48, v48
    v_fmac_f32 v29, v49, v49
    v_fmac_f32 v28, v50, v50
    v_fmac_f32 v29, v51, v51
    s_add_u32 m0, s57, 896
    s_nop 0
    buffer_load_dwordx4 v5, s[28:31], s40 offen offset:128 lds
    s_add_u32 m0, s57, 1792
    s_nop 0
    buffer_load_dwordx4 v5, s[28:31], s40 offen offset:256 lds
    s_add_u32 m0, s57, 2688
    s_nop 0
    buffer_load_dwordx4 v5, s[28:31], s40 offen offset:384 lds
    s_waitcnt lgkmcnt(2)
    v_lshlrev_b32 v48, 16, v36
    v_and_b32 v49, 0xffff0000, v36
    v_lshlrev_b32 v50, 16, v37
    v_and_b32 v51, 0xffff0000, v37
    v_fmac_f32 v28, v48, v48
    v_fmac_f32 v29, v49, v49
    v_fmac_f32 v28, v50, v50
    v_fmac_f32 v29, v51, v51
    v_lshlrev_b32 v48, 16, v38
    v_and_b32 v49, 0xffff0000, v38
    v_lshlrev_b32 v50, 16, v39
    v_and_b32 v51, 0xffff0000, v39
    v_fmac_f32 v28, v48, v48
    v_fmac_f32 v29, v49, v49
    v_fmac_f32 v28, v50, v50
    v_fmac_f32 v29, v51, v51
    s_add_u32 m0, s58, 16384
    s_add_u32 s41, s36, s39
    s_mov_b32 exec_hi, 0
    buffer_load_dwordx4 v6, s[28:31], s41 offen lds
    s_mov_b32 exec_hi, -1
    s_add_u32 s36, s36, 294912
    s_cmp_eq_u32 s36, s37
    s_cselect_b32 s36, s54, s36
    s_lshl_b32 s59, s2, 2
    s_or_b32 s59, s59, s51
    s_cmp_lg_u32 s59, 0
    s_cbranch_scc1 K1_nz2
    v_mov_b32 v8, 1
    v_mov_b32 v9, 0
    s_mov_b64 exec, 1
    buffer_store_dword v8, v9, s[44:47], 0 offen sc1
    s_mov_b64 exec, -1
K1_nz2:
    s_waitcnt vmcnt(7) lgkmcnt(0)
    s_barrier
    s_add_u32 m0, s57, 106496
    s_mov_b32 s23, s20
    buffer_load_dwordx4 v3, s[24:27], s23 offen lds
    s_add_u32 m0, s57, 106496
    s_nop 0
    buffer_load_dwordx4 v4, s[24:27], s23 offen offset:1024 lds
    s_add_u32 m0, s57, 18432
    s_add_u32 s40, s36, s38
    buffer_load_dwordx4 v5, s[28:31], s40 offen offset:0 lds
    v_lshlrev_b32 v48, 16, v40
    v_and_b32 v49, 0xffff0000, v40
    v_lshlrev_b32 v50, 16, v41
    v_and_b32 v51, 0xffff0000, v41
    v_fmac_f32 v28, v48, v48
    v_fmac_f32 v29, v49, v49
    v_fmac_f32 v28, v50, v50
    v_fmac_f32 v29, v51, v51
    v_lshlrev_b32 v48, 16, v42
    v_and_b32 v49, 0xffff0000, v42
    v_lshlrev_b32 v50, 16, v43
    v_and_b32 v51, 0xffff0000, v43
    v_fmac_f32 v28, v48, v48
    v_fmac_f32 v29, v49, v49
    v_fmac_f32 v28, v50, v50
    v_fmac_f32 v29, v51, v51
    s_add_u32 m0, s57, 19328
    s_nop 0
    buffer_load_dwordx4 v5, s[28:31], s40 offen offset:128 lds
    s_add_u32 m0, s57, 20224
    s_nop 0
    buffer_load_dwordx4 v5, s[28:31], s40 offen offset:256 lds
    s_add_u32 m0, s57, 21120
    s_nop 0
    buffer_load_dwordx4 v5, s[28:31], s40 offen offset:384 lds
    v_lshlrev_b32 v48, 16, v44
    v_and_b32 v49, 0xffff0000, v44
    v_lshlrev_b32 v50, 16, v45
    v_and_b32 v51, 0xffff0000, v45
    v_fmac_f32 v28, v48, v48
    v_fmac_f32 v29, v49, v49
    v_fmac_f32 v28, v50, v50
    v_fmac_f32 v29, v51, v51
    v_lshlrev_b32 v48, 16, v46
    v_and_b32 v49, 0xffff0000, v46
    v_lshlrev_b32 v50, 16, v47
    v_and_b32 v51, 0xffff0000, v47
    v_fmac_f32 v28, v48, v48
    v_fmac_f32 v29, v49, v49
    v_fmac_f32 v28, v50, v50
    v_fmac_f32 v29, v51, v51
    s_add_u32 m0, s58, 34816
    s_add_u32 s41, s36, s39
    s_mov_b32 exec_hi, 0
    buffer_load_dwordx4 v6, s[28:31], s41 offen lds
    s_mov_b32 exec_hi, -1
    s_add_u32 s36, s36, 294912
    s_cmp_eq_u32 s36, s37
    s_cselect_b32 s36, s54, s36
    s_waitcnt vmcnt(7)
    s_barrier
    ds_read_b128 v[32:35], v24 offset:16384
    ds_read_b128 v[36:39], v25 offset:16384
    ds_read_b128 v[40:43], v26 offset:16384
    ds_read_b128 v[44:47], v27 offset:16384
    s_add_u32 m0, s57, 108544
    s_add_u32 s23, s20, 589824
    buffer_load_dwordx4 v3, s[24:27], s23 offen lds
    s_add_u32 m0, s57, 108544
    s_nop 0
    buffer_load_dwordx4 v4, s[24:27], s23 offen offset:1024 lds
    s_add_u32 s20, s20, 128
    s_cmp_eq_u32 s20, s21
    s_cselect_b32 s20, s53, s20
    s_add_u32 m0, s57, 36864
    s_add_u32 s40, s36, s38
    buffer_load_dwordx4 v5, s[28:31], s40 offen offset:0 lds
    s_waitcnt lgkmcnt(3)
    v_lshlrev_b32 v48, 16, v32
    v_and_b32 v49, 0xffff0000, v32
    v_lshlrev_b32 v50, 16, v33
    v_and_b32 v51, 0xffff0000, v33
    v_fmac_f32 v28, v48, v48
    v_fmac_f32 v29, v49, v49
    v_fmac_f32 v28, v50, v50
    v_fmac_f32 v29, v51, v51
    v_lshlrev_b32 v48, 16, v34
    v_and_b32 v49, 0xffff0000, v34
    v_lshlrev_b32 v50, 16, v35
    v_and_b32 v51, 0xffff0000, v35
    v_fmac_f32 v28, v48, v48
    v_fmac_f32 v29, v49, v49
    v_fmac_f32 v28, v50, v50
    v_fmac_f32 v29, v51, v51
    s_add_u32 m0, s57, 37760
    s_nop 0
    buffer_load_dwordx4 v5, s[28:31], s40 offen offset:128 lds
    s_add_u32 m0, s57, 38656
    s_nop 0
    buffer_load_dwordx4 v5, s[28:31], s40 offen offset:256 lds
    s_add_u32 m0, s57, 39552
    s_nop 0
    buffer_load_dwordx4 v5, s[28:31], s40 offen offset:384 lds
    s_waitcnt lgkmcnt(2)
    v_lshlrev_b32 v48, 16, v36
    v_and_b32 v49, 0xffff0000, v36
    v_lshlrev_b32 v50, 16, v37
    v_and_b32 v51, 0xffff0000, v37
    v_fmac_f32 v28, v48, v48
    v_fmac_f32 v29, v49, v49
    v_fmac_f32 v28, v50, v50
    v_fmac_f32 v29, v51, v51
    v_lshlrev_b32 v48, 16, v38
    v_and_b32 v49, 0xffff0000, v38
    v_lshlrev_b32 v50, 16, v39
    v_and_b32 v51, 0xffff0000, v39
    v_fmac_f32 v28, v48, v48
    v_fmac_f32 v29, v49, v49
    v_fmac_f32 v28, v50, v50
    v_fmac_f32 v29, v51, v51
    s_add_u32 m0, s58, 53248
    s_add_u32 s41, s36, s39
    s_mov_b32 exec_hi, 0
    buffer_load_dwordx4 v6, s[28:31], s41 offen lds
    s_mov_b32 exec_hi, -1
    s_add_u32 s36, s36, 294912
    s_cmp_eq_u32 s36, s37
    s_cselect_b32 s36, s54, s36
    s_waitcnt vmcnt(7) lgkmcnt(0)
    s_barrier
    s_add_u32 m0, s57, 73728
    s_mov_b32 s23, s20
    buffer_load_dwordx4 v3, s[24:27], s23 offen lds
    s_add_u32 m0, s57, 73728
    s_nop 0
    buffer_load_dwordx4 v4, s[24:27], s23 offen offset:1024 lds
    s_add_u32 m0, s57, 55296
    s_add_u32 s40, s36, s38
    buffer_load_dwordx4 v5, s[28:31], s40 offen offset:0 lds
    v_lshlrev_b32 v48, 16, v40
    v_and_b32 v49, 0xffff0000, v40
    v_lshlrev_b32 v50, 16, v41
    v_and_b32 v51, 0xffff0000, v41
    v_fmac_f32 v28, v48, v48
    v_fmac_f32 v29, v49, v49
    v_fmac_f32 v28, v50, v50
    v_fmac_f32 v29, v51, v51
    v_lshlrev_b32 v48, 16, v42
    v_and_b32 v49, 0xffff0000, v42
    v_lshlrev_b32 v50, 16, v43
    v_and_b32 v51, 0xffff0000, v43
    v_fmac_f32 v28, v48, v48
    v_fmac_f32 v29, v49, v49
    v_fmac_f32 v28, v50, v50
    v_fmac_f32 v29, v51, v51
    s_add_u32 m0, s57, 56192
    s_nop 0
    buffer_load_dwordx4 v5, s[28:31], s40 offen offset:128 lds
    s_add_u32 m0, s57, 57088
    s_nop 0
    buffer_load_dwordx4 v5, s[28:31], s40 offen offset:256 lds
    s_add_u32 m0, s57, 57984
    s_nop 0
    buffer_load_dwordx4 v5, s[28:31], s40 offen offset:384 lds
    v_lshlrev_b32 v48, 16, v44
    v_and_b32 v49, 0xffff0000, v44
    v_lshlrev_b32 v50, 16, v45
    v_and_b32 v51, 0xffff0000, v45
    v_fmac_f32 v28, v48, v48
    v_fmac_f32 v29, v49, v49
    v_fmac_f32 v28, v50, v50
    v_fmac_f32 v29, v51, v51
    v_lshlrev_b32 v48, 16, v46
    v_and_b32 v49, 0xffff0000, v46
    v_lshlrev_b32 v50, 16, v47
    v_and_b32 v51, 0xffff0000, v47
    v_fmac_f32 v28, v48, v48
    v_fmac_f32 v29, v49, v49
    v_fmac_f32 v28, v50, v50
    v_fmac_f32 v29, v51, v51
    s_add_u32 m0, s58, 71680
    s_add_u32 s41, s36, s39
    s_mov_b32 exec_hi, 0
    buffer_load_dwordx4 v6, s[28:31], s41 offen lds
    s_mov_b32 exec_hi, -1
    s_add_u32 s36, s36, 294912
    s_cmp_eq_u32 s36, s37
    s_cselect_b32 s36, s54, s36
    s_waitcnt vmcnt(7)
    s_barrier
    ds_read_b128 v[32:35], v24 offset:32768
    ds_read_b128 v[36:39], v25 offset:32768
    ds_read_b128 v[40:43], v26 offset:32768
    ds_read_b128 v[44:47], v27 offset:32768
    s_add_u32 m0, s57, 75776
    s_add_u32 s23, s20, 589824
    buffer_load_dwordx4 v3, s[24:27], s23 offen lds
    s_add_u32 m0, s57, 75776
    s_nop 0
    buffer_load_dwordx4 v4, s[24:27], s23 offen offset:1024 lds
    s_add_u32 s20, s20, 128
    s_cmp_eq_u32 s20, s21
    s_cselect_b32 s20, s53, s20
    s_add_u32 m0, s57, 0
    s_add_u32 s40, s36, s38
    buffer_load_dwordx4 v5, s[28:31], s40 offen offset:0 lds
    s_waitcnt lgkmcnt(3)
    v_lshlrev_b32 v48, 16, v32
    v_and_b32 v49, 0xffff0000, v32
    v_lshlrev_b32 v50, 16, v33
    v_and_b32 v51, 0xffff0000, v33
    v_fmac_f32 v28, v48, v48
    v_fmac_f32 v29, v49, v49
    v_fmac_f32 v28, v50, v50
    v_fmac_f32 v29, v51, v51
    v_lshlrev_b32 v48, 16, v34
    v_and_b32 v49, 0xffff0000, v34
    v_lshlrev_b32 v50, 16, v35
    v_and_b32 v51, 0xffff0000, v35
    v_fmac_f32 v28, v48, v48
    v_fmac_f32 v29, v49, v49
    v_fmac_f32 v28, v50, v50
    v_fmac_f32 v29, v51, v51
    s_add_u32 m0, s57, 896
    s_nop 0
    buffer_load_dwordx4 v5, s[28:31], s40 offen offset:128 lds
    s_add_u32 m0, s57, 1792
    s_nop 0
    buffer_load_dwordx4 v5, s[28:31], s40 offen offset:256 lds
    s_add_u32 m0, s57, 2688
    s_nop 0
    buffer_load_dwordx4 v5, s[28:31], s40 offen offset:384 lds
    s_waitcnt lgkmcnt(2)
    v_lshlrev_b32 v48, 16, v36
    v_and_b32 v49, 0xffff0000, v36
    v_lshlrev_b32 v50, 16, v37
    v_and_b32 v51, 0xffff0000, v37
    v_fmac_f32 v28, v48, v48
    v_fmac_f32 v29, v49, v49
    v_fmac_f32 v28, v50, v50
    v_fmac_f32 v29, v51, v51
    v_lshlrev_b32 v48, 16, v38
    v_and_b32 v49, 0xffff0000, v38
    v_lshlrev_b32 v50, 16, v39
    v_and_b32 v51, 0xffff0000, v39
    v_fmac_f32 v28, v48, v48
    v_fmac_f32 v29, v49, v49
    v_fmac_f32 v28, v50, v50
    v_fmac_f32 v29, v51, v51
    s_add_u32 m0, s58, 16384
    s_add_u32 s41, s36, s39
    s_mov_b32 exec_hi, 0
    buffer_load_dwordx4 v6, s[28:31], s41 offen lds
    s_mov_b32 exec_hi, -1
    s_add_u32 s36, s36, 294912
    s_cmp_eq_u32 s36, s37
    s_cselect_b32 s36, s54, s36
    s_waitcnt vmcnt(7) lgkmcnt(0)
    s_barrier
    s_add_u32 m0, s57, 90112
    s_mov_b32 s23, s20
    buffer_load_dwordx4 v3, s[24:27], s23 offen lds
    s_add_u32 m0, s57, 90112
    s_nop 0
    buffer_load_dwordx4 v4, s[24:27], s23 offen offset:1024 lds
    s_add_u32 m0, s57, 18432
    s_add_u32 s40, s36, s38
    buffer_load_dwordx4 v5, s[28:31], s40 offen offset:0 lds
    v_lshlrev_b32 v48, 16, v40
    v_and_b32 v49, 0xffff0000, v40
    v_lshlrev_b32 v50, 16, v41
    v_and_b32 v51, 0xffff0000, v41
    v_fmac_f32 v28, v48, v48
    v_fmac_f32 v29, v49, v49
    v_fmac_f32 v28, v50, v50
    v_fmac_f32 v29, v51, v51
    v_lshlrev_b32 v48, 16, v42
    v_and_b32 v49, 0xffff0000, v42
    v_lshlrev_b32 v50, 16, v43
    v_and_b32 v51, 0xffff0000, v43
    v_fmac_f32 v28, v48, v48
    v_fmac_f32 v29, v49, v49
    v_fmac_f32 v28, v50, v50
    v_fmac_f32 v29, v51, v51
    s_add_u32 m0, s57, 19328
    s_nop 0
    buffer_load_dwordx4 v5, s[28:31], s40 offen offset:128 lds
    s_add_u32 m0, s57, 20224
    s_nop 0
    buffer_load_dwordx4 v5, s[28:31], s40 offen offset:256 lds
    s_add_u32 m0, s57, 21120
    s_nop 0
    buffer_load_dwordx4 v5, s[28:31], s40 offen offset:384 lds
    v_lshlrev_b32 v48, 16, v44
    v_and_b32 v49, 0xffff0000, v44
    v_lshlrev_b32 v50, 16, v45
    v_and_b32 v51, 0xffff0000, v45
    v_fmac_f32 v28, v48, v48
    v_fmac_f32 v29, v49, v49
    v_fmac_f32 v28, v50, v50
    v_fmac_f32 v29, v51, v51
    v_lshlrev_b32 v48, 16, v46
    v_and_b32 v49, 0xffff0000, v46
    v_lshlrev_b32 v50, 16, v47
    v_and_b32 v51, 0xffff0000, v47
    v_fmac_f32 v28, v48, v48
    v_fmac_f32 v29, v49, v49
    v_fmac_f32 v28, v50, v50
    v_fmac_f32 v29, v51, v51
    s_add_u32 m0, s58, 34816
    s_add_u32 s41, s36, s39
    s_mov_b32 exec_hi, 0
    buffer_load_dwordx4 v6, s[28:31], s41 offen lds
    s_mov_b32 exec_hi, -1
    s_add_u32 s36, s36, 294912
    s_cmp_eq_u32 s36, s37
    s_cselect_b32 s36, s54, s36
    s_getpc_b64 s[80:81]
    s_add_u32 s80, s80, fft_tab@rel32@lo+4
    s_addc_u32 s81, s81, fft_tab@rel32@hi+12
    s_mov_b32 s82, 45056
    s_mov_b32 s83, 0x20000
    s_lshr_b32 s65, s60, 1
    s_lshl_b32 s65, s65, 2
    s_add_u32 s65, s65, s51
    s_mov_b32 m0, 157184
    s_lshl_b32 s65, s65, 10
    buffer_load_dword v56, s[80:83], s65 offen lds
    s_mov_b32 m0, 157184
    s_nop 0
    buffer_load_dword v58, s[16:19], s96 offen lds
    s_waitcnt vmcnt(9)
    s_barrier
    ds_read_b128 v[32:35], v24 offset:0
    ds_read_b128 v[36:39], v25 offset:0
    ds_read_b128 v[40:43], v26 offset:0
    ds_read_b128 v[44:47], v27 offset:0
    s_add_u32 m0, s57, 92160
    s_add_u32 s23, s20, 589824
    buffer_load_dwordx4 v3, s[24:27], s23 offen lds
    s_add_u32 m0, s57, 92160
    s_nop 0
    buffer_load_dwordx4 v4, s[24:27], s23 offen offset:1024 lds
    s_add_u32 s20, s20, 128
    s_cmp_eq_u32 s20, s21
    s_cselect_b32 s20, s53, s20
    s_add_u32 m0, s57, 36864
    s_add_u32 s40, s36, s38
    buffer_load_dwordx4 v5, s[28:31], s40 offen offset:0 lds
    s_waitcnt lgkmcnt(3)
    v_lshlrev_b32 v48, 16, v32
    v_and_b32 v49, 0xffff0000, v32
    v_lshlrev_b32 v50, 16, v33
    v_and_b32 v51, 0xffff0000, v33
    v_fmac_f32 v28, v48, v48
    v_fmac_f32 v29, v49, v49
    v_fmac_f32 v28, v50, v50
    v_fmac_f32 v29, v51, v51
    v_lshlrev_b32 v48, 16, v34
    v_and_b32 v49, 0xffff0000, v34
    v_lshlrev_b32 v50, 16, v35
    v_and_b32 v51, 0xffff0000, v35
    v_fmac_f32 v28, v48, v48
    v_fmac_f32 v29, v49, v49
    v_fmac_f32 v28, v50, v50
    v_fmac_f32 v29, v51, v51
    s_add_u32 m0, s57, 37760
    s_nop 0
    buffer_load_dwordx4 v5, s[28:31], s40 offen offset:128 lds
    s_add_u32 m0, s57, 38656
    s_nop 0
    buffer_load_dwordx4 v5, s[28:31], s40 offen offset:256 lds
    s_add_u32 m0, s57, 39552
    s_nop 0
    buffer_load_dwordx4 v5, s[28:31], s40 offen offset:384 lds
    s_waitcnt lgkmcnt(2)
    v_lshlrev_b32 v48, 16, v36
    v_and_b32 v49, 0xffff0000, v36
    v_lshlrev_b32 v50, 16, v37
    v_and_b32 v51, 0xffff0000, v37
    v_fmac_f32 v28, v48, v48
    v_fmac_f32 v29, v49, v49
    v_fmac_f32 v28, v50, v50
    v_fmac_f32 v29, v51, v51
    v_lshlrev_b32 v48, 16, v38
    v_and_b32 v49, 0xffff0000, v38
    v_lshlrev_b32 v50, 16, v39
    v_and_b32 v51, 0xffff0000, v39
    v_fmac_f32 v28, v48, v48
    v_fmac_f32 v29, v49, v49
    v_fmac_f32 v28, v50, v50
    v_fmac_f32 v29, v51, v51
    s_add_u32 m0, s58, 53248
    s_add_u32 s41, s36, s39
    s_mov_b32 exec_hi, 0
    buffer_load_dwordx4 v6, s[28:31], s41 offen lds
    s_mov_b32 exec_hi, -1
    s_add_u32 s36, s36, 294912
    s_cmp_eq_u32 s36, s37
    s_cselect_b32 s36, s54, s36
    buffer_load_dword v54, v53, s[44:47], 0 offen sc1
    s_waitcnt vmcnt(10) lgkmcnt(0)
    s_barrier
    s_add_u32 m0, s57, 106496
    s_mov_b32 s23, s20
    buffer_load_dwordx4 v3, s[24:27], s23 offen lds
    s_add_u32 m0, s57, 106496
    s_nop 0
    buffer_load_dwordx4 v4, s[24:27], s23 offen offset:1024 lds
    s_add_u32 m0, s57, 55296
    s_add_u32 s40, s36, s38
    buffer_load_dwordx4 v5, s[28:31], s40 offen offset:0 lds
    v_lshlrev_b32 v48, 16, v40
    v_and_b32 v49, 0xffff0000, v40
    v_lshlrev_b32 v50, 16, v41
    v_and_b32 v51, 0xffff0000, v41
    v_fmac_f32 v28, v48, v48
    v_fmac_f32 v29, v49, v49
    v_fmac_f32 v28, v50, v50
    v_fmac_f32 v29, v51, v51
    v_lshlrev_b32 v48, 16, v42
    v_and_b32 v49, 0xffff0000, v42
    v_lshlrev_b32 v50, 16, v43
    v_and_b32 v51, 0xffff0000, v43
    v_fmac_f32 v28, v48, v48
    v_fmac_f32 v29, v49, v49
    v_fmac_f32 v28, v50, v50
    v_fmac_f32 v29, v51, v51
    s_add_u32 m0, s57, 56192
    s_nop 0
    buffer_load_dwordx4 v5, s[28:31], s40 offen offset:128 lds
    s_add_u32 m0, s57, 57088
    s_nop 0
    buffer_load_dwordx4 v5, s[28:31], s40 offen offset:256 lds
    s_add_u32 m0, s57, 57984
    s_nop 0
    buffer_load_dwordx4 v5, s[28:31], s40 offen offset:384 lds
    v_lshlrev_b32 v48, 16, v44
    v_and_b32 v49, 0xffff0000, v44
    v_lshlrev_b32 v50, 16, v45
    v_and_b32 v51, 0xffff0000, v45
    v_fmac_f32 v28, v48, v48
    v_fmac_f32 v29, v49, v49
    v_fmac_f32 v28, v50, v50
    v_fmac_f32 v29, v51, v51
    v_lshlrev_b32 v48, 16, v46
    v_and_b32 v49, 0xffff0000, v46
    v_lshlrev_b32 v50, 16, v47
    v_and_b32 v51, 0xffff0000, v47
    v_fmac_f32 v28, v48, v48
    v_fmac_f32 v29, v49, v49
    v_fmac_f32 v28, v50, v50
    v_fmac_f32 v29, v51, v51
    s_add_u32 m0, s58, 71680
    s_add_u32 s41, s36, s39
    s_mov_b32 exec_hi, 0
    buffer_load_dwordx4 v6, s[28:31], s41 offen lds
    s_mov_b32 exec_hi, -1
    s_add_u32 s36, s36, 294912
    s_cmp_eq_u32 s36, s37
    s_cselect_b32 s36, s54, s36
    s_waitcnt vmcnt(8)
    s_barrier
    ds_read_b128 v[32:35], v24 offset:16384
    ds_read_b128 v[36:39], v25 offset:16384
    ds_read_b128 v[40:43], v26 offset:16384
    ds_read_b128 v[44:47], v27 offset:16384
    s_add_u32 m0, s57, 108544
    s_add_u32 s23, s20, 589824
    buffer_load_dwordx4 v3, s[24:27], s23 offen lds
    s_add_u32 m0, s57, 108544
    s_nop 0
    buffer_load_dwordx4 v4, s[24:27], s23 offen offset:1024 lds
    s_add_u32 s20, s20, 128
    s_cmp_eq_u32 s20, s21
    s_cselect_b32 s20, s53, s20
    s_add_u32 m0, s57, 0
    s_add_u32 s40, s36, s38
    buffer_load_dwordx4 v5, s[28:31], s40 offen offset:0 lds
    s_waitcnt lgkmcnt(3)
    v_lshlrev_b32 v48, 16, v32
    v_and_b32 v49, 0xffff0000, v32
    v_lshlrev_b32 v50, 16, v33
    v_and_b32 v51, 0xffff0000, v33
    v_fmac_f32 v28, v48, v48
    v_fmac_f32 v29, v49, v49
    v_fmac_f32 v28, v50, v50
    v_fmac_f32 v29, v51, v51
    v_lshlrev_b32 v48, 16, v34
    v_and_b32 v49, 0xffff0000, v34
    v_lshlrev_b32 v50, 16, v35
    v_and_b32 v51, 0xffff0000, v35
    v_fmac_f32 v28, v48, v48
    v_fmac_f32 v29, v49, v49
    v_fmac_f32 v28, v50, v50
    v_fmac_f32 v29, v51, v51
    s_add_u32 m0, s57, 896
    s_nop 0
    buffer_load_dwordx4 v5, s[28:31], s40 offen offset:128 lds
    s_add_u32 m0, s57, 1792
    s_nop 0
    buffer_load_dwordx4 v5, s[28:31], s40 offen offset:256 lds
    s_add_u32 m0, s57, 2688
    s_nop 0
    buffer_load_dwordx4 v5, s[28:31], s40 offen offset:384 lds
    s_waitcnt lgkmcnt(2)
    v_lshlrev_b32 v48, 16, v36
    v_and_b32 v49, 0xffff0000, v36
    v_lshlrev_b32 v50, 16, v37
    v_and_b32 v51, 0xffff0000, v37
    v_fmac_f32 v28, v48, v48
    v_fmac_f32 v29, v49, v49
    v_fmac_f32 v28, v50, v50
    v_fmac_f32 v29, v51, v51
    v_lshlrev_b32 v48, 16, v38
    v_and_b32 v49, 0xffff0000, v38
    v_lshlrev_b32 v50, 16, v39
    v_and_b32 v51, 0xffff0000, v39
    v_fmac_f32 v28, v48, v48
    v_fmac_f32 v29, v49, v49
    v_fmac_f32 v28, v50, v50
    v_fmac_f32 v29, v51, v51
    s_add_u32 m0, s58, 16384
    s_add_u32 s41, s36, s39
    s_mov_b32 exec_hi, 0
    buffer_load_dwordx4 v6, s[28:31], s41 offen lds
    s_mov_b32 exec_hi, -1
    s_add_u32 s36, s36, 294912
    s_cmp_eq_u32 s36, s37
    s_cselect_b32 s36, s54, s36
    s_getpc_b64 s[80:81]
K1_pc2:
    s_sub_u32 s80, s80, K1_pc2-K1_start
    s_subb_u32 s81, s81, 0
    s_mov_b32 s82, code_end-K1_start
    s_mov_b32 s83, 0x20000
    s_lshl_b32 s59, s60, 2
    s_add_u32 s59, s59, s51
    s_mul_i32 s59, s59, 768
    buffer_load_dword v255, v57, s[80:83], s59 offen
    s_mov_b64 s[84:85], s[6:7]
    s_mov_b32 s86, 1183744
    s_mov_b32 s87, 0x20000
    s_mov_b64 s[76:77], s[8:9]
    s_mov_b32 s78, 1183744
    s_mov_b32 s79, 0x20000
    s_mul_i32 s67, s2, 4624
    s_lshl_b32 s68, s51, 6
    s_add_u32 s67, s67, s68
    buffer_load_dwordx3 v[112:114], v30, s[84:87], s67 offen offset:0
    buffer_load_dwordx3 v[116:118], v30, s[76:79], s67 offen offset:0
    buffer_load_dwordx3 v[120:122], v30, s[84:87], s67 offen offset:256
    buffer_load_dwordx3 v[124:126], v30, s[76:79], s67 offen offset:256
    buffer_load_dwordx3 v[128:130], v30, s[84:87], s67 offen offset:512
    buffer_load_dwordx3 v[132:134], v30, s[76:79], s67 offen offset:512
    s_lshl_b32 s69, s51, 18
    s_lshl_b32 s68, s2, 7
    s_add_u32 s69, s69, s68
    s_add_u32 s4, s32, 21233664
    s_addc_u32 s5, s33, 0
    s_mov_b32 s6, 2392064
    s_mov_b32 s7, 0x20000
    s_mov_b32 s8, 0x05040100
    s_mov_b32 s9, 0x07060302
    s_waitcnt vmcnt(14) lgkmcnt(0)
    s_barrier
    s_add_u32 m0, s57, 18432
    s_add_u32 s40, s36, s38
    buffer_load_dwordx4 v5, s[28:31], s40 offen offset:0 lds
    s_add_u32 m0, s57, 19328
    s_nop 0
    buffer_load_dwordx4 v5, s[28:31], s40 offen offset:128 lds
    s_add_u32 m0, s57, 20224
    s_nop 0
    buffer_load_dwordx4 v5, s[28:31], s40 offen offset:256 lds
    v_lshlrev_b32 v48, 16, v40
    v_and_b32 v49, 0xffff0000, v40
    v_lshlrev_b32 v50, 16, v41
    v_and_b32 v51, 0xffff0000, v41
    v_fmac_f32 v28, v48, v48
    v_fmac_f32 v29, v49, v49
    v_fmac_f32 v28, v50, v50
    v_fmac_f32 v29, v51, v51
    v_lshlrev_b32 v48, 16, v42
    v_and_b32 v49, 0xffff0000, v42
    v_lshlrev_b32 v50, 16, v43
    v_and_b32 v51, 0xffff0000, v43
    v_fmac_f32 v28, v48, v48
    v_fmac_f32 v29, v49, v49
    v_fmac_f32 v28, v50, v50
    v_fmac_f32 v29, v51, v51
    s_add_u32 m0, s57, 21120
    s_nop 0
    buffer_load_dwordx4 v5, s[28:31], s40 offen offset:384 lds
    s_add_u32 m0, s58, 34816
    s_add_u32 s41, s36, s39
    s_mov_b32 exec_hi, 0
    buffer_load_dwordx4 v6, s[28:31], s41 offen lds
    s_mov_b32 exec_hi, -1
    s_add_u32 s36, s36, 294912
    s_cmp_eq_u32 s36, s37
    s_cselect_b32 s36, s54, s36
    v_lshlrev_b32 v48, 16, v44
    v_and_b32 v49, 0xffff0000, v44
    v_lshlrev_b32 v50, 16, v45
    v_and_b32 v51, 0xffff0000, v45
    v_fmac_f32 v28, v48, v48
    v_fmac_f32 v29, v49, v49
    v_fmac_f32 v28, v50, v50
    v_fmac_f32 v29, v51, v51
    v_lshlrev_b32 v48, 16, v46
    v_and_b32 v49, 0xffff0000, v46
    v_lshlrev_b32 v50, 16, v47
    v_and_b32 v51, 0xffff0000, v47
    v_fmac_f32 v28, v48, v48
    v_fmac_f32 v29, v49, v49
    v_fmac_f32 v28, v50, v50
    v_fmac_f32 v29, v51, v51
    v_cmp_ne_u32 vcc, 1, v54
    s_nop 4
    s_cbranch_vccz K1_in_d
    s_mov_b32 s72, 0x40000
K1_in:
    buffer_load_dword v54, v53, s[44:47], 0 offen sc1
    s_waitcnt vmcnt(0)
    v_cmp_ne_u32 vcc, 1, v54
    s_sub_u32 s72, s72, 1
    s_cbranch_scc1 K1_in_d
    s_nop 2
    s_cbranch_vccz K1_in_d
    s_sleep 1
    s_branch K1_in
K1_in_d:
    s_mov_b32 m0, 157184
    s_nop 0
    buffer_load_dword v52, s[16:19], s95 offen lds
    s_add_u32 s95, s95, 5248
    s_waitcnt vmcnt(13)
    s_barrier
    ds_read_b128 v[32:35], v24 offset:32768
    ds_read_b128 v[36:39], v25 offset:32768
    ds_read_b128 v[40:43], v26 offset:32768
    ds_read_b128 v[44:47], v27 offset:32768
    s_waitcnt lgkmcnt(3)
    v_lshlrev_b32 v48, 16, v32
    v_and_b32 v49, 0xffff0000, v32
    v_lshlrev_b32 v50, 16, v33
    v_and_b32 v51, 0xffff0000, v33
    v_fmac_f32 v28, v48, v48
    v_fmac_f32 v29, v49, v49
    v_fmac_f32 v28, v50, v50
    v_fmac_f32 v29, v51, v51
    v_lshlrev_b32 v48, 16, v34
    v_and_b32 v49, 0xffff0000, v34
    v_lshlrev_b32 v50, 16, v35
    v_and_b32 v51, 0xffff0000, v35
    v_fmac_f32 v28, v48, v48
    v_fmac_f32 v29, v49, v49
    v_fmac_f32 v28, v50, v50
    v_fmac_f32 v29, v51, v51
    s_waitcnt lgkmcnt(2)
    v_lshlrev_b32 v48, 16, v36
    v_and_b32 v49, 0xffff0000, v36
    v_lshlrev_b32 v50, 16, v37
    v_and_b32 v51, 0xffff0000, v37
    v_fmac_f32 v28, v48, v48
    v_fmac_f32 v29, v49, v49
    v_fmac_f32 v28, v50, v50
    v_fmac_f32 v29, v51, v51
    v_lshlrev_b32 v48, 16, v38
    v_and_b32 v49, 0xffff0000, v38
    v_lshlrev_b32 v50, 16, v39
    v_and_b32 v51, 0xffff0000, v39
    v_fmac_f32 v28, v48, v48
    v_fmac_f32 v29, v49, v49
    v_fmac_f32 v28, v50, v50
    v_fmac_f32 v29, v51, v51
    s_waitcnt lgkmcnt(1)
    v_lshlrev_b32 v48, 16, v40
    v_and_b32 v49, 0xffff0000, v40
    v_lshlrev_b32 v50, 16, v41
    v_and_b32 v51, 0xffff0000, v41
    v_fmac_f32 v28, v48, v48
    v_fmac_f32 v29, v49, v49
    v_fmac_f32 v28, v50, v50
    v_fmac_f32 v29, v51, v51
    v_lshlrev_b32 v48, 16, v42
    v_and_b32 v49, 0xffff0000, v42
    v_lshlrev_b32 v50, 16, v43
    v_and_b32 v51, 0xffff0000, v43
    v_fmac_f32 v28, v48, v48
    v_fmac_f32 v29, v49, v49
    v_fmac_f32 v28, v50, v50
    v_fmac_f32 v29, v51, v51
    s_waitcnt vmcnt(1) lgkmcnt(0)
    s_barrier
    v_lshlrev_b32 v48, 16, v44
    v_and_b32 v49, 0xffff0000, v44
    v_lshlrev_b32 v50, 16, v45
    v_and_b32 v51, 0xffff0000, v45
    v_fmac_f32 v28, v48, v48
    v_fmac_f32 v29, v49, v49
    v_fmac_f32 v28, v50, v50
    v_fmac_f32 v29, v51, v51
    v_lshlrev_b32 v48, 16, v46
    v_and_b32 v49, 0xffff0000, v46
    v_lshlrev_b32 v50, 16, v47
    v_and_b32 v51, 0xffff0000, v47
    v_fmac_f32 v28, v48, v48
    v_fmac_f32 v29, v49, v49
    v_fmac_f32 v28, v50, v50
    v_fmac_f32 v29, v51, v51
    v_add_f32 v28, v28, v29
    ds_write_b32 v59, v28
    s_waitcnt lgkmcnt(0)
    s_barrier
    v_alignbit_b32 v112, v113, v112, v253
    v_alignbit_b32 v113, v114, v113, v253
    v_alignbit_b32 v116, v117, v116, v253
    v_alignbit_b32 v117, v118, v117, v253
    v_alignbit_b32 v120, v121, v120, v253
    v_alignbit_b32 v121, v122, v121, v253
    v_alignbit_b32 v124, v125, v124, v253
    v_alignbit_b32 v125, v126, v125, v253
    v_alignbit_b32 v128, v129, v128, v253
    v_alignbit_b32 v129, v130, v129, v253
    v_alignbit_b32 v132, v133, v132, v253
    v_alignbit_b32 v133, v134, v133, v253
    s_and_b32 s68, s2, 3
    s_cmp_lg_u32 s68, 0
    s_cbranch_scc1 K1_nexr0
    v_perm_b32 v136, v116, v112, s8
    v_perm_b32 v137, v116, v112, s9
    v_perm_b32 v138, v117, v113, s8
    v_perm_b32 v139, v117, v113, s9
    v_perm_b32 v140, v124, v120, s8
    v_perm_b32 v141, v124, v120, s9
    v_perm_b32 v142, v125, v121, s8
    v_perm_b32 v143, v125, v121, s9
    v_perm_b32 v144, v132, v128, s8
    v_perm_b32 v145, v132, v128, s9
    v_perm_b32 v146, v133, v129, s8
    v_perm_b32 v147, v133, v129, s9
    s_branch K1_nexr
K1_nexr0:
    s_cmp_lg_u32 s68, 1
    s_cbranch_scc1 K1_nexr1
    v_perm_b32 v137, v116, v112, s8
    v_perm_b32 v138, v116, v112, s9
    v_perm_b32 v139, v117, v113, s8
    v_perm_b32 v136, v117, v113, s9
    v_perm_b32 v141, v124, v120, s8
    v_perm_b32 v142, v124, v120, s9
    v_perm_b32 v143, v125, v121, s8
    v_perm_b32 v140, v125, v121, s9
    v_perm_b32 v145, v132, v128, s8
    v_perm_b32 v146, v132, v128, s9
    v_perm_b32 v147, v133, v129, s8
    v_perm_b32 v144, v133, v129, s9
    s_branch K1_nexr
K1_nexr1:
    s_cmp_lg_u32 s68, 2
    s_cbranch_scc1 K1_nexr2
    v_perm_b32 v138, v116, v112, s8
    v_perm_b32 v139, v116, v112, s9
    v_perm_b32 v136, v117, v113, s8
    v_perm_b32 v137, v117, v113, s9
    v_perm_b32 v142, v124, v120, s8
    v_perm_b32 v143, v124, v120, s9
    v_perm_b32 v140, v125, v121, s8
    v_perm_b32 v141, v125, v121, s9
    v_perm_b32 v146, v132, v128, s8
    v_perm_b32 v147, v132, v128, s9
    v_perm_b32 v144, v133, v129, s8
    v_perm_b32 v145, v133, v129, s9
    s_branch K1_nexr
K1_nexr2:
    v_perm_b32 v139, v116, v112, s8
    v_perm_b32 v136, v116, v112, s9
    v_perm_b32 v137, v117, v113, s8
    v_perm_b32 v138, v117, v113, s9
    v_perm_b32 v143, v124, v120, s8
    v_perm_b32 v140, v124, v120, s9
    v_perm_b32 v141, v125, v121, s8
    v_perm_b32 v142, v125, v121, s9
    v_perm_b32 v147, v132, v128, s8
    v_perm_b32 v144, v132, v128, s9
    v_perm_b32 v145, v133, v129, s8
    v_perm_b32 v146, v133, v129, s9
K1_nexr:
    s_add_u32 s68, s69, 0
    buffer_store_dwordx4 v[136:139], v31, s[4:7], s68 offen sc1
    s_add_u32 s68, s69, 1048576
    buffer_store_dwordx4 v[140:143], v31, s[4:7], s68 offen sc1
    s_add_u32 s68, s69, 2097152
    buffer_store_dwordx4 v[144:147], v31, s[4:7], s68 offen sc1
    s_barrier
    s_mov_b32 s11, s69
    v_mov_b32 v252, v31
    s_branch K2_start
K1_end:
    s_endpgm
.p2align 8
K2_start:
    s_mov_b64 s[24:25], s[16:17]
    s_and_b32 s49, s2, 7
    s_lshr_b32 s50, s2, 3
    s_mov_b32 s26, 5308416
    s_mov_b32 s27, 0x20000
    s_mov_b32 s34, 0x10000000
    s_mov_b32 s35, 0x20000
    v_lshlrev_b32 v7, 4, v0
    s_cmp_lt_u32 s50, 8
    s_cbranch_scc1 K2_fft
    s_sub_u32 s50, s50, 8
    s_lshr_b32 s51, s49, 1
    s_and_b32 s52, s49, 1
    s_lshl_b32 s52, s52, 3
    s_and_b32 s59, s50, 7
    s_add_u32 s52, s52, s59
    s_lshr_b32 s53, s50, 3
    s_cmp_lt_u32 s48, 4
    s_cbranch_scc1 K2_comp
    s_sub_u32 s54, s48, 4
    s_lshl_b32 s55, s52, 2
    s_add_u32 s55, s55, s54
    s_mul_i32 s55, s55, 294912
    s_mul_i32 s59, s51, 73728
    s_add_u32 s55, s55, s59
    s_mul_i32 s56, s51, 1327104
    s_mul_i32 s59, s54, 9216
    s_add_u32 s56, s56, s59
    s_mul_i32 s59, s53, 192
    s_add_u32 s56, s56, s59
    v_lshrrev_b32 v2, 3, v0
    v_and_b32 v3, 7, v0
    v_and_b32 v4, 6, v2
    v_xor_b32 v3, v3, v4
    v_mul_u32_u24 v2, 1152, v2
    v_lshl_add_u32 v2, v3, 4, v2
    s_and_b32 s59, s53, 1
    s_lshl_b32 s60, s59, 6
    v_add_u32 v244, s60, v2
    s_sub_u32 s60, 640, s60
    v_add_u32 v245, s60, v2
    s_lshl_b32 s60, s59, 7
    s_sub_u32 s61, 128, s60
    s_lshl_b32 s60, s60, 1
    s_add_u32 s60, s60, 384
    v_lshrrev_b32 v3, 2, v3
    v_mad_u32_u24 v246, v3, s60, v2
    v_add_u32 v246, s61, v246
    s_lshl_b32 s57, s54, 11
    s_mul_i32 s58, s54, 3072
    s_add_u32 s58, s58, 8192
    s_and_b32 s60, s52, 0
    s_mul_i32 s60, s60, 9
    s_lshr_b32 s60, s60, 1
    s_waitcnt lgkmcnt(0)
    s_add_u32 s59, s53, 1
    s_and_b32 s59, s59, 3
    s_mul_i32 s60, s59, 18432
    s_add_u32 s76, s55, s60
    s_mul_i32 s60, s59, 331776
    s_add_u32 s80, s56, s60
    s_add_u32 s59, s53, 2
    s_and_b32 s59, s59, 3
    s_mul_i32 s60, s59, 18432
    s_add_u32 s77, s55, s60
    s_mul_i32 s60, s59, 331776
    s_add_u32 s81, s56, s60
    s_add_u32 s59, s53, 3
    s_and_b32 s59, s59, 3
    s_mul_i32 s60, s59, 18432
    s_add_u32 s78, s55, s60
    s_mul_i32 s60, s59, 331776
    s_add_u32 s82, s56, s60
    s_add_u32 s59, s53, 4
    s_and_b32 s59, s59, 3
    s_mul_i32 s60, s59, 18432
    s_add_u32 s79, s55, s60
    s_mul_i32 s60, s59, 331776
    s_add_u32 s83, s56, s60
    s_and_b32 s59, s53, 1
    s_mul_i32 s60, s59, 294912
    s_add_u32 s75, s80, s60
    s_xor_b32 s59, s59, 1
    s_mul_i32 s60, s59, 36864
    s_add_u32 s74, s80, s60
    s_lshl_b32 s59, s54, 2
    s_add_u32 s59, s59, 159744
    v_mov_b32 v240, s59
    v_xor_b32 v241, 8, v240
    v_mov_b32 v243, 0
    v_mov_b32 v242, 1
    s_add_u32 m0, s58, 0
    s_add_u32 s61, s74, 0
    buffer_load_dwordx4 v244, s[24:27], s61 offen  lds
    s_add_u32 m0, s58, 1024
    s_nop 0
    buffer_load_dwordx4 v245, s[24:27], s61 offen  lds
    s_add_u32 m0, s58, 2048
    s_nop 0
    buffer_load_dwordx4 v246, s[24:27], s61 offen  lds
    s_add_u32 m0, s58, 20480
    s_add_u32 s61, s74, 36864
    buffer_load_dwordx4 v244, s[24:27], s61 offen  lds
    s_add_u32 m0, s58, 21504
    s_nop 0
    buffer_load_dwordx4 v245, s[24:27], s61 offen  lds
    s_add_u32 m0, s58, 22528
    s_nop 0
    buffer_load_dwordx4 v246, s[24:27], s61 offen  lds
    s_barrier
    ds_read_b128 v[32:35], v250
    ds_read_b128 v[36:39], v250 offset:1024
    ds_read_b128 v[40:43], v250 offset:8192
    s_waitcnt lgkmcnt(0)
    buffer_store_dwordx4 v[32:35], v251, s[32:35], s14 offen sc1
    buffer_store_dwordx4 v[36:39], v251, s[32:35], s15 offen sc1
    s_cmp_lg_u32 s48, 4
    s_cbranch_scc1 K1_nexg
    buffer_store_dwordx4 v[40:43], v251, s[32:35], s10 offen sc1
K1_nexg:
    s_and_b32 s59, s2, 7
    s_lshl_b32 s59, s59, 7
    s_add_u32 s59, s59, 37576704
    v_mov_b32 v8, 160896
    v_mov_b32 v9, 1
    s_waitcnt vmcnt(0)
    s_mov_b64 exec, 1
    ds_add_rtn_u32 v10, v8, v9
    v_mov_b32 v8, 0
    s_waitcnt lgkmcnt(0)
    v_readfirstlane_b32 s23, v10
    s_nop 0
    s_cmp_lg_u32 s23, 3
    s_cbranch_scc1 K1_nsg
    buffer_atomic_add v9, v8, s[32:35], s59 offen sc1
K1_nsg:
    s_mov_b64 exec, -1
    s_add_u32 m0, s58, 40960
    s_add_u32 s61, s74, 73728
    buffer_load_dwordx4 v244, s[24:27], s61 offen  lds
    s_add_u32 m0, s58, 41984
    s_nop 0
    buffer_load_dwordx4 v245, s[24:27], s61 offen  lds
    s_add_u32 m0, s58, 43008
    s_nop 0
    buffer_load_dwordx4 v246, s[24:27], s61 offen  lds
    s_add_u32 m0, s58, 61440
    s_add_u32 s61, s74, 110592
    buffer_load_dwordx4 v244, s[24:27], s61 offen  lds
    s_add_u32 m0, s58, 62464
    s_nop 0
    buffer_load_dwordx4 v245, s[24:27], s61 offen  lds
    s_add_u32 m0, s58, 63488
    s_nop 0
    buffer_load_dwordx4 v246, s[24:27], s61 offen  lds
    s_lshl_b32 s62, s52, 2
    s_add_u32 s62, s62, s51
    s_lshl_b32 s62, s62, 7
    s_add_u32 s62, s62, 37568512
    s_barrier
    ds_write_b32 v240, v243
    ds_write_b32 v240, v243 offset:16
    s_add_u32 m0, s58, 81920
    s_add_u32 s61, s74, 147456
    buffer_load_dwordx4 v244, s[24:27], s61 offen  lds
    s_add_u32 m0, s58, 82944
    s_nop 0
    buffer_load_dwordx4 v245, s[24:27], s61 offen  lds
    s_add_u32 m0, s58, 83968
    s_nop 0
    buffer_load_dwordx4 v246, s[24:27], s61 offen  lds
    s_and_b32 s64, s54, 1
    s_lshr_b32 s65, s54, 1
    v_and_b32 v1, 15, v0
    v_lshrrev_b32 v3, 4, v0
    v_lshl_add_u32 v4, v3, 3, s64
    v_cvt_f32_u32 v4, v4
    s_lshl_b32 s63, s53, 1
    s_add_u32 s63, s63, s65
    s_mul_i32 s63, s63, 48
    v_add_u32 v10, s63, v1
    v_cmp_eq_f32 s[70:71], 0, v4
    v_cvt_f32_u32 v11, v10
    v_lshlrev_b32 v204, 31, v10
    v_mul_f32 v11, 0x3ae38e39, v11
    v_or_b32 v204, 0x3f003f00, v204
    v_mul_f32 v12, v4, v11
    v_add_f32 v13, v11, v11
    s_add_u32 m0, s58, 102400
    s_add_u32 s61, s74, 184320
    buffer_load_dwordx4 v244, s[24:27], s61 offen  lds
    s_add_u32 m0, s58, 103424
    s_nop 0
    buffer_load_dwordx4 v245, s[24:27], s61 offen  lds
    s_add_u32 m0, s58, 104448
    s_nop 0
    buffer_load_dwordx4 v246, s[24:27], s61 offen  lds
    v_mul_f32 v14, 0x42000000, v11
    v_cos_f32 v148, v12
    v_sin_f32_e64 v149, -v12
    v_cos_f32 v202, v13
    v_sin_f32 v203, v13
    v_cos_f32 v196, v14
    v_sin_f32 v197, v14
    v_pk_mul_f32 v[152:153], v[148:149], v[202:203] op_sel_hi:[1,0]
    v_pk_fma_f32 v[152:153], v[148:149], v[202:203], v[152:153] op_sel:[1,1,0] op_sel_hi:[0,1,1] neg_hi:[0,1,0]
    v_pk_mul_f32 v[156:157], v[148:149], v[196:197] op_sel_hi:[1,0]
    v_pk_fma_f32 v[156:157], v[148:149], v[196:197], v[156:157] op_sel:[1,1,0] op_sel_hi:[0,1,1] neg_hi:[0,1,0]
    v_pk_mul_f32 v[150:151], v[152:153], v[202:203] op_sel_hi:[1,0]
    v_pk_fma_f32 v[150:151], v[152:153], v[202:203], v[150:151] op_sel:[1,1,0] op_sel_hi:[0,1,1] neg_hi:[0,1,0]
    v_pk_mul_f32 v[160:161], v[152:153], v[196:197] op_sel_hi:[1,0]
    v_pk_fma_f32 v[160:161], v[152:153], v[196:197], v[160:161] op_sel:[1,1,0] op_sel_hi:[0,1,1] neg_hi:[0,1,0]
    v_pk_mul_f32 v[154:155], v[150:151], v[202:203] op_sel_hi:[1,0]
    v_pk_fma_f32 v[154:155], v[150:151], v[202:203], v[154:155] op_sel:[1,1,0] op_sel_hi:[0,1,1] neg_hi:[0,1,0]
    s_waitcnt vmcnt(6)
    s_waitcnt lgkmcnt(0)
    s_barrier
    s_add_u32 m0, s58, 0
    s_add_u32 s61, s74, 221184
    buffer_load_dwordx4 v244, s[24:27], s61 offen  lds
    s_add_u32 m0, s58, 1024
    s_nop 0
    buffer_load_dwordx4 v245, s[24:27], s61 offen  lds
    s_add_u32 m0, s58, 2048
    s_nop 0
    buffer_load_dwordx4 v246, s[24:27], s61 offen  lds
    v_pk_mul_f32 v[158:159], v[150:151], v[196:197] op_sel_hi:[1,0]
    v_pk_fma_f32 v[158:159], v[150:151], v[196:197], v[158:159] op_sel:[1,1,0] op_sel_hi:[0,1,1] neg_hi:[0,1,0]
    v_pk_mul_f32 v[162:163], v[154:155], v[196:197] op_sel_hi:[1,0]
    v_pk_fma_f32 v[162:163], v[154:155], v[196:197], v[162:163] op_sel:[1,1,0] op_sel_hi:[0,1,1] neg_hi:[0,1,0]
    v_add_f32 v196, v196, v196
    v_add_f32 v11, 0x3ce38e39, v11
    v_mul_f32 v12, v4, v11
    v_add_f32 v13, v11, v11
    v_mul_f32 v14, 0x42000000, v11
    v_cos_f32 v164, v12
    v_sin_f32_e64 v165, -v12
    v_cos_f32 v202, v13
    v_sin_f32 v203, v13
    v_cos_f32 v198, v14
    v_sin_f32 v199, v14
    v_pk_mul_f32 v[168:169], v[164:165], v[202:203] op_sel_hi:[1,0]
    v_pk_fma_f32 v[168:169], v[164:165], v[202:203], v[168:169] op_sel:[1,1,0] op_sel_hi:[0,1,1] neg_hi:[0,1,0]
    s_add_u32 m0, s58, 20480
    s_add_u32 s61, s74, 258048
    buffer_load_dwordx4 v244, s[24:27], s61 offen  lds
    s_add_u32 m0, s58, 21504
    s_nop 0
    buffer_load_dwordx4 v245, s[24:27], s61 offen  lds
    s_add_u32 m0, s58, 22528
    s_nop 0
    buffer_load_dwordx4 v246, s[24:27], s61 offen  lds
    v_pk_mul_f32 v[172:173], v[164:165], v[198:199] op_sel_hi:[1,0]
    v_pk_fma_f32 v[172:173], v[164:165], v[198:199], v[172:173] op_sel:[1,1,0] op_sel_hi:[0,1,1] neg_hi:[0,1,0]
    v_pk_mul_f32 v[166:167], v[168:169], v[202:203] op_sel_hi:[1,0]
    v_pk_fma_f32 v[166:167], v[168:169], v[202:203], v[166:167] op_sel:[1,1,0] op_sel_hi:[0,1,1] neg_hi:[0,1,0]
    v_pk_mul_f32 v[176:177], v[168:169], v[198:199] op_sel_hi:[1,0]
    v_pk_fma_f32 v[176:177], v[168:169], v[198:199], v[176:177] op_sel:[1,1,0] op_sel_hi:[0,1,1] neg_hi:[0,1,0]
    v_pk_mul_f32 v[170:171], v[166:167], v[202:203] op_sel_hi:[1,0]
    v_pk_fma_f32 v[170:171], v[166:167], v[202:203], v[170:171] op_sel:[1,1,0] op_sel_hi:[0,1,1] neg_hi:[0,1,0]
    v_pk_mul_f32 v[174:175], v[166:167], v[198:199] op_sel_hi:[1,0]
    v_pk_fma_f32 v[174:175], v[166:167], v[198:199], v[174:175] op_sel:[1,1,0] op_sel_hi:[0,1,1] neg_hi:[0,1,0]
    v_pk_mul_f32 v[178:179], v[170:171], v[198:199] op_sel_hi:[1,0]
    v_pk_fma_f32 v[178:179], v[170:171], v[198:199], v[178:179] op_sel:[1,1,0] op_sel_hi:[0,1,1] neg_hi:[0,1,0]
    v_add_f32 v198, v198, v198
    v_add_f32 v11, 0x3ce38e39, v11
    v_mul_f32 v12, v4, v11
    v_add_f32 v13, v11, v11
    v_mul_f32 v14, 0x42000000, v11
    s_waitcnt vmcnt(6)
    s_barrier
    s_add_u32 m0, s58, 40960
    s_mov_b32 s61, s75
    buffer_load_dwordx4 v244, s[24:27], s61 offen  lds
    s_add_u32 m0, s58, 41984
    s_nop 0
    buffer_load_dwordx4 v245, s[24:27], s61 offen  lds
    s_add_u32 m0, s58, 43008
    s_nop 0
    buffer_load_dwordx4 v246, s[24:27], s61 offen  lds
    v_cos_f32 v180, v12
    v_sin_f32_e64 v181, -v12
    v_cos_f32 v202, v13
    v_sin_f32 v203, v13
    v_cos_f32 v200, v14
    v_sin_f32 v201, v14
    v_pk_mul_f32 v[184:185], v[180:181], v[202:203] op_sel_hi:[1,0]
    v_pk_fma_f32 v[184:185], v[180:181], v[202:203], v[184:185] op_sel:[1,1,0] op_sel_hi:[0,1,1] neg_hi:[0,1,0]
    v_pk_mul_f32 v[188:189], v[180:181], v[200:201] op_sel_hi:[1,0]
    v_pk_fma_f32 v[188:189], v[180:181], v[200:201], v[188:189] op_sel:[1,1,0] op_sel_hi:[0,1,1] neg_hi:[0,1,0]
    v_pk_mul_f32 v[182:183], v[184:185], v[202:203] op_sel_hi:[1,0]
    v_pk_fma_f32 v[182:183], v[184:185], v[202:203], v[182:183] op_sel:[1,1,0] op_sel_hi:[0,1,1] neg_hi:[0,1,0]
    v_pk_mul_f32 v[192:193], v[184:185], v[200:201] op_sel_hi:[1,0]
    v_pk_fma_f32 v[192:193], v[184:185], v[200:201], v[192:193] op_sel:[1,1,0] op_sel_hi:[0,1,1] neg_hi:[0,1,0]
    v_pk_mul_f32 v[186:187], v[182:183], v[202:203] op_sel_hi:[1,0]
    v_pk_fma_f32 v[186:187], v[182:183], v[202:203], v[186:187] op_sel:[1,1,0] op_sel_hi:[0,1,1] neg_hi:[0,1,0]
    v_pk_mul_f32 v[190:191], v[182:183], v[200:201] op_sel_hi:[1,0]
    s_add_u32 m0, s58, 61440
    s_add_u32 s61, s81, 0
    buffer_load_dwordx4 v244, s[24:27], s61 offen  lds
    s_add_u32 m0, s58, 62464
    s_nop 0
    buffer_load_dwordx4 v245, s[24:27], s61 offen  lds
    s_add_u32 m0, s58, 63488
    s_nop 0
    buffer_load_dwordx4 v246, s[24:27], s61 offen  lds
    v_pk_fma_f32 v[190:191], v[182:183], v[200:201], v[190:191] op_sel:[1,1,0] op_sel_hi:[0,1,1] neg_hi:[0,1,0]
    v_pk_mul_f32 v[194:195], v[186:187], v[200:201] op_sel_hi:[1,0]
    v_pk_fma_f32 v[194:195], v[186:187], v[200:201], v[194:195] op_sel:[1,1,0] op_sel_hi:[0,1,1] neg_hi:[0,1,0]
    v_add_f32 v200, v200, v200
    v_cvt_pk_bf16_f32 v40, v148, v149
    v_cvt_pk_bf16_f32 v41, v150, v151
    v_cvt_pk_bf16_f32 v42, v152, v153
    v_cvt_pk_bf16_f32 v43, v154, v155
    v_cndmask_b32_e64 v40, v40, v204, s[70:71]
    v_cvt_pk_bf16_f32 v44, v164, v165
    v_cvt_pk_bf16_f32 v45, v166, v167
    v_cvt_pk_bf16_f32 v46, v168, v169
    v_cvt_pk_bf16_f32 v47, v170, v171
    v_cndmask_b32_e64 v44, v44, v204, s[70:71]
    v_cvt_pk_bf16_f32 v48, v180, v181
    v_cvt_pk_bf16_f32 v49, v182, v183
    v_cvt_pk_bf16_f32 v50, v184, v185
    buffer_load_dword v247, v243, s[32:35], s62 offen sc1
    s_waitcnt vmcnt(7)
    s_barrier
    s_waitcnt vmcnt(0)
    v_cmp_ne_u32 vcc, 16, v247
    s_nop 4
    s_cbranch_vccz K2_pb_d
    s_mov_b32 s72, 0x40000
K2_pb:
    buffer_load_dword v247, v243, s[32:35], s62 offen sc1
    s_waitcnt vmcnt(0)
    v_cmp_ne_u32 vcc, 16, v247
    s_sub_u32 s72, s72, 1
    s_cbranch_scc1 K2_pb_d
    s_nop 2
    s_cbranch_vccz K2_pb_d
    s_sleep 12
    s_branch K2_pb
K2_pb_d:
    s_add_u32 m0, s57, 61440
    s_add_u32 s59, s77, 0
    buffer_load_dwordx4 v7, s[32:35], s59 offen sc1 lds
    buffer_load_dwordx4 v7, s[32:35], s59 offen offset:1024 sc1 lds
    v_cvt_pk_bf16_f32 v51, v186, v187
    v_cndmask_b32_e64 v48, v48, v204, s[70:71]
    v_cvt_pk_bf16_f32 v52, v156, v157
    v_cvt_pk_bf16_f32 v53, v158, v159
    v_cvt_pk_bf16_f32 v54, v160, v161
    v_cvt_pk_bf16_f32 v55, v162, v163
    v_cvt_pk_bf16_f32 v56, v172, v173
    v_cvt_pk_bf16_f32 v57, v174, v175
    v_cvt_pk_bf16_f32 v58, v176, v177
    v_cvt_pk_bf16_f32 v59, v178, v179
    v_cvt_pk_bf16_f32 v60, v188, v189
    v_cvt_pk_bf16_f32 v61, v190, v191
    v_cvt_pk_bf16_f32 v62, v192, v193
    v_cvt_pk_bf16_f32 v63, v194, v195
    v_fma_f32 v148, v156, v196, -v148
    v_fma_f32 v149, v157, v196, -v149
    v_fma_f32 v150, v158, v196, -v150
    s_add_u32 m0, s57, 81920
    s_add_u32 s59, s77, 2048
    buffer_load_dwordx4 v7, s[32:35], s59 offen sc1 lds
    buffer_load_dwordx4 v7, s[32:35], s59 offen offset:1024 sc1 lds
    s_add_u32 m0, s58, 81920
    s_add_u32 s61, s81, 36864
    buffer_load_dwordx4 v244, s[24:27], s61 offen  lds
    s_add_u32 m0, s58, 82944
    s_nop 0
    buffer_load_dwordx4 v245, s[24:27], s61 offen  lds
    s_add_u32 m0, s58, 83968
    s_nop 0
    buffer_load_dwordx4 v246, s[24:27], s61 offen  lds
    v_fma_f32 v151, v159, v196, -v151
    v_fma_f32 v152, v160, v196, -v152
    v_fma_f32 v153, v161, v196, -v153
    v_fma_f32 v154, v162, v196, -v154
    v_fma_f32 v155, v163, v196, -v155
    v_fma_f32 v164, v172, v198, -v164
    v_fma_f32 v165, v173, v198, -v165
    v_fma_f32 v166, v174, v198, -v166
    v_fma_f32 v167, v175, v198, -v167
    v_fma_f32 v168, v176, v198, -v168
    v_fma_f32 v169, v177, v198, -v169
    v_fma_f32 v170, v178, v198, -v170
    v_fma_f32 v171, v179, v198, -v171
    v_fma_f32 v180, v188, v200, -v180
    v_fma_f32 v181, v189, v200, -v181
    v_fma_f32 v182, v190, v200, -v182
    v_fma_f32 v183, v191, v200, -v183
    s_add_u32 m0, s57, 102400
    s_add_u32 s59, s77, 4096
    buffer_load_dwordx4 v7, s[32:35], s59 offen sc1 lds
    buffer_load_dwordx4 v7, s[32:35], s59 offen offset:1024 sc1 lds
    s_add_u32 m0, s58, 102400
    s_add_u32 s61, s81, 73728
    buffer_load_dwordx4 v244, s[24:27], s61 offen  lds
    s_add_u32 m0, s58, 103424
    s_nop 0
    buffer_load_dwordx4 v245, s[24:27], s61 offen  lds
    s_add_u32 m0, s58, 104448
    s_nop 0
    buffer_load_dwordx4 v246, s[24:27], s61 offen  lds
    v_fma_f32 v184, v192, v200, -v184
    v_fma_f32 v185, v193, v200, -v185
    v_fma_f32 v186, v194, v200, -v186
    v_fma_f32 v187, v195, v200, -v187
    v_cvt_pk_bf16_f32 v64, v148, v149
    v_cvt_pk_bf16_f32 v65, v150, v151
    v_cvt_pk_bf16_f32 v66, v152, v153
    v_cvt_pk_bf16_f32 v67, v154, v155
    v_cvt_pk_bf16_f32 v68, v164, v165
    v_cvt_pk_bf16_f32 v69, v166, v167
    v_cvt_pk_bf16_f32 v70, v168, v169
    v_cvt_pk_bf16_f32 v71, v170, v171
    v_cvt_pk_bf16_f32 v72, v180, v181
    v_cvt_pk_bf16_f32 v73, v182, v183
    v_cvt_pk_bf16_f32 v74, v184, v185
    v_cvt_pk_bf16_f32 v75, v186, v187
    v_fma_f32 v156, v148, v196, -v156
    s_waitcnt vmcnt(10)
    s_barrier
    s_add_u32 m0, s57, 0
    s_add_u32 s59, s77, 6144
    buffer_load_dwordx4 v7, s[32:35], s59 offen sc1 lds
    buffer_load_dwordx4 v7, s[32:35], s59 offen offset:1024 sc1 lds
    s_add_u32 m0, s58, 0
    s_add_u32 s61, s81, 110592
    buffer_load_dwordx4 v244, s[24:27], s61 offen  lds
    s_add_u32 m0, s58, 1024
    s_nop 0
    buffer_load_dwordx4 v245, s[24:27], s61 offen  lds
    s_add_u32 m0, s58, 2048
    s_nop 0
    buffer_load_dwordx4 v246, s[24:27], s61 offen  lds
    v_fma_f32 v157, v149, v196, -v157
    v_fma_f32 v158, v150, v196, -v158
    v_fma_f32 v159, v151, v196, -v159
    v_fma_f32 v160, v152, v196, -v160
    v_fma_f32 v161, v153, v196, -v161
    v_fma_f32 v162, v154, v196, -v162
    v_fma_f32 v163, v155, v196, -v163
    v_fma_f32 v172, v164, v198, -v172
    v_fma_f32 v173, v165, v198, -v173
    v_fma_f32 v174, v166, v198, -v174
    v_fma_f32 v175, v167, v198, -v175
    v_fma_f32 v176, v168, v198, -v176
    v_fma_f32 v177, v169, v198, -v177
    v_fma_f32 v178, v170, v198, -v178
    v_fma_f32 v179, v171, v198, -v179
    v_fma_f32 v188, v180, v200, -v188
    v_fma_f32 v189, v181, v200, -v189
    s_add_u32 m0, s57, 20480
    s_add_u32 s59, s77, 8192
    buffer_load_dwordx4 v7, s[32:35], s59 offen sc1 lds
    buffer_load_dwordx4 v7, s[32:35], s59 offen offset:1024 sc1 lds
    s_add_u32 m0, s58, 20480
    s_add_u32 s61, s81, 147456
    buffer_load_dwordx4 v244, s[24:27], s61 offen  lds
    s_add_u32 m0, s58, 21504
    s_nop 0
    buffer_load_dwordx4 v245, s[24:27], s61 offen  lds
    s_add_u32 m0, s58, 22528
    s_nop 0
    buffer_load_dwordx4 v246, s[24:27], s61 offen  lds
    v_fma_f32 v190, v182, v200, -v190
    v_fma_f32 v191, v183, v200, -v191
    v_fma_f32 v192, v184, v200, -v192
    v_fma_f32 v193, v185, v200, -v193
    v_fma_f32 v194, v186, v200, -v194
    v_fma_f32 v195, v187, v200, -v195
    v_cvt_pk_bf16_f32 v76, v156, v157
    v_cvt_pk_bf16_f32 v77, v158, v159
    v_cvt_pk_bf16_f32 v78, v160, v161
    v_cvt_pk_bf16_f32 v79, v162, v163
    v_cvt_pk_bf16_f32 v80, v172, v173
    v_cvt_pk_bf16_f32 v81, v174, v175
    v_cvt_pk_bf16_f32 v82, v176, v177
    v_cvt_pk_bf16_f32 v83, v178, v179
    v_cvt_pk_bf16_f32 v84, v188, v189
    v_cvt_pk_bf16_f32 v85, v190, v191
    v_cvt_pk_bf16_f32 v86, v192, v193
    s_waitcnt vmcnt(10)
    s_barrier
    s_add_u32 m0, s57, 40960
    s_add_u32 s59, s77, 10240
    buffer_load_dwordx4 v7, s[32:35], s59 offen sc1 lds
    buffer_load_dwordx4 v7, s[32:35], s59 offen offset:1024 sc1 lds
    s_add_u32 m0, s58, 40960
    s_add_u32 s61, s81, 184320
    buffer_load_dwordx4 v244, s[24:27], s61 offen  lds
    s_add_u32 m0, s58, 41984
    s_nop 0
    buffer_load_dwordx4 v245, s[24:27], s61 offen  lds
    s_add_u32 m0, s58, 43008
    s_nop 0
    buffer_load_dwordx4 v246, s[24:27], s61 offen  lds
    v_cvt_pk_bf16_f32 v87, v194, v195
    v_fma_f32 v148, v156, v196, -v148
    v_fma_f32 v149, v157, v196, -v149
    v_fma_f32 v150, v158, v196, -v150
    v_fma_f32 v151, v159, v196, -v151
    v_fma_f32 v152, v160, v196, -v152
    v_fma_f32 v153, v161, v196, -v153
    v_fma_f32 v154, v162, v196, -v154
    v_fma_f32 v155, v163, v196, -v155
    v_fma_f32 v164, v172, v198, -v164
    v_fma_f32 v165, v173, v198, -v165
    v_fma_f32 v166, v174, v198, -v166
    v_fma_f32 v167, v175, v198, -v167
    v_fma_f32 v168, v176, v198, -v168
    v_fma_f32 v169, v177, v198, -v169
    v_fma_f32 v170, v178, v198, -v170
    v_fma_f32 v171, v179, v198, -v171
    s_add_u32 m0, s57, 61440
    s_add_u32 s59, s77, 12288
    buffer_load_dwordx4 v7, s[32:35], s59 offen sc1 lds
    buffer_load_dwordx4 v7, s[32:35], s59 offen offset:1024 sc1 lds
    s_add_u32 m0, s58, 61440
    s_add_u32 s61, s81, 221184
    buffer_load_dwordx4 v244, s[24:27], s61 offen  lds
    s_add_u32 m0, s58, 62464
    s_nop 0
    buffer_load_dwordx4 v245, s[24:27], s61 offen  lds
    s_add_u32 m0, s58, 63488
    s_nop 0
    buffer_load_dwordx4 v246, s[24:27], s61 offen  lds
    v_fma_f32 v180, v188, v200, -v180
    v_fma_f32 v181, v189, v200, -v181
    v_fma_f32 v182, v190, v200, -v182
    v_fma_f32 v183, v191, v200, -v183
    v_fma_f32 v184, v192, v200, -v184
    v_fma_f32 v185, v193, v200, -v185
    v_fma_f32 v186, v194, v200, -v186
    v_fma_f32 v187, v195, v200, -v187
    v_cvt_pk_bf16_f32 v88, v148, v149
    v_cvt_pk_bf16_f32 v89, v150, v151
    v_cvt_pk_bf16_f32 v90, v152, v153
    v_cvt_pk_bf16_f32 v91, v154, v155
    v_cvt_pk_bf16_f32 v92, v164, v165
    v_cvt_pk_bf16_f32 v93, v166, v167
    v_cvt_pk_bf16_f32 v94, v168, v169
    v_cvt_pk_bf16_f32 v95, v170, v171
    v_cvt_pk_bf16_f32 v96, v180, v181
    s_waitcnt vmcnt(10)
    s_barrier
    s_add_u32 m0, s57, 81920
    s_add_u32 s59, s77, 14336
    buffer_load_dwordx4 v7, s[32:35], s59 offen sc1 lds
    buffer_load_dwordx4 v7, s[32:35], s59 offen offset:1024 sc1 lds
    s_add_u32 m0, s58, 81920
    s_add_u32 s61, s81, 258048
    buffer_load_dwordx4 v244, s[24:27], s61 offen  lds
    s_add_u32 m0, s58, 82944
    s_nop 0
    buffer_load_dwordx4 v245, s[24:27], s61 offen  lds
    s_add_u32 m0, s58, 83968
    s_nop 0
    buffer_load_dwordx4 v246, s[24:27], s61 offen  lds
    v_cvt_pk_bf16_f32 v97, v182, v183
    v_cvt_pk_bf16_f32 v98, v184, v185
    v_cvt_pk_bf16_f32 v99, v186, v187
    v_fma_f32 v156, v148, v196, -v156
    v_fma_f32 v157, v149, v196, -v157
    v_fma_f32 v158, v150, v196, -v158
    v_fma_f32 v159, v151, v196, -v159
    v_fma_f32 v160, v152, v196, -v160
    v_fma_f32 v161, v153, v196, -v161
    v_fma_f32 v162, v154, v196, -v162
    v_fma_f32 v163, v155, v196, -v163
    v_fma_f32 v172, v164, v198, -v172
    v_fma_f32 v173, v165, v198, -v173
    v_fma_f32 v174, v166, v198, -v174
    v_fma_f32 v175, v167, v198, -v175
    v_fma_f32 v176, v168, v198, -v176
    v_fma_f32 v177, v169, v198, -v177
    s_add_u32 m0, s57, 102400
    s_add_u32 s59, s77, 16384
    buffer_load_dwordx4 v7, s[32:35], s59 offen sc1 lds
    buffer_load_dwordx4 v7, s[32:35], s59 offen offset:1024 sc1 lds
    s_add_u32 m0, s58, 102400
    s_add_u32 s61, s81, 294912
    buffer_load_dwordx4 v244, s[24:27], s61 offen  lds
    s_add_u32 m0, s58, 103424
    s_nop 0
    buffer_load_dwordx4 v245, s[24:27], s61 offen  lds
    s_add_u32 m0, s58, 104448
    s_nop 0
    buffer_load_dwordx4 v246, s[24:27], s61 offen  lds
    v_fma_f32 v178, v170, v198, -v178
    v_fma_f32 v179, v171, v198, -v179
    v_fma_f32 v188, v180, v200, -v188
    v_fma_f32 v189, v181, v200, -v189
    v_fma_f32 v190, v182, v200, -v190
    v_fma_f32 v191, v183, v200, -v191
    v_fma_f32 v192, v184, v200, -v192
    v_fma_f32 v193, v185, v200, -v193
    v_fma_f32 v194, v186, v200, -v194
    v_fma_f32 v195, v187, v200, -v195
    v_cvt_pk_bf16_f32 v100, v156, v157
    v_cvt_pk_bf16_f32 v101, v158, v159
    v_cvt_pk_bf16_f32 v102, v160, v161
    v_cvt_pk_bf16_f32 v103, v162, v163
    v_cvt_pk_bf16_f32 v104, v172, v173
    v_cvt_pk_bf16_f32 v105, v174, v175
    v_cvt_pk_bf16_f32 v106, v176, v177
    s_waitcnt vmcnt(10)
    s_barrier
    s_add_u32 m0, s57, 0
    s_add_u32 s59, s78, 0
    buffer_load_dwordx4 v7, s[32:35], s59 offen sc1 lds
    buffer_load_dwordx4 v7, s[32:35], s59 offen offset:1024 sc1 lds
    s_add_u32 m0, s58, 0
    s_add_u32 s61, s82, 0
    buffer_load_dwordx4 v244, s[24:27], s61 offen  lds
    s_add_u32 m0, s58, 1024
    s_nop 0
    buffer_load_dwordx4 v245, s[24:27], s61 offen  lds
    s_add_u32 m0, s58, 2048
    s_nop 0
    buffer_load_dwordx4 v246, s[24:27], s61 offen  lds
    v_cvt_pk_bf16_f32 v107, v178, v179
    v_cvt_pk_bf16_f32 v108, v188, v189
    v_cvt_pk_bf16_f32 v109, v190, v191
    v_cvt_pk_bf16_f32 v110, v192, v193
    v_cvt_pk_bf16_f32 v111, v194, v195
    v_fma_f32 v148, v156, v196, -v148
    v_fma_f32 v149, v157, v196, -v149
    v_fma_f32 v150, v158, v196, -v150
    v_fma_f32 v151, v159, v196, -v151
    v_fma_f32 v152, v160, v196, -v152
    v_fma_f32 v153, v161, v196, -v153
    v_fma_f32 v154, v162, v196, -v154
    v_fma_f32 v155, v163, v196, -v155
    v_fma_f32 v164, v172, v198, -v164
    v_fma_f32 v165, v173, v198, -v165
    v_fma_f32 v166, v174, v198, -v166
    v_fma_f32 v167, v175, v198, -v167
    s_add_u32 m0, s57, 20480
    s_add_u32 s59, s78, 2048
    buffer_load_dwordx4 v7, s[32:35], s59 offen sc1 lds
    buffer_load_dwordx4 v7, s[32:35], s59 offen offset:1024 sc1 lds
    s_add_u32 m0, s58, 20480
    s_add_u32 s61, s82, 36864
    buffer_load_dwordx4 v244, s[24:27], s61 offen  lds
    s_add_u32 m0, s58, 21504
    s_nop 0
    buffer_load_dwordx4 v245, s[24:27], s61 offen  lds
    s_add_u32 m0, s58, 22528
    s_nop 0
    buffer_load_dwordx4 v246, s[24:27], s61 offen  lds
    v_fma_f32 v168, v176, v198, -v168
    v_fma_f32 v169, v177, v198, -v169
    v_fma_f32 v170, v178, v198, -v170
    v_fma_f32 v171, v179, v198, -v171
    v_fma_f32 v180, v188, v200, -v180
    v_fma_f32 v181, v189, v200, -v181
    v_fma_f32 v182, v190, v200, -v182
    v_fma_f32 v183, v191, v200, -v183
    v_fma_f32 v184, v192, v200, -v184
    v_fma_f32 v185, v193, v200, -v185
    v_fma_f32 v186, v194, v200, -v186
    v_fma_f32 v187, v195, v200, -v187
    v_cvt_pk_bf16_f32 v112, v148, v149
    v_cvt_pk_bf16_f32 v113, v150, v151
    v_cvt_pk_bf16_f32 v114, v152, v153
    v_cvt_pk_bf16_f32 v115, v154, v155
    v_cvt_pk_bf16_f32 v116, v164, v165
    s_waitcnt vmcnt(10)
    s_barrier
    s_add_u32 m0, s57, 40960
    s_add_u32 s59, s78, 4096
    buffer_load_dwordx4 v7, s[32:35], s59 offen sc1 lds
    buffer_load_dwordx4 v7, s[32:35], s59 offen offset:1024 sc1 lds
    s_add_u32 m0, s58, 40960
    s_add_u32 s61, s82, 73728
    buffer_load_dwordx4 v244, s[24:27], s61 offen  lds
    s_add_u32 m0, s58, 41984
    s_nop 0
    buffer_load_dwordx4 v245, s[24:27], s61 offen  lds
    s_add_u32 m0, s58, 43008
    s_nop 0
    buffer_load_dwordx4 v246, s[24:27], s61 offen  lds
    v_cvt_pk_bf16_f32 v117, v166, v167
    v_cvt_pk_bf16_f32 v118, v168, v169
    v_cvt_pk_bf16_f32 v119, v170, v171
    v_cvt_pk_bf16_f32 v120, v180, v181
    v_cvt_pk_bf16_f32 v121, v182, v183
    v_cvt_pk_bf16_f32 v122, v184, v185
    v_cvt_pk_bf16_f32 v123, v186, v187
    v_fma_f32 v156, v148, v196, -v156
    v_fma_f32 v157, v149, v196, -v157
    v_fma_f32 v158, v150, v196, -v158
    v_fma_f32 v159, v151, v196, -v159
    v_fma_f32 v160, v152, v196, -v160
    v_fma_f32 v161, v153, v196, -v161
    v_fma_f32 v162, v154, v196, -v162
    v_fma_f32 v163, v155, v196, -v163
    v_fma_f32 v172, v164, v198, -v172
    v_fma_f32 v173, v165, v198, -v173
    s_add_u32 m0, s57, 61440
    s_add_u32 s59, s78, 6144
    buffer_load_dwordx4 v7, s[32:35], s59 offen sc1 lds
    buffer_load_dwordx4 v7, s[32:35], s59 offen offset:1024 sc1 lds
    s_add_u32 m0, s58, 61440
    s_add_u32 s61, s82, 110592
    buffer_load_dwordx4 v244, s[24:27], s61 offen  lds
    s_add_u32 m0, s58, 62464
    s_nop 0
    buffer_load_dwordx4 v245, s[24:27], s61 offen  lds
    s_add_u32 m0, s58, 63488
    s_nop 0
    buffer_load_dwordx4 v246, s[24:27], s61 offen  lds
    v_fma_f32 v174, v166, v198, -v174
    v_fma_f32 v175, v167, v198, -v175
    v_fma_f32 v176, v168, v198, -v176
    v_fma_f32 v177, v169, v198, -v177
    v_fma_f32 v178, v170, v198, -v178
    v_fma_f32 v179, v171, v198, -v179
    v_fma_f32 v188, v180, v200, -v188
    v_fma_f32 v189, v181, v200, -v189
    v_fma_f32 v190, v182, v200, -v190
    v_fma_f32 v191, v183, v200, -v191
    v_fma_f32 v192, v184, v200, -v192
    v_fma_f32 v193, v185, v200, -v193
    v_fma_f32 v194, v186, v200, -v194
    v_fma_f32 v195, v187, v200, -v195
    v_cvt_pk_bf16_f32 v124, v156, v157
    v_cvt_pk_bf16_f32 v125, v158, v159
    v_cvt_pk_bf16_f32 v126, v160, v161
    s_waitcnt vmcnt(10)
    s_barrier
    s_add_u32 m0, s57, 81920
    s_add_u32 s59, s78, 8192
    buffer_load_dwordx4 v7, s[32:35], s59 offen sc1 lds
    buffer_load_dwordx4 v7, s[32:35], s59 offen offset:1024 sc1 lds
    s_add_u32 m0, s58, 81920
    s_add_u32 s61, s82, 147456
    buffer_load_dwordx4 v244, s[24:27], s61 offen  lds
    s_add_u32 m0, s58, 82944
    s_nop 0
    buffer_load_dwordx4 v245, s[24:27], s61 offen  lds
    s_add_u32 m0, s58, 83968
    s_nop 0
    buffer_load_dwordx4 v246, s[24:27], s61 offen  lds
    v_cvt_pk_bf16_f32 v127, v162, v163
    v_cvt_pk_bf16_f32 v128, v172, v173
    v_cvt_pk_bf16_f32 v129, v174, v175
    v_cvt_pk_bf16_f32 v130, v176, v177
    v_cvt_pk_bf16_f32 v131, v178, v179
    v_cvt_pk_bf16_f32 v132, v188, v189
    v_cvt_pk_bf16_f32 v133, v190, v191
    v_cvt_pk_bf16_f32 v134, v192, v193
    v_cvt_pk_bf16_f32 v135, v194, v195
    v_fma_f32 v148, v156, v196, -v148
    v_fma_f32 v149, v157, v196, -v149
    v_fma_f32 v150, v158, v196, -v150
    v_fma_f32 v151, v159, v196, -v151
    v_fma_f32 v152, v160, v196, -v152
    v_fma_f32 v153, v161, v196, -v153
    v_fma_f32 v154, v162, v196, -v154
    v_fma_f32 v155, v163, v196, -v155
    s_add_u32 m0, s57, 102400
    s_add_u32 s59, s78, 10240
    buffer_load_dwordx4 v7, s[32:35], s59 offen sc1 lds
    buffer_load_dwordx4 v7, s[32:35], s59 offen offset:1024 sc1 lds
    s_add_u32 m0, s58, 102400
    s_add_u32 s61, s82, 184320
    buffer_load_dwordx4 v244, s[24:27], s61 offen  lds
    s_add_u32 m0, s58, 103424
    s_nop 0
    buffer_load_dwordx4 v245, s[24:27], s61 offen  lds
    s_add_u32 m0, s58, 104448
    s_nop 0
    buffer_load_dwordx4 v246, s[24:27], s61 offen  lds
    v_fma_f32 v164, v172, v198, -v164
    v_fma_f32 v165, v173, v198, -v165
    v_fma_f32 v166, v174, v198, -v166
    v_fma_f32 v167, v175, v198, -v167
    v_fma_f32 v168, v176, v198, -v168
    v_fma_f32 v169, v177, v198, -v169
    v_fma_f32 v170, v178, v198, -v170
    v_fma_f32 v171, v179, v198, -v171
    v_fma_f32 v180, v188, v200, -v180
    v_fma_f32 v181, v189, v200, -v181
    v_fma_f32 v182, v190, v200, -v182
    v_fma_f32 v183, v191, v200, -v183
    v_fma_f32 v184, v192, v200, -v184
    v_fma_f32 v185, v193, v200, -v185
    v_fma_f32 v186, v194, v200, -v186
    v_fma_f32 v187, v195, v200, -v187
    v_cvt_pk_bf16_f32 v136, v148, v149
    s_waitcnt vmcnt(10)
    s_barrier
    s_add_u32 m0, s57, 0
    s_add_u32 s59, s78, 12288
    buffer_load_dwordx4 v7, s[32:35], s59 offen sc1 lds
    buffer_load_dwordx4 v7, s[32:35], s59 offen offset:1024 sc1 lds
    s_add_u32 m0, s58, 0
    s_add_u32 s61, s82, 221184
    buffer_load_dwordx4 v244, s[24:27], s61 offen  lds
    s_add_u32 m0, s58, 1024
    s_nop 0
    buffer_load_dwordx4 v245, s[24:27], s61 offen  lds
    s_add_u32 m0, s58, 2048
    s_nop 0
    buffer_load_dwordx4 v246, s[24:27], s61 offen  lds
    v_cvt_pk_bf16_f32 v137, v150, v151
    v_cvt_pk_bf16_f32 v138, v152, v153
    v_cvt_pk_bf16_f32 v139, v154, v155
    v_cvt_pk_bf16_f32 v140, v164, v165
    v_cvt_pk_bf16_f32 v141, v166, v167
    v_cvt_pk_bf16_f32 v142, v168, v169
    v_cvt_pk_bf16_f32 v143, v170, v171
    v_cvt_pk_bf16_f32 v144, v180, v181
    v_cvt_pk_bf16_f32 v145, v182, v183
    v_cvt_pk_bf16_f32 v146, v184, v185
    v_cvt_pk_bf16_f32 v147, v186, v187
    v_min_u32 v8, 7, v0
    v_min_u32 v9, 1, v8
    v_lshlrev_b32 v8, 7, v8
    v_sub_u32 v9, 37, v9
    s_mov_b32 s69, 37566464
    s_lshl_b32 s66, s52, 2
    s_add_u32 m0, s57, 20480
    s_add_u32 s59, s78, 14336
    buffer_load_dwordx4 v7, s[32:35], s59 offen sc1 lds
    buffer_load_dwordx4 v7, s[32:35], s59 offen offset:1024 sc1 lds
    s_add_u32 m0, s58, 20480
    s_add_u32 s61, s82, 258048
    buffer_load_dwordx4 v244, s[24:27], s61 offen  lds
    s_add_u32 m0, s58, 21504
    s_nop 0
    buffer_load_dwordx4 v245, s[24:27], s61 offen  lds
    s_add_u32 m0, s58, 22528
    s_nop 0
    buffer_load_dwordx4 v246, s[24:27], s61 offen  lds
    s_add_u32 s66, s66, s51
    s_lshl_b32 s68, s64, 1
    s_add_u32 s68, s68, s65
    s_mul_i32 s67, s68, 589824
    s_lshl_b32 s66, s66, 7
    s_add_u32 s67, s67, s66
    s_add_u32 s67, s67, 25427968
    s_mul_i32 s68, s68, 9216
    s_add_u32 s68, s68, 122880
    v_lshrrev_b32 v5, 3, v0
    v_and_b32 v6, 4, v5
    v_xor_b32 v6, v6, v0
    v_and_b32 v6, 7, v6
    v_lshlrev_b32 v6, 4, v6
    v_lshl_add_u32 v6, v5, 13, v6
    v_lshlrev_b32 v10, 9, v3
    v_lshl_add_u32 v10, v1, 2, v10
    s_waitcnt vmcnt(10)
    s_barrier
    s_add_u32 m0, s57, 40960
    s_add_u32 s59, s78, 16384
    buffer_load_dwordx4 v7, s[32:35], s59 offen sc1 lds
    buffer_load_dwordx4 v7, s[32:35], s59 offen offset:1024 sc1 lds
    s_add_u32 m0, s58, 40960
    s_add_u32 s61, s82, 294912
    buffer_load_dwordx4 v244, s[24:27], s61 offen  lds
    s_add_u32 m0, s58, 41984
    s_nop 0
    buffer_load_dwordx4 v245, s[24:27], s61 offen  lds
    s_add_u32 m0, s58, 43008
    s_nop 0
    buffer_load_dwordx4 v246, s[24:27], s61 offen  lds
    v_and_b32 v11, 1, v3
    v_lshl_add_u32 v10, v11, 6, v10
    s_mul_i32 s66, s64, 18432
    s_add_u32 s66, s66, 122880
    v_add_u32 v10, s66, v10
    v_xor_b32 v11, 64, v10
    v_add_u32 v12, 128, v10
    v_add_u32 v13, 128, v11
    s_mul_i32 s66, s54, 20480
    v_add_u32 v14, s66, v7
    s_add_u32 m0, s57, 61440
    s_add_u32 s59, s79, 0
    buffer_load_dwordx4 v7, s[32:35], s59 offen sc1 lds
    buffer_load_dwordx4 v7, s[32:35], s59 offen offset:1024 sc1 lds
    s_add_u32 m0, s58, 61440
    s_add_u32 s61, s83, 0
    buffer_load_dwordx4 v244, s[24:27], s61 offen  lds
    s_add_u32 m0, s58, 62464
    s_nop 0
    buffer_load_dwordx4 v245, s[24:27], s61 offen  lds
    s_add_u32 m0, s58, 63488
    s_nop 0
    buffer_load_dwordx4 v246, s[24:27], s61 offen  lds
    s_waitcnt vmcnt(10)
    s_barrier
    s_add_u32 m0, s57, 81920
    s_add_u32 s59, s79, 2048
    buffer_load_dwordx4 v7, s[32:35], s59 offen sc1 lds
    buffer_load_dwordx4 v7, s[32:35], s59 offen offset:1024 sc1 lds
    s_add_u32 m0, s58, 81920
    s_add_u32 s61, s83, 36864
    buffer_load_dwordx4 v244, s[24:27], s61 offen  lds
    s_add_u32 m0, s58, 82944
    s_nop 0
    buffer_load_dwordx4 v245, s[24:27], s61 offen  lds
    s_add_u32 m0, s58, 83968
    s_nop 0
    buffer_load_dwordx4 v246, s[24:27], s61 offen  lds
    s_add_u32 m0, s57, 102400
    s_add_u32 s59, s79, 4096
    buffer_load_dwordx4 v7, s[32:35], s59 offen sc1 lds
    buffer_load_dwordx4 v7, s[32:35], s59 offen offset:1024 sc1 lds
    s_add_u32 m0, s58, 102400
    s_add_u32 s61, s83, 73728
    buffer_load_dwordx4 v244, s[24:27], s61 offen  lds
    s_add_u32 m0, s58, 103424
    s_nop 0
    buffer_load_dwordx4 v245, s[24:27], s61 offen  lds
    s_add_u32 m0, s58, 104448
    s_nop 0
    buffer_load_dwordx4 v246, s[24:27], s61 offen  lds
    s_waitcnt vmcnt(10)
    s_barrier
    s_add_u32 m0, s57, 0
    s_add_u32 s59, s79, 6144
    buffer_load_dwordx4 v7, s[32:35], s59 offen sc1 lds
    buffer_load_dwordx4 v7, s[32:35], s59 offen offset:1024 sc1 lds
    s_add_u32 m0, s58, 0
    s_add_u32 s61, s83, 110592
    buffer_load_dwordx4 v244, s[24:27], s61 offen  lds
    s_add_u32 m0, s58, 1024
    s_nop 0
    buffer_load_dwordx4 v245, s[24:27], s61 offen  lds
    s_add_u32 m0, s58, 2048
    s_nop 0
    buffer_load_dwordx4 v246, s[24:27], s61 offen  lds
    s_add_u32 m0, s57, 20480
    s_add_u32 s59, s79, 8192
    buffer_load_dwordx4 v7, s[32:35], s59 offen sc1 lds
    buffer_load_dwordx4 v7, s[32:35], s59 offen offset:1024 sc1 lds
    s_add_u32 m0, s58, 20480
    s_add_u32 s61, s83, 147456
    buffer_load_dwordx4 v244, s[24:27], s61 offen  lds
    s_add_u32 m0, s58, 21504
    s_nop 0
    buffer_load_dwordx4 v245, s[24:27], s61 offen  lds
    s_add_u32 m0, s58, 22528
    s_nop 0
    buffer_load_dwordx4 v246, s[24:27], s61 offen  lds
    s_waitcnt vmcnt(10)
    s_barrier
    s_add_u32 m0, s57, 40960
    s_add_u32 s59, s79, 10240
    buffer_load_dwordx4 v7, s[32:35], s59 offen sc1 lds
    buffer_load_dwordx4 v7, s[32:35], s59 offen offset:1024 sc1 lds
    s_add_u32 m0, s58, 40960
    s_add_u32 s61, s83, 184320
    buffer_load_dwordx4 v244, s[24:27], s61 offen  lds
    s_add_u32 m0, s58, 41984
    s_nop 0
    buffer_load_dwordx4 v245, s[24:27], s61 offen  lds
    s_add_u32 m0, s58, 43008
    s_nop 0
    buffer_load_dwordx4 v246, s[24:27], s61 offen  lds
    s_add_u32 m0, s57, 61440
    s_add_u32 s59, s79, 12288
    buffer_load_dwordx4 v7, s[32:35], s59 offen sc1 lds
    buffer_load_dwordx4 v7, s[32:35], s59 offen offset:1024 sc1 lds
    s_add_u32 m0, s58, 61440
    s_add_u32 s61, s83, 221184
    buffer_load_dwordx4 v244, s[24:27], s61 offen  lds
    s_add_u32 m0, s58, 62464
    s_nop 0
    buffer_load_dwordx4 v245, s[24:27], s61 offen  lds
    s_add_u32 m0, s58, 63488
    s_nop 0
    buffer_load_dwordx4 v246, s[24:27], s61 offen  lds
    s_waitcnt vmcnt(10)
    s_barrier
    buffer_load_dword v15, v8, s[32:35], s69 offen sc1
    s_add_u32 m0, s57, 81920
    s_add_u32 s59, s79, 14336
    buffer_load_dwordx4 v7, s[32:35], s59 offen sc1 lds
    buffer_load_dwordx4 v7, s[32:35], s59 offen offset:1024 sc1 lds
    s_add_u32 m0, s58, 81920
    s_add_u32 s61, s83, 258048
    buffer_load_dwordx4 v244, s[24:27], s61 offen  lds
    s_add_u32 m0, s58, 82944
    s_nop 0
    buffer_load_dwordx4 v245, s[24:27], s61 offen  lds
    s_add_u32 m0, s58, 83968
    s_nop 0
    buffer_load_dwordx4 v246, s[24:27], s61 offen  lds
    s_add_u32 m0, s57, 102400
    s_add_u32 s59, s79, 16384
    buffer_load_dwordx4 v7, s[32:35], s59 offen sc1 lds
    buffer_load_dwordx4 v7, s[32:35], s59 offen offset:1024 sc1 lds
    s_add_u32 m0, s58, 102400
    s_add_u32 s61, s83, 294912
    buffer_load_dwordx4 v244, s[24:27], s61 offen  lds
    s_add_u32 m0, s58, 103424
    s_nop 0
    buffer_load_dwordx4 v245, s[24:27], s61 offen  lds
    s_add_u32 m0, s58, 104448
    s_nop 0
    buffer_load_dwordx4 v246, s[24:27], s61 offen  lds
    s_waitcnt vmcnt(11)
    s_barrier
    s_waitcnt vmcnt(10)
    v_cmp_ne_u32 vcc, v15, v9
    s_mov_b32 m0, s68
    s_nop 3
    s_cbranch_vccnz K2_late
    v_mov_b32 v249, 159760
    ds_write_b32 v249, v242
    buffer_load_dwordx4 v6, s[32:35], s67 offen sc1 lds
    s_add_u32 m0, m0, 1024
    s_add_u32 s67, s67, 65536
    buffer_load_dwordx4 v6, s[32:35], s67 offen sc1 lds
    s_add_u32 m0, m0, 1024
    s_add_u32 s67, s67, 65536
    buffer_load_dwordx4 v6, s[32:35], s67 offen sc1 lds
    s_add_u32 m0, m0, 1024
    s_add_u32 s67, s67, 65536
    buffer_load_dwordx4 v6, s[32:35], s67 offen sc1 lds
    s_add_u32 m0, m0, 1024
    s_add_u32 s67, s67, 65536
    buffer_load_dwordx4 v6, s[32:35], s67 offen sc1 lds
    s_add_u32 m0, m0, 1024
    s_add_u32 s67, s67, 65536
    buffer_load_dwordx4 v6, s[32:35], s67 offen sc1 lds
    s_add_u32 m0, m0, 1024
    s_add_u32 s67, s67, 65536
    buffer_load_dwordx4 v6, s[32:35], s67 offen sc1 lds
    s_add_u32 m0, m0, 1024
    s_add_u32 s67, s67, 65536
    buffer_load_dwordx4 v6, s[32:35], s67 offen sc1 lds
    s_add_u32 m0, m0, 1024
    s_add_u32 s67, s67, 65536
    buffer_load_dwordx4 v6, s[32:35], s67 offen sc1 lds
    s_waitcnt vmcnt(9)
    s_barrier
    s_branch K2_vw
K2_late:
    s_waitcnt vmcnt(0)
    s_barrier
    v_mov_b32 v249, 159760
    s_cmp_lg_u32 s54, 0
    s_cbranch_scc1 K2_pl
    s_mov_b32 s72, 0x40000
K2_pv:
    buffer_load_dword v15, v8, s[32:35], s69 offen sc1
    s_waitcnt vmcnt(0)
    v_cmp_ne_u32 vcc, v9, v15
    s_sub_u32 s72, s72, 1
    s_cbranch_scc1 K2_pv_d
    s_nop 2
    s_cbranch_vccz K2_pv_d
    s_sleep 8
    s_branch K2_pv
K2_pv_d:
    s_branch K2_pl_d
K2_pl:
    s_mov_b32 s72, 0x400000
K2_pl2:
    ds_read_b32 v15, v249
    s_waitcnt lgkmcnt(0)
    v_cmp_ne_u32 vcc, 0, v15
    s_sub_u32 s72, s72, 1
    s_cbranch_scc1 K2_pl_d
    s_nop 2
    s_cbranch_vccnz K2_pl_d
    s_sleep 2
    s_branch K2_pl2
K2_pl_d:
    s_mov_b32 m0, s68
    s_nop 0
    v_mov_b32 v249, 159760
    ds_write_b32 v249, v242
    buffer_load_dwordx4 v6, s[32:35], s67 offen sc1 lds
    s_add_u32 m0, m0, 1024
    s_add_u32 s67, s67, 65536
    buffer_load_dwordx4 v6, s[32:35], s67 offen sc1 lds
    s_add_u32 m0, m0, 1024
    s_add_u32 s67, s67, 65536
    buffer_load_dwordx4 v6, s[32:35], s67 offen sc1 lds
    s_add_u32 m0, m0, 1024
    s_add_u32 s67, s67, 65536
    buffer_load_dwordx4 v6, s[32:35], s67 offen sc1 lds
    s_add_u32 m0, m0, 1024
    s_add_u32 s67, s67, 65536
    buffer_load_dwordx4 v6, s[32:35], s67 offen sc1 lds
    s_add_u32 m0, m0, 1024
    s_add_u32 s67, s67, 65536
    buffer_load_dwordx4 v6, s[32:35], s67 offen sc1 lds
    s_add_u32 m0, m0, 1024
    s_add_u32 s67, s67, 65536
    buffer_load_dwordx4 v6, s[32:35], s67 offen sc1 lds
    s_add_u32 m0, m0, 1024
    s_add_u32 s67, s67, 65536
    buffer_load_dwordx4 v6, s[32:35], s67 offen sc1 lds
    s_add_u32 m0, m0, 1024
    s_add_u32 s67, s67, 65536
    buffer_load_dwordx4 v6, s[32:35], s67 offen sc1 lds
K2_vw:
    s_waitcnt vmcnt(0)
    ds_write_b32 v240, v242
    s_mov_b32 s72, 0x400000
K2_hs:
    ds_read_b32 v243, v241
    s_waitcnt lgkmcnt(0)
    v_cmp_eq_u32 vcc, 0, v243
    s_sub_u32 s72, s72, 1
    s_cbranch_scc1 K2_hs_d
    s_nop 2
    s_cbranch_vccnz K2_hs
K2_hs_d:
    ds_read2st64_b32 v[208:209], v10 offset0:0 offset1:1
    ds_read2st64_b32 v[210:211], v12 offset0:0 offset1:1
    ds_read2st64_b32 v[212:213], v11 offset0:0 offset1:1
    ds_read2st64_b32 v[214:215], v13 offset0:0 offset1:1
    ds_read2st64_b32 v[216:217], v10 offset0:8 offset1:9
    ds_read2st64_b32 v[218:219], v12 offset0:8 offset1:9
    ds_read2st64_b32 v[220:221], v11 offset0:8 offset1:9
    ds_read2st64_b32 v[222:223], v13 offset0:8 offset1:9
    ds_read2st64_b32 v[224:225], v10 offset0:16 offset1:17
    ds_read2st64_b32 v[226:227], v12 offset0:16 offset1:17
    ds_read2st64_b32 v[228:229], v11 offset0:16 offset1:17
    ds_read2st64_b32 v[230:231], v13 offset0:16 offset1:17
    s_waitcnt lgkmcnt(8)
    v_mfma_f32_16x16x32_bf16 v[16:19], v[40:43], v[208:211], 0
    ds_read2st64_b32 v[232:233], v10 offset0:24 offset1:25
    v_mfma_f32_16x16x32_bf16 v[20:23], v[40:43], v[212:215], 0
    ds_read2st64_b32 v[234:235], v12 offset0:24 offset1:25
    v_mfma_f32_16x16x32_bf16 v[24:27], v[44:47], v[208:211], 0
    ds_read2st64_b32 v[236:237], v11 offset0:24 offset1:25
    v_mfma_f32_16x16x32_bf16 v[28:31], v[44:47], v[212:215], 0
    ds_read2st64_b32 v[238:239], v13 offset0:24 offset1:25
    v_mfma_f32_16x16x32_bf16 v[32:35], v[48:51], v[208:211], 0
    v_mfma_f32_16x16x32_bf16 v[36:39], v[48:51], v[212:215], 0
    s_waitcnt lgkmcnt(8)
    v_mfma_f32_16x16x32_bf16 v[16:19], v[52:55], v[216:219], v[16:19]
    ds_read2st64_b32 v[208:209], v10 offset0:32 offset1:33
    v_mfma_f32_16x16x32_bf16 v[20:23], v[52:55], v[220:223], v[20:23]
    ds_read2st64_b32 v[210:211], v12 offset0:32 offset1:33
    v_mfma_f32_16x16x32_bf16 v[24:27], v[56:59], v[216:219], v[24:27]
    ds_read2st64_b32 v[212:213], v11 offset0:32 offset1:33
    v_mfma_f32_16x16x32_bf16 v[28:31], v[56:59], v[220:223], v[28:31]
    ds_read2st64_b32 v[214:215], v13 offset0:32 offset1:33
    v_mfma_f32_16x16x32_bf16 v[32:35], v[60:63], v[216:219], v[32:35]
    v_mfma_f32_16x16x32_bf16 v[36:39], v[60:63], v[220:223], v[36:39]
    s_waitcnt lgkmcnt(8)
    v_mfma_f32_16x16x32_bf16 v[16:19], v[64:67], v[224:227], v[16:19]
    ds_read2st64_b32 v[216:217], v10 offset0:40 offset1:41
    v_mfma_f32_16x16x32_bf16 v[20:23], v[64:67], v[228:231], v[20:23]
    ds_read2st64_b32 v[218:219], v12 offset0:40 offset1:41
    v_mfma_f32_16x16x32_bf16 v[24:27], v[68:71], v[224:227], v[24:27]
    ds_read2st64_b32 v[220:221], v11 offset0:40 offset1:41
    v_mfma_f32_16x16x32_bf16 v[28:31], v[68:71], v[228:231], v[28:31]
    ds_read2st64_b32 v[222:223], v13 offset0:40 offset1:41
    v_mfma_f32_16x16x32_bf16 v[32:35], v[72:75], v[224:227], v[32:35]
    v_mfma_f32_16x16x32_bf16 v[36:39], v[72:75], v[228:231], v[36:39]
    s_waitcnt lgkmcnt(8)
    v_mfma_f32_16x16x32_bf16 v[16:19], v[76:79], v[232:235], v[16:19]
    ds_read2st64_b32 v[224:225], v10 offset0:48 offset1:49
    v_mfma_f32_16x16x32_bf16 v[20:23], v[76:79], v[236:239], v[20:23]
    ds_read2st64_b32 v[226:227], v12 offset0:48 offset1:49
    v_mfma_f32_16x16x32_bf16 v[24:27], v[80:83], v[232:235], v[24:27]
    ds_read2st64_b32 v[228:229], v11 offset0:48 offset1:49
    v_mfma_f32_16x16x32_bf16 v[28:31], v[80:83], v[236:239], v[28:31]
    ds_read2st64_b32 v[230:231], v13 offset0:48 offset1:49
    v_mfma_f32_16x16x32_bf16 v[32:35], v[84:87], v[232:235], v[32:35]
    v_mfma_f32_16x16x32_bf16 v[36:39], v[84:87], v[236:239], v[36:39]
    s_waitcnt lgkmcnt(8)
    v_mfma_f32_16x16x32_bf16 v[16:19], v[88:91], v[208:211], v[16:19]
    ds_read2st64_b32 v[232:233], v10 offset0:56 offset1:57
    v_mfma_f32_16x16x32_bf16 v[20:23], v[88:91], v[212:215], v[20:23]
    ds_read2st64_b32 v[234:235], v12 offset0:56 offset1:57
    v_mfma_f32_16x16x32_bf16 v[24:27], v[92:95], v[208:211], v[24:27]
    ds_read2st64_b32 v[236:237], v11 offset0:56 offset1:57
    v_mfma_f32_16x16x32_bf16 v[28:31], v[92:95], v[212:215], v[28:31]
    ds_read2st64_b32 v[238:239], v13 offset0:56 offset1:57
    v_mfma_f32_16x16x32_bf16 v[32:35], v[96:99], v[208:211], v[32:35]
    v_mfma_f32_16x16x32_bf16 v[36:39], v[96:99], v[212:215], v[36:39]
    s_waitcnt lgkmcnt(8)
    v_mfma_f32_16x16x32_bf16 v[16:19], v[100:103], v[216:219], v[16:19]
    ds_read2st64_b32 v[208:209], v10 offset0:64 offset1:65
    v_mfma_f32_16x16x32_bf16 v[20:23], v[100:103], v[220:223], v[20:23]
    ds_read2st64_b32 v[210:211], v12 offset0:64 offset1:65
    v_mfma_f32_16x16x32_bf16 v[24:27], v[104:107], v[216:219], v[24:27]
    ds_read2st64_b32 v[212:213], v11 offset0:64 offset1:65
    v_mfma_f32_16x16x32_bf16 v[28:31], v[104:107], v[220:223], v[28:31]
    ds_read2st64_b32 v[214:215], v13 offset0:64 offset1:65
    v_mfma_f32_16x16x32_bf16 v[32:35], v[108:111], v[216:219], v[32:35]
    v_mfma_f32_16x16x32_bf16 v[36:39], v[108:111], v[220:223], v[36:39]
    s_waitcnt lgkmcnt(8)
    v_mfma_f32_16x16x32_bf16 v[16:19], v[112:115], v[224:227], v[16:19]
    v_mfma_f32_16x16x32_bf16 v[20:23], v[112:115], v[228:231], v[20:23]
    v_mfma_f32_16x16x32_bf16 v[24:27], v[116:119], v[224:227], v[24:27]
    v_mfma_f32_16x16x32_bf16 v[28:31], v[116:119], v[228:231], v[28:31]
    v_mfma_f32_16x16x32_bf16 v[32:35], v[120:123], v[224:227], v[32:35]
    v_mfma_f32_16x16x32_bf16 v[36:39], v[120:123], v[228:231], v[36:39]
    s_waitcnt lgkmcnt(4)
    v_mfma_f32_16x16x32_bf16 v[16:19], v[124:127], v[232:235], v[16:19]
    v_mfma_f32_16x16x32_bf16 v[20:23], v[124:127], v[236:239], v[20:23]
    v_mfma_f32_16x16x32_bf16 v[24:27], v[128:131], v[232:235], v[24:27]
    v_mfma_f32_16x16x32_bf16 v[28:31], v[128:131], v[236:239], v[28:31]
    v_mfma_f32_16x16x32_bf16 v[32:35], v[132:135], v[232:235], v[32:35]
    v_mfma_f32_16x16x32_bf16 v[36:39], v[132:135], v[236:239], v[36:39]
    s_waitcnt lgkmcnt(0)
    v_mfma_f32_16x16x32_bf16 v[16:19], v[136:139], v[208:211], v[16:19]
    v_mfma_f32_16x16x32_bf16 v[20:23], v[136:139], v[212:215], v[20:23]
    v_mfma_f32_16x16x32_bf16 v[24:27], v[140:143], v[208:211], v[24:27]
    v_mfma_f32_16x16x32_bf16 v[28:31], v[140:143], v[212:215], v[28:31]
    v_mfma_f32_16x16x32_bf16 v[32:35], v[144:147], v[208:211], v[32:35]
    v_mfma_f32_16x16x32_bf16 v[36:39], v[144:147], v[212:215], v[36:39]
    s_nop 2
    ds_write_b128 v14, v[16:19] offset:0
    ds_write_b128 v14, v[20:23] offset:1024
    ds_write_b128 v14, v[24:27] offset:2048
    ds_write_b128 v14, v[28:31] offset:3072
    ds_write_b128 v14, v[32:35] offset:4096
    ds_write_b128 v14, v[36:39] offset:5120
    s_waitcnt lgkmcnt(0)
    s_mul_i32 s60, s52, 3
    s_add_u32 s60, s60, s53
    s_lshl_b32 s60, s60, 7
    s_add_u32 s60, s60, 37560320
    v_mov_b32 v13, 0
    v_mov_b32 v15, 1
    s_barrier
    s_cmp_lg_u32 s54, 0
    s_cbranch_scc1 K2_lx
    s_mov_b64 exec, 1
    buffer_atomic_add v15, v13, s[32:35], s60 offen sc0 sc1
    s_waitcnt vmcnt(0)
    v_cmp_ne_u32 vcc, 3, v15
    s_nop 4
    s_cbranch_vccz K2_pp_d
    s_mov_b32 s72, 0x40000
K2_pp:
    buffer_load_dword v15, v13, s[32:35], s60 offen sc1
    s_waitcnt vmcnt(0)
    v_cmp_ne_u32 vcc, 4, v15
    s_sub_u32 s72, s72, 1
    s_cbranch_scc1 K2_pp_d
    s_nop 2
    s_cbranch_vccz K2_pp_d
    s_branch K2_pp
K2_pp_d:
    s_mov_b64 exec, -1
    s_barrier
K2_lx:
    s_endpgm
K2_comp:
    s_and_b32 s54, s48, 1
    s_lshr_b32 s55, s48, 1
    v_lshrrev_b32 v8, 4, v0
    v_and_b32 v9, 15, v0
    v_lshlrev_b32 v10, 8, v8
    v_lshl_add_u32 v10, v9, 4, v10
    s_lshl_b32 s59, s54, 12
    v_add_u32 v5, s59, v10
    v_add_u32 v248, 132096, v5
    v_lshrrev_b32 v10, 2, v9
    v_and_b32 v11, 1, v8
    v_lshl_add_u32 v10, v11, 2, v10
    v_lshrrev_b32 v11, 1, v8
    v_mul_u32_u24 v11, 3072, v11
    v_lshl_add_u32 v11, v10, 7, v11
    v_and_b32 v12, 3, v0
    v_lshl_add_u32 v11, v12, 3, v11
    v_add_u32 v11, 8192, v11
    v_lshrrev_b32 v10, 1, v10
    s_lshl_b32 s59, s55, 10
    v_lshl_add_u32 v12, v10, 5, v11
    v_add_u32 v1, s59, v12
    v_xor_b32 v2, 32, v1
    v_xor_b32 v3, 64, v1
    v_xor_b32 v4, 0x60, v1
    s_lshl_b32 s59, s55, 6
    v_xor_b32 v12, s59, v12
    v_add_u32 v6, 2048, v12
    v_xor_b32 v13, 32, v6
    s_waitcnt lgkmcnt(0)
    s_barrier
    ds_read_b128 v[112:115], v5 offset:0
    ds_read_b128 v[116:119], v5 offset:1024
    ds_read_b128 v[120:123], v5 offset:2048
    ds_read_b128 v[124:127], v5 offset:3072
    ds_read_b64_tr_b16 v[128:129], v1 offset:0
    ds_read_b64_tr_b16 v[130:131], v1 offset:6144
    ds_read_b64_tr_b16 v[132:133], v2 offset:0
    ds_read_b64_tr_b16 v[134:135], v2 offset:6144
    ds_read_b64_tr_b16 v[136:137], v3 offset:0
    ds_read_b64_tr_b16 v[138:139], v3 offset:6144
    ds_read_b64_tr_b16 v[140:141], v4 offset:0
    ds_read_b64_tr_b16 v[142:143], v4 offset:6144
    ds_read_b64_tr_b16 v[144:145], v6 offset:0
    ds_read_b64_tr_b16 v[146:147], v6 offset:6144
    ds_read_b64_tr_b16 v[148:149], v13 offset:0
    ds_read_b64_tr_b16 v[150:151], v13 offset:6144
    s_waitcnt lgkmcnt(10)
    v_mfma_f32_16x16x32_bf16 v[16:19], v[128:131], v[112:115], 0
    ds_read_b128 v[152:155], v5 offset:20480
    v_mfma_f32_16x16x32_bf16 v[40:43], v[128:131], v[116:119], 0
    ds_read_b128 v[156:159], v5 offset:21504
    v_mfma_f32_16x16x32_bf16 v[64:67], v[128:131], v[120:123], 0
    ds_read_b128 v[160:163], v5 offset:22528
    v_mfma_f32_16x16x32_bf16 v[88:91], v[128:131], v[124:127], 0
    ds_read_b128 v[164:167], v5 offset:23552
    s_waitcnt lgkmcnt(12)
    v_mfma_f32_16x16x32_bf16 v[20:23], v[132:135], v[112:115], 0
    ds_read_b64_tr_b16 v[168:169], v1 offset:20480
    v_mfma_f32_16x16x32_bf16 v[44:47], v[132:135], v[116:119], 0
    ds_read_b64_tr_b16 v[170:171], v1 offset:26624
    v_mfma_f32_16x16x32_bf16 v[68:71], v[132:135], v[120:123], 0
    ds_read_b64_tr_b16 v[172:173], v2 offset:20480
    v_mfma_f32_16x16x32_bf16 v[92:95], v[132:135], v[124:127], 0
    ds_read_b64_tr_b16 v[174:175], v2 offset:26624
    s_waitcnt lgkmcnt(14)
    v_mfma_f32_16x16x32_bf16 v[24:27], v[136:139], v[112:115], 0
    ds_read_b64_tr_b16 v[176:177], v3 offset:20480
    v_mfma_f32_16x16x32_bf16 v[48:51], v[136:139], v[116:119], 0
    ds_read_b64_tr_b16 v[178:179], v3 offset:26624
    v_mfma_f32_16x16x32_bf16 v[72:75], v[136:139], v[120:123], 0
    ds_read_b64_tr_b16 v[180:181], v4 offset:20480
    v_mfma_f32_16x16x32_bf16 v[96:99], v[136:139], v[124:127], 0
    ds_read_b64_tr_b16 v[182:183], v4 offset:26624
    s_waitcnt lgkmcnt(15)
    v_mfma_f32_16x16x32_bf16 v[28:31], v[140:143], v[112:115], 0
    ds_read_b64_tr_b16 v[184:185], v6 offset:20480
    v_mfma_f32_16x16x32_bf16 v[52:55], v[140:143], v[116:119], 0
    ds_read_b64_tr_b16 v[186:187], v6 offset:26624
    v_mfma_f32_16x16x32_bf16 v[76:79], v[140:143], v[120:123], 0
    ds_read_b64_tr_b16 v[188:189], v13 offset:20480
    v_mfma_f32_16x16x32_bf16 v[100:103], v[140:143], v[124:127], 0
    ds_read_b64_tr_b16 v[190:191], v13 offset:26624
    s_waitcnt lgkmcnt(15)
    v_mfma_f32_16x16x32_bf16 v[32:35], v[144:147], v[112:115], 0
    v_mfma_f32_16x16x32_bf16 v[56:59], v[144:147], v[116:119], 0
    v_mfma_f32_16x16x32_bf16 v[80:83], v[144:147], v[120:123], 0
    v_mfma_f32_16x16x32_bf16 v[104:107], v[144:147], v[124:127], 0
    v_mfma_f32_16x16x32_bf16 v[36:39], v[148:151], v[112:115], 0
    v_mfma_f32_16x16x32_bf16 v[60:63], v[148:151], v[116:119], 0
    v_mfma_f32_16x16x32_bf16 v[84:87], v[148:151], v[120:123], 0
    v_mfma_f32_16x16x32_bf16 v[108:111], v[148:151], v[124:127], 0
    v_mov_b32 v14, 0
    v_mov_b32 v15, 1
    s_waitcnt vmcnt(0)
    s_mov_b64 exec, 1
    buffer_atomic_add v15, v14, s[32:35], s98 offen sc1
    s_mov_b64 exec, -1
    s_waitcnt lgkmcnt(0)
    v_mfma_f32_16x16x32_bf16 v[16:19], v[168:171], v[152:155], v[16:19]
    s_barrier
    v_mfma_f32_16x16x32_bf16 v[40:43], v[168:171], v[156:159], v[40:43]
    ds_read_b128 v[112:115], v5 offset:40960
    v_mfma_f32_16x16x32_bf16 v[64:67], v[168:171], v[160:163], v[64:67]
    ds_read_b128 v[116:119], v5 offset:41984
    v_mfma_f32_16x16x32_bf16 v[88:91], v[168:171], v[164:167], v[88:91]
    ds_read_b128 v[120:123], v5 offset:43008
    v_mfma_f32_16x16x32_bf16 v[20:23], v[172:175], v[152:155], v[20:23]
    ds_read_b128 v[124:127], v5 offset:44032
    v_mfma_f32_16x16x32_bf16 v[44:47], v[172:175], v[156:159], v[44:47]
    ds_read_b64_tr_b16 v[128:129], v1 offset:40960
    v_mfma_f32_16x16x32_bf16 v[68:71], v[172:175], v[160:163], v[68:71]
    ds_read_b64_tr_b16 v[130:131], v1 offset:47104
    v_mfma_f32_16x16x32_bf16 v[92:95], v[172:175], v[164:167], v[92:95]
    ds_read_b64_tr_b16 v[132:133], v2 offset:40960
    v_mfma_f32_16x16x32_bf16 v[24:27], v[176:179], v[152:155], v[24:27]
    ds_read_b64_tr_b16 v[134:135], v2 offset:47104
    v_mfma_f32_16x16x32_bf16 v[48:51], v[176:179], v[156:159], v[48:51]
    ds_read_b64_tr_b16 v[136:137], v3 offset:40960
    v_mfma_f32_16x16x32_bf16 v[72:75], v[176:179], v[160:163], v[72:75]
    ds_read_b64_tr_b16 v[138:139], v3 offset:47104
    v_mfma_f32_16x16x32_bf16 v[96:99], v[176:179], v[164:167], v[96:99]
    ds_read_b64_tr_b16 v[140:141], v4 offset:40960
    v_mfma_f32_16x16x32_bf16 v[28:31], v[180:183], v[152:155], v[28:31]
    ds_read_b64_tr_b16 v[142:143], v4 offset:47104
    v_mfma_f32_16x16x32_bf16 v[52:55], v[180:183], v[156:159], v[52:55]
    ds_read_b64_tr_b16 v[144:145], v6 offset:40960
    v_mfma_f32_16x16x32_bf16 v[76:79], v[180:183], v[160:163], v[76:79]
    ds_read_b64_tr_b16 v[146:147], v6 offset:47104
    v_mfma_f32_16x16x32_bf16 v[100:103], v[180:183], v[164:167], v[100:103]
    ds_read_b64_tr_b16 v[148:149], v13 offset:40960
    v_mfma_f32_16x16x32_bf16 v[32:35], v[184:187], v[152:155], v[32:35]
    ds_read_b64_tr_b16 v[150:151], v13 offset:47104
    v_mfma_f32_16x16x32_bf16 v[56:59], v[184:187], v[156:159], v[56:59]
    v_mfma_f32_16x16x32_bf16 v[80:83], v[184:187], v[160:163], v[80:83]
    v_mfma_f32_16x16x32_bf16 v[104:107], v[184:187], v[164:167], v[104:107]
    v_mfma_f32_16x16x32_bf16 v[36:39], v[188:191], v[152:155], v[36:39]
    v_mfma_f32_16x16x32_bf16 v[60:63], v[188:191], v[156:159], v[60:63]
    v_mfma_f32_16x16x32_bf16 v[84:87], v[188:191], v[160:163], v[84:87]
    v_mfma_f32_16x16x32_bf16 v[108:111], v[188:191], v[164:167], v[108:111]
    s_waitcnt lgkmcnt(10)
    v_mfma_f32_16x16x32_bf16 v[16:19], v[128:131], v[112:115], v[16:19]
    v_add_u32 v1, 0xf000, v1
    v_add_u32 v2, 0xf000, v2
    v_add_u32 v3, 0xf000, v3
    v_add_u32 v4, 0xf000, v4
    v_add_u32 v5, 0xf000, v5
    v_add_u32 v6, 0xf000, v6
    v_add_u32 v13, 0xf000, v13
    ds_read_b128 v[152:155], v5 offset:0
    v_mfma_f32_16x16x32_bf16 v[40:43], v[128:131], v[116:119], v[40:43]
    ds_read_b128 v[156:159], v5 offset:1024
    v_mfma_f32_16x16x32_bf16 v[64:67], v[128:131], v[120:123], v[64:67]
    ds_read_b128 v[160:163], v5 offset:2048
    v_mfma_f32_16x16x32_bf16 v[88:91], v[128:131], v[124:127], v[88:91]
    ds_read_b128 v[164:167], v5 offset:3072
    s_waitcnt lgkmcnt(12)
    v_mfma_f32_16x16x32_bf16 v[20:23], v[132:135], v[112:115], v[20:23]
    ds_read_b64_tr_b16 v[168:169], v1 offset:0
    v_mfma_f32_16x16x32_bf16 v[44:47], v[132:135], v[116:119], v[44:47]
    ds_read_b64_tr_b16 v[170:171], v1 offset:6144
    v_mfma_f32_16x16x32_bf16 v[68:71], v[132:135], v[120:123], v[68:71]
    ds_read_b64_tr_b16 v[172:173], v2 offset:0
    v_mfma_f32_16x16x32_bf16 v[92:95], v[132:135], v[124:127], v[92:95]
    ds_read_b64_tr_b16 v[174:175], v2 offset:6144
    s_waitcnt lgkmcnt(14)
    v_mfma_f32_16x16x32_bf16 v[24:27], v[136:139], v[112:115], v[24:27]
    ds_read_b64_tr_b16 v[176:177], v3 offset:0
    v_mfma_f32_16x16x32_bf16 v[48:51], v[136:139], v[116:119], v[48:51]
    ds_read_b64_tr_b16 v[178:179], v3 offset:6144
    v_mfma_f32_16x16x32_bf16 v[72:75], v[136:139], v[120:123], v[72:75]
    ds_read_b64_tr_b16 v[180:181], v4 offset:0
    v_mfma_f32_16x16x32_bf16 v[96:99], v[136:139], v[124:127], v[96:99]
    ds_read_b64_tr_b16 v[182:183], v4 offset:6144
    s_waitcnt lgkmcnt(15)
    v_mfma_f32_16x16x32_bf16 v[28:31], v[140:143], v[112:115], v[28:31]
    ds_read_b64_tr_b16 v[184:185], v6 offset:0
    v_mfma_f32_16x16x32_bf16 v[52:55], v[140:143], v[116:119], v[52:55]
    ds_read_b64_tr_b16 v[186:187], v6 offset:6144
    v_mfma_f32_16x16x32_bf16 v[76:79], v[140:143], v[120:123], v[76:79]
    ds_read_b64_tr_b16 v[188:189], v13 offset:0
    v_mfma_f32_16x16x32_bf16 v[100:103], v[140:143], v[124:127], v[100:103]
    ds_read_b64_tr_b16 v[190:191], v13 offset:6144
    s_waitcnt lgkmcnt(15)
    v_mfma_f32_16x16x32_bf16 v[32:35], v[144:147], v[112:115], v[32:35]
    s_mov_b64 s[36:37], s[4:5]
    v_mfma_f32_16x16x32_bf16 v[56:59], v[144:147], v[116:119], v[56:59]
    s_mov_b64 s[40:41], s[18:19]
    v_mfma_f32_16x16x32_bf16 v[80:83], v[144:147], v[120:123], v[80:83]
    s_mul_i32 s57, s51, 2359296
    v_mfma_f32_16x16x32_bf16 v[104:107], v[144:147], v[124:127], v[104:107]
    s_lshl_b32 s59, s52, 2
    v_mfma_f32_16x16x32_bf16 v[36:39], v[148:151], v[112:115], v[36:39]
    s_lshl_b32 s60, s54, 1
    v_mfma_f32_16x16x32_bf16 v[60:63], v[148:151], v[116:119], v[60:63]
    s_add_u32 s59, s59, s60
    v_mfma_f32_16x16x32_bf16 v[84:87], v[148:151], v[120:123], v[84:87]
    s_mul_i32 s59, s59, 36864
    v_mfma_f32_16x16x32_bf16 v[108:111], v[148:151], v[124:127], v[108:111]
    s_add_u32 s57, s57, s59
    s_waitcnt lgkmcnt(0)
    v_mfma_f32_16x16x32_bf16 v[16:19], v[168:171], v[152:155], v[16:19]
    s_barrier
    v_mfma_f32_16x16x32_bf16 v[40:43], v[168:171], v[156:159], v[40:43]
    ds_read_b128 v[112:115], v5 offset:20480
    v_mfma_f32_16x16x32_bf16 v[64:67], v[168:171], v[160:163], v[64:67]
    ds_read_b128 v[116:119], v5 offset:21504
    v_mfma_f32_16x16x32_bf16 v[88:91], v[168:171], v[164:167], v[88:91]
    ds_read_b128 v[120:123], v5 offset:22528
    v_mfma_f32_16x16x32_bf16 v[20:23], v[172:175], v[152:155], v[20:23]
    ds_read_b128 v[124:127], v5 offset:23552
    v_mfma_f32_16x16x32_bf16 v[44:47], v[172:175], v[156:159], v[44:47]
    ds_read_b64_tr_b16 v[128:129], v1 offset:20480
    v_mfma_f32_16x16x32_bf16 v[68:71], v[172:175], v[160:163], v[68:71]
    ds_read_b64_tr_b16 v[130:131], v1 offset:26624
    v_mfma_f32_16x16x32_bf16 v[92:95], v[172:175], v[164:167], v[92:95]
    ds_read_b64_tr_b16 v[132:133], v2 offset:20480
    v_mfma_f32_16x16x32_bf16 v[24:27], v[176:179], v[152:155], v[24:27]
    ds_read_b64_tr_b16 v[134:135], v2 offset:26624
    v_mfma_f32_16x16x32_bf16 v[48:51], v[176:179], v[156:159], v[48:51]
    ds_read_b64_tr_b16 v[136:137], v3 offset:20480
    v_mfma_f32_16x16x32_bf16 v[72:75], v[176:179], v[160:163], v[72:75]
    ds_read_b64_tr_b16 v[138:139], v3 offset:26624
    v_mfma_f32_16x16x32_bf16 v[96:99], v[176:179], v[164:167], v[96:99]
    ds_read_b64_tr_b16 v[140:141], v4 offset:20480
    v_mfma_f32_16x16x32_bf16 v[28:31], v[180:183], v[152:155], v[28:31]
    ds_read_b64_tr_b16 v[142:143], v4 offset:26624
    v_mfma_f32_16x16x32_bf16 v[52:55], v[180:183], v[156:159], v[52:55]
    ds_read_b64_tr_b16 v[144:145], v6 offset:20480
    v_mfma_f32_16x16x32_bf16 v[76:79], v[180:183], v[160:163], v[76:79]
    ds_read_b64_tr_b16 v[146:147], v6 offset:26624
    v_mfma_f32_16x16x32_bf16 v[100:103], v[180:183], v[164:167], v[100:103]
    ds_read_b64_tr_b16 v[148:149], v13 offset:20480
    v_mfma_f32_16x16x32_bf16 v[32:35], v[184:187], v[152:155], v[32:35]
    ds_read_b64_tr_b16 v[150:151], v13 offset:26624
    v_mfma_f32_16x16x32_bf16 v[56:59], v[184:187], v[156:159], v[56:59]
    s_mul_i32 s59, s53, 6
    v_mfma_f32_16x16x32_bf16 v[80:83], v[184:187], v[160:163], v[80:83]
    s_mul_i32 s60, s55, 3
    v_mfma_f32_16x16x32_bf16 v[104:107], v[184:187], v[164:167], v[104:107]
    s_add_u32 s59, s59, s60
    v_mfma_f32_16x16x32_bf16 v[36:39], v[188:191], v[152:155], v[36:39]
    s_lshl_b32 s59, s59, 10
    v_mfma_f32_16x16x32_bf16 v[60:63], v[188:191], v[156:159], v[60:63]
    s_add_u32 s57, s57, s59
    v_mfma_f32_16x16x32_bf16 v[84:87], v[188:191], v[160:163], v[84:87]
    s_add_u32 s57, s57, 27787264
    v_mfma_f32_16x16x32_bf16 v[108:111], v[188:191], v[164:167], v[108:111]
    s_mov_b32 s38, 2359296
    s_waitcnt lgkmcnt(10)
    v_mfma_f32_16x16x32_bf16 v[16:19], v[128:131], v[112:115], v[16:19]
    ds_read_b128 v[152:155], v5 offset:40960
    v_mfma_f32_16x16x32_bf16 v[40:43], v[128:131], v[116:119], v[40:43]
    ds_read_b128 v[156:159], v5 offset:41984
    v_mfma_f32_16x16x32_bf16 v[64:67], v[128:131], v[120:123], v[64:67]
    ds_read_b128 v[160:163], v5 offset:43008
    v_mfma_f32_16x16x32_bf16 v[88:91], v[128:131], v[124:127], v[88:91]
    ds_read_b128 v[164:167], v5 offset:44032
    s_waitcnt lgkmcnt(12)
    v_mfma_f32_16x16x32_bf16 v[20:23], v[132:135], v[112:115], v[20:23]
    ds_read_b64_tr_b16 v[168:169], v1 offset:40960
    v_mfma_f32_16x16x32_bf16 v[44:47], v[132:135], v[116:119], v[44:47]
    ds_read_b64_tr_b16 v[170:171], v1 offset:47104
    v_mfma_f32_16x16x32_bf16 v[68:71], v[132:135], v[120:123], v[68:71]
    ds_read_b64_tr_b16 v[172:173], v2 offset:40960
    v_mfma_f32_16x16x32_bf16 v[92:95], v[132:135], v[124:127], v[92:95]
    ds_read_b64_tr_b16 v[174:175], v2 offset:47104
    s_waitcnt lgkmcnt(14)
    v_mfma_f32_16x16x32_bf16 v[24:27], v[136:139], v[112:115], v[24:27]
    ds_read_b64_tr_b16 v[176:177], v3 offset:40960
    v_mfma_f32_16x16x32_bf16 v[48:51], v[136:139], v[116:119], v[48:51]
    ds_read_b64_tr_b16 v[178:179], v3 offset:47104
    v_mfma_f32_16x16x32_bf16 v[72:75], v[136:139], v[120:123], v[72:75]
    ds_read_b64_tr_b16 v[180:181], v4 offset:40960
    v_mfma_f32_16x16x32_bf16 v[96:99], v[136:139], v[124:127], v[96:99]
    ds_read_b64_tr_b16 v[182:183], v4 offset:47104
    s_waitcnt lgkmcnt(15)
    v_mfma_f32_16x16x32_bf16 v[28:31], v[140:143], v[112:115], v[28:31]
    ds_read_b64_tr_b16 v[184:185], v6 offset:40960
    v_mfma_f32_16x16x32_bf16 v[52:55], v[140:143], v[116:119], v[52:55]
    ds_read_b64_tr_b16 v[186:187], v6 offset:47104
    v_mfma_f32_16x16x32_bf16 v[76:79], v[140:143], v[120:123], v[76:79]
    ds_read_b64_tr_b16 v[188:189], v13 offset:40960
    v_mfma_f32_16x16x32_bf16 v[100:103], v[140:143], v[124:127], v[100:103]
    ds_read_b64_tr_b16 v[190:191], v13 offset:47104
    s_waitcnt lgkmcnt(15)
    v_mfma_f32_16x16x32_bf16 v[32:35], v[144:147], v[112:115], v[32:35]
    s_mov_b32 s39, 0x20000
    v_mfma_f32_16x16x32_bf16 v[56:59], v[144:147], v[116:119], v[56:59]
    s_mov_b32 s42, 2359296
    v_mfma_f32_16x16x32_bf16 v[80:83], v[144:147], v[120:123], v[80:83]
    s_mov_b32 s43, 0x20000
    v_mfma_f32_16x16x32_bf16 v[104:107], v[144:147], v[124:127], v[104:107]
    v_and_b32 v240, 8, v9
    v_mfma_f32_16x16x32_bf16 v[36:39], v[148:151], v[112:115], v[36:39]
    v_add_u32 v240, v240, v9
    v_mfma_f32_16x16x32_bf16 v[60:63], v[148:151], v[116:119], v[60:63]
    v_mul_u32_u24 v240, 73728, v240
    v_mfma_f32_16x16x32_bf16 v[84:87], v[148:151], v[120:123], v[84:87]
    v_and_b32 v241, 1, v8
    v_mfma_f32_16x16x32_bf16 v[108:111], v[148:151], v[124:127], v[108:111]
    v_lshl_add_u32 v240, v241, 5, v240
    s_waitcnt lgkmcnt(0)
    v_mfma_f32_16x16x32_bf16 v[16:19], v[168:171], v[152:155], v[16:19]
    s_barrier
    v_mfma_f32_16x16x32_bf16 v[40:43], v[168:171], v[156:159], v[40:43]
    v_add_u32 v1, 0xffff1000, v1
    v_add_u32 v2, 0xffff1000, v2
    v_add_u32 v3, 0xffff1000, v3
    v_add_u32 v4, 0xffff1000, v4
    v_add_u32 v5, 0xffff1000, v5
    v_add_u32 v6, 0xffff1000, v6
    v_add_u32 v13, 0xffff1000, v13
    ds_read_b128 v[112:115], v248 offset:0
    v_mfma_f32_16x16x32_bf16 v[64:67], v[168:171], v[160:163], v[64:67]
    ds_read_b128 v[116:119], v248 offset:1024
    v_mfma_f32_16x16x32_bf16 v[88:91], v[168:171], v[164:167], v[88:91]
    ds_read_b128 v[120:123], v248 offset:2048
    v_mfma_f32_16x16x32_bf16 v[20:23], v[172:175], v[152:155], v[20:23]
    ds_read_b128 v[124:127], v248 offset:3072
    v_mfma_f32_16x16x32_bf16 v[44:47], v[172:175], v[156:159], v[44:47]
    ds_read_b64_tr_b16 v[128:129], v1 offset:0
    v_mfma_f32_16x16x32_bf16 v[68:71], v[172:175], v[160:163], v[68:71]
    ds_read_b64_tr_b16 v[130:131], v1 offset:6144
    v_mfma_f32_16x16x32_bf16 v[92:95], v[172:175], v[164:167], v[92:95]
    ds_read_b64_tr_b16 v[132:133], v2 offset:0
    v_mfma_f32_16x16x32_bf16 v[24:27], v[176:179], v[152:155], v[24:27]
    ds_read_b64_tr_b16 v[134:135], v2 offset:6144
    v_mfma_f32_16x16x32_bf16 v[48:51], v[176:179], v[156:159], v[48:51]
    ds_read_b64_tr_b16 v[136:137], v3 offset:0
    v_mfma_f32_16x16x32_bf16 v[72:75], v[176:179], v[160:163], v[72:75]
    ds_read_b64_tr_b16 v[138:139], v3 offset:6144
    v_mfma_f32_16x16x32_bf16 v[96:99], v[176:179], v[164:167], v[96:99]
    ds_read_b64_tr_b16 v[140:141], v4 offset:0
    v_mfma_f32_16x16x32_bf16 v[28:31], v[180:183], v[152:155], v[28:31]
    ds_read_b64_tr_b16 v[142:143], v4 offset:6144
    v_mfma_f32_16x16x32_bf16 v[52:55], v[180:183], v[156:159], v[52:55]
    ds_read_b64_tr_b16 v[144:145], v6 offset:0
    v_mfma_f32_16x16x32_bf16 v[76:79], v[180:183], v[160:163], v[76:79]
    ds_read_b64_tr_b16 v[146:147], v6 offset:6144
    v_mfma_f32_16x16x32_bf16 v[100:103], v[180:183], v[164:167], v[100:103]
    ds_read_b64_tr_b16 v[148:149], v13 offset:0
    v_mfma_f32_16x16x32_bf16 v[32:35], v[184:187], v[152:155], v[32:35]
    ds_read_b64_tr_b16 v[150:151], v13 offset:6144
    v_mfma_f32_16x16x32_bf16 v[56:59], v[184:187], v[156:159], v[56:59]
    v_lshrrev_b32 v242, 1, v8
    v_mfma_f32_16x16x32_bf16 v[80:83], v[184:187], v[160:163], v[80:83]
    v_lshl_add_u32 v240, v242, 4, v240
    v_mfma_f32_16x16x32_bf16 v[104:107], v[184:187], v[164:167], v[104:107]
    s_lshl_b32 s66, s52, 2
    v_mfma_f32_16x16x32_bf16 v[36:39], v[188:191], v[152:155], v[36:39]
    s_add_u32 s66, s66, s51
    v_mfma_f32_16x16x32_bf16 v[60:63], v[188:191], v[156:159], v[60:63]
    s_mul_i32 s74, s54, 9
    v_mfma_f32_16x16x32_bf16 v[84:87], v[188:191], v[160:163], v[84:87]
    s_mul_i32 s59, s53, 3
    v_mfma_f32_16x16x32_bf16 v[108:111], v[188:191], v[164:167], v[108:111]
    s_add_u32 s74, s74, s59
    s_waitcnt lgkmcnt(10)
    v_mfma_f32_16x16x32_bf16 v[16:19], v[128:131], v[112:115], v[16:19]
    ds_read_b128 v[152:155], v248 offset:8192
    v_mfma_f32_16x16x32_bf16 v[40:43], v[128:131], v[116:119], v[40:43]
    ds_read_b128 v[156:159], v248 offset:9216
    v_mfma_f32_16x16x32_bf16 v[64:67], v[128:131], v[120:123], v[64:67]
    ds_read_b128 v[160:163], v248 offset:10240
    v_mfma_f32_16x16x32_bf16 v[88:91], v[128:131], v[124:127], v[88:91]
    ds_read_b128 v[164:167], v248 offset:11264
    s_waitcnt lgkmcnt(12)
    v_mfma_f32_16x16x32_bf16 v[20:23], v[132:135], v[112:115], v[20:23]
    ds_read_b64_tr_b16 v[168:169], v1 offset:20480
    v_mfma_f32_16x16x32_bf16 v[44:47], v[132:135], v[116:119], v[44:47]
    ds_read_b64_tr_b16 v[170:171], v1 offset:26624
    v_mfma_f32_16x16x32_bf16 v[68:71], v[132:135], v[120:123], v[68:71]
    ds_read_b64_tr_b16 v[172:173], v2 offset:20480
    v_mfma_f32_16x16x32_bf16 v[92:95], v[132:135], v[124:127], v[92:95]
    ds_read_b64_tr_b16 v[174:175], v2 offset:26624
    s_waitcnt lgkmcnt(14)
    v_mfma_f32_16x16x32_bf16 v[24:27], v[136:139], v[112:115], v[24:27]
    ds_read_b64_tr_b16 v[176:177], v3 offset:20480
    v_mfma_f32_16x16x32_bf16 v[48:51], v[136:139], v[116:119], v[48:51]
    ds_read_b64_tr_b16 v[178:179], v3 offset:26624
    v_mfma_f32_16x16x32_bf16 v[72:75], v[136:139], v[120:123], v[72:75]
    ds_read_b64_tr_b16 v[180:181], v4 offset:20480
    v_mfma_f32_16x16x32_bf16 v[96:99], v[136:139], v[124:127], v[96:99]
    ds_read_b64_tr_b16 v[182:183], v4 offset:26624
    s_waitcnt lgkmcnt(15)
    v_mfma_f32_16x16x32_bf16 v[28:31], v[140:143], v[112:115], v[28:31]
    ds_read_b64_tr_b16 v[184:185], v6 offset:20480
    v_mfma_f32_16x16x32_bf16 v[52:55], v[140:143], v[116:119], v[52:55]
    ds_read_b64_tr_b16 v[186:187], v6 offset:26624
    v_mfma_f32_16x16x32_bf16 v[76:79], v[140:143], v[120:123], v[76:79]
    ds_read_b64_tr_b16 v[188:189], v13 offset:20480
    v_mfma_f32_16x16x32_bf16 v[100:103], v[140:143], v[124:127], v[100:103]
    ds_read_b64_tr_b16 v[190:191], v13 offset:26624
    s_waitcnt lgkmcnt(15)
    v_mfma_f32_16x16x32_bf16 v[32:35], v[144:147], v[112:115], v[32:35]
    s_mul_i32 s58, s66, 1152
    v_mfma_f32_16x16x32_bf16 v[56:59], v[144:147], v[116:119], v[56:59]
    s_lshl_b32 s59, s74, 6
    v_mfma_f32_16x16x32_bf16 v[80:83], v[144:147], v[120:123], v[80:83]
    s_add_u32 s58, s58, s59
    v_mfma_f32_16x16x32_bf16 v[104:107], v[144:147], v[124:127], v[104:107]
    s_mul_i32 s59, s55, 589824
    v_mfma_f32_16x16x32_bf16 v[36:39], v[148:151], v[112:115], v[36:39]
    s_add_u32 s58, s58, s59
    v_mfma_f32_16x16x32_bf16 v[60:63], v[148:151], v[116:119], v[60:63]
    s_mul_i32 s73, s66, 36864
    v_mfma_f32_16x16x32_bf16 v[84:87], v[148:151], v[120:123], v[84:87]
    s_lshl_b32 s59, s53, 1
    v_mfma_f32_16x16x32_bf16 v[108:111], v[148:151], v[124:127], v[108:111]
    s_add_u32 s59, s59, s54
    s_waitcnt lgkmcnt(0)
    v_mfma_f32_16x16x32_bf16 v[16:19], v[168:171], v[152:155], v[16:19]
    s_barrier
    v_mfma_f32_16x16x32_bf16 v[40:43], v[168:171], v[156:159], v[40:43]
    ds_read_b128 v[112:115], v248 offset:16384
    v_mfma_f32_16x16x32_bf16 v[64:67], v[168:171], v[160:163], v[64:67]
    ds_read_b128 v[116:119], v248 offset:17408
    v_mfma_f32_16x16x32_bf16 v[88:91], v[168:171], v[164:167], v[88:91]
    ds_read_b128 v[120:123], v248 offset:18432
    v_mfma_f32_16x16x32_bf16 v[20:23], v[172:175], v[152:155], v[20:23]
    ds_read_b128 v[124:127], v248 offset:19456
    v_mfma_f32_16x16x32_bf16 v[44:47], v[172:175], v[156:159], v[44:47]
    ds_read_b64_tr_b16 v[128:129], v1 offset:40960
    v_mfma_f32_16x16x32_bf16 v[68:71], v[172:175], v[160:163], v[68:71]
    ds_read_b64_tr_b16 v[130:131], v1 offset:47104
    v_mfma_f32_16x16x32_bf16 v[92:95], v[172:175], v[164:167], v[92:95]
    ds_read_b64_tr_b16 v[132:133], v2 offset:40960
    v_mfma_f32_16x16x32_bf16 v[24:27], v[176:179], v[152:155], v[24:27]
    ds_read_b64_tr_b16 v[134:135], v2 offset:47104
    v_mfma_f32_16x16x32_bf16 v[48:51], v[176:179], v[156:159], v[48:51]
    ds_read_b64_tr_b16 v[136:137], v3 offset:40960
    v_mfma_f32_16x16x32_bf16 v[72:75], v[176:179], v[160:163], v[72:75]
    ds_read_b64_tr_b16 v[138:139], v3 offset:47104
    v_mfma_f32_16x16x32_bf16 v[96:99], v[176:179], v[164:167], v[96:99]
    ds_read_b64_tr_b16 v[140:141], v4 offset:40960
    v_mfma_f32_16x16x32_bf16 v[28:31], v[180:183], v[152:155], v[28:31]
    ds_read_b64_tr_b16 v[142:143], v4 offset:47104
    v_mfma_f32_16x16x32_bf16 v[52:55], v[180:183], v[156:159], v[52:55]
    ds_read_b64_tr_b16 v[144:145], v6 offset:40960
    v_mfma_f32_16x16x32_bf16 v[76:79], v[180:183], v[160:163], v[76:79]
    ds_read_b64_tr_b16 v[146:147], v6 offset:47104
    v_mfma_f32_16x16x32_bf16 v[100:103], v[180:183], v[164:167], v[100:103]
    ds_read_b64_tr_b16 v[148:149], v13 offset:40960
    v_mfma_f32_16x16x32_bf16 v[32:35], v[184:187], v[152:155], v[32:35]
    ds_read_b64_tr_b16 v[150:151], v13 offset:47104
    v_mfma_f32_16x16x32_bf16 v[56:59], v[184:187], v[156:159], v[56:59]
    s_mul_i32 s59, s59, 3072
    v_mfma_f32_16x16x32_bf16 v[80:83], v[184:187], v[160:163], v[80:83]
    s_add_u32 s73, s73, s59
    v_mfma_f32_16x16x32_bf16 v[104:107], v[184:187], v[164:167], v[104:107]
    s_add_u32 s59, s53, s54
    v_mfma_f32_16x16x32_bf16 v[36:39], v[188:191], v[152:155], v[36:39]
    s_and_b32 s59, s59, 1
    s_cselect_b32 s76, 2048, 0
    s_cselect_b32 s77, 0, 1024
    v_mfma_f32_16x16x32_bf16 v[60:63], v[188:191], v[156:159], v[60:63]
    s_add_u32 s78, s77, 1024
    v_mfma_f32_16x16x32_bf16 v[84:87], v[188:191], v[160:163], v[84:87]
    s_mul_i32 s59, s55, 18432
    v_mfma_f32_16x16x32_bf16 v[108:111], v[188:191], v[164:167], v[108:111]
    s_add_u32 s73, s73, s59
    s_waitcnt lgkmcnt(10)
    v_mfma_f32_16x16x32_bf16 v[16:19], v[128:131], v[112:115], v[16:19]
    v_add_u32 v1, 0xf000, v1
    v_add_u32 v2, 0xf000, v2
    v_add_u32 v3, 0xf000, v3
    v_add_u32 v4, 0xf000, v4
    v_add_u32 v5, 0xf000, v5
    v_add_u32 v6, 0xf000, v6
    v_add_u32 v13, 0xf000, v13
    ds_read_b128 v[152:155], v5 offset:0
    v_mfma_f32_16x16x32_bf16 v[40:43], v[128:131], v[116:119], v[40:43]
    ds_read_b128 v[156:159], v5 offset:1024
    v_mfma_f32_16x16x32_bf16 v[64:67], v[128:131], v[120:123], v[64:67]
    ds_read_b128 v[160:163], v5 offset:2048
    v_mfma_f32_16x16x32_bf16 v[88:91], v[128:131], v[124:127], v[88:91]
    ds_read_b128 v[164:167], v5 offset:3072
    s_waitcnt lgkmcnt(12)
    v_mfma_f32_16x16x32_bf16 v[20:23], v[132:135], v[112:115], v[20:23]
    ds_read_b64_tr_b16 v[168:169], v1 offset:0
    v_mfma_f32_16x16x32_bf16 v[44:47], v[132:135], v[116:119], v[44:47]
    ds_read_b64_tr_b16 v[170:171], v1 offset:6144
    v_mfma_f32_16x16x32_bf16 v[68:71], v[132:135], v[120:123], v[68:71]
    ds_read_b64_tr_b16 v[172:173], v2 offset:0
    v_mfma_f32_16x16x32_bf16 v[92:95], v[132:135], v[124:127], v[92:95]
    ds_read_b64_tr_b16 v[174:175], v2 offset:6144
    s_waitcnt lgkmcnt(14)
    v_mfma_f32_16x16x32_bf16 v[24:27], v[136:139], v[112:115], v[24:27]
    ds_read_b64_tr_b16 v[176:177], v3 offset:0
    v_mfma_f32_16x16x32_bf16 v[48:51], v[136:139], v[116:119], v[48:51]
    ds_read_b64_tr_b16 v[178:179], v3 offset:6144
    v_mfma_f32_16x16x32_bf16 v[72:75], v[136:139], v[120:123], v[72:75]
    ds_read_b64_tr_b16 v[180:181], v4 offset:0
    v_mfma_f32_16x16x32_bf16 v[96:99], v[136:139], v[124:127], v[96:99]
    ds_read_b64_tr_b16 v[182:183], v4 offset:6144
    s_waitcnt lgkmcnt(15)
    v_mfma_f32_16x16x32_bf16 v[28:31], v[140:143], v[112:115], v[28:31]
    ds_read_b64_tr_b16 v[184:185], v6 offset:0
    v_mfma_f32_16x16x32_bf16 v[52:55], v[140:143], v[116:119], v[52:55]
    ds_read_b64_tr_b16 v[186:187], v6 offset:6144
    v_mfma_f32_16x16x32_bf16 v[76:79], v[140:143], v[120:123], v[76:79]
    ds_read_b64_tr_b16 v[188:189], v13 offset:0
    v_mfma_f32_16x16x32_bf16 v[100:103], v[140:143], v[124:127], v[100:103]
    ds_read_b64_tr_b16 v[190:191], v13 offset:6144
    s_waitcnt lgkmcnt(15)
    v_mfma_f32_16x16x32_bf16 v[32:35], v[144:147], v[112:115], v[32:35]
    s_add_u32 s73, s73, 27787264
    v_mfma_f32_16x16x32_bf16 v[56:59], v[144:147], v[116:119], v[56:59]
    v_mfma_f32_16x16x32_bf16 v[80:83], v[144:147], v[120:123], v[80:83]
    v_mfma_f32_16x16x32_bf16 v[104:107], v[144:147], v[124:127], v[104:107]
    v_mfma_f32_16x16x32_bf16 v[36:39], v[148:151], v[112:115], v[36:39]
    v_mfma_f32_16x16x32_bf16 v[60:63], v[148:151], v[116:119], v[60:63]
    v_mfma_f32_16x16x32_bf16 v[84:87], v[148:151], v[120:123], v[84:87]
    v_mfma_f32_16x16x32_bf16 v[108:111], v[148:151], v[124:127], v[108:111]
    s_waitcnt lgkmcnt(0)
    v_mfma_f32_16x16x32_bf16 v[16:19], v[168:171], v[152:155], v[16:19]
    s_barrier
    v_mfma_f32_16x16x32_bf16 v[40:43], v[168:171], v[156:159], v[40:43]
    ds_read_b128 v[112:115], v5 offset:20480
    v_mfma_f32_16x16x32_bf16 v[64:67], v[168:171], v[160:163], v[64:67]
    ds_read_b128 v[116:119], v5 offset:21504
    v_mfma_f32_16x16x32_bf16 v[88:91], v[168:171], v[164:167], v[88:91]
    ds_read_b128 v[120:123], v5 offset:22528
    v_mfma_f32_16x16x32_bf16 v[20:23], v[172:175], v[152:155], v[20:23]
    ds_read_b128 v[124:127], v5 offset:23552
    v_mfma_f32_16x16x32_bf16 v[44:47], v[172:175], v[156:159], v[44:47]
    ds_read_b64_tr_b16 v[128:129], v1 offset:20480
    v_mfma_f32_16x16x32_bf16 v[68:71], v[172:175], v[160:163], v[68:71]
    ds_read_b64_tr_b16 v[130:131], v1 offset:26624
    v_mfma_f32_16x16x32_bf16 v[92:95], v[172:175], v[164:167], v[92:95]
    ds_read_b64_tr_b16 v[132:133], v2 offset:20480
    v_mfma_f32_16x16x32_bf16 v[24:27], v[176:179], v[152:155], v[24:27]
    ds_read_b64_tr_b16 v[134:135], v2 offset:26624
    v_mfma_f32_16x16x32_bf16 v[48:51], v[176:179], v[156:159], v[48:51]
    ds_read_b64_tr_b16 v[136:137], v3 offset:20480
    v_mfma_f32_16x16x32_bf16 v[72:75], v[176:179], v[160:163], v[72:75]
    ds_read_b64_tr_b16 v[138:139], v3 offset:26624
    v_mfma_f32_16x16x32_bf16 v[96:99], v[176:179], v[164:167], v[96:99]
    ds_read_b64_tr_b16 v[140:141], v4 offset:20480
    v_mfma_f32_16x16x32_bf16 v[28:31], v[180:183], v[152:155], v[28:31]
    ds_read_b64_tr_b16 v[142:143], v4 offset:26624
    v_mfma_f32_16x16x32_bf16 v[52:55], v[180:183], v[156:159], v[52:55]
    ds_read_b64_tr_b16 v[144:145], v6 offset:20480
    v_mfma_f32_16x16x32_bf16 v[76:79], v[180:183], v[160:163], v[76:79]
    ds_read_b64_tr_b16 v[146:147], v6 offset:26624
    v_mfma_f32_16x16x32_bf16 v[100:103], v[180:183], v[164:167], v[100:103]
    ds_read_b64_tr_b16 v[148:149], v13 offset:20480
    v_mfma_f32_16x16x32_bf16 v[32:35], v[184:187], v[152:155], v[32:35]
    ds_read_b64_tr_b16 v[150:151], v13 offset:26624
    v_mfma_f32_16x16x32_bf16 v[56:59], v[184:187], v[156:159], v[56:59]
    v_mfma_f32_16x16x32_bf16 v[80:83], v[184:187], v[160:163], v[80:83]
    v_mfma_f32_16x16x32_bf16 v[104:107], v[184:187], v[164:167], v[104:107]
    v_mfma_f32_16x16x32_bf16 v[36:39], v[188:191], v[152:155], v[36:39]
    v_mfma_f32_16x16x32_bf16 v[60:63], v[188:191], v[156:159], v[60:63]
    v_mfma_f32_16x16x32_bf16 v[84:87], v[188:191], v[160:163], v[84:87]
    v_mfma_f32_16x16x32_bf16 v[108:111], v[188:191], v[164:167], v[108:111]
    s_waitcnt lgkmcnt(10)
    v_mfma_f32_16x16x32_bf16 v[16:19], v[128:131], v[112:115], v[16:19]
    ds_read_b128 v[152:155], v5 offset:40960
    v_mfma_f32_16x16x32_bf16 v[40:43], v[128:131], v[116:119], v[40:43]
    ds_read_b128 v[156:159], v5 offset:41984
    v_mfma_f32_16x16x32_bf16 v[64:67], v[128:131], v[120:123], v[64:67]
    ds_read_b128 v[160:163], v5 offset:43008
    v_mfma_f32_16x16x32_bf16 v[88:91], v[128:131], v[124:127], v[88:91]
    ds_read_b128 v[164:167], v5 offset:44032
    s_waitcnt lgkmcnt(12)
    v_mfma_f32_16x16x32_bf16 v[20:23], v[132:135], v[112:115], v[20:23]
    ds_read_b64_tr_b16 v[168:169], v1 offset:40960
    v_mfma_f32_16x16x32_bf16 v[44:47], v[132:135], v[116:119], v[44:47]
    ds_read_b64_tr_b16 v[170:171], v1 offset:47104
    v_mfma_f32_16x16x32_bf16 v[68:71], v[132:135], v[120:123], v[68:71]
    ds_read_b64_tr_b16 v[172:173], v2 offset:40960
    v_mfma_f32_16x16x32_bf16 v[92:95], v[132:135], v[124:127], v[92:95]
    ds_read_b64_tr_b16 v[174:175], v2 offset:47104
    s_waitcnt lgkmcnt(14)
    v_mfma_f32_16x16x32_bf16 v[24:27], v[136:139], v[112:115], v[24:27]
    ds_read_b64_tr_b16 v[176:177], v3 offset:40960
    v_mfma_f32_16x16x32_bf16 v[48:51], v[136:139], v[116:119], v[48:51]
    ds_read_b64_tr_b16 v[178:179], v3 offset:47104
    v_mfma_f32_16x16x32_bf16 v[72:75], v[136:139], v[120:123], v[72:75]
    ds_read_b64_tr_b16 v[180:181], v4 offset:40960
    v_mfma_f32_16x16x32_bf16 v[96:99], v[136:139], v[124:127], v[96:99]
    ds_read_b64_tr_b16 v[182:183], v4 offset:47104
    s_waitcnt lgkmcnt(15)
    v_mfma_f32_16x16x32_bf16 v[28:31], v[140:143], v[112:115], v[28:31]
    ds_read_b64_tr_b16 v[184:185], v6 offset:40960
    v_mfma_f32_16x16x32_bf16 v[52:55], v[140:143], v[116:119], v[52:55]
    ds_read_b64_tr_b16 v[186:187], v6 offset:47104
    v_mfma_f32_16x16x32_bf16 v[76:79], v[140:143], v[120:123], v[76:79]
    ds_read_b64_tr_b16 v[188:189], v13 offset:40960
    v_mfma_f32_16x16x32_bf16 v[100:103], v[140:143], v[124:127], v[100:103]
    ds_read_b64_tr_b16 v[190:191], v13 offset:47104
    s_waitcnt lgkmcnt(15)
    v_mfma_f32_16x16x32_bf16 v[32:35], v[144:147], v[112:115], v[32:35]
    v_mfma_f32_16x16x32_bf16 v[56:59], v[144:147], v[116:119], v[56:59]
    v_mfma_f32_16x16x32_bf16 v[80:83], v[144:147], v[120:123], v[80:83]
    v_mfma_f32_16x16x32_bf16 v[104:107], v[144:147], v[124:127], v[104:107]
    v_mfma_f32_16x16x32_bf16 v[36:39], v[148:151], v[112:115], v[36:39]
    v_mfma_f32_16x16x32_bf16 v[60:63], v[148:151], v[116:119], v[60:63]
    v_mfma_f32_16x16x32_bf16 v[84:87], v[148:151], v[120:123], v[84:87]
    v_mfma_f32_16x16x32_bf16 v[108:111], v[148:151], v[124:127], v[108:111]
    s_waitcnt lgkmcnt(0)
    v_mfma_f32_16x16x32_bf16 v[16:19], v[168:171], v[152:155], v[16:19]
    s_barrier
    v_mfma_f32_16x16x32_bf16 v[40:43], v[168:171], v[156:159], v[40:43]
    v_add_u32 v1, 0xffff1000, v1
    v_add_u32 v2, 0xffff1000, v2
    v_add_u32 v3, 0xffff1000, v3
    v_add_u32 v4, 0xffff1000, v4
    v_add_u32 v5, 0xffff1000, v5
    v_add_u32 v6, 0xffff1000, v6
    v_add_u32 v13, 0xffff1000, v13
    ds_read_b128 v[112:115], v5 offset:0
    v_mfma_f32_16x16x32_bf16 v[64:67], v[168:171], v[160:163], v[64:67]
    ds_read_b128 v[116:119], v5 offset:1024
    v_mfma_f32_16x16x32_bf16 v[88:91], v[168:171], v[164:167], v[88:91]
    ds_read_b128 v[120:123], v5 offset:2048
    v_mfma_f32_16x16x32_bf16 v[20:23], v[172:175], v[152:155], v[20:23]
    ds_read_b128 v[124:127], v5 offset:3072
    v_mfma_f32_16x16x32_bf16 v[44:47], v[172:175], v[156:159], v[44:47]
    ds_read_b64_tr_b16 v[128:129], v1 offset:0
    v_mfma_f32_16x16x32_bf16 v[68:71], v[172:175], v[160:163], v[68:71]
    ds_read_b64_tr_b16 v[130:131], v1 offset:6144
    v_mfma_f32_16x16x32_bf16 v[92:95], v[172:175], v[164:167], v[92:95]
    ds_read_b64_tr_b16 v[132:133], v2 offset:0
    v_mfma_f32_16x16x32_bf16 v[24:27], v[176:179], v[152:155], v[24:27]
    ds_read_b64_tr_b16 v[134:135], v2 offset:6144
    v_mfma_f32_16x16x32_bf16 v[48:51], v[176:179], v[156:159], v[48:51]
    ds_read_b64_tr_b16 v[136:137], v3 offset:0
    v_mfma_f32_16x16x32_bf16 v[72:75], v[176:179], v[160:163], v[72:75]
    ds_read_b64_tr_b16 v[138:139], v3 offset:6144
    v_mfma_f32_16x16x32_bf16 v[96:99], v[176:179], v[164:167], v[96:99]
    ds_read_b64_tr_b16 v[140:141], v4 offset:0
    v_mfma_f32_16x16x32_bf16 v[28:31], v[180:183], v[152:155], v[28:31]
    ds_read_b64_tr_b16 v[142:143], v4 offset:6144
    v_mfma_f32_16x16x32_bf16 v[52:55], v[180:183], v[156:159], v[52:55]
    ds_read_b64_tr_b16 v[144:145], v6 offset:0
    v_mfma_f32_16x16x32_bf16 v[76:79], v[180:183], v[160:163], v[76:79]
    ds_read_b64_tr_b16 v[146:147], v6 offset:6144
    v_mfma_f32_16x16x32_bf16 v[100:103], v[180:183], v[164:167], v[100:103]
    ds_read_b64_tr_b16 v[148:149], v13 offset:0
    v_mfma_f32_16x16x32_bf16 v[32:35], v[184:187], v[152:155], v[32:35]
    ds_read_b64_tr_b16 v[150:151], v13 offset:6144
    v_mfma_f32_16x16x32_bf16 v[56:59], v[184:187], v[156:159], v[56:59]
    v_mfma_f32_16x16x32_bf16 v[80:83], v[184:187], v[160:163], v[80:83]
    v_mfma_f32_16x16x32_bf16 v[104:107], v[184:187], v[164:167], v[104:107]
    v_mfma_f32_16x16x32_bf16 v[36:39], v[188:191], v[152:155], v[36:39]
    v_mfma_f32_16x16x32_bf16 v[60:63], v[188:191], v[156:159], v[60:63]
    v_mfma_f32_16x16x32_bf16 v[84:87], v[188:191], v[160:163], v[84:87]
    v_mfma_f32_16x16x32_bf16 v[108:111], v[188:191], v[164:167], v[108:111]
    s_waitcnt lgkmcnt(10)
    v_mfma_f32_16x16x32_bf16 v[16:19], v[128:131], v[112:115], v[16:19]
    ds_read_b128 v[152:155], v5 offset:20480
    v_mfma_f32_16x16x32_bf16 v[40:43], v[128:131], v[116:119], v[40:43]
    ds_read_b128 v[156:159], v5 offset:21504
    v_mfma_f32_16x16x32_bf16 v[64:67], v[128:131], v[120:123], v[64:67]
    ds_read_b128 v[160:163], v5 offset:22528
    v_mfma_f32_16x16x32_bf16 v[88:91], v[128:131], v[124:127], v[88:91]
    ds_read_b128 v[164:167], v5 offset:23552
    s_waitcnt lgkmcnt(12)
    v_mfma_f32_16x16x32_bf16 v[20:23], v[132:135], v[112:115], v[20:23]
    ds_read_b64_tr_b16 v[168:169], v1 offset:20480
    v_mfma_f32_16x16x32_bf16 v[44:47], v[132:135], v[116:119], v[44:47]
    ds_read_b64_tr_b16 v[170:171], v1 offset:26624
    v_mfma_f32_16x16x32_bf16 v[68:71], v[132:135], v[120:123], v[68:71]
    ds_read_b64_tr_b16 v[172:173], v2 offset:20480
    v_mfma_f32_16x16x32_bf16 v[92:95], v[132:135], v[124:127], v[92:95]
    ds_read_b64_tr_b16 v[174:175], v2 offset:26624
    s_waitcnt lgkmcnt(14)
    v_mfma_f32_16x16x32_bf16 v[24:27], v[136:139], v[112:115], v[24:27]
    ds_read_b64_tr_b16 v[176:177], v3 offset:20480
    v_mfma_f32_16x16x32_bf16 v[48:51], v[136:139], v[116:119], v[48:51]
    ds_read_b64_tr_b16 v[178:179], v3 offset:26624
    v_mfma_f32_16x16x32_bf16 v[72:75], v[136:139], v[120:123], v[72:75]
    ds_read_b64_tr_b16 v[180:181], v4 offset:20480
    v_mfma_f32_16x16x32_bf16 v[96:99], v[136:139], v[124:127], v[96:99]
    ds_read_b64_tr_b16 v[182:183], v4 offset:26624
    s_waitcnt lgkmcnt(15)
    v_mfma_f32_16x16x32_bf16 v[28:31], v[140:143], v[112:115], v[28:31]
    ds_read_b64_tr_b16 v[184:185], v6 offset:20480
    v_mfma_f32_16x16x32_bf16 v[52:55], v[140:143], v[116:119], v[52:55]
    ds_read_b64_tr_b16 v[186:187], v6 offset:26624
    v_mfma_f32_16x16x32_bf16 v[76:79], v[140:143], v[120:123], v[76:79]
    ds_read_b64_tr_b16 v[188:189], v13 offset:20480
    v_mfma_f32_16x16x32_bf16 v[100:103], v[140:143], v[124:127], v[100:103]
    ds_read_b64_tr_b16 v[190:191], v13 offset:26624
    s_waitcnt lgkmcnt(15)
    v_mfma_f32_16x16x32_bf16 v[32:35], v[144:147], v[112:115], v[32:35]
    v_mfma_f32_16x16x32_bf16 v[56:59], v[144:147], v[116:119], v[56:59]
    v_mfma_f32_16x16x32_bf16 v[80:83], v[144:147], v[120:123], v[80:83]
    v_mfma_f32_16x16x32_bf16 v[104:107], v[144:147], v[124:127], v[104:107]
    v_mfma_f32_16x16x32_bf16 v[36:39], v[148:151], v[112:115], v[36:39]
    v_mfma_f32_16x16x32_bf16 v[60:63], v[148:151], v[116:119], v[60:63]
    v_mfma_f32_16x16x32_bf16 v[84:87], v[148:151], v[120:123], v[84:87]
    v_mfma_f32_16x16x32_bf16 v[108:111], v[148:151], v[124:127], v[108:111]
    s_waitcnt lgkmcnt(0)
    v_mfma_f32_16x16x32_bf16 v[16:19], v[168:171], v[152:155], v[16:19]
    s_barrier
    v_mfma_f32_16x16x32_bf16 v[40:43], v[168:171], v[156:159], v[40:43]
    ds_read_b128 v[112:115], v5 offset:40960
    v_mfma_f32_16x16x32_bf16 v[64:67], v[168:171], v[160:163], v[64:67]
    ds_read_b128 v[116:119], v5 offset:41984
    v_mfma_f32_16x16x32_bf16 v[88:91], v[168:171], v[164:167], v[88:91]
    ds_read_b128 v[120:123], v5 offset:43008
    v_mfma_f32_16x16x32_bf16 v[20:23], v[172:175], v[152:155], v[20:23]
    ds_read_b128 v[124:127], v5 offset:44032
    v_mfma_f32_16x16x32_bf16 v[44:47], v[172:175], v[156:159], v[44:47]
    ds_read_b64_tr_b16 v[128:129], v1 offset:40960
    v_mfma_f32_16x16x32_bf16 v[68:71], v[172:175], v[160:163], v[68:71]
    ds_read_b64_tr_b16 v[130:131], v1 offset:47104
    v_mfma_f32_16x16x32_bf16 v[92:95], v[172:175], v[164:167], v[92:95]
    ds_read_b64_tr_b16 v[132:133], v2 offset:40960
    v_mfma_f32_16x16x32_bf16 v[24:27], v[176:179], v[152:155], v[24:27]
    ds_read_b64_tr_b16 v[134:135], v2 offset:47104
    v_mfma_f32_16x16x32_bf16 v[48:51], v[176:179], v[156:159], v[48:51]
    ds_read_b64_tr_b16 v[136:137], v3 offset:40960
    v_mfma_f32_16x16x32_bf16 v[72:75], v[176:179], v[160:163], v[72:75]
    ds_read_b64_tr_b16 v[138:139], v3 offset:47104
    v_mfma_f32_16x16x32_bf16 v[96:99], v[176:179], v[164:167], v[96:99]
    ds_read_b64_tr_b16 v[140:141], v4 offset:40960
    v_mfma_f32_16x16x32_bf16 v[28:31], v[180:183], v[152:155], v[28:31]
    ds_read_b64_tr_b16 v[142:143], v4 offset:47104
    v_mfma_f32_16x16x32_bf16 v[52:55], v[180:183], v[156:159], v[52:55]
    ds_read_b64_tr_b16 v[144:145], v6 offset:40960
    v_mfma_f32_16x16x32_bf16 v[76:79], v[180:183], v[160:163], v[76:79]
    ds_read_b64_tr_b16 v[146:147], v6 offset:47104
    v_mfma_f32_16x16x32_bf16 v[100:103], v[180:183], v[164:167], v[100:103]
    ds_read_b64_tr_b16 v[148:149], v13 offset:40960
    v_mfma_f32_16x16x32_bf16 v[32:35], v[184:187], v[152:155], v[32:35]
    ds_read_b64_tr_b16 v[150:151], v13 offset:47104
    v_mfma_f32_16x16x32_bf16 v[56:59], v[184:187], v[156:159], v[56:59]
    v_mfma_f32_16x16x32_bf16 v[80:83], v[184:187], v[160:163], v[80:83]
    v_mfma_f32_16x16x32_bf16 v[104:107], v[184:187], v[164:167], v[104:107]
    v_mfma_f32_16x16x32_bf16 v[36:39], v[188:191], v[152:155], v[36:39]
    v_mfma_f32_16x16x32_bf16 v[60:63], v[188:191], v[156:159], v[60:63]
    v_mfma_f32_16x16x32_bf16 v[84:87], v[188:191], v[160:163], v[84:87]
    v_mfma_f32_16x16x32_bf16 v[108:111], v[188:191], v[164:167], v[108:111]
    s_waitcnt lgkmcnt(10)
    v_mfma_f32_16x16x32_bf16 v[16:19], v[128:131], v[112:115], v[16:19]
    v_add_u32 v1, 0xf000, v1
    v_add_u32 v2, 0xf000, v2
    v_add_u32 v3, 0xf000, v3
    v_add_u32 v4, 0xf000, v4
    v_add_u32 v5, 0xf000, v5
    v_add_u32 v6, 0xf000, v6
    v_add_u32 v13, 0xf000, v13
    ds_read_b128 v[152:155], v5 offset:0
    v_mfma_f32_16x16x32_bf16 v[40:43], v[128:131], v[116:119], v[40:43]
    ds_read_b128 v[156:159], v5 offset:1024
    v_mfma_f32_16x16x32_bf16 v[64:67], v[128:131], v[120:123], v[64:67]
    ds_read_b128 v[160:163], v5 offset:2048
    v_mfma_f32_16x16x32_bf16 v[88:91], v[128:131], v[124:127], v[88:91]
    ds_read_b128 v[164:167], v5 offset:3072
    s_waitcnt lgkmcnt(12)
    v_mfma_f32_16x16x32_bf16 v[20:23], v[132:135], v[112:115], v[20:23]
    ds_read_b64_tr_b16 v[168:169], v1 offset:0
    v_mfma_f32_16x16x32_bf16 v[44:47], v[132:135], v[116:119], v[44:47]
    ds_read_b64_tr_b16 v[170:171], v1 offset:6144
    v_mfma_f32_16x16x32_bf16 v[68:71], v[132:135], v[120:123], v[68:71]
    ds_read_b64_tr_b16 v[172:173], v2 offset:0
    v_mfma_f32_16x16x32_bf16 v[92:95], v[132:135], v[124:127], v[92:95]
    ds_read_b64_tr_b16 v[174:175], v2 offset:6144
    s_waitcnt lgkmcnt(14)
    v_mfma_f32_16x16x32_bf16 v[24:27], v[136:139], v[112:115], v[24:27]
    ds_read_b64_tr_b16 v[176:177], v3 offset:0
    v_mfma_f32_16x16x32_bf16 v[48:51], v[136:139], v[116:119], v[48:51]
    ds_read_b64_tr_b16 v[178:179], v3 offset:6144
    v_mfma_f32_16x16x32_bf16 v[72:75], v[136:139], v[120:123], v[72:75]
    ds_read_b64_tr_b16 v[180:181], v4 offset:0
    v_mfma_f32_16x16x32_bf16 v[96:99], v[136:139], v[124:127], v[96:99]
    ds_read_b64_tr_b16 v[182:183], v4 offset:6144
    s_waitcnt lgkmcnt(15)
    v_mfma_f32_16x16x32_bf16 v[28:31], v[140:143], v[112:115], v[28:31]
    ds_read_b64_tr_b16 v[184:185], v6 offset:0
    v_mfma_f32_16x16x32_bf16 v[52:55], v[140:143], v[116:119], v[52:55]
    ds_read_b64_tr_b16 v[186:187], v6 offset:6144
    v_mfma_f32_16x16x32_bf16 v[76:79], v[140:143], v[120:123], v[76:79]
    ds_read_b64_tr_b16 v[188:189], v13 offset:0
    v_mfma_f32_16x16x32_bf16 v[100:103], v[140:143], v[124:127], v[100:103]
    ds_read_b64_tr_b16 v[190:191], v13 offset:6144
    s_waitcnt lgkmcnt(15)
    v_mfma_f32_16x16x32_bf16 v[32:35], v[144:147], v[112:115], v[32:35]
    v_mfma_f32_16x16x32_bf16 v[56:59], v[144:147], v[116:119], v[56:59]
    v_mfma_f32_16x16x32_bf16 v[80:83], v[144:147], v[120:123], v[80:83]
    v_mfma_f32_16x16x32_bf16 v[104:107], v[144:147], v[124:127], v[104:107]
    v_mfma_f32_16x16x32_bf16 v[36:39], v[148:151], v[112:115], v[36:39]
    v_mfma_f32_16x16x32_bf16 v[60:63], v[148:151], v[116:119], v[60:63]
    v_mfma_f32_16x16x32_bf16 v[84:87], v[148:151], v[120:123], v[84:87]
    v_mfma_f32_16x16x32_bf16 v[108:111], v[148:151], v[124:127], v[108:111]
    s_waitcnt lgkmcnt(0)
    v_mfma_f32_16x16x32_bf16 v[16:19], v[168:171], v[152:155], v[16:19]
    s_barrier
    v_mfma_f32_16x16x32_bf16 v[40:43], v[168:171], v[156:159], v[40:43]
    ds_read_b128 v[112:115], v5 offset:20480
    v_mfma_f32_16x16x32_bf16 v[64:67], v[168:171], v[160:163], v[64:67]
    ds_read_b128 v[116:119], v5 offset:21504
    v_mfma_f32_16x16x32_bf16 v[88:91], v[168:171], v[164:167], v[88:91]
    ds_read_b128 v[120:123], v5 offset:22528
    v_mfma_f32_16x16x32_bf16 v[20:23], v[172:175], v[152:155], v[20:23]
    ds_read_b128 v[124:127], v5 offset:23552
    v_mfma_f32_16x16x32_bf16 v[44:47], v[172:175], v[156:159], v[44:47]
    ds_read_b64_tr_b16 v[128:129], v1 offset:20480
    v_mfma_f32_16x16x32_bf16 v[68:71], v[172:175], v[160:163], v[68:71]
    ds_read_b64_tr_b16 v[130:131], v1 offset:26624
    v_mfma_f32_16x16x32_bf16 v[92:95], v[172:175], v[164:167], v[92:95]
    ds_read_b64_tr_b16 v[132:133], v2 offset:20480
    v_mfma_f32_16x16x32_bf16 v[24:27], v[176:179], v[152:155], v[24:27]
    ds_read_b64_tr_b16 v[134:135], v2 offset:26624
    v_mfma_f32_16x16x32_bf16 v[48:51], v[176:179], v[156:159], v[48:51]
    ds_read_b64_tr_b16 v[136:137], v3 offset:20480
    v_mfma_f32_16x16x32_bf16 v[72:75], v[176:179], v[160:163], v[72:75]
    ds_read_b64_tr_b16 v[138:139], v3 offset:26624
    v_mfma_f32_16x16x32_bf16 v[96:99], v[176:179], v[164:167], v[96:99]
    ds_read_b64_tr_b16 v[140:141], v4 offset:20480
    v_mfma_f32_16x16x32_bf16 v[28:31], v[180:183], v[152:155], v[28:31]
    ds_read_b64_tr_b16 v[142:143], v4 offset:26624
    v_mfma_f32_16x16x32_bf16 v[52:55], v[180:183], v[156:159], v[52:55]
    ds_read_b64_tr_b16 v[144:145], v6 offset:20480
    v_mfma_f32_16x16x32_bf16 v[76:79], v[180:183], v[160:163], v[76:79]
    ds_read_b64_tr_b16 v[146:147], v6 offset:26624
    v_mfma_f32_16x16x32_bf16 v[100:103], v[180:183], v[164:167], v[100:103]
    ds_read_b64_tr_b16 v[148:149], v13 offset:20480
    v_mfma_f32_16x16x32_bf16 v[32:35], v[184:187], v[152:155], v[32:35]
    ds_read_b64_tr_b16 v[150:151], v13 offset:26624
    v_mfma_f32_16x16x32_bf16 v[56:59], v[184:187], v[156:159], v[56:59]
    v_mfma_f32_16x16x32_bf16 v[80:83], v[184:187], v[160:163], v[80:83]
    v_mfma_f32_16x16x32_bf16 v[104:107], v[184:187], v[164:167], v[104:107]
    v_mfma_f32_16x16x32_bf16 v[36:39], v[188:191], v[152:155], v[36:39]
    v_mfma_f32_16x16x32_bf16 v[60:63], v[188:191], v[156:159], v[60:63]
    v_mfma_f32_16x16x32_bf16 v[84:87], v[188:191], v[160:163], v[84:87]
    v_mfma_f32_16x16x32_bf16 v[108:111], v[188:191], v[164:167], v[108:111]
    s_waitcnt lgkmcnt(10)
    v_mfma_f32_16x16x32_bf16 v[16:19], v[128:131], v[112:115], v[16:19]
    ds_read_b128 v[152:155], v5 offset:40960
    v_mfma_f32_16x16x32_bf16 v[40:43], v[128:131], v[116:119], v[40:43]
    ds_read_b128 v[156:159], v5 offset:41984
    v_mfma_f32_16x16x32_bf16 v[64:67], v[128:131], v[120:123], v[64:67]
    ds_read_b128 v[160:163], v5 offset:43008
    v_mfma_f32_16x16x32_bf16 v[88:91], v[128:131], v[124:127], v[88:91]
    ds_read_b128 v[164:167], v5 offset:44032
    s_waitcnt lgkmcnt(12)
    v_mfma_f32_16x16x32_bf16 v[20:23], v[132:135], v[112:115], v[20:23]
    ds_read_b64_tr_b16 v[168:169], v1 offset:40960
    v_mfma_f32_16x16x32_bf16 v[44:47], v[132:135], v[116:119], v[44:47]
    ds_read_b64_tr_b16 v[170:171], v1 offset:47104
    v_mfma_f32_16x16x32_bf16 v[68:71], v[132:135], v[120:123], v[68:71]
    ds_read_b64_tr_b16 v[172:173], v2 offset:40960
    v_mfma_f32_16x16x32_bf16 v[92:95], v[132:135], v[124:127], v[92:95]
    ds_read_b64_tr_b16 v[174:175], v2 offset:47104
    s_waitcnt lgkmcnt(14)
    v_mfma_f32_16x16x32_bf16 v[24:27], v[136:139], v[112:115], v[24:27]
    ds_read_b64_tr_b16 v[176:177], v3 offset:40960
    v_mfma_f32_16x16x32_bf16 v[48:51], v[136:139], v[116:119], v[48:51]
    ds_read_b64_tr_b16 v[178:179], v3 offset:47104
    v_mfma_f32_16x16x32_bf16 v[72:75], v[136:139], v[120:123], v[72:75]
    ds_read_b64_tr_b16 v[180:181], v4 offset:40960
    v_mfma_f32_16x16x32_bf16 v[96:99], v[136:139], v[124:127], v[96:99]
    ds_read_b64_tr_b16 v[182:183], v4 offset:47104
    s_waitcnt lgkmcnt(15)
    v_mfma_f32_16x16x32_bf16 v[28:31], v[140:143], v[112:115], v[28:31]
    ds_read_b64_tr_b16 v[184:185], v6 offset:40960
    v_mfma_f32_16x16x32_bf16 v[52:55], v[140:143], v[116:119], v[52:55]
    ds_read_b64_tr_b16 v[186:187], v6 offset:47104
    v_mfma_f32_16x16x32_bf16 v[76:79], v[140:143], v[120:123], v[76:79]
    ds_read_b64_tr_b16 v[188:189], v13 offset:40960
    v_mfma_f32_16x16x32_bf16 v[100:103], v[140:143], v[124:127], v[100:103]
    ds_read_b64_tr_b16 v[190:191], v13 offset:47104
    s_waitcnt lgkmcnt(15)
    v_mfma_f32_16x16x32_bf16 v[32:35], v[144:147], v[112:115], v[32:35]
    v_mfma_f32_16x16x32_bf16 v[56:59], v[144:147], v[116:119], v[56:59]
    v_mfma_f32_16x16x32_bf16 v[80:83], v[144:147], v[120:123], v[80:83]
    v_mfma_f32_16x16x32_bf16 v[104:107], v[144:147], v[124:127], v[104:107]
    v_mfma_f32_16x16x32_bf16 v[36:39], v[148:151], v[112:115], v[36:39]
    v_mfma_f32_16x16x32_bf16 v[60:63], v[148:151], v[116:119], v[60:63]
    v_mfma_f32_16x16x32_bf16 v[84:87], v[148:151], v[120:123], v[84:87]
    v_mfma_f32_16x16x32_bf16 v[108:111], v[148:151], v[124:127], v[108:111]
    s_waitcnt lgkmcnt(0)
    v_mfma_f32_16x16x32_bf16 v[16:19], v[168:171], v[152:155], v[16:19]
    s_barrier
    v_mfma_f32_16x16x32_bf16 v[40:43], v[168:171], v[156:159], v[40:43]
    v_add_u32 v1, 0xffff1000, v1
    v_add_u32 v2, 0xffff1000, v2
    v_add_u32 v3, 0xffff1000, v3
    v_add_u32 v4, 0xffff1000, v4
    v_add_u32 v5, 0xffff1000, v5
    v_add_u32 v6, 0xffff1000, v6
    v_add_u32 v13, 0xffff1000, v13
    ds_read_b128 v[112:115], v5 offset:0
    v_mfma_f32_16x16x32_bf16 v[64:67], v[168:171], v[160:163], v[64:67]
    ds_read_b128 v[116:119], v5 offset:1024
    v_mfma_f32_16x16x32_bf16 v[88:91], v[168:171], v[164:167], v[88:91]
    ds_read_b128 v[120:123], v5 offset:2048
    v_mfma_f32_16x16x32_bf16 v[20:23], v[172:175], v[152:155], v[20:23]
    ds_read_b128 v[124:127], v5 offset:3072
    v_mfma_f32_16x16x32_bf16 v[44:47], v[172:175], v[156:159], v[44:47]
    ds_read_b64_tr_b16 v[128:129], v1 offset:0
    v_mfma_f32_16x16x32_bf16 v[68:71], v[172:175], v[160:163], v[68:71]
    ds_read_b64_tr_b16 v[130:131], v1 offset:6144
    v_mfma_f32_16x16x32_bf16 v[92:95], v[172:175], v[164:167], v[92:95]
    ds_read_b64_tr_b16 v[132:133], v2 offset:0
    v_mfma_f32_16x16x32_bf16 v[24:27], v[176:179], v[152:155], v[24:27]
    ds_read_b64_tr_b16 v[134:135], v2 offset:6144
    v_mfma_f32_16x16x32_bf16 v[48:51], v[176:179], v[156:159], v[48:51]
    ds_read_b64_tr_b16 v[136:137], v3 offset:0
    v_mfma_f32_16x16x32_bf16 v[72:75], v[176:179], v[160:163], v[72:75]
    ds_read_b64_tr_b16 v[138:139], v3 offset:6144
    v_mfma_f32_16x16x32_bf16 v[96:99], v[176:179], v[164:167], v[96:99]
    ds_read_b64_tr_b16 v[140:141], v4 offset:0
    v_mfma_f32_16x16x32_bf16 v[28:31], v[180:183], v[152:155], v[28:31]
    ds_read_b64_tr_b16 v[142:143], v4 offset:6144
    v_mfma_f32_16x16x32_bf16 v[52:55], v[180:183], v[156:159], v[52:55]
    ds_read_b64_tr_b16 v[144:145], v6 offset:0
    v_mfma_f32_16x16x32_bf16 v[76:79], v[180:183], v[160:163], v[76:79]
    ds_read_b64_tr_b16 v[146:147], v6 offset:6144
    v_mfma_f32_16x16x32_bf16 v[100:103], v[180:183], v[164:167], v[100:103]
    ds_read_b64_tr_b16 v[148:149], v13 offset:0
    v_mfma_f32_16x16x32_bf16 v[32:35], v[184:187], v[152:155], v[32:35]
    ds_read_b64_tr_b16 v[150:151], v13 offset:6144
    v_mfma_f32_16x16x32_bf16 v[56:59], v[184:187], v[156:159], v[56:59]
    v_mfma_f32_16x16x32_bf16 v[80:83], v[184:187], v[160:163], v[80:83]
    v_mfma_f32_16x16x32_bf16 v[104:107], v[184:187], v[164:167], v[104:107]
    v_mfma_f32_16x16x32_bf16 v[36:39], v[188:191], v[152:155], v[36:39]
    v_mfma_f32_16x16x32_bf16 v[60:63], v[188:191], v[156:159], v[60:63]
    v_mfma_f32_16x16x32_bf16 v[84:87], v[188:191], v[160:163], v[84:87]
    v_mfma_f32_16x16x32_bf16 v[108:111], v[188:191], v[164:167], v[108:111]
    s_waitcnt lgkmcnt(10)
    v_mfma_f32_16x16x32_bf16 v[16:19], v[128:131], v[112:115], v[16:19]
    ds_read_b128 v[152:155], v5 offset:20480
    v_mfma_f32_16x16x32_bf16 v[40:43], v[128:131], v[116:119], v[40:43]
    ds_read_b128 v[156:159], v5 offset:21504
    v_mfma_f32_16x16x32_bf16 v[64:67], v[128:131], v[120:123], v[64:67]
    ds_read_b128 v[160:163], v5 offset:22528
    v_mfma_f32_16x16x32_bf16 v[88:91], v[128:131], v[124:127], v[88:91]
    ds_read_b128 v[164:167], v5 offset:23552
    s_waitcnt lgkmcnt(12)
    v_mfma_f32_16x16x32_bf16 v[20:23], v[132:135], v[112:115], v[20:23]
    ds_read_b64_tr_b16 v[168:169], v1 offset:20480
    v_mfma_f32_16x16x32_bf16 v[44:47], v[132:135], v[116:119], v[44:47]
    ds_read_b64_tr_b16 v[170:171], v1 offset:26624
    v_mfma_f32_16x16x32_bf16 v[68:71], v[132:135], v[120:123], v[68:71]
    ds_read_b64_tr_b16 v[172:173], v2 offset:20480
    v_mfma_f32_16x16x32_bf16 v[92:95], v[132:135], v[124:127], v[92:95]
    ds_read_b64_tr_b16 v[174:175], v2 offset:26624
    s_waitcnt lgkmcnt(14)
    v_mfma_f32_16x16x32_bf16 v[24:27], v[136:139], v[112:115], v[24:27]
    ds_read_b64_tr_b16 v[176:177], v3 offset:20480
    v_mfma_f32_16x16x32_bf16 v[48:51], v[136:139], v[116:119], v[48:51]
    ds_read_b64_tr_b16 v[178:179], v3 offset:26624
    v_mfma_f32_16x16x32_bf16 v[72:75], v[136:139], v[120:123], v[72:75]
    ds_read_b64_tr_b16 v[180:181], v4 offset:20480
    v_mfma_f32_16x16x32_bf16 v[96:99], v[136:139], v[124:127], v[96:99]
    ds_read_b64_tr_b16 v[182:183], v4 offset:26624
    s_waitcnt lgkmcnt(15)
    v_mfma_f32_16x16x32_bf16 v[28:31], v[140:143], v[112:115], v[28:31]
    ds_read_b64_tr_b16 v[184:185], v6 offset:20480
    v_mfma_f32_16x16x32_bf16 v[52:55], v[140:143], v[116:119], v[52:55]
    ds_read_b64_tr_b16 v[186:187], v6 offset:26624
    v_mfma_f32_16x16x32_bf16 v[76:79], v[140:143], v[120:123], v[76:79]
    ds_read_b64_tr_b16 v[188:189], v13 offset:20480
    v_mfma_f32_16x16x32_bf16 v[100:103], v[140:143], v[124:127], v[100:103]
    ds_read_b64_tr_b16 v[190:191], v13 offset:26624
    s_waitcnt lgkmcnt(15)
    v_mfma_f32_16x16x32_bf16 v[32:35], v[144:147], v[112:115], v[32:35]
    v_mfma_f32_16x16x32_bf16 v[56:59], v[144:147], v[116:119], v[56:59]
    v_mfma_f32_16x16x32_bf16 v[80:83], v[144:147], v[120:123], v[80:83]
    v_mfma_f32_16x16x32_bf16 v[104:107], v[144:147], v[124:127], v[104:107]
    v_mfma_f32_16x16x32_bf16 v[36:39], v[148:151], v[112:115], v[36:39]
    v_mfma_f32_16x16x32_bf16 v[60:63], v[148:151], v[116:119], v[60:63]
    v_mfma_f32_16x16x32_bf16 v[84:87], v[148:151], v[120:123], v[84:87]
    v_mfma_f32_16x16x32_bf16 v[108:111], v[148:151], v[124:127], v[108:111]
    s_waitcnt lgkmcnt(0)
    v_mfma_f32_16x16x32_bf16 v[16:19], v[168:171], v[152:155], v[16:19]
    s_barrier
    v_mfma_f32_16x16x32_bf16 v[40:43], v[168:171], v[156:159], v[40:43]
    ds_read_b128 v[112:115], v5 offset:40960
    v_mfma_f32_16x16x32_bf16 v[64:67], v[168:171], v[160:163], v[64:67]
    ds_read_b128 v[116:119], v5 offset:41984
    v_mfma_f32_16x16x32_bf16 v[88:91], v[168:171], v[164:167], v[88:91]
    ds_read_b128 v[120:123], v5 offset:43008
    v_mfma_f32_16x16x32_bf16 v[20:23], v[172:175], v[152:155], v[20:23]
    ds_read_b128 v[124:127], v5 offset:44032
    v_mfma_f32_16x16x32_bf16 v[44:47], v[172:175], v[156:159], v[44:47]
    ds_read_b64_tr_b16 v[128:129], v1 offset:40960
    v_mfma_f32_16x16x32_bf16 v[68:71], v[172:175], v[160:163], v[68:71]
    ds_read_b64_tr_b16 v[130:131], v1 offset:47104
    v_mfma_f32_16x16x32_bf16 v[92:95], v[172:175], v[164:167], v[92:95]
    ds_read_b64_tr_b16 v[132:133], v2 offset:40960
    v_mfma_f32_16x16x32_bf16 v[24:27], v[176:179], v[152:155], v[24:27]
    ds_read_b64_tr_b16 v[134:135], v2 offset:47104
    v_mfma_f32_16x16x32_bf16 v[48:51], v[176:179], v[156:159], v[48:51]
    ds_read_b64_tr_b16 v[136:137], v3 offset:40960
    v_mfma_f32_16x16x32_bf16 v[72:75], v[176:179], v[160:163], v[72:75]
    ds_read_b64_tr_b16 v[138:139], v3 offset:47104
    v_mfma_f32_16x16x32_bf16 v[96:99], v[176:179], v[164:167], v[96:99]
    ds_read_b64_tr_b16 v[140:141], v4 offset:40960
    v_mfma_f32_16x16x32_bf16 v[28:31], v[180:183], v[152:155], v[28:31]
    ds_read_b64_tr_b16 v[142:143], v4 offset:47104
    v_mfma_f32_16x16x32_bf16 v[52:55], v[180:183], v[156:159], v[52:55]
    ds_read_b64_tr_b16 v[144:145], v6 offset:40960
    v_mfma_f32_16x16x32_bf16 v[76:79], v[180:183], v[160:163], v[76:79]
    ds_read_b64_tr_b16 v[146:147], v6 offset:47104
    v_mfma_f32_16x16x32_bf16 v[100:103], v[180:183], v[164:167], v[100:103]
    ds_read_b64_tr_b16 v[148:149], v13 offset:40960
    v_mfma_f32_16x16x32_bf16 v[32:35], v[184:187], v[152:155], v[32:35]
    ds_read_b64_tr_b16 v[150:151], v13 offset:47104
    v_mfma_f32_16x16x32_bf16 v[56:59], v[184:187], v[156:159], v[56:59]
    v_mfma_f32_16x16x32_bf16 v[80:83], v[184:187], v[160:163], v[80:83]
    v_mfma_f32_16x16x32_bf16 v[104:107], v[184:187], v[164:167], v[104:107]
    v_mfma_f32_16x16x32_bf16 v[36:39], v[188:191], v[152:155], v[36:39]
    v_mfma_f32_16x16x32_bf16 v[60:63], v[188:191], v[156:159], v[60:63]
    v_mfma_f32_16x16x32_bf16 v[84:87], v[188:191], v[160:163], v[84:87]
    v_mfma_f32_16x16x32_bf16 v[108:111], v[188:191], v[164:167], v[108:111]
    s_waitcnt lgkmcnt(10)
    v_mfma_f32_16x16x32_bf16 v[16:19], v[128:131], v[112:115], v[16:19]
    v_add_u32 v1, 0xf000, v1
    v_add_u32 v2, 0xf000, v2
    v_add_u32 v3, 0xf000, v3
    v_add_u32 v4, 0xf000, v4
    v_add_u32 v5, 0xf000, v5
    v_add_u32 v6, 0xf000, v6
    v_add_u32 v13, 0xf000, v13
    ds_read_b128 v[152:155], v5 offset:0
    v_mfma_f32_16x16x32_bf16 v[40:43], v[128:131], v[116:119], v[40:43]
    ds_read_b128 v[156:159], v5 offset:1024
    v_mfma_f32_16x16x32_bf16 v[64:67], v[128:131], v[120:123], v[64:67]
    ds_read_b128 v[160:163], v5 offset:2048
    v_mfma_f32_16x16x32_bf16 v[88:91], v[128:131], v[124:127], v[88:91]
    ds_read_b128 v[164:167], v5 offset:3072
    s_waitcnt lgkmcnt(12)
    v_mfma_f32_16x16x32_bf16 v[20:23], v[132:135], v[112:115], v[20:23]
    ds_read_b64_tr_b16 v[168:169], v1 offset:0
    v_mfma_f32_16x16x32_bf16 v[44:47], v[132:135], v[116:119], v[44:47]
    ds_read_b64_tr_b16 v[170:171], v1 offset:6144
    v_mfma_f32_16x16x32_bf16 v[68:71], v[132:135], v[120:123], v[68:71]
    ds_read_b64_tr_b16 v[172:173], v2 offset:0
    v_mfma_f32_16x16x32_bf16 v[92:95], v[132:135], v[124:127], v[92:95]
    ds_read_b64_tr_b16 v[174:175], v2 offset:6144
    s_waitcnt lgkmcnt(14)
    v_mfma_f32_16x16x32_bf16 v[24:27], v[136:139], v[112:115], v[24:27]
    ds_read_b64_tr_b16 v[176:177], v3 offset:0
    v_mfma_f32_16x16x32_bf16 v[48:51], v[136:139], v[116:119], v[48:51]
    ds_read_b64_tr_b16 v[178:179], v3 offset:6144
    v_mfma_f32_16x16x32_bf16 v[72:75], v[136:139], v[120:123], v[72:75]
    ds_read_b64_tr_b16 v[180:181], v4 offset:0
    v_mfma_f32_16x16x32_bf16 v[96:99], v[136:139], v[124:127], v[96:99]
    ds_read_b64_tr_b16 v[182:183], v4 offset:6144
    s_waitcnt lgkmcnt(15)
    v_mfma_f32_16x16x32_bf16 v[28:31], v[140:143], v[112:115], v[28:31]
    ds_read_b64_tr_b16 v[184:185], v6 offset:0
    v_mfma_f32_16x16x32_bf16 v[52:55], v[140:143], v[116:119], v[52:55]
    ds_read_b64_tr_b16 v[186:187], v6 offset:6144
    v_mfma_f32_16x16x32_bf16 v[76:79], v[140:143], v[120:123], v[76:79]
    ds_read_b64_tr_b16 v[188:189], v13 offset:0
    v_mfma_f32_16x16x32_bf16 v[100:103], v[140:143], v[124:127], v[100:103]
    ds_read_b64_tr_b16 v[190:191], v13 offset:6144
    s_waitcnt lgkmcnt(15)
    v_mfma_f32_16x16x32_bf16 v[32:35], v[144:147], v[112:115], v[32:35]
    v_mfma_f32_16x16x32_bf16 v[56:59], v[144:147], v[116:119], v[56:59]
    v_mfma_f32_16x16x32_bf16 v[80:83], v[144:147], v[120:123], v[80:83]
    v_mfma_f32_16x16x32_bf16 v[104:107], v[144:147], v[124:127], v[104:107]
    v_mfma_f32_16x16x32_bf16 v[36:39], v[148:151], v[112:115], v[36:39]
    v_mfma_f32_16x16x32_bf16 v[60:63], v[148:151], v[116:119], v[60:63]
    v_mfma_f32_16x16x32_bf16 v[84:87], v[148:151], v[120:123], v[84:87]
    v_mfma_f32_16x16x32_bf16 v[108:111], v[148:151], v[124:127], v[108:111]
    s_waitcnt lgkmcnt(0)
    v_mfma_f32_16x16x32_bf16 v[16:19], v[168:171], v[152:155], v[16:19]
    s_barrier
    v_mfma_f32_16x16x32_bf16 v[40:43], v[168:171], v[156:159], v[40:43]
    ds_read_b128 v[112:115], v5 offset:20480
    v_mfma_f32_16x16x32_bf16 v[64:67], v[168:171], v[160:163], v[64:67]
    ds_read_b128 v[116:119], v5 offset:21504
    v_mfma_f32_16x16x32_bf16 v[88:91], v[168:171], v[164:167], v[88:91]
    ds_read_b128 v[120:123], v5 offset:22528
    v_mfma_f32_16x16x32_bf16 v[20:23], v[172:175], v[152:155], v[20:23]
    ds_read_b128 v[124:127], v5 offset:23552
    v_mfma_f32_16x16x32_bf16 v[44:47], v[172:175], v[156:159], v[44:47]
    ds_read_b64_tr_b16 v[128:129], v1 offset:20480
    v_mfma_f32_16x16x32_bf16 v[68:71], v[172:175], v[160:163], v[68:71]
    ds_read_b64_tr_b16 v[130:131], v1 offset:26624
    v_mfma_f32_16x16x32_bf16 v[92:95], v[172:175], v[164:167], v[92:95]
    ds_read_b64_tr_b16 v[132:133], v2 offset:20480
    v_mfma_f32_16x16x32_bf16 v[24:27], v[176:179], v[152:155], v[24:27]
    ds_read_b64_tr_b16 v[134:135], v2 offset:26624
    v_mfma_f32_16x16x32_bf16 v[48:51], v[176:179], v[156:159], v[48:51]
    ds_read_b64_tr_b16 v[136:137], v3 offset:20480
    v_mfma_f32_16x16x32_bf16 v[72:75], v[176:179], v[160:163], v[72:75]
    ds_read_b64_tr_b16 v[138:139], v3 offset:26624
    v_mfma_f32_16x16x32_bf16 v[96:99], v[176:179], v[164:167], v[96:99]
    ds_read_b64_tr_b16 v[140:141], v4 offset:20480
    v_mfma_f32_16x16x32_bf16 v[28:31], v[180:183], v[152:155], v[28:31]
    ds_read_b64_tr_b16 v[142:143], v4 offset:26624
    v_mfma_f32_16x16x32_bf16 v[52:55], v[180:183], v[156:159], v[52:55]
    ds_read_b64_tr_b16 v[144:145], v6 offset:20480
    v_mfma_f32_16x16x32_bf16 v[76:79], v[180:183], v[160:163], v[76:79]
    ds_read_b64_tr_b16 v[146:147], v6 offset:26624
    v_mfma_f32_16x16x32_bf16 v[100:103], v[180:183], v[164:167], v[100:103]
    ds_read_b64_tr_b16 v[148:149], v13 offset:20480
    v_mfma_f32_16x16x32_bf16 v[32:35], v[184:187], v[152:155], v[32:35]
    ds_read_b64_tr_b16 v[150:151], v13 offset:26624
    v_mfma_f32_16x16x32_bf16 v[56:59], v[184:187], v[156:159], v[56:59]
    v_mfma_f32_16x16x32_bf16 v[80:83], v[184:187], v[160:163], v[80:83]
    v_mfma_f32_16x16x32_bf16 v[104:107], v[184:187], v[164:167], v[104:107]
    v_mfma_f32_16x16x32_bf16 v[36:39], v[188:191], v[152:155], v[36:39]
    v_mfma_f32_16x16x32_bf16 v[60:63], v[188:191], v[156:159], v[60:63]
    v_mfma_f32_16x16x32_bf16 v[84:87], v[188:191], v[160:163], v[84:87]
    v_mfma_f32_16x16x32_bf16 v[108:111], v[188:191], v[164:167], v[108:111]
    s_waitcnt lgkmcnt(10)
    v_mfma_f32_16x16x32_bf16 v[16:19], v[128:131], v[112:115], v[16:19]
    ds_read_b128 v[152:155], v5 offset:40960
    v_mfma_f32_16x16x32_bf16 v[40:43], v[128:131], v[116:119], v[40:43]
    ds_read_b128 v[156:159], v5 offset:41984
    v_mfma_f32_16x16x32_bf16 v[64:67], v[128:131], v[120:123], v[64:67]
    ds_read_b128 v[160:163], v5 offset:43008
    v_mfma_f32_16x16x32_bf16 v[88:91], v[128:131], v[124:127], v[88:91]
    ds_read_b128 v[164:167], v5 offset:44032
    s_waitcnt lgkmcnt(12)
    v_mfma_f32_16x16x32_bf16 v[20:23], v[132:135], v[112:115], v[20:23]
    ds_read_b64_tr_b16 v[168:169], v1 offset:40960
    v_mfma_f32_16x16x32_bf16 v[44:47], v[132:135], v[116:119], v[44:47]
    ds_read_b64_tr_b16 v[170:171], v1 offset:47104
    v_mfma_f32_16x16x32_bf16 v[68:71], v[132:135], v[120:123], v[68:71]
    ds_read_b64_tr_b16 v[172:173], v2 offset:40960
    v_mfma_f32_16x16x32_bf16 v[92:95], v[132:135], v[124:127], v[92:95]
    ds_read_b64_tr_b16 v[174:175], v2 offset:47104
    s_waitcnt lgkmcnt(14)
    v_mfma_f32_16x16x32_bf16 v[24:27], v[136:139], v[112:115], v[24:27]
    ds_read_b64_tr_b16 v[176:177], v3 offset:40960
    v_mfma_f32_16x16x32_bf16 v[48:51], v[136:139], v[116:119], v[48:51]
    ds_read_b64_tr_b16 v[178:179], v3 offset:47104
    v_mfma_f32_16x16x32_bf16 v[72:75], v[136:139], v[120:123], v[72:75]
    ds_read_b64_tr_b16 v[180:181], v4 offset:40960
    v_mfma_f32_16x16x32_bf16 v[96:99], v[136:139], v[124:127], v[96:99]
    ds_read_b64_tr_b16 v[182:183], v4 offset:47104
    s_waitcnt lgkmcnt(15)
    v_mfma_f32_16x16x32_bf16 v[28:31], v[140:143], v[112:115], v[28:31]
    ds_read_b64_tr_b16 v[184:185], v6 offset:40960
    v_mfma_f32_16x16x32_bf16 v[52:55], v[140:143], v[116:119], v[52:55]
    ds_read_b64_tr_b16 v[186:187], v6 offset:47104
    v_mfma_f32_16x16x32_bf16 v[76:79], v[140:143], v[120:123], v[76:79]
    ds_read_b64_tr_b16 v[188:189], v13 offset:40960
    v_mfma_f32_16x16x32_bf16 v[100:103], v[140:143], v[124:127], v[100:103]
    ds_read_b64_tr_b16 v[190:191], v13 offset:47104
    s_waitcnt lgkmcnt(15)
    v_mfma_f32_16x16x32_bf16 v[32:35], v[144:147], v[112:115], v[32:35]
    v_mfma_f32_16x16x32_bf16 v[56:59], v[144:147], v[116:119], v[56:59]
    v_mfma_f32_16x16x32_bf16 v[80:83], v[144:147], v[120:123], v[80:83]
    v_mfma_f32_16x16x32_bf16 v[104:107], v[144:147], v[124:127], v[104:107]
    v_mfma_f32_16x16x32_bf16 v[36:39], v[148:151], v[112:115], v[36:39]
    v_mfma_f32_16x16x32_bf16 v[60:63], v[148:151], v[116:119], v[60:63]
    v_mfma_f32_16x16x32_bf16 v[84:87], v[148:151], v[120:123], v[84:87]
    v_mfma_f32_16x16x32_bf16 v[108:111], v[148:151], v[124:127], v[108:111]
    s_waitcnt lgkmcnt(0)
    v_mfma_f32_16x16x32_bf16 v[16:19], v[168:171], v[152:155], v[16:19]
    s_barrier
    v_mfma_f32_16x16x32_bf16 v[40:43], v[168:171], v[156:159], v[40:43]
    v_add_u32 v1, 0xffff1000, v1
    v_add_u32 v2, 0xffff1000, v2
    v_add_u32 v3, 0xffff1000, v3
    v_add_u32 v4, 0xffff1000, v4
    v_add_u32 v5, 0xffff1000, v5
    v_add_u32 v6, 0xffff1000, v6
    v_add_u32 v13, 0xffff1000, v13
    ds_read_b128 v[112:115], v5 offset:0
    v_mfma_f32_16x16x32_bf16 v[64:67], v[168:171], v[160:163], v[64:67]
    ds_read_b128 v[116:119], v5 offset:1024
    v_mfma_f32_16x16x32_bf16 v[88:91], v[168:171], v[164:167], v[88:91]
    ds_read_b128 v[120:123], v5 offset:2048
    v_mfma_f32_16x16x32_bf16 v[20:23], v[172:175], v[152:155], v[20:23]
    ds_read_b128 v[124:127], v5 offset:3072
    v_mfma_f32_16x16x32_bf16 v[44:47], v[172:175], v[156:159], v[44:47]
    ds_read_b64_tr_b16 v[128:129], v1 offset:0
    v_mfma_f32_16x16x32_bf16 v[68:71], v[172:175], v[160:163], v[68:71]
    ds_read_b64_tr_b16 v[130:131], v1 offset:6144
    v_mfma_f32_16x16x32_bf16 v[92:95], v[172:175], v[164:167], v[92:95]
    ds_read_b64_tr_b16 v[132:133], v2 offset:0
    v_mfma_f32_16x16x32_bf16 v[24:27], v[176:179], v[152:155], v[24:27]
    ds_read_b64_tr_b16 v[134:135], v2 offset:6144
    v_mfma_f32_16x16x32_bf16 v[48:51], v[176:179], v[156:159], v[48:51]
    ds_read_b64_tr_b16 v[136:137], v3 offset:0
    v_mfma_f32_16x16x32_bf16 v[72:75], v[176:179], v[160:163], v[72:75]
    ds_read_b64_tr_b16 v[138:139], v3 offset:6144
    v_mfma_f32_16x16x32_bf16 v[96:99], v[176:179], v[164:167], v[96:99]
    ds_read_b64_tr_b16 v[140:141], v4 offset:0
    v_mfma_f32_16x16x32_bf16 v[28:31], v[180:183], v[152:155], v[28:31]
    ds_read_b64_tr_b16 v[142:143], v4 offset:6144
    v_mfma_f32_16x16x32_bf16 v[52:55], v[180:183], v[156:159], v[52:55]
    ds_read_b64_tr_b16 v[144:145], v6 offset:0
    v_mfma_f32_16x16x32_bf16 v[76:79], v[180:183], v[160:163], v[76:79]
    ds_read_b64_tr_b16 v[146:147], v6 offset:6144
    v_mfma_f32_16x16x32_bf16 v[100:103], v[180:183], v[164:167], v[100:103]
    ds_read_b64_tr_b16 v[148:149], v13 offset:0
    v_mfma_f32_16x16x32_bf16 v[32:35], v[184:187], v[152:155], v[32:35]
    ds_read_b64_tr_b16 v[150:151], v13 offset:6144
    v_mfma_f32_16x16x32_bf16 v[56:59], v[184:187], v[156:159], v[56:59]
    v_mfma_f32_16x16x32_bf16 v[80:83], v[184:187], v[160:163], v[80:83]
    v_mfma_f32_16x16x32_bf16 v[104:107], v[184:187], v[164:167], v[104:107]
    v_mfma_f32_16x16x32_bf16 v[36:39], v[188:191], v[152:155], v[36:39]
    v_mfma_f32_16x16x32_bf16 v[60:63], v[188:191], v[156:159], v[60:63]
    v_mfma_f32_16x16x32_bf16 v[84:87], v[188:191], v[160:163], v[84:87]
    v_mfma_f32_16x16x32_bf16 v[108:111], v[188:191], v[164:167], v[108:111]
    s_waitcnt lgkmcnt(10)
    v_mfma_f32_16x16x32_bf16 v[16:19], v[128:131], v[112:115], v[16:19]
    ds_read_b128 v[152:155], v5 offset:20480
    v_mfma_f32_16x16x32_bf16 v[40:43], v[128:131], v[116:119], v[40:43]
    ds_read_b128 v[156:159], v5 offset:21504
    v_mfma_f32_16x16x32_bf16 v[64:67], v[128:131], v[120:123], v[64:67]
    ds_read_b128 v[160:163], v5 offset:22528
    v_mfma_f32_16x16x32_bf16 v[88:91], v[128:131], v[124:127], v[88:91]
    ds_read_b128 v[164:167], v5 offset:23552
    s_waitcnt lgkmcnt(12)
    v_mfma_f32_16x16x32_bf16 v[20:23], v[132:135], v[112:115], v[20:23]
    ds_read_b64_tr_b16 v[168:169], v1 offset:20480
    v_mfma_f32_16x16x32_bf16 v[44:47], v[132:135], v[116:119], v[44:47]
    ds_read_b64_tr_b16 v[170:171], v1 offset:26624
    v_mfma_f32_16x16x32_bf16 v[68:71], v[132:135], v[120:123], v[68:71]
    ds_read_b64_tr_b16 v[172:173], v2 offset:20480
    v_mfma_f32_16x16x32_bf16 v[92:95], v[132:135], v[124:127], v[92:95]
    ds_read_b64_tr_b16 v[174:175], v2 offset:26624
    s_waitcnt lgkmcnt(14)
    v_mfma_f32_16x16x32_bf16 v[24:27], v[136:139], v[112:115], v[24:27]
    ds_read_b64_tr_b16 v[176:177], v3 offset:20480
    v_mfma_f32_16x16x32_bf16 v[48:51], v[136:139], v[116:119], v[48:51]
    ds_read_b64_tr_b16 v[178:179], v3 offset:26624
    v_mfma_f32_16x16x32_bf16 v[72:75], v[136:139], v[120:123], v[72:75]
    ds_read_b64_tr_b16 v[180:181], v4 offset:20480
    v_mfma_f32_16x16x32_bf16 v[96:99], v[136:139], v[124:127], v[96:99]
    ds_read_b64_tr_b16 v[182:183], v4 offset:26624
    s_waitcnt lgkmcnt(15)
    v_mfma_f32_16x16x32_bf16 v[28:31], v[140:143], v[112:115], v[28:31]
    ds_read_b64_tr_b16 v[184:185], v6 offset:20480
    v_mfma_f32_16x16x32_bf16 v[52:55], v[140:143], v[116:119], v[52:55]
    ds_read_b64_tr_b16 v[186:187], v6 offset:26624
    v_mfma_f32_16x16x32_bf16 v[76:79], v[140:143], v[120:123], v[76:79]
    ds_read_b64_tr_b16 v[188:189], v13 offset:20480
    v_mfma_f32_16x16x32_bf16 v[100:103], v[140:143], v[124:127], v[100:103]
    ds_read_b64_tr_b16 v[190:191], v13 offset:26624
    s_waitcnt lgkmcnt(15)
    v_mfma_f32_16x16x32_bf16 v[32:35], v[144:147], v[112:115], v[32:35]
    v_mfma_f32_16x16x32_bf16 v[56:59], v[144:147], v[116:119], v[56:59]
    v_mfma_f32_16x16x32_bf16 v[80:83], v[144:147], v[120:123], v[80:83]
    v_mfma_f32_16x16x32_bf16 v[104:107], v[144:147], v[124:127], v[104:107]
    v_mfma_f32_16x16x32_bf16 v[36:39], v[148:151], v[112:115], v[36:39]
    v_mfma_f32_16x16x32_bf16 v[60:63], v[148:151], v[116:119], v[60:63]
    v_mfma_f32_16x16x32_bf16 v[84:87], v[148:151], v[120:123], v[84:87]
    v_mfma_f32_16x16x32_bf16 v[108:111], v[148:151], v[124:127], v[108:111]
    s_waitcnt lgkmcnt(0)
    v_mfma_f32_16x16x32_bf16 v[16:19], v[168:171], v[152:155], v[16:19]
    s_barrier
    v_mfma_f32_16x16x32_bf16 v[40:43], v[168:171], v[156:159], v[40:43]
    ds_read_b128 v[112:115], v5 offset:40960
    v_mfma_f32_16x16x32_bf16 v[64:67], v[168:171], v[160:163], v[64:67]
    ds_read_b128 v[116:119], v5 offset:41984
    v_mfma_f32_16x16x32_bf16 v[88:91], v[168:171], v[164:167], v[88:91]
    ds_read_b128 v[120:123], v5 offset:43008
    v_mfma_f32_16x16x32_bf16 v[20:23], v[172:175], v[152:155], v[20:23]
    ds_read_b128 v[124:127], v5 offset:44032
    v_mfma_f32_16x16x32_bf16 v[44:47], v[172:175], v[156:159], v[44:47]
    ds_read_b64_tr_b16 v[128:129], v1 offset:40960
    v_mfma_f32_16x16x32_bf16 v[68:71], v[172:175], v[160:163], v[68:71]
    ds_read_b64_tr_b16 v[130:131], v1 offset:47104
    v_mfma_f32_16x16x32_bf16 v[92:95], v[172:175], v[164:167], v[92:95]
    ds_read_b64_tr_b16 v[132:133], v2 offset:40960
    v_mfma_f32_16x16x32_bf16 v[24:27], v[176:179], v[152:155], v[24:27]
    ds_read_b64_tr_b16 v[134:135], v2 offset:47104
    v_mfma_f32_16x16x32_bf16 v[48:51], v[176:179], v[156:159], v[48:51]
    ds_read_b64_tr_b16 v[136:137], v3 offset:40960
    v_mfma_f32_16x16x32_bf16 v[72:75], v[176:179], v[160:163], v[72:75]
    ds_read_b64_tr_b16 v[138:139], v3 offset:47104
    v_mfma_f32_16x16x32_bf16 v[96:99], v[176:179], v[164:167], v[96:99]
    ds_read_b64_tr_b16 v[140:141], v4 offset:40960
    v_mfma_f32_16x16x32_bf16 v[28:31], v[180:183], v[152:155], v[28:31]
    ds_read_b64_tr_b16 v[142:143], v4 offset:47104
    v_mfma_f32_16x16x32_bf16 v[52:55], v[180:183], v[156:159], v[52:55]
    ds_read_b64_tr_b16 v[144:145], v6 offset:40960
    v_mfma_f32_16x16x32_bf16 v[76:79], v[180:183], v[160:163], v[76:79]
    ds_read_b64_tr_b16 v[146:147], v6 offset:47104
    v_mfma_f32_16x16x32_bf16 v[100:103], v[180:183], v[164:167], v[100:103]
    ds_read_b64_tr_b16 v[148:149], v13 offset:40960
    v_mfma_f32_16x16x32_bf16 v[32:35], v[184:187], v[152:155], v[32:35]
    ds_read_b64_tr_b16 v[150:151], v13 offset:47104
    v_mfma_f32_16x16x32_bf16 v[56:59], v[184:187], v[156:159], v[56:59]
    v_mfma_f32_16x16x32_bf16 v[80:83], v[184:187], v[160:163], v[80:83]
    v_mfma_f32_16x16x32_bf16 v[104:107], v[184:187], v[164:167], v[104:107]
    v_mfma_f32_16x16x32_bf16 v[36:39], v[188:191], v[152:155], v[36:39]
    v_mfma_f32_16x16x32_bf16 v[60:63], v[188:191], v[156:159], v[60:63]
    v_mfma_f32_16x16x32_bf16 v[84:87], v[188:191], v[160:163], v[84:87]
    v_mfma_f32_16x16x32_bf16 v[108:111], v[188:191], v[164:167], v[108:111]
    s_waitcnt lgkmcnt(10)
    v_mfma_f32_16x16x32_bf16 v[16:19], v[128:131], v[112:115], v[16:19]
    v_add_u32 v1, 0xf000, v1
    v_add_u32 v2, 0xf000, v2
    v_add_u32 v3, 0xf000, v3
    v_add_u32 v4, 0xf000, v4
    v_add_u32 v5, 0xf000, v5
    v_add_u32 v6, 0xf000, v6
    v_add_u32 v13, 0xf000, v13
    ds_read_b128 v[152:155], v5 offset:0
    v_mfma_f32_16x16x32_bf16 v[40:43], v[128:131], v[116:119], v[40:43]
    ds_read_b128 v[156:159], v5 offset:1024
    v_mfma_f32_16x16x32_bf16 v[64:67], v[128:131], v[120:123], v[64:67]
    ds_read_b128 v[160:163], v5 offset:2048
    v_mfma_f32_16x16x32_bf16 v[88:91], v[128:131], v[124:127], v[88:91]
    ds_read_b128 v[164:167], v5 offset:3072
    s_waitcnt lgkmcnt(12)
    v_mfma_f32_16x16x32_bf16 v[20:23], v[132:135], v[112:115], v[20:23]
    ds_read_b64_tr_b16 v[168:169], v1 offset:0
    v_mfma_f32_16x16x32_bf16 v[44:47], v[132:135], v[116:119], v[44:47]
    ds_read_b64_tr_b16 v[170:171], v1 offset:6144
    v_mfma_f32_16x16x32_bf16 v[68:71], v[132:135], v[120:123], v[68:71]
    ds_read_b64_tr_b16 v[172:173], v2 offset:0
    v_mfma_f32_16x16x32_bf16 v[92:95], v[132:135], v[124:127], v[92:95]
    ds_read_b64_tr_b16 v[174:175], v2 offset:6144
    s_waitcnt lgkmcnt(14)
    v_mfma_f32_16x16x32_bf16 v[24:27], v[136:139], v[112:115], v[24:27]
    ds_read_b64_tr_b16 v[176:177], v3 offset:0
    v_mfma_f32_16x16x32_bf16 v[48:51], v[136:139], v[116:119], v[48:51]
    ds_read_b64_tr_b16 v[178:179], v3 offset:6144
    v_mfma_f32_16x16x32_bf16 v[72:75], v[136:139], v[120:123], v[72:75]
    ds_read_b64_tr_b16 v[180:181], v4 offset:0
    v_mfma_f32_16x16x32_bf16 v[96:99], v[136:139], v[124:127], v[96:99]
    ds_read_b64_tr_b16 v[182:183], v4 offset:6144
    s_waitcnt lgkmcnt(15)
    v_mfma_f32_16x16x32_bf16 v[28:31], v[140:143], v[112:115], v[28:31]
    ds_read_b64_tr_b16 v[184:185], v6 offset:0
    v_mfma_f32_16x16x32_bf16 v[52:55], v[140:143], v[116:119], v[52:55]
    ds_read_b64_tr_b16 v[186:187], v6 offset:6144
    v_mfma_f32_16x16x32_bf16 v[76:79], v[140:143], v[120:123], v[76:79]
    ds_read_b64_tr_b16 v[188:189], v13 offset:0
    v_mfma_f32_16x16x32_bf16 v[100:103], v[140:143], v[124:127], v[100:103]
    ds_read_b64_tr_b16 v[190:191], v13 offset:6144
    s_waitcnt lgkmcnt(15)
    v_mfma_f32_16x16x32_bf16 v[32:35], v[144:147], v[112:115], v[32:35]
    v_mfma_f32_16x16x32_bf16 v[56:59], v[144:147], v[116:119], v[56:59]
    v_mfma_f32_16x16x32_bf16 v[80:83], v[144:147], v[120:123], v[80:83]
    v_mfma_f32_16x16x32_bf16 v[104:107], v[144:147], v[124:127], v[104:107]
    v_mfma_f32_16x16x32_bf16 v[36:39], v[148:151], v[112:115], v[36:39]
    v_mfma_f32_16x16x32_bf16 v[60:63], v[148:151], v[116:119], v[60:63]
    v_mfma_f32_16x16x32_bf16 v[84:87], v[148:151], v[120:123], v[84:87]
    v_mfma_f32_16x16x32_bf16 v[108:111], v[148:151], v[124:127], v[108:111]
    s_waitcnt lgkmcnt(0)
    v_mfma_f32_16x16x32_bf16 v[16:19], v[168:171], v[152:155], v[16:19]
    s_barrier
    v_mfma_f32_16x16x32_bf16 v[40:43], v[168:171], v[156:159], v[40:43]
    ds_read_b128 v[112:115], v5 offset:20480
    v_mfma_f32_16x16x32_bf16 v[64:67], v[168:171], v[160:163], v[64:67]
    ds_read_b128 v[116:119], v5 offset:21504
    v_mfma_f32_16x16x32_bf16 v[88:91], v[168:171], v[164:167], v[88:91]
    ds_read_b128 v[120:123], v5 offset:22528
    v_mfma_f32_16x16x32_bf16 v[20:23], v[172:175], v[152:155], v[20:23]
    ds_read_b128 v[124:127], v5 offset:23552
    v_mfma_f32_16x16x32_bf16 v[44:47], v[172:175], v[156:159], v[44:47]
    ds_read_b64_tr_b16 v[128:129], v1 offset:20480
    v_mfma_f32_16x16x32_bf16 v[68:71], v[172:175], v[160:163], v[68:71]
    ds_read_b64_tr_b16 v[130:131], v1 offset:26624
    v_mfma_f32_16x16x32_bf16 v[92:95], v[172:175], v[164:167], v[92:95]
    ds_read_b64_tr_b16 v[132:133], v2 offset:20480
    v_mfma_f32_16x16x32_bf16 v[24:27], v[176:179], v[152:155], v[24:27]
    ds_read_b64_tr_b16 v[134:135], v2 offset:26624
    v_mfma_f32_16x16x32_bf16 v[48:51], v[176:179], v[156:159], v[48:51]
    ds_read_b64_tr_b16 v[136:137], v3 offset:20480
    v_mfma_f32_16x16x32_bf16 v[72:75], v[176:179], v[160:163], v[72:75]
    ds_read_b64_tr_b16 v[138:139], v3 offset:26624
    v_mfma_f32_16x16x32_bf16 v[96:99], v[176:179], v[164:167], v[96:99]
    ds_read_b64_tr_b16 v[140:141], v4 offset:20480
    v_mfma_f32_16x16x32_bf16 v[28:31], v[180:183], v[152:155], v[28:31]
    ds_read_b64_tr_b16 v[142:143], v4 offset:26624
    v_mfma_f32_16x16x32_bf16 v[52:55], v[180:183], v[156:159], v[52:55]
    ds_read_b64_tr_b16 v[144:145], v6 offset:20480
    v_mfma_f32_16x16x32_bf16 v[76:79], v[180:183], v[160:163], v[76:79]
    ds_read_b64_tr_b16 v[146:147], v6 offset:26624
    v_mfma_f32_16x16x32_bf16 v[100:103], v[180:183], v[164:167], v[100:103]
    ds_read_b64_tr_b16 v[148:149], v13 offset:20480
    v_mfma_f32_16x16x32_bf16 v[32:35], v[184:187], v[152:155], v[32:35]
    ds_read_b64_tr_b16 v[150:151], v13 offset:26624
    v_mfma_f32_16x16x32_bf16 v[56:59], v[184:187], v[156:159], v[56:59]
    v_mfma_f32_16x16x32_bf16 v[80:83], v[184:187], v[160:163], v[80:83]
    v_mfma_f32_16x16x32_bf16 v[104:107], v[184:187], v[164:167], v[104:107]
    v_mfma_f32_16x16x32_bf16 v[36:39], v[188:191], v[152:155], v[36:39]
    v_mfma_f32_16x16x32_bf16 v[60:63], v[188:191], v[156:159], v[60:63]
    v_mfma_f32_16x16x32_bf16 v[84:87], v[188:191], v[160:163], v[84:87]
    v_mfma_f32_16x16x32_bf16 v[108:111], v[188:191], v[164:167], v[108:111]
    s_waitcnt lgkmcnt(10)
    v_mfma_f32_16x16x32_bf16 v[16:19], v[128:131], v[112:115], v[16:19]
    ds_read_b128 v[152:155], v5 offset:40960
    v_mfma_f32_16x16x32_bf16 v[40:43], v[128:131], v[116:119], v[40:43]
    ds_read_b128 v[156:159], v5 offset:41984
    v_mfma_f32_16x16x32_bf16 v[64:67], v[128:131], v[120:123], v[64:67]
    ds_read_b128 v[160:163], v5 offset:43008
    v_mfma_f32_16x16x32_bf16 v[88:91], v[128:131], v[124:127], v[88:91]
    ds_read_b128 v[164:167], v5 offset:44032
    s_waitcnt lgkmcnt(12)
    v_mfma_f32_16x16x32_bf16 v[20:23], v[132:135], v[112:115], v[20:23]
    ds_read_b64_tr_b16 v[168:169], v1 offset:40960
    v_mfma_f32_16x16x32_bf16 v[44:47], v[132:135], v[116:119], v[44:47]
    ds_read_b64_tr_b16 v[170:171], v1 offset:47104
    v_mfma_f32_16x16x32_bf16 v[68:71], v[132:135], v[120:123], v[68:71]
    ds_read_b64_tr_b16 v[172:173], v2 offset:40960
    v_mfma_f32_16x16x32_bf16 v[92:95], v[132:135], v[124:127], v[92:95]
    ds_read_b64_tr_b16 v[174:175], v2 offset:47104
    s_waitcnt lgkmcnt(14)
    v_mfma_f32_16x16x32_bf16 v[24:27], v[136:139], v[112:115], v[24:27]
    ds_read_b64_tr_b16 v[176:177], v3 offset:40960
    v_mfma_f32_16x16x32_bf16 v[48:51], v[136:139], v[116:119], v[48:51]
    ds_read_b64_tr_b16 v[178:179], v3 offset:47104
    v_mfma_f32_16x16x32_bf16 v[72:75], v[136:139], v[120:123], v[72:75]
    ds_read_b64_tr_b16 v[180:181], v4 offset:40960
    v_mfma_f32_16x16x32_bf16 v[96:99], v[136:139], v[124:127], v[96:99]
    ds_read_b64_tr_b16 v[182:183], v4 offset:47104
    s_waitcnt lgkmcnt(15)
    v_mfma_f32_16x16x32_bf16 v[28:31], v[140:143], v[112:115], v[28:31]
    ds_read_b64_tr_b16 v[184:185], v6 offset:40960
    v_mfma_f32_16x16x32_bf16 v[52:55], v[140:143], v[116:119], v[52:55]
    ds_read_b64_tr_b16 v[186:187], v6 offset:47104
    v_mfma_f32_16x16x32_bf16 v[76:79], v[140:143], v[120:123], v[76:79]
    ds_read_b64_tr_b16 v[188:189], v13 offset:40960
    v_mfma_f32_16x16x32_bf16 v[100:103], v[140:143], v[124:127], v[100:103]
    ds_read_b64_tr_b16 v[190:191], v13 offset:47104
    s_waitcnt lgkmcnt(15)
    v_mfma_f32_16x16x32_bf16 v[32:35], v[144:147], v[112:115], v[32:35]
    v_mfma_f32_16x16x32_bf16 v[56:59], v[144:147], v[116:119], v[56:59]
    v_mfma_f32_16x16x32_bf16 v[80:83], v[144:147], v[120:123], v[80:83]
    v_mfma_f32_16x16x32_bf16 v[104:107], v[144:147], v[124:127], v[104:107]
    v_mfma_f32_16x16x32_bf16 v[36:39], v[148:151], v[112:115], v[36:39]
    v_mfma_f32_16x16x32_bf16 v[60:63], v[148:151], v[116:119], v[60:63]
    v_mfma_f32_16x16x32_bf16 v[84:87], v[148:151], v[120:123], v[84:87]
    v_mfma_f32_16x16x32_bf16 v[108:111], v[148:151], v[124:127], v[108:111]
    s_waitcnt lgkmcnt(0)
    v_mfma_f32_16x16x32_bf16 v[16:19], v[168:171], v[152:155], v[16:19]
    s_barrier
    v_mfma_f32_16x16x32_bf16 v[40:43], v[168:171], v[156:159], v[40:43]
    v_add_u32 v1, 0xffff1000, v1
    v_add_u32 v2, 0xffff1000, v2
    v_add_u32 v3, 0xffff1000, v3
    v_add_u32 v4, 0xffff1000, v4
    v_add_u32 v5, 0xffff1000, v5
    v_add_u32 v6, 0xffff1000, v6
    v_add_u32 v13, 0xffff1000, v13
    ds_read_b128 v[112:115], v5 offset:0
    v_mfma_f32_16x16x32_bf16 v[64:67], v[168:171], v[160:163], v[64:67]
    ds_read_b128 v[116:119], v5 offset:1024
    v_mfma_f32_16x16x32_bf16 v[88:91], v[168:171], v[164:167], v[88:91]
    ds_read_b128 v[120:123], v5 offset:2048
    v_mfma_f32_16x16x32_bf16 v[20:23], v[172:175], v[152:155], v[20:23]
    ds_read_b128 v[124:127], v5 offset:3072
    v_mfma_f32_16x16x32_bf16 v[44:47], v[172:175], v[156:159], v[44:47]
    ds_read_b64_tr_b16 v[128:129], v1 offset:0
    v_mfma_f32_16x16x32_bf16 v[68:71], v[172:175], v[160:163], v[68:71]
    ds_read_b64_tr_b16 v[130:131], v1 offset:6144
    v_mfma_f32_16x16x32_bf16 v[92:95], v[172:175], v[164:167], v[92:95]
    ds_read_b64_tr_b16 v[132:133], v2 offset:0
    v_mfma_f32_16x16x32_bf16 v[24:27], v[176:179], v[152:155], v[24:27]
    ds_read_b64_tr_b16 v[134:135], v2 offset:6144
    v_mfma_f32_16x16x32_bf16 v[48:51], v[176:179], v[156:159], v[48:51]
    ds_read_b64_tr_b16 v[136:137], v3 offset:0
    v_mfma_f32_16x16x32_bf16 v[72:75], v[176:179], v[160:163], v[72:75]
    ds_read_b64_tr_b16 v[138:139], v3 offset:6144
    v_mfma_f32_16x16x32_bf16 v[96:99], v[176:179], v[164:167], v[96:99]
    ds_read_b64_tr_b16 v[140:141], v4 offset:0
    v_mfma_f32_16x16x32_bf16 v[28:31], v[180:183], v[152:155], v[28:31]
    ds_read_b64_tr_b16 v[142:143], v4 offset:6144
    v_mfma_f32_16x16x32_bf16 v[52:55], v[180:183], v[156:159], v[52:55]
    ds_read_b64_tr_b16 v[144:145], v6 offset:0
    v_mfma_f32_16x16x32_bf16 v[76:79], v[180:183], v[160:163], v[76:79]
    ds_read_b64_tr_b16 v[146:147], v6 offset:6144
    v_mfma_f32_16x16x32_bf16 v[100:103], v[180:183], v[164:167], v[100:103]
    ds_read_b64_tr_b16 v[148:149], v13 offset:0
    v_mfma_f32_16x16x32_bf16 v[32:35], v[184:187], v[152:155], v[32:35]
    ds_read_b64_tr_b16 v[150:151], v13 offset:6144
    v_mfma_f32_16x16x32_bf16 v[56:59], v[184:187], v[156:159], v[56:59]
    v_mfma_f32_16x16x32_bf16 v[80:83], v[184:187], v[160:163], v[80:83]
    v_mfma_f32_16x16x32_bf16 v[104:107], v[184:187], v[164:167], v[104:107]
    v_mfma_f32_16x16x32_bf16 v[36:39], v[188:191], v[152:155], v[36:39]
    v_mfma_f32_16x16x32_bf16 v[60:63], v[188:191], v[156:159], v[60:63]
    v_mfma_f32_16x16x32_bf16 v[84:87], v[188:191], v[160:163], v[84:87]
    v_mfma_f32_16x16x32_bf16 v[108:111], v[188:191], v[164:167], v[108:111]
    s_waitcnt lgkmcnt(10)
    v_mfma_f32_16x16x32_bf16 v[16:19], v[128:131], v[112:115], v[16:19]
    ds_read_b128 v[152:155], v5 offset:20480
    v_mfma_f32_16x16x32_bf16 v[40:43], v[128:131], v[116:119], v[40:43]
    ds_read_b128 v[156:159], v5 offset:21504
    v_mfma_f32_16x16x32_bf16 v[64:67], v[128:131], v[120:123], v[64:67]
    ds_read_b128 v[160:163], v5 offset:22528
    v_mfma_f32_16x16x32_bf16 v[88:91], v[128:131], v[124:127], v[88:91]
    ds_read_b128 v[164:167], v5 offset:23552
    s_waitcnt lgkmcnt(12)
    v_mfma_f32_16x16x32_bf16 v[20:23], v[132:135], v[112:115], v[20:23]
    ds_read_b64_tr_b16 v[168:169], v1 offset:20480
    v_mfma_f32_16x16x32_bf16 v[44:47], v[132:135], v[116:119], v[44:47]
    ds_read_b64_tr_b16 v[170:171], v1 offset:26624
    v_mfma_f32_16x16x32_bf16 v[68:71], v[132:135], v[120:123], v[68:71]
    ds_read_b64_tr_b16 v[172:173], v2 offset:20480
    v_mfma_f32_16x16x32_bf16 v[92:95], v[132:135], v[124:127], v[92:95]
    ds_read_b64_tr_b16 v[174:175], v2 offset:26624
    s_waitcnt lgkmcnt(14)
    v_mfma_f32_16x16x32_bf16 v[24:27], v[136:139], v[112:115], v[24:27]
    ds_read_b64_tr_b16 v[176:177], v3 offset:20480
    v_mfma_f32_16x16x32_bf16 v[48:51], v[136:139], v[116:119], v[48:51]
    ds_read_b64_tr_b16 v[178:179], v3 offset:26624
    v_mfma_f32_16x16x32_bf16 v[72:75], v[136:139], v[120:123], v[72:75]
    ds_read_b64_tr_b16 v[180:181], v4 offset:20480
    v_mfma_f32_16x16x32_bf16 v[96:99], v[136:139], v[124:127], v[96:99]
    ds_read_b64_tr_b16 v[182:183], v4 offset:26624
    s_waitcnt lgkmcnt(15)
    v_mfma_f32_16x16x32_bf16 v[28:31], v[140:143], v[112:115], v[28:31]
    ds_read_b64_tr_b16 v[184:185], v6 offset:20480
    v_mfma_f32_16x16x32_bf16 v[52:55], v[140:143], v[116:119], v[52:55]
    ds_read_b64_tr_b16 v[186:187], v6 offset:26624
    v_mfma_f32_16x16x32_bf16 v[76:79], v[140:143], v[120:123], v[76:79]
    ds_read_b64_tr_b16 v[188:189], v13 offset:20480
    v_mfma_f32_16x16x32_bf16 v[100:103], v[140:143], v[124:127], v[100:103]
    ds_read_b64_tr_b16 v[190:191], v13 offset:26624
    s_waitcnt lgkmcnt(15)
    v_mfma_f32_16x16x32_bf16 v[32:35], v[144:147], v[112:115], v[32:35]
    v_mfma_f32_16x16x32_bf16 v[56:59], v[144:147], v[116:119], v[56:59]
    v_mfma_f32_16x16x32_bf16 v[80:83], v[144:147], v[120:123], v[80:83]
    v_mfma_f32_16x16x32_bf16 v[104:107], v[144:147], v[124:127], v[104:107]
    v_mfma_f32_16x16x32_bf16 v[36:39], v[148:151], v[112:115], v[36:39]
    v_mfma_f32_16x16x32_bf16 v[60:63], v[148:151], v[116:119], v[60:63]
    v_mfma_f32_16x16x32_bf16 v[84:87], v[148:151], v[120:123], v[84:87]
    v_mfma_f32_16x16x32_bf16 v[108:111], v[148:151], v[124:127], v[108:111]
    s_waitcnt lgkmcnt(0)
    v_mfma_f32_16x16x32_bf16 v[16:19], v[168:171], v[152:155], v[16:19]
    s_barrier
    v_mfma_f32_16x16x32_bf16 v[40:43], v[168:171], v[156:159], v[40:43]
    ds_read_b128 v[112:115], v5 offset:40960
    v_mfma_f32_16x16x32_bf16 v[64:67], v[168:171], v[160:163], v[64:67]
    ds_read_b128 v[116:119], v5 offset:41984
    v_mfma_f32_16x16x32_bf16 v[88:91], v[168:171], v[164:167], v[88:91]
    ds_read_b128 v[120:123], v5 offset:43008
    v_mfma_f32_16x16x32_bf16 v[20:23], v[172:175], v[152:155], v[20:23]
    ds_read_b128 v[124:127], v5 offset:44032
    v_mfma_f32_16x16x32_bf16 v[44:47], v[172:175], v[156:159], v[44:47]
    ds_read_b64_tr_b16 v[128:129], v1 offset:40960
    v_mfma_f32_16x16x32_bf16 v[68:71], v[172:175], v[160:163], v[68:71]
    ds_read_b64_tr_b16 v[130:131], v1 offset:47104
    v_mfma_f32_16x16x32_bf16 v[92:95], v[172:175], v[164:167], v[92:95]
    ds_read_b64_tr_b16 v[132:133], v2 offset:40960
    v_mfma_f32_16x16x32_bf16 v[24:27], v[176:179], v[152:155], v[24:27]
    ds_read_b64_tr_b16 v[134:135], v2 offset:47104
    v_mfma_f32_16x16x32_bf16 v[48:51], v[176:179], v[156:159], v[48:51]
    ds_read_b64_tr_b16 v[136:137], v3 offset:40960
    v_mfma_f32_16x16x32_bf16 v[72:75], v[176:179], v[160:163], v[72:75]
    ds_read_b64_tr_b16 v[138:139], v3 offset:47104
    v_mfma_f32_16x16x32_bf16 v[96:99], v[176:179], v[164:167], v[96:99]
    ds_read_b64_tr_b16 v[140:141], v4 offset:40960
    v_mfma_f32_16x16x32_bf16 v[28:31], v[180:183], v[152:155], v[28:31]
    ds_read_b64_tr_b16 v[142:143], v4 offset:47104
    v_mfma_f32_16x16x32_bf16 v[52:55], v[180:183], v[156:159], v[52:55]
    ds_read_b64_tr_b16 v[144:145], v6 offset:40960
    v_mfma_f32_16x16x32_bf16 v[76:79], v[180:183], v[160:163], v[76:79]
    ds_read_b64_tr_b16 v[146:147], v6 offset:47104
    v_mfma_f32_16x16x32_bf16 v[100:103], v[180:183], v[164:167], v[100:103]
    ds_read_b64_tr_b16 v[148:149], v13 offset:40960
    v_mfma_f32_16x16x32_bf16 v[32:35], v[184:187], v[152:155], v[32:35]
    ds_read_b64_tr_b16 v[150:151], v13 offset:47104
    v_mfma_f32_16x16x32_bf16 v[56:59], v[184:187], v[156:159], v[56:59]
    v_mfma_f32_16x16x32_bf16 v[80:83], v[184:187], v[160:163], v[80:83]
    v_mfma_f32_16x16x32_bf16 v[104:107], v[184:187], v[164:167], v[104:107]
    v_mfma_f32_16x16x32_bf16 v[36:39], v[188:191], v[152:155], v[36:39]
    v_mfma_f32_16x16x32_bf16 v[60:63], v[188:191], v[156:159], v[60:63]
    v_mfma_f32_16x16x32_bf16 v[84:87], v[188:191], v[160:163], v[84:87]
    v_mfma_f32_16x16x32_bf16 v[108:111], v[188:191], v[164:167], v[108:111]
    s_waitcnt lgkmcnt(10)
    v_mfma_f32_16x16x32_bf16 v[16:19], v[128:131], v[112:115], v[16:19]
    v_add_u32 v1, 0xf000, v1
    v_add_u32 v2, 0xf000, v2
    v_add_u32 v3, 0xf000, v3
    v_add_u32 v4, 0xf000, v4
    v_add_u32 v5, 0xf000, v5
    v_add_u32 v6, 0xf000, v6
    v_add_u32 v13, 0xf000, v13
    ds_read_b128 v[152:155], v5 offset:0
    v_mfma_f32_16x16x32_bf16 v[40:43], v[128:131], v[116:119], v[40:43]
    ds_read_b128 v[156:159], v5 offset:1024
    v_mfma_f32_16x16x32_bf16 v[64:67], v[128:131], v[120:123], v[64:67]
    ds_read_b128 v[160:163], v5 offset:2048
    v_mfma_f32_16x16x32_bf16 v[88:91], v[128:131], v[124:127], v[88:91]
    ds_read_b128 v[164:167], v5 offset:3072
    s_waitcnt lgkmcnt(12)
    v_mfma_f32_16x16x32_bf16 v[20:23], v[132:135], v[112:115], v[20:23]
    ds_read_b64_tr_b16 v[168:169], v1 offset:0
    v_mfma_f32_16x16x32_bf16 v[44:47], v[132:135], v[116:119], v[44:47]
    ds_read_b64_tr_b16 v[170:171], v1 offset:6144
    v_mfma_f32_16x16x32_bf16 v[68:71], v[132:135], v[120:123], v[68:71]
    ds_read_b64_tr_b16 v[172:173], v2 offset:0
    v_mfma_f32_16x16x32_bf16 v[92:95], v[132:135], v[124:127], v[92:95]
    ds_read_b64_tr_b16 v[174:175], v2 offset:6144
    s_waitcnt lgkmcnt(14)
    v_mfma_f32_16x16x32_bf16 v[24:27], v[136:139], v[112:115], v[24:27]
    ds_read_b64_tr_b16 v[176:177], v3 offset:0
    v_mfma_f32_16x16x32_bf16 v[48:51], v[136:139], v[116:119], v[48:51]
    ds_read_b64_tr_b16 v[178:179], v3 offset:6144
    v_mfma_f32_16x16x32_bf16 v[72:75], v[136:139], v[120:123], v[72:75]
    ds_read_b64_tr_b16 v[180:181], v4 offset:0
    v_mfma_f32_16x16x32_bf16 v[96:99], v[136:139], v[124:127], v[96:99]
    ds_read_b64_tr_b16 v[182:183], v4 offset:6144
    s_waitcnt lgkmcnt(15)
    v_mfma_f32_16x16x32_bf16 v[28:31], v[140:143], v[112:115], v[28:31]
    ds_read_b64_tr_b16 v[184:185], v6 offset:0
    v_mfma_f32_16x16x32_bf16 v[52:55], v[140:143], v[116:119], v[52:55]
    ds_read_b64_tr_b16 v[186:187], v6 offset:6144
    v_mfma_f32_16x16x32_bf16 v[76:79], v[140:143], v[120:123], v[76:79]
    ds_read_b64_tr_b16 v[188:189], v13 offset:0
    v_mfma_f32_16x16x32_bf16 v[100:103], v[140:143], v[124:127], v[100:103]
    ds_read_b64_tr_b16 v[190:191], v13 offset:6144
    s_waitcnt lgkmcnt(15)
    v_mfma_f32_16x16x32_bf16 v[32:35], v[144:147], v[112:115], v[32:35]
    v_mfma_f32_16x16x32_bf16 v[56:59], v[144:147], v[116:119], v[56:59]
    v_mfma_f32_16x16x32_bf16 v[80:83], v[144:147], v[120:123], v[80:83]
    v_mfma_f32_16x16x32_bf16 v[104:107], v[144:147], v[124:127], v[104:107]
    v_mfma_f32_16x16x32_bf16 v[36:39], v[148:151], v[112:115], v[36:39]
    v_mfma_f32_16x16x32_bf16 v[60:63], v[148:151], v[116:119], v[60:63]
    v_mfma_f32_16x16x32_bf16 v[84:87], v[148:151], v[120:123], v[84:87]
    v_mfma_f32_16x16x32_bf16 v[108:111], v[148:151], v[124:127], v[108:111]
    buffer_load_dwordx4 v[216:219], v240, s[36:39], s58 offen offset:0
    buffer_load_dwordx4 v[220:223], v240, s[36:39], s58 offen offset:64
    buffer_load_dwordx4 v[224:227], v240, s[36:39], s58 offen offset:128
    s_waitcnt lgkmcnt(0)
    v_mfma_f32_16x16x32_bf16 v[16:19], v[168:171], v[152:155], v[16:19]
    s_barrier
    v_mfma_f32_16x16x32_bf16 v[40:43], v[168:171], v[156:159], v[40:43]
    ds_read_b128 v[112:115], v5 offset:20480
    v_mfma_f32_16x16x32_bf16 v[64:67], v[168:171], v[160:163], v[64:67]
    ds_read_b128 v[116:119], v5 offset:21504
    v_mfma_f32_16x16x32_bf16 v[88:91], v[168:171], v[164:167], v[88:91]
    ds_read_b128 v[120:123], v5 offset:22528
    v_mfma_f32_16x16x32_bf16 v[20:23], v[172:175], v[152:155], v[20:23]
    ds_read_b128 v[124:127], v5 offset:23552
    v_mfma_f32_16x16x32_bf16 v[44:47], v[172:175], v[156:159], v[44:47]
    ds_read_b64_tr_b16 v[128:129], v1 offset:20480
    v_mfma_f32_16x16x32_bf16 v[68:71], v[172:175], v[160:163], v[68:71]
    ds_read_b64_tr_b16 v[130:131], v1 offset:26624
    v_mfma_f32_16x16x32_bf16 v[92:95], v[172:175], v[164:167], v[92:95]
    ds_read_b64_tr_b16 v[132:133], v2 offset:20480
    v_mfma_f32_16x16x32_bf16 v[24:27], v[176:179], v[152:155], v[24:27]
    ds_read_b64_tr_b16 v[134:135], v2 offset:26624
    v_mfma_f32_16x16x32_bf16 v[48:51], v[176:179], v[156:159], v[48:51]
    ds_read_b64_tr_b16 v[136:137], v3 offset:20480
    v_mfma_f32_16x16x32_bf16 v[72:75], v[176:179], v[160:163], v[72:75]
    ds_read_b64_tr_b16 v[138:139], v3 offset:26624
    v_mfma_f32_16x16x32_bf16 v[96:99], v[176:179], v[164:167], v[96:99]
    ds_read_b64_tr_b16 v[140:141], v4 offset:20480
    v_mfma_f32_16x16x32_bf16 v[28:31], v[180:183], v[152:155], v[28:31]
    ds_read_b64_tr_b16 v[142:143], v4 offset:26624
    v_mfma_f32_16x16x32_bf16 v[52:55], v[180:183], v[156:159], v[52:55]
    ds_read_b64_tr_b16 v[144:145], v6 offset:20480
    v_mfma_f32_16x16x32_bf16 v[76:79], v[180:183], v[160:163], v[76:79]
    ds_read_b64_tr_b16 v[146:147], v6 offset:26624
    v_mfma_f32_16x16x32_bf16 v[100:103], v[180:183], v[164:167], v[100:103]
    ds_read_b64_tr_b16 v[148:149], v13 offset:20480
    v_mfma_f32_16x16x32_bf16 v[32:35], v[184:187], v[152:155], v[32:35]
    ds_read_b64_tr_b16 v[150:151], v13 offset:26624
    v_mfma_f32_16x16x32_bf16 v[56:59], v[184:187], v[156:159], v[56:59]
    v_mfma_f32_16x16x32_bf16 v[80:83], v[184:187], v[160:163], v[80:83]
    v_mfma_f32_16x16x32_bf16 v[104:107], v[184:187], v[164:167], v[104:107]
    v_mfma_f32_16x16x32_bf16 v[36:39], v[188:191], v[152:155], v[36:39]
    v_mfma_f32_16x16x32_bf16 v[60:63], v[188:191], v[156:159], v[60:63]
    v_mfma_f32_16x16x32_bf16 v[84:87], v[188:191], v[160:163], v[84:87]
    v_mfma_f32_16x16x32_bf16 v[108:111], v[188:191], v[164:167], v[108:111]
    s_waitcnt lgkmcnt(10)
    v_mfma_f32_16x16x32_bf16 v[16:19], v[128:131], v[112:115], v[16:19]
    ds_read_b128 v[152:155], v5 offset:40960
    v_mfma_f32_16x16x32_bf16 v[40:43], v[128:131], v[116:119], v[40:43]
    ds_read_b128 v[156:159], v5 offset:41984
    v_mfma_f32_16x16x32_bf16 v[64:67], v[128:131], v[120:123], v[64:67]
    ds_read_b128 v[160:163], v5 offset:43008
    v_mfma_f32_16x16x32_bf16 v[88:91], v[128:131], v[124:127], v[88:91]
    ds_read_b128 v[164:167], v5 offset:44032
    s_waitcnt lgkmcnt(12)
    v_mfma_f32_16x16x32_bf16 v[20:23], v[132:135], v[112:115], v[20:23]
    ds_read_b64_tr_b16 v[168:169], v1 offset:40960
    v_mfma_f32_16x16x32_bf16 v[44:47], v[132:135], v[116:119], v[44:47]
    ds_read_b64_tr_b16 v[170:171], v1 offset:47104
    v_mfma_f32_16x16x32_bf16 v[68:71], v[132:135], v[120:123], v[68:71]
    ds_read_b64_tr_b16 v[172:173], v2 offset:40960
    v_mfma_f32_16x16x32_bf16 v[92:95], v[132:135], v[124:127], v[92:95]
    ds_read_b64_tr_b16 v[174:175], v2 offset:47104
    s_waitcnt lgkmcnt(14)
    v_mfma_f32_16x16x32_bf16 v[24:27], v[136:139], v[112:115], v[24:27]
    ds_read_b64_tr_b16 v[176:177], v3 offset:40960
    v_mfma_f32_16x16x32_bf16 v[48:51], v[136:139], v[116:119], v[48:51]
    ds_read_b64_tr_b16 v[178:179], v3 offset:47104
    v_mfma_f32_16x16x32_bf16 v[72:75], v[136:139], v[120:123], v[72:75]
    ds_read_b64_tr_b16 v[180:181], v4 offset:40960
    v_mfma_f32_16x16x32_bf16 v[96:99], v[136:139], v[124:127], v[96:99]
    ds_read_b64_tr_b16 v[182:183], v4 offset:47104
    s_waitcnt lgkmcnt(15)
    v_mfma_f32_16x16x32_bf16 v[28:31], v[140:143], v[112:115], v[28:31]
    ds_read_b64_tr_b16 v[184:185], v6 offset:40960
    v_mfma_f32_16x16x32_bf16 v[52:55], v[140:143], v[116:119], v[52:55]
    ds_read_b64_tr_b16 v[186:187], v6 offset:47104
    v_mfma_f32_16x16x32_bf16 v[76:79], v[140:143], v[120:123], v[76:79]
    ds_read_b64_tr_b16 v[188:189], v13 offset:40960
    v_mfma_f32_16x16x32_bf16 v[100:103], v[140:143], v[124:127], v[100:103]
    ds_read_b64_tr_b16 v[190:191], v13 offset:47104
    s_waitcnt lgkmcnt(15)
    v_mfma_f32_16x16x32_bf16 v[32:35], v[144:147], v[112:115], v[32:35]
    v_mfma_f32_16x16x32_bf16 v[56:59], v[144:147], v[116:119], v[56:59]
    v_mfma_f32_16x16x32_bf16 v[80:83], v[144:147], v[120:123], v[80:83]
    v_mfma_f32_16x16x32_bf16 v[104:107], v[144:147], v[124:127], v[104:107]
    v_mfma_f32_16x16x32_bf16 v[36:39], v[148:151], v[112:115], v[36:39]
    v_mfma_f32_16x16x32_bf16 v[60:63], v[148:151], v[116:119], v[60:63]
    v_mfma_f32_16x16x32_bf16 v[84:87], v[148:151], v[120:123], v[84:87]
    v_mfma_f32_16x16x32_bf16 v[108:111], v[148:151], v[124:127], v[108:111]
    s_waitcnt lgkmcnt(10)
    v_mfma_f32_16x16x32_bf16 v[16:19], v[168:171], v[152:155], v[16:19]
    v_mfma_f32_16x16x32_bf16 v[40:43], v[168:171], v[156:159], v[40:43]
    v_mfma_f32_16x16x32_bf16 v[64:67], v[168:171], v[160:163], v[64:67]
    v_mfma_f32_16x16x32_bf16 v[88:91], v[168:171], v[164:167], v[88:91]
    s_waitcnt lgkmcnt(8)
    v_mfma_f32_16x16x32_bf16 v[20:23], v[172:175], v[152:155], v[20:23]
    v_mfma_f32_16x16x32_bf16 v[44:47], v[172:175], v[156:159], v[44:47]
    v_mfma_f32_16x16x32_bf16 v[68:71], v[172:175], v[160:163], v[68:71]
    v_mfma_f32_16x16x32_bf16 v[92:95], v[172:175], v[164:167], v[92:95]
    s_waitcnt lgkmcnt(6)
    v_mfma_f32_16x16x32_bf16 v[24:27], v[176:179], v[152:155], v[24:27]
    v_mfma_f32_16x16x32_bf16 v[48:51], v[176:179], v[156:159], v[48:51]
    v_mfma_f32_16x16x32_bf16 v[72:75], v[176:179], v[160:163], v[72:75]
    v_mfma_f32_16x16x32_bf16 v[96:99], v[176:179], v[164:167], v[96:99]
    s_waitcnt lgkmcnt(4)
    v_mfma_f32_16x16x32_bf16 v[28:31], v[180:183], v[152:155], v[28:31]
    v_mfma_f32_16x16x32_bf16 v[52:55], v[180:183], v[156:159], v[52:55]
    v_mfma_f32_16x16x32_bf16 v[76:79], v[180:183], v[160:163], v[76:79]
    v_mfma_f32_16x16x32_bf16 v[100:103], v[180:183], v[164:167], v[100:103]
    s_waitcnt lgkmcnt(2)
    v_mfma_f32_16x16x32_bf16 v[32:35], v[184:187], v[152:155], v[32:35]
    v_mfma_f32_16x16x32_bf16 v[56:59], v[184:187], v[156:159], v[56:59]
    v_mfma_f32_16x16x32_bf16 v[80:83], v[184:187], v[160:163], v[80:83]
    v_mfma_f32_16x16x32_bf16 v[104:107], v[184:187], v[164:167], v[104:107]
    s_waitcnt lgkmcnt(0)
    v_mfma_f32_16x16x32_bf16 v[36:39], v[188:191], v[152:155], v[36:39]
    v_mfma_f32_16x16x32_bf16 v[60:63], v[188:191], v[156:159], v[60:63]
    v_mfma_f32_16x16x32_bf16 v[84:87], v[188:191], v[160:163], v[84:87]
    v_mfma_f32_16x16x32_bf16 v[108:111], v[188:191], v[164:167], v[108:111]
K2_tailc:
    s_lshl_b32 s59, s54, 1
    s_sub_u32 s75, s51, s59
    s_mul_i32 s59, s55, 20480
    s_add_u32 s59, s59, 8192
    v_add_u32 v243, s59, v7
    v_cvt_pk_bf16_f32 v112, v16, v17
    v_cvt_pk_bf16_f32 v113, v18, v19
    v_cvt_pk_bf16_f32 v114, v20, v21
    v_cvt_pk_bf16_f32 v115, v22, v23
    s_nop 0
    v_permlane16_swap_b32 v112, v114
    v_permlane16_swap_b32 v113, v115
    s_add_u32 s59, s57, 0
    s_cmp_eq_u32 s75, 0
    s_cbranch_scc1 K2_own00
    buffer_store_dwordx4 v[112:115], v7, s[32:35], s59 offen offset:0 sc1
    s_branch K2_owd00
K2_own00:
    ds_write_b128 v243, v[112:115] offset:0
K2_owd00:
    v_cvt_pk_bf16_f32 v116, v24, v25
    v_cvt_pk_bf16_f32 v117, v26, v27
    v_cvt_pk_bf16_f32 v118, v28, v29
    v_cvt_pk_bf16_f32 v119, v30, v31
    s_nop 0
    v_permlane16_swap_b32 v116, v118
    v_permlane16_swap_b32 v117, v119
    s_cmp_eq_u32 s75, 0
    s_cbranch_scc1 K2_own01
    buffer_store_dwordx4 v[116:119], v7, s[32:35], s59 offen offset:1024 sc1
    s_branch K2_owd01
K2_own01:
    ds_write_b128 v243, v[116:119] offset:1024
K2_owd01:
    v_cvt_pk_bf16_f32 v120, v32, v33
    v_cvt_pk_bf16_f32 v121, v34, v35
    v_cvt_pk_bf16_f32 v122, v36, v37
    v_cvt_pk_bf16_f32 v123, v38, v39
    s_nop 0
    v_permlane16_swap_b32 v120, v122
    v_permlane16_swap_b32 v121, v123
    s_cmp_eq_u32 s75, 0
    s_cbranch_scc1 K2_own02
    buffer_store_dwordx4 v[120:123], v7, s[32:35], s59 offen offset:2048 sc1
    s_branch K2_owd02
K2_own02:
    ds_write_b128 v243, v[120:123] offset:2048
K2_owd02:
    v_cvt_pk_bf16_f32 v124, v40, v41
    v_cvt_pk_bf16_f32 v125, v42, v43
    v_cvt_pk_bf16_f32 v126, v44, v45
    v_cvt_pk_bf16_f32 v127, v46, v47
    s_nop 0
    v_permlane16_swap_b32 v124, v126
    v_permlane16_swap_b32 v125, v127
    s_add_u32 s59, s57, 18432
    s_cmp_eq_u32 s75, 0
    s_cbranch_scc1 K2_own10
    buffer_store_dwordx4 v[124:127], v7, s[32:35], s59 offen offset:0 sc1
    s_branch K2_owd10
K2_own10:
    ds_write_b128 v243, v[124:127] offset:40960
K2_owd10:
    v_cvt_pk_bf16_f32 v128, v48, v49
    v_cvt_pk_bf16_f32 v129, v50, v51
    v_cvt_pk_bf16_f32 v130, v52, v53
    v_cvt_pk_bf16_f32 v131, v54, v55
    s_nop 0
    v_permlane16_swap_b32 v128, v130
    v_permlane16_swap_b32 v129, v131
    s_cmp_eq_u32 s75, 0
    s_cbranch_scc1 K2_own11
    buffer_store_dwordx4 v[128:131], v7, s[32:35], s59 offen offset:1024 sc1
    s_branch K2_owd11
K2_own11:
    ds_write_b128 v243, v[128:131] offset:41984
K2_owd11:
    v_cvt_pk_bf16_f32 v132, v56, v57
    v_cvt_pk_bf16_f32 v133, v58, v59
    v_cvt_pk_bf16_f32 v134, v60, v61
    v_cvt_pk_bf16_f32 v135, v62, v63
    s_nop 0
    v_permlane16_swap_b32 v132, v134
    v_permlane16_swap_b32 v133, v135
    s_cmp_eq_u32 s75, 0
    s_cbranch_scc1 K2_own12
    buffer_store_dwordx4 v[132:135], v7, s[32:35], s59 offen offset:2048 sc1
    s_branch K2_owd12
K2_own12:
    ds_write_b128 v243, v[132:135] offset:43008
K2_owd12:
    v_cvt_pk_bf16_f32 v136, v64, v65
    v_cvt_pk_bf16_f32 v137, v66, v67
    v_cvt_pk_bf16_f32 v138, v68, v69
    v_cvt_pk_bf16_f32 v139, v70, v71
    s_nop 0
    v_permlane16_swap_b32 v136, v138
    v_permlane16_swap_b32 v137, v139
    s_add_u32 s59, s57, 36864
    s_cmp_eq_u32 s75, 1
    s_cbranch_scc1 K2_own20
    buffer_store_dwordx4 v[136:139], v7, s[32:35], s59 offen offset:0 sc1
    s_branch K2_owd20
K2_own20:
    ds_write_b128 v243, v[136:139] offset:0
K2_owd20:
    v_cvt_pk_bf16_f32 v140, v72, v73
    v_cvt_pk_bf16_f32 v141, v74, v75
    v_cvt_pk_bf16_f32 v142, v76, v77
    v_cvt_pk_bf16_f32 v143, v78, v79
    s_nop 0
    v_permlane16_swap_b32 v140, v142
    v_permlane16_swap_b32 v141, v143
    s_cmp_eq_u32 s75, 1
    s_cbranch_scc1 K2_own21
    buffer_store_dwordx4 v[140:143], v7, s[32:35], s59 offen offset:1024 sc1
    s_branch K2_owd21
K2_own21:
    ds_write_b128 v243, v[140:143] offset:1024
K2_owd21:
    v_cvt_pk_bf16_f32 v112, v80, v81
    v_cvt_pk_bf16_f32 v113, v82, v83
    v_cvt_pk_bf16_f32 v114, v84, v85
    v_cvt_pk_bf16_f32 v115, v86, v87
    s_nop 0
    v_permlane16_swap_b32 v112, v114
    v_permlane16_swap_b32 v113, v115
    s_cmp_eq_u32 s75, 1
    s_cbranch_scc1 K2_own22
    buffer_store_dwordx4 v[112:115], v7, s[32:35], s59 offen offset:2048 sc1
    s_branch K2_owd22
K2_own22:
    ds_write_b128 v243, v[112:115] offset:2048
K2_owd22:
    v_cvt_pk_bf16_f32 v116, v88, v89
    v_cvt_pk_bf16_f32 v117, v90, v91
    v_cvt_pk_bf16_f32 v118, v92, v93
    v_cvt_pk_bf16_f32 v119, v94, v95
    s_nop 0
    v_permlane16_swap_b32 v116, v118
    v_permlane16_swap_b32 v117, v119
    s_add_u32 s59, s57, 55296
    s_cmp_eq_u32 s75, 1
    s_cbranch_scc1 K2_own30
    buffer_store_dwordx4 v[116:119], v7, s[32:35], s59 offen offset:0 sc1
    s_branch K2_owd30
K2_own30:
    ds_write_b128 v243, v[116:119] offset:40960
K2_owd30:
    v_cvt_pk_bf16_f32 v120, v96, v97
    v_cvt_pk_bf16_f32 v121, v98, v99
    v_cvt_pk_bf16_f32 v122, v100, v101
    v_cvt_pk_bf16_f32 v123, v102, v103
    s_nop 0
    v_permlane16_swap_b32 v120, v122
    v_permlane16_swap_b32 v121, v123
    s_cmp_eq_u32 s75, 1
    s_cbranch_scc1 K2_own31
    buffer_store_dwordx4 v[120:123], v7, s[32:35], s59 offen offset:1024 sc1
    s_branch K2_owd31
K2_own31:
    ds_write_b128 v243, v[120:123] offset:41984
K2_owd31:
    v_cvt_pk_bf16_f32 v124, v104, v105
    v_cvt_pk_bf16_f32 v125, v106, v107
    v_cvt_pk_bf16_f32 v126, v108, v109
    v_cvt_pk_bf16_f32 v127, v110, v111
    s_nop 0
    v_permlane16_swap_b32 v124, v126
    v_permlane16_swap_b32 v125, v127
    s_cmp_eq_u32 s75, 1
    s_cbranch_scc1 K2_own32
    buffer_store_dwordx4 v[124:127], v7, s[32:35], s59 offen offset:2048 sc1
    s_branch K2_owd32
K2_own32:
    ds_write_b128 v243, v[124:127] offset:43008
K2_owd32:
    v_lshlrev_b32 v10, 9, v242
    v_lshl_add_u32 v10, v9, 4, v10
    s_lshl_b32 s59, s55, 10
    v_add_u32 v10, s59, v10
    v_lshl_add_u32 v11, v241, 11, v10
    v_mul_u32_u24 v12, 36864, v241
    v_add_u32 v12, v12, v10
    s_mov_b32 s66, 0x3f317218
    s_mov_b32 s67, s66
    s_mov_b32 s70, 0x35e38e39
    s_mov_b32 s71, s70
    s_lshl_b32 s68, s54, 31
    s_xor_b32 s68, s68, s70
    s_mov_b32 s69, s68
    s_mul_i32 s60, s52, 3
    s_add_u32 s60, s60, s53
    s_lshl_b32 s60, s60, 7
    s_add_u32 s60, s60, 37560320
    s_mul_i32 s59, s48, 20480
    s_add_u32 s59, s59, 8192
    v_add_u32 v243, s59, v7
    v_add_u32 v244, s76, v243
    v_add_u32 v245, s77, v243
    v_add_u32 v246, s78, v243
    v_mov_b32 v13, 0
    v_mov_b32 v14, 1
    s_waitcnt vmcnt(0) lgkmcnt(0)
    s_barrier
    ds_read_b128 v[16:19], v11 offset:0
    ds_read_b128 v[20:23], v11 offset:256
    ds_read_b128 v[24:27], v11 offset:20480
    ds_read_b128 v[28:31], v11 offset:20736
    ds_read_b128 v[32:35], v12 offset:4096
    ds_read_b128 v[36:39], v12 offset:4352
    ds_read_b128 v[40:43], v12 offset:24576
    ds_read_b128 v[44:47], v12 offset:24832
    ds_read_b128 v[48:51], v11 offset:43008
    ds_read_b128 v[52:55], v11 offset:43264
    ds_read_b128 v[56:59], v11 offset:63488
    ds_read_b128 v[60:63], v11 offset:63744
    ds_read_b128 v[64:67], v244
    ds_read_b128 v[80:83], v245
    ds_read_b128 v[96:99], v246
    v_lshlrev_b32 v192, 16, v216
    v_and_b32 v193, 0xffff0000, v216
    v_lshlrev_b32 v194, 16, v217
    v_and_b32 v195, 0xffff0000, v217
    v_lshlrev_b32 v196, 16, v218
    v_and_b32 v197, 0xffff0000, v218
    v_lshlrev_b32 v198, 16, v219
    v_and_b32 v199, 0xffff0000, v219
    v_lshlrev_b32 v200, 16, v220
    v_and_b32 v201, 0xffff0000, v220
    v_lshlrev_b32 v202, 16, v221
    v_and_b32 v203, 0xffff0000, v221
    v_lshlrev_b32 v204, 16, v222
    v_and_b32 v205, 0xffff0000, v222
    v_lshlrev_b32 v206, 16, v223
    v_and_b32 v207, 0xffff0000, v223
    v_lshlrev_b32 v208, 16, v224
    v_and_b32 v209, 0xffff0000, v224
    v_lshlrev_b32 v210, 16, v225
    v_and_b32 v211, 0xffff0000, v225
    v_lshlrev_b32 v212, 16, v226
    v_and_b32 v213, 0xffff0000, v226
    v_lshlrev_b32 v214, 16, v227
    v_and_b32 v215, 0xffff0000, v227
    s_waitcnt lgkmcnt(11)
    v_pk_fma_f32 v[192:193], v[16:17], s[70:71], v[192:193]
    v_pk_fma_f32 v[194:195], v[18:19], s[70:71], v[194:195]
    v_pk_fma_f32 v[196:197], v[20:21], s[70:71], v[196:197]
    v_pk_fma_f32 v[198:199], v[22:23], s[70:71], v[198:199]
    v_pk_fma_f32 v[192:193], v[24:25], s[68:69], v[192:193]
    v_pk_fma_f32 v[194:195], v[26:27], s[68:69], v[194:195]
    v_pk_fma_f32 v[196:197], v[28:29], s[68:69], v[196:197]
    v_pk_fma_f32 v[198:199], v[30:31], s[68:69], v[198:199]
    s_waitcnt lgkmcnt(7)
    v_pk_fma_f32 v[200:201], v[32:33], s[70:71], v[200:201]
    v_pk_fma_f32 v[202:203], v[34:35], s[70:71], v[202:203]
    v_pk_fma_f32 v[204:205], v[36:37], s[70:71], v[204:205]
    v_pk_fma_f32 v[206:207], v[38:39], s[70:71], v[206:207]
    v_pk_fma_f32 v[200:201], v[40:41], s[68:69], v[200:201]
    v_pk_fma_f32 v[202:203], v[42:43], s[68:69], v[202:203]
    v_pk_fma_f32 v[204:205], v[44:45], s[68:69], v[204:205]
    v_pk_fma_f32 v[206:207], v[46:47], s[68:69], v[206:207]
    s_waitcnt lgkmcnt(3)
    v_pk_fma_f32 v[208:209], v[48:49], s[70:71], v[208:209]
    v_pk_fma_f32 v[210:211], v[50:51], s[70:71], v[210:211]
    v_pk_fma_f32 v[212:213], v[52:53], s[70:71], v[212:213]
    v_pk_fma_f32 v[214:215], v[54:55], s[70:71], v[214:215]
    v_pk_fma_f32 v[208:209], v[56:57], s[68:69], v[208:209]
    v_pk_fma_f32 v[210:211], v[58:59], s[68:69], v[210:211]
    v_pk_fma_f32 v[212:213], v[60:61], s[68:69], v[212:213]
    v_pk_fma_f32 v[214:215], v[62:63], s[68:69], v[214:215]
    s_waitcnt lgkmcnt(0)
    v_lshlrev_b32 v228, 16, v64
    v_and_b32 v229, 0xffff0000, v64
    v_lshlrev_b32 v230, 16, v65
    v_and_b32 v231, 0xffff0000, v65
    v_lshlrev_b32 v232, 16, v66
    v_and_b32 v233, 0xffff0000, v66
    v_lshlrev_b32 v234, 16, v67
    v_and_b32 v235, 0xffff0000, v67
    v_pk_fma_f32 v[192:193], v[228:229], s[66:67], v[192:193]
    v_pk_fma_f32 v[194:195], v[230:231], s[66:67], v[194:195]
    v_pk_fma_f32 v[196:197], v[232:233], s[66:67], v[196:197]
    v_pk_fma_f32 v[198:199], v[234:235], s[66:67], v[198:199]
    v_lshlrev_b32 v228, 16, v80
    v_and_b32 v229, 0xffff0000, v80
    v_lshlrev_b32 v230, 16, v81
    v_and_b32 v231, 0xffff0000, v81
    v_lshlrev_b32 v232, 16, v82
    v_and_b32 v233, 0xffff0000, v82
    v_lshlrev_b32 v234, 16, v83
    v_and_b32 v235, 0xffff0000, v83
    v_pk_fma_f32 v[200:201], v[228:229], s[66:67], v[200:201]
    v_pk_fma_f32 v[202:203], v[230:231], s[66:67], v[202:203]
    v_pk_fma_f32 v[204:205], v[232:233], s[66:67], v[204:205]
    v_pk_fma_f32 v[206:207], v[234:235], s[66:67], v[206:207]
    v_lshlrev_b32 v228, 16, v96
    v_and_b32 v229, 0xffff0000, v96
    v_lshlrev_b32 v230, 16, v97
    v_and_b32 v231, 0xffff0000, v97
    v_lshlrev_b32 v232, 16, v98
    v_and_b32 v233, 0xffff0000, v98
    v_lshlrev_b32 v234, 16, v99
    v_and_b32 v235, 0xffff0000, v99
    v_pk_fma_f32 v[208:209], v[228:229], s[66:67], v[208:209]
    v_pk_fma_f32 v[210:211], v[230:231], s[66:67], v[210:211]
    v_pk_fma_f32 v[212:213], v[232:233], s[66:67], v[212:213]
    v_pk_fma_f32 v[214:215], v[234:235], s[66:67], v[214:215]
    s_add_u32 s59, s51, 1
    s_and_b32 s59, s59, 3
    s_mul_i32 s59, s59, 2359296
    s_add_u32 s80, s59, s73
    s_add_u32 s59, s51, 2
    s_and_b32 s59, s59, 3
    s_mul_i32 s59, s59, 2359296
    s_add_u32 s81, s59, s73
    s_add_u32 s59, s51, 3
    s_and_b32 s59, s59, 3
    s_mul_i32 s59, s59, 2359296
    s_add_u32 s82, s59, s73
    v_add_u32 v244, s76, v7
    v_add_u32 v245, s77, v7
    v_add_u32 v246, s78, v7
    v_mov_b32 v14, 4
    s_barrier
    buffer_load_dwordx4 v[68:71], v244, s[32:35], s80 offen sc1
    buffer_load_dwordx4 v[72:75], v244, s[32:35], s81 offen sc1
    buffer_load_dwordx4 v[76:79], v244, s[32:35], s82 offen sc1
    buffer_load_dwordx4 v[84:87], v245, s[32:35], s80 offen sc1
    buffer_load_dwordx4 v[88:91], v245, s[32:35], s81 offen sc1
    buffer_load_dwordx4 v[92:95], v245, s[32:35], s82 offen sc1
    buffer_load_dwordx4 v[100:103], v246, s[32:35], s80 offen sc1
    buffer_load_dwordx4 v[104:107], v246, s[32:35], s81 offen sc1
    buffer_load_dwordx4 v[108:111], v246, s[32:35], s82 offen sc1
    s_waitcnt vmcnt(8)
    v_lshlrev_b32 v228, 16, v68
    v_and_b32 v229, 0xffff0000, v68
    v_lshlrev_b32 v230, 16, v69
    v_and_b32 v231, 0xffff0000, v69
    v_lshlrev_b32 v232, 16, v70
    v_and_b32 v233, 0xffff0000, v70
    v_lshlrev_b32 v234, 16, v71
    v_and_b32 v235, 0xffff0000, v71
    v_pk_fma_f32 v[192:193], v[228:229], s[66:67], v[192:193]
    v_pk_fma_f32 v[194:195], v[230:231], s[66:67], v[194:195]
    v_pk_fma_f32 v[196:197], v[232:233], s[66:67], v[196:197]
    v_pk_fma_f32 v[198:199], v[234:235], s[66:67], v[198:199]
    s_waitcnt vmcnt(7)
    v_lshlrev_b32 v228, 16, v72
    v_and_b32 v229, 0xffff0000, v72
    v_lshlrev_b32 v230, 16, v73
    v_and_b32 v231, 0xffff0000, v73
    v_lshlrev_b32 v232, 16, v74
    v_and_b32 v233, 0xffff0000, v74
    v_lshlrev_b32 v234, 16, v75
    v_and_b32 v235, 0xffff0000, v75
    v_pk_fma_f32 v[192:193], v[228:229], s[66:67], v[192:193]
    v_pk_fma_f32 v[194:195], v[230:231], s[66:67], v[194:195]
    v_pk_fma_f32 v[196:197], v[232:233], s[66:67], v[196:197]
    v_pk_fma_f32 v[198:199], v[234:235], s[66:67], v[198:199]
    s_waitcnt vmcnt(6)
    v_lshlrev_b32 v228, 16, v76
    v_and_b32 v229, 0xffff0000, v76
    v_lshlrev_b32 v230, 16, v77
    v_and_b32 v231, 0xffff0000, v77
    v_lshlrev_b32 v232, 16, v78
    v_and_b32 v233, 0xffff0000, v78
    v_lshlrev_b32 v234, 16, v79
    v_and_b32 v235, 0xffff0000, v79
    v_pk_fma_f32 v[192:193], v[228:229], s[66:67], v[192:193]
    v_pk_fma_f32 v[194:195], v[230:231], s[66:67], v[194:195]
    v_pk_fma_f32 v[196:197], v[232:233], s[66:67], v[196:197]
    v_pk_fma_f32 v[198:199], v[234:235], s[66:67], v[198:199]
    v_cvt_pk_bf16_f32 v216, v192, v193
    v_cvt_pk_bf16_f32 v217, v194, v195
    v_cvt_pk_bf16_f32 v218, v196, v197
    v_cvt_pk_bf16_f32 v219, v198, v199
    buffer_store_dwordx4 v[216:219], v240, s[40:43], s58 offen offset:0
    s_waitcnt vmcnt(6)
    v_lshlrev_b32 v228, 16, v84
    v_and_b32 v229, 0xffff0000, v84
    v_lshlrev_b32 v230, 16, v85
    v_and_b32 v231, 0xffff0000, v85
    v_lshlrev_b32 v232, 16, v86
    v_and_b32 v233, 0xffff0000, v86
    v_lshlrev_b32 v234, 16, v87
    v_and_b32 v235, 0xffff0000, v87
    v_pk_fma_f32 v[200:201], v[228:229], s[66:67], v[200:201]
    v_pk_fma_f32 v[202:203], v[230:231], s[66:67], v[202:203]
    v_pk_fma_f32 v[204:205], v[232:233], s[66:67], v[204:205]
    v_pk_fma_f32 v[206:207], v[234:235], s[66:67], v[206:207]
    s_waitcnt vmcnt(5)
    v_lshlrev_b32 v228, 16, v88
    v_and_b32 v229, 0xffff0000, v88
    v_lshlrev_b32 v230, 16, v89
    v_and_b32 v231, 0xffff0000, v89
    v_lshlrev_b32 v232, 16, v90
    v_and_b32 v233, 0xffff0000, v90
    v_lshlrev_b32 v234, 16, v91
    v_and_b32 v235, 0xffff0000, v91
    v_pk_fma_f32 v[200:201], v[228:229], s[66:67], v[200:201]
    v_pk_fma_f32 v[202:203], v[230:231], s[66:67], v[202:203]
    v_pk_fma_f32 v[204:205], v[232:233], s[66:67], v[204:205]
    v_pk_fma_f32 v[206:207], v[234:235], s[66:67], v[206:207]
    s_waitcnt vmcnt(4)
    v_lshlrev_b32 v228, 16, v92
    v_and_b32 v229, 0xffff0000, v92
    v_lshlrev_b32 v230, 16, v93
    v_and_b32 v231, 0xffff0000, v93
    v_lshlrev_b32 v232, 16, v94
    v_and_b32 v233, 0xffff0000, v94
    v_lshlrev_b32 v234, 16, v95
    v_and_b32 v235, 0xffff0000, v95
    v_pk_fma_f32 v[200:201], v[228:229], s[66:67], v[200:201]
    v_pk_fma_f32 v[202:203], v[230:231], s[66:67], v[202:203]
    v_pk_fma_f32 v[204:205], v[232:233], s[66:67], v[204:205]
    v_pk_fma_f32 v[206:207], v[234:235], s[66:67], v[206:207]
    v_cvt_pk_bf16_f32 v220, v200, v201
    v_cvt_pk_bf16_f32 v221, v202, v203
    v_cvt_pk_bf16_f32 v222, v204, v205
    v_cvt_pk_bf16_f32 v223, v206, v207
    buffer_store_dwordx4 v[220:223], v240, s[40:43], s58 offen offset:64
    s_waitcnt vmcnt(4)
    v_lshlrev_b32 v228, 16, v100
    v_and_b32 v229, 0xffff0000, v100
    v_lshlrev_b32 v230, 16, v101
    v_and_b32 v231, 0xffff0000, v101
    v_lshlrev_b32 v232, 16, v102
    v_and_b32 v233, 0xffff0000, v102
    v_lshlrev_b32 v234, 16, v103
    v_and_b32 v235, 0xffff0000, v103
    v_pk_fma_f32 v[208:209], v[228:229], s[66:67], v[208:209]
    v_pk_fma_f32 v[210:211], v[230:231], s[66:67], v[210:211]
    v_pk_fma_f32 v[212:213], v[232:233], s[66:67], v[212:213]
    v_pk_fma_f32 v[214:215], v[234:235], s[66:67], v[214:215]
    s_waitcnt vmcnt(3)
    v_lshlrev_b32 v228, 16, v104
    v_and_b32 v229, 0xffff0000, v104
    v_lshlrev_b32 v230, 16, v105
    v_and_b32 v231, 0xffff0000, v105
    v_lshlrev_b32 v232, 16, v106
    v_and_b32 v233, 0xffff0000, v106
    v_lshlrev_b32 v234, 16, v107
    v_and_b32 v235, 0xffff0000, v107
    v_pk_fma_f32 v[208:209], v[228:229], s[66:67], v[208:209]
    v_pk_fma_f32 v[210:211], v[230:231], s[66:67], v[210:211]
    v_pk_fma_f32 v[212:213], v[232:233], s[66:67], v[212:213]
    v_pk_fma_f32 v[214:215], v[234:235], s[66:67], v[214:215]
    s_waitcnt vmcnt(2)
    v_lshlrev_b32 v228, 16, v108
    v_and_b32 v229, 0xffff0000, v108
    v_lshlrev_b32 v230, 16, v109
    v_and_b32 v231, 0xffff0000, v109
    v_lshlrev_b32 v232, 16, v110
    v_and_b32 v233, 0xffff0000, v110
    v_lshlrev_b32 v234, 16, v111
    v_and_b32 v235, 0xffff0000, v111
    v_pk_fma_f32 v[208:209], v[228:229], s[66:67], v[208:209]
    v_pk_fma_f32 v[210:211], v[230:231], s[66:67], v[210:211]
    v_pk_fma_f32 v[212:213], v[232:233], s[66:67], v[212:213]
    v_pk_fma_f32 v[214:215], v[234:235], s[66:67], v[214:215]
    v_cvt_pk_bf16_f32 v224, v208, v209
    v_cvt_pk_bf16_f32 v225, v210, v211
    v_cvt_pk_bf16_f32 v226, v212, v213
    v_cvt_pk_bf16_f32 v227, v214, v215
    buffer_store_dwordx4 v[224:227], v240, s[40:43], s58 offen offset:128
    s_endpgm
K2_fft:
    s_lshl_b32 s51, s49, 3
    s_add_u32 s51, s51, s50
    s_cmp_ge_u32 s48, 4
    s_cbranch_scc1 K2_fs
    v_mov_b32 v14, 0
    v_mov_b32 v15, 1
    s_waitcnt vmcnt(0)
    s_mov_b64 exec, 1
    buffer_atomic_add v15, v14, s[32:35], s98 offen sc1
    s_mov_b64 exec, -1
    s_branch K2_fs2
K2_fs:
    s_getpc_b64 s[28:29]
    s_add_u32 s28, s28, fft_tab@rel32@lo+4
    s_addc_u32 s29, s29, fft_tab@rel32@hi+12
    s_mov_b32 s30, 45056
    s_mov_b32 s31, 0x20000
    s_sub_u32 s59, s48, 4
    s_lshl_b32 s59, s59, 10
K2_tl0:
    s_mov_b32 m0, s59
    s_nop 0
    buffer_load_dwordx4 v7, s[28:31], s59 offen lds
    s_add_u32 s59, s59, 4096
    s_cmp_lt_u32 s59, 28672
    s_cbranch_scc1 K2_tl0
    s_barrier
    ds_read_b128 v[32:35], v250
    ds_read_b128 v[36:39], v250 offset:1024
    ds_read_b128 v[40:43], v250 offset:8192
    s_waitcnt lgkmcnt(0)
    buffer_store_dwordx4 v[32:35], v251, s[32:35], s14 offen sc1
    buffer_store_dwordx4 v[36:39], v251, s[32:35], s15 offen sc1
    s_cmp_lg_u32 s48, 4
    s_cbranch_scc1 K1_nexf
    buffer_store_dwordx4 v[40:43], v251, s[32:35], s10 offen sc1
K1_nexf:
    s_and_b32 s59, s2, 7
    s_lshl_b32 s59, s59, 7
    s_add_u32 s59, s59, 37576704
    v_mov_b32 v8, 160896
    v_mov_b32 v9, 1
    s_waitcnt vmcnt(0)
    s_mov_b64 exec, 1
    ds_add_rtn_u32 v10, v8, v9
    v_mov_b32 v8, 0
    s_waitcnt lgkmcnt(0)
    v_readfirstlane_b32 s23, v10
    s_nop 0
    s_cmp_lg_u32 s23, 3
    s_cbranch_scc1 K1_nsf
    buffer_atomic_add v9, v8, s[32:35], s59 offen sc1
K1_nsf:
    s_mov_b64 exec, -1
K2_fs2:
    s_cmp_ge_u32 s51, 58
    s_cbranch_scc1 K2_xpf
    s_mul_i32 s52, s51, 5
    s_cmp_lt_u32 s48, 5
    s_cbranch_scc1 K2_fft_go
    s_sub_u32 s53, s48, 5
    s_lshl_b32 s60, s53, 10
    s_add_u32 s60, s60, 28672
    s_lshr_b32 s54, s52, 2
    s_lshl_b32 s54, s54, 15
    s_add_u32 s54, s54, 21233664
    s_lshl_b32 s53, s53, 10
    s_waitcnt vmcnt(0)
    s_barrier
    s_cmp_lg_u32 s48, 5
    s_cbranch_scc1 K2_pw_d
    v_min_u32 v8, 7, v0
    v_lshlrev_b32 v8, 7, v8
    s_mov_b32 s62, 37576704
    s_mov_b32 s72, 0x40000
K2_pw:
    buffer_load_dword v15, v8, s[32:35], s62 offen sc1
    s_waitcnt vmcnt(0)
    v_cmp_ne_u32 vcc, 32, v15
    s_sub_u32 s72, s72, 1
    s_cbranch_scc1 K2_pw_d
    s_nop 2
    s_cbranch_vccz K2_pw_d
    s_sleep 10
    s_branch K2_pw
K2_pw_d:
    s_barrier
K2_wl:
    s_add_u32 m0, s53, 45056
    s_add_u32 s59, s53, s54
    buffer_load_dwordx4 v7, s[32:35], s59 offen sc1 lds
    s_add_u32 s53, s53, 3072
    s_cmp_lt_u32 s53, 65536
    s_cbranch_scc1 K2_wl
K2_tl2:
    s_mov_b32 m0, s60
    s_nop 0
    buffer_load_dwordx4 v7, s[28:31], s60 offen lds
    s_add_u32 s60, s60, 3072
    s_cmp_lt_u32 s60, 45056
    s_cbranch_scc1 K2_tl2
    s_waitcnt vmcnt(0)
    s_barrier
K2_xpf:
    s_endpgm
K2_fft_go:
    s_add_u32 s56, s52, s48
    s_cmp_gt_u32 s56, 288
    s_cbranch_scc1 K2_xpf
    s_lshr_b32 s54, s56, 1
    s_and_b32 s59, s56, 1
    s_mul_i32 s59, s59, 144
    s_add_u32 s54, s54, s59
    s_mov_b32 s61, 0
    s_cmp_eq_u32 s56, 0
    s_cselect_b32 s61, 1, s61
    s_cmp_eq_u32 s56, 288
    s_cselect_b32 s61, 2, s61
    s_cselect_b32 s54, 0, s54
    s_cselect_b32 s59, 4096, 0
    s_lshl_b32 s62, s54, 13
    s_add_u32 s57, s62, 18874368
    s_add_u32 s58, s57, 4096
    s_add_u32 s57, s57, s59
    s_cmp_lg_u32 s61, 0
    s_cselect_b32 s58, 0x10000000, s58
    v_and_b32 v2, 31, v0
    v_lshrrev_b32 v3, 5, v0
    v_lshlrev_b32 v4, 4, v3
    v_lshl_add_u32 v4, v2, 6, v4
    s_waitcnt lgkmcnt(0)
    s_barrier
    s_barrier
    buffer_load_dwordx4 v[16:19], v4, s[32:35], s57 offen offset:0 sc1
    buffer_load_dwordx4 v[32:35], v4, s[32:35], s58 offen offset:0 sc1
    buffer_load_dwordx4 v[20:23], v4, s[32:35], s57 offen offset:32 sc1
    buffer_load_dwordx4 v[36:39], v4, s[32:35], s58 offen offset:32 sc1
    buffer_load_dwordx4 v[24:27], v4, s[32:35], s57 offen offset:2048 sc1
    buffer_load_dwordx4 v[40:43], v4, s[32:35], s58 offen offset:2048 sc1
    buffer_load_dwordx4 v[28:31], v4, s[32:35], s57 offen offset:2080 sc1
    buffer_load_dwordx4 v[44:47], v4, s[32:35], s58 offen offset:2080 sc1
    v_lshrrev_b32 v5, 3, v2
    v_add_u32 v5, s56, v5
    v_and_b32 v5, 3, v5
    v_lshlrev_b32 v5, 2, v5
    v_lshl_add_u32 v5, v2, 4, v5
    v_lshl_add_u32 v5, v3, 11, v5
    s_lshr_b32 s59, s56, 2
    s_lshr_b32 s60, s52, 2
    s_sub_u32 s59, s59, s60
    s_lshl_b32 s59, s59, 15
    s_add_u32 s59, s59, 45056
    v_add_u32 v5, s59, v5
    v_and_b32 v6, 7, v2
    v_bfe_u32 v8, v2, 3, 1
    v_lshl_add_u32 v6, v8, 4, v6
    v_bfe_u32 v8, v2, 4, 1
    v_lshl_add_u32 v6, v8, 3, v6
    v_lshlrev_b32 v6, 2, v6
    v_lshl_add_u32 v6, v3, 9, v6
    s_add_u32 s62, s62, 25427968
    s_mov_b32 s64, -2.0
    s_mov_b32 s65, -2.0
    ds_read_b128 v[128:131], v7 offset:0
    ds_read_b128 v[132:135], v7 offset:1024
    ds_read_b128 v[136:139], v7 offset:2048
    ds_read_b128 v[140:143], v7 offset:3072
    ds_read_b128 v[176:179], v7 offset:12288
    ds_read_b128 v[180:183], v7 offset:13312
    ds_read_b128 v[184:187], v7 offset:14336
    ds_read_b128 v[188:191], v7 offset:15360
    ds_read_b128 v[192:195], v7 offset:16384
    ds_read_b128 v[196:199], v7 offset:17408
    ds_read_b128 v[200:203], v7 offset:18432
    ds_read_b128 v[204:207], v7 offset:19456
    s_waitcnt vmcnt(0)
    v_xor_b32 v48, 0x80008000, v16
    v_xor_b32 v49, 0x80008000, v17
    v_xor_b32 v50, 0x80008000, v18
    v_xor_b32 v51, 0x80008000, v19
    v_xor_b32 v52, 0x80008000, v20
    v_xor_b32 v53, 0x80008000, v21
    v_xor_b32 v54, 0x80008000, v22
    v_xor_b32 v55, 0x80008000, v23
    v_xor_b32 v56, 0x80008000, v24
    v_xor_b32 v57, 0x80008000, v25
    v_xor_b32 v58, 0x80008000, v26
    v_xor_b32 v59, 0x80008000, v27
    v_xor_b32 v60, 0x80008000, v28
    v_xor_b32 v61, 0x80008000, v29
    v_xor_b32 v62, 0x80008000, v30
    v_xor_b32 v63, 0x80008000, v31
    s_waitcnt lgkmcnt(8)
    v_mfma_f32_32x32x16_bf16 v[64:79], v[16:19], v[128:131], 0
    v_mfma_f32_32x32x16_bf16 v[64:79], v[32:35], v[136:139], v[64:79]
    v_mfma_f32_32x32x16_bf16 v[64:79], v[20:23], v[132:135], v[64:79]
    v_mfma_f32_32x32x16_bf16 v[64:79], v[36:39], v[140:143], v[64:79]
    v_mfma_f32_32x32x16_bf16 v[96:111], v[32:35], v[128:131], 0
    v_mfma_f32_32x32x16_bf16 v[96:111], v[48:51], v[136:139], v[96:111]
    v_mfma_f32_32x32x16_bf16 v[96:111], v[36:39], v[132:135], v[96:111]
    v_mfma_f32_32x32x16_bf16 v[96:111], v[52:55], v[140:143], v[96:111]
    v_mfma_f32_32x32x16_bf16 v[80:95], v[24:27], v[128:131], 0
    v_mfma_f32_32x32x16_bf16 v[80:95], v[40:43], v[136:139], v[80:95]
    v_mfma_f32_32x32x16_bf16 v[80:95], v[28:31], v[132:135], v[80:95]
    v_mfma_f32_32x32x16_bf16 v[80:95], v[44:47], v[140:143], v[80:95]
    v_mfma_f32_32x32x16_bf16 v[112:127], v[40:43], v[128:131], 0
    v_mfma_f32_32x32x16_bf16 v[112:127], v[56:59], v[136:139], v[112:127]
    v_mfma_f32_32x32x16_bf16 v[112:127], v[44:47], v[132:135], v[112:127]
    v_mfma_f32_32x32x16_bf16 v[112:127], v[60:63], v[140:143], v[112:127]
    s_waitcnt lgkmcnt(6)
    v_pk_mul_f32 v[8:9], v[64:65], v[176:177]
    v_pk_mul_f32 v[10:11], v[66:67], v[178:179]
    s_nop 0
    v_pk_mul_f32 v[12:13], v[96:97], v[176:177]
    v_pk_mul_f32 v[14:15], v[98:99], v[178:179]
    v_pk_fma_f32 v[8:9], v[96:97], v[180:181], v[8:9]
    v_pk_fma_f32 v[10:11], v[98:99], v[182:183], v[10:11]
    v_pk_fma_f32 v[12:13], v[64:65], v[180:181], v[12:13] neg_lo:[1,0,0] neg_hi:[1,0,0]
    v_pk_fma_f32 v[14:15], v[66:67], v[182:183], v[14:15] neg_lo:[1,0,0] neg_hi:[1,0,0]
    ds_read_b128 v[208:211], v7 offset:20480
    ds_read_b128 v[212:215], v7 offset:21504
    ds_read_b128 v[144:147], v7 offset:4096
    v_cvt_pk_bf16_f32 v16, v8, v10
    v_cvt_pk_bf16_f32 v24, v9, v11
    v_cvt_pk_bf16_f32 v32, v12, v14
    v_cvt_pk_bf16_f32 v40, v13, v15
    v_xor_b32 v48, 0x80008000, v16
    v_xor_b32 v56, 0x80008000, v24
    s_waitcnt lgkmcnt(7)
    v_pk_mul_f32 v[8:9], v[68:69], v[184:185]
    v_pk_mul_f32 v[10:11], v[70:71], v[186:187]
    v_pk_mul_f32 v[12:13], v[100:101], v[184:185]
    v_pk_mul_f32 v[14:15], v[102:103], v[186:187]
    v_pk_fma_f32 v[8:9], v[100:101], v[188:189], v[8:9]
    v_pk_fma_f32 v[10:11], v[102:103], v[190:191], v[10:11]
    v_pk_fma_f32 v[12:13], v[68:69], v[188:189], v[12:13] neg_lo:[1,0,0] neg_hi:[1,0,0]
    v_pk_fma_f32 v[14:15], v[70:71], v[190:191], v[14:15] neg_lo:[1,0,0] neg_hi:[1,0,0]
    ds_read_b128 v[216:219], v7 offset:22528
    ds_read_b128 v[220:223], v7 offset:23552
    ds_read_b128 v[148:151], v7 offset:5120
    v_cvt_pk_bf16_f32 v17, v8, v10
    v_cvt_pk_bf16_f32 v25, v9, v11
    v_cvt_pk_bf16_f32 v33, v12, v14
    v_cvt_pk_bf16_f32 v41, v13, v15
    v_xor_b32 v49, 0x80008000, v17
    v_xor_b32 v57, 0x80008000, v25
    s_waitcnt lgkmcnt(8)
    v_pk_mul_f32 v[8:9], v[72:73], v[192:193]
    v_pk_mul_f32 v[10:11], v[74:75], v[194:195]
    v_pk_mul_f32 v[12:13], v[104:105], v[192:193]
    v_pk_mul_f32 v[14:15], v[106:107], v[194:195]
    v_pk_fma_f32 v[8:9], v[104:105], v[196:197], v[8:9]
    v_pk_fma_f32 v[10:11], v[106:107], v[198:199], v[10:11]
    v_pk_fma_f32 v[12:13], v[72:73], v[196:197], v[12:13] neg_lo:[1,0,0] neg_hi:[1,0,0]
    v_pk_fma_f32 v[14:15], v[74:75], v[198:199], v[14:15] neg_lo:[1,0,0] neg_hi:[1,0,0]
    ds_read_b128 v[224:227], v7 offset:24576
    ds_read_b128 v[228:231], v7 offset:25600
    ds_read_b128 v[152:155], v7 offset:6144
    v_cvt_pk_bf16_f32 v18, v8, v10
    v_cvt_pk_bf16_f32 v26, v9, v11
    v_cvt_pk_bf16_f32 v34, v12, v14
    v_cvt_pk_bf16_f32 v42, v13, v15
    v_xor_b32 v50, 0x80008000, v18
    v_xor_b32 v58, 0x80008000, v26
    s_waitcnt lgkmcnt(9)
    v_pk_mul_f32 v[8:9], v[76:77], v[200:201]
    v_pk_mul_f32 v[10:11], v[78:79], v[202:203]
    v_pk_mul_f32 v[12:13], v[108:109], v[200:201]
    v_pk_mul_f32 v[14:15], v[110:111], v[202:203]
    v_pk_fma_f32 v[8:9], v[108:109], v[204:205], v[8:9]
    v_pk_fma_f32 v[10:11], v[110:111], v[206:207], v[10:11]
    v_pk_fma_f32 v[12:13], v[76:77], v[204:205], v[12:13] neg_lo:[1,0,0] neg_hi:[1,0,0]
    v_pk_fma_f32 v[14:15], v[78:79], v[206:207], v[14:15] neg_lo:[1,0,0] neg_hi:[1,0,0]
    ds_read_b128 v[232:235], v7 offset:26624
    ds_read_b128 v[236:239], v7 offset:27648
    ds_read_b128 v[156:159], v7 offset:7168
    v_cvt_pk_bf16_f32 v19, v8, v10
    v_cvt_pk_bf16_f32 v27, v9, v11
    v_cvt_pk_bf16_f32 v35, v12, v14
    v_cvt_pk_bf16_f32 v43, v13, v15
    v_xor_b32 v51, 0x80008000, v19
    v_xor_b32 v59, 0x80008000, v27
    s_waitcnt lgkmcnt(10)
    v_pk_mul_f32 v[8:9], v[80:81], v[208:209]
    v_pk_mul_f32 v[10:11], v[82:83], v[210:211]
    v_pk_mul_f32 v[12:13], v[112:113], v[208:209]
    v_pk_mul_f32 v[14:15], v[114:115], v[210:211]
    v_pk_fma_f32 v[8:9], v[112:113], v[212:213], v[8:9]
    v_pk_fma_f32 v[10:11], v[114:115], v[214:215], v[10:11]
    v_pk_fma_f32 v[12:13], v[80:81], v[212:213], v[12:13] neg_lo:[1,0,0] neg_hi:[1,0,0]
    v_pk_fma_f32 v[14:15], v[82:83], v[214:215], v[14:15] neg_lo:[1,0,0] neg_hi:[1,0,0]
    ds_read_b128 v[160:163], v7 offset:8192
    v_cvt_pk_bf16_f32 v20, v8, v10
    v_cvt_pk_bf16_f32 v28, v9, v11
    v_cvt_pk_bf16_f32 v36, v12, v14
    v_cvt_pk_bf16_f32 v44, v13, v15
    v_xor_b32 v52, 0x80008000, v20
    v_xor_b32 v60, 0x80008000, v28
    s_waitcnt lgkmcnt(8)
    v_pk_mul_f32 v[8:9], v[84:85], v[216:217]
    v_pk_mul_f32 v[10:11], v[86:87], v[218:219]
    v_pk_mul_f32 v[12:13], v[116:117], v[216:217]
    v_pk_mul_f32 v[14:15], v[118:119], v[218:219]
    v_pk_fma_f32 v[8:9], v[116:117], v[220:221], v[8:9]
    v_pk_fma_f32 v[10:11], v[118:119], v[222:223], v[10:11]
    v_pk_fma_f32 v[12:13], v[84:85], v[220:221], v[12:13] neg_lo:[1,0,0] neg_hi:[1,0,0]
    v_pk_fma_f32 v[14:15], v[86:87], v[222:223], v[14:15] neg_lo:[1,0,0] neg_hi:[1,0,0]
    ds_read_b128 v[164:167], v7 offset:9216
    v_cvt_pk_bf16_f32 v21, v8, v10
    v_cvt_pk_bf16_f32 v29, v9, v11
    v_cvt_pk_bf16_f32 v37, v12, v14
    v_cvt_pk_bf16_f32 v45, v13, v15
    v_xor_b32 v53, 0x80008000, v21
    v_xor_b32 v61, 0x80008000, v29
    s_waitcnt lgkmcnt(6)
    v_pk_mul_f32 v[8:9], v[88:89], v[224:225]
    v_pk_mul_f32 v[10:11], v[90:91], v[226:227]
    v_pk_mul_f32 v[12:13], v[120:121], v[224:225]
    v_pk_mul_f32 v[14:15], v[122:123], v[226:227]
    v_pk_fma_f32 v[8:9], v[120:121], v[228:229], v[8:9]
    v_pk_fma_f32 v[10:11], v[122:123], v[230:231], v[10:11]
    v_pk_fma_f32 v[12:13], v[88:89], v[228:229], v[12:13] neg_lo:[1,0,0] neg_hi:[1,0,0]
    v_pk_fma_f32 v[14:15], v[90:91], v[230:231], v[14:15] neg_lo:[1,0,0] neg_hi:[1,0,0]
    ds_read_b128 v[168:171], v7 offset:10240
    v_cvt_pk_bf16_f32 v22, v8, v10
    v_cvt_pk_bf16_f32 v30, v9, v11
    v_cvt_pk_bf16_f32 v38, v12, v14
    v_cvt_pk_bf16_f32 v46, v13, v15
    v_xor_b32 v54, 0x80008000, v22
    v_xor_b32 v62, 0x80008000, v30
    s_waitcnt lgkmcnt(4)
    v_pk_mul_f32 v[8:9], v[92:93], v[232:233]
    v_pk_mul_f32 v[10:11], v[94:95], v[234:235]
    v_pk_mul_f32 v[12:13], v[124:125], v[232:233]
    v_pk_mul_f32 v[14:15], v[126:127], v[234:235]
    v_pk_fma_f32 v[8:9], v[124:125], v[236:237], v[8:9]
    v_pk_fma_f32 v[10:11], v[126:127], v[238:239], v[10:11]
    v_pk_fma_f32 v[12:13], v[92:93], v[236:237], v[12:13] neg_lo:[1,0,0] neg_hi:[1,0,0]
    v_pk_fma_f32 v[14:15], v[94:95], v[238:239], v[14:15] neg_lo:[1,0,0] neg_hi:[1,0,0]
    ds_read_b128 v[172:175], v7 offset:11264
    v_cvt_pk_bf16_f32 v23, v8, v10
    v_cvt_pk_bf16_f32 v31, v9, v11
    v_cvt_pk_bf16_f32 v39, v12, v14
    v_cvt_pk_bf16_f32 v47, v13, v15
    v_xor_b32 v55, 0x80008000, v23
    v_xor_b32 v63, 0x80008000, v31
    s_waitcnt lgkmcnt(0)
    s_barrier
    v_mfma_f32_32x32x16_bf16 v[64:79], v[144:147], v[16:19], 0
    ds_read_b32 v180, v5 offset:0
    ds_read_b32 v181, v5 offset:512
    v_mfma_f32_32x32x16_bf16 v[64:79], v[160:163], v[32:35], v[64:79]
    ds_read_b32 v182, v5 offset:1024
    ds_read_b32 v183, v5 offset:1536
    v_mfma_f32_32x32x16_bf16 v[64:79], v[148:151], v[20:23], v[64:79]
    ds_read_b32 v188, v5 offset:4096
    ds_read_b32 v189, v5 offset:4608
    v_mfma_f32_32x32x16_bf16 v[64:79], v[164:167], v[36:39], v[64:79]
    ds_read_b32 v190, v5 offset:5120
    ds_read_b32 v191, v5 offset:5632
    v_mfma_f32_32x32x16_bf16 v[80:95], v[152:155], v[24:27], 0
    ds_read_b32 v196, v5 offset:8192
    ds_read_b32 v197, v5 offset:8704
    v_mfma_f32_32x32x16_bf16 v[80:95], v[168:171], v[40:43], v[80:95]
    ds_read_b32 v198, v5 offset:9216
    ds_read_b32 v199, v5 offset:9728
    v_mfma_f32_32x32x16_bf16 v[80:95], v[156:159], v[28:31], v[80:95]
    ds_read_b32 v204, v5 offset:12288
    ds_read_b32 v205, v5 offset:12800
    v_mfma_f32_32x32x16_bf16 v[80:95], v[172:175], v[44:47], v[80:95]
    ds_read_b32 v206, v5 offset:13312
    ds_read_b32 v207, v5 offset:13824
    v_mfma_f32_32x32x16_bf16 v[96:111], v[144:147], v[32:35], 0
    ds_read_b32 v212, v5 offset:16384
    ds_read_b32 v213, v5 offset:16896
    v_mfma_f32_32x32x16_bf16 v[96:111], v[160:163], v[48:51], v[96:111]
    ds_read_b32 v214, v5 offset:17408
    ds_read_b32 v215, v5 offset:17920
    v_mfma_f32_32x32x16_bf16 v[96:111], v[148:151], v[36:39], v[96:111]
    ds_read_b32 v220, v5 offset:20480
    ds_read_b32 v221, v5 offset:20992
    v_mfma_f32_32x32x16_bf16 v[96:111], v[164:167], v[52:55], v[96:111]
    ds_read_b32 v222, v5 offset:21504
    ds_read_b32 v223, v5 offset:22016
    v_mfma_f32_32x32x16_bf16 v[112:127], v[152:155], v[40:43], 0
    ds_read_b32 v228, v5 offset:24576
    ds_read_b32 v229, v5 offset:25088
    v_mfma_f32_32x32x16_bf16 v[112:127], v[168:171], v[56:59], v[112:127]
    ds_read_b32 v230, v5 offset:25600
    ds_read_b32 v231, v5 offset:26112
    v_mfma_f32_32x32x16_bf16 v[112:127], v[156:159], v[44:47], v[112:127]
    ds_read_b32 v236, v5 offset:28672
    ds_read_b32 v237, v5 offset:29184
    v_mfma_f32_32x32x16_bf16 v[112:127], v[172:175], v[60:63], v[112:127]
    ds_read_b32 v238, v5 offset:29696
    ds_read_b32 v239, v5 offset:30208
    v_pk_add_f32 v[64:65], v[64:65], v[80:81]
    v_pk_add_f32 v[66:67], v[66:67], v[82:83]
    v_pk_add_f32 v[68:69], v[68:69], v[84:85]
    v_pk_add_f32 v[70:71], v[70:71], v[86:87]
    v_pk_add_f32 v[72:73], v[72:73], v[88:89]
    v_pk_add_f32 v[74:75], v[74:75], v[90:91]
    v_pk_add_f32 v[76:77], v[76:77], v[92:93]
    v_pk_add_f32 v[78:79], v[78:79], v[94:95]
    v_pk_fma_f32 v[80:81], v[80:81], s[64:65], v[64:65]
    v_pk_fma_f32 v[82:83], v[82:83], s[64:65], v[66:67]
    v_pk_fma_f32 v[84:85], v[84:85], s[64:65], v[68:69]
    v_pk_fma_f32 v[86:87], v[86:87], s[64:65], v[70:71]
    v_pk_fma_f32 v[88:89], v[88:89], s[64:65], v[72:73]
    v_pk_fma_f32 v[90:91], v[90:91], s[64:65], v[74:75]
    v_pk_fma_f32 v[92:93], v[92:93], s[64:65], v[76:77]
    v_pk_fma_f32 v[94:95], v[94:95], s[64:65], v[78:79]
    v_pk_add_f32 v[96:97], v[96:97], v[112:113]
    v_pk_add_f32 v[98:99], v[98:99], v[114:115]
    v_pk_add_f32 v[100:101], v[100:101], v[116:117]
    v_pk_add_f32 v[102:103], v[102:103], v[118:119]
    v_pk_add_f32 v[104:105], v[104:105], v[120:121]
    v_pk_add_f32 v[106:107], v[106:107], v[122:123]
    v_pk_add_f32 v[108:109], v[108:109], v[124:125]
    v_pk_add_f32 v[110:111], v[110:111], v[126:127]
    v_pk_fma_f32 v[112:113], v[112:113], s[64:65], v[96:97]
    v_pk_fma_f32 v[114:115], v[114:115], s[64:65], v[98:99]
    v_pk_fma_f32 v[116:117], v[116:117], s[64:65], v[100:101]
    v_pk_fma_f32 v[118:119], v[118:119], s[64:65], v[102:103]
    v_pk_fma_f32 v[120:121], v[120:121], s[64:65], v[104:105]
    v_pk_fma_f32 v[122:123], v[122:123], s[64:65], v[106:107]
    v_pk_fma_f32 v[124:125], v[124:125], s[64:65], v[108:109]
    v_pk_fma_f32 v[126:127], v[126:127], s[64:65], v[110:111]
    s_waitcnt lgkmcnt(15)
    v_lshlrev_b32 v176, 16, v180
    v_lshlrev_b32 v177, 16, v181
    v_lshlrev_b32 v178, 16, v182
    v_lshlrev_b32 v179, 16, v183
    v_and_b32 v180, 0xffff0000, v180
    v_and_b32 v181, 0xffff0000, v181
    v_and_b32 v182, 0xffff0000, v182
    v_and_b32 v183, 0xffff0000, v183
    v_pk_mul_f32 v[8:9], v[64:65], v[176:177]
    v_pk_mul_f32 v[10:11], v[66:67], v[178:179]
    v_pk_mul_f32 v[12:13], v[96:97], v[176:177]
    v_pk_mul_f32 v[14:15], v[98:99], v[178:179]
    v_pk_fma_f32 v[8:9], v[96:97], v[180:181], v[8:9] neg_lo:[1,0,0] neg_hi:[1,0,0]
    v_pk_fma_f32 v[10:11], v[98:99], v[182:183], v[10:11] neg_lo:[1,0,0] neg_hi:[1,0,0]
    v_pk_fma_f32 v[12:13], v[64:65], v[180:181], v[12:13]
    v_pk_fma_f32 v[14:15], v[66:67], v[182:183], v[14:15]
    v_cvt_pk_bf16_f32 v16, v8, v10
    v_cvt_pk_bf16_f32 v24, v9, v11
    v_cvt_pk_bf16_f32 v32, v12, v14
    v_cvt_pk_bf16_f32 v40, v13, v15
    v_xor_b32 v48, 0x80008000, v32
    v_xor_b32 v56, 0x80008000, v40
    v_lshlrev_b32 v184, 16, v188
    v_lshlrev_b32 v185, 16, v189
    v_lshlrev_b32 v186, 16, v190
    v_lshlrev_b32 v187, 16, v191
    v_and_b32 v188, 0xffff0000, v188
    v_and_b32 v189, 0xffff0000, v189
    v_and_b32 v190, 0xffff0000, v190
    v_and_b32 v191, 0xffff0000, v191
    v_pk_mul_f32 v[8:9], v[68:69], v[184:185]
    v_pk_mul_f32 v[10:11], v[70:71], v[186:187]
    v_pk_mul_f32 v[12:13], v[100:101], v[184:185]
    v_pk_mul_f32 v[14:15], v[102:103], v[186:187]
    v_pk_fma_f32 v[8:9], v[100:101], v[188:189], v[8:9] neg_lo:[1,0,0] neg_hi:[1,0,0]
    v_pk_fma_f32 v[10:11], v[102:103], v[190:191], v[10:11] neg_lo:[1,0,0] neg_hi:[1,0,0]
    v_pk_fma_f32 v[12:13], v[68:69], v[188:189], v[12:13]
    v_pk_fma_f32 v[14:15], v[70:71], v[190:191], v[14:15]
    v_cvt_pk_bf16_f32 v17, v8, v10
    v_cvt_pk_bf16_f32 v25, v9, v11
    v_cvt_pk_bf16_f32 v33, v12, v14
    v_cvt_pk_bf16_f32 v41, v13, v15
    v_xor_b32 v49, 0x80008000, v33
    v_xor_b32 v57, 0x80008000, v41
    v_lshlrev_b32 v192, 16, v196
    v_lshlrev_b32 v193, 16, v197
    v_lshlrev_b32 v194, 16, v198
    v_lshlrev_b32 v195, 16, v199
    v_and_b32 v196, 0xffff0000, v196
    v_and_b32 v197, 0xffff0000, v197
    v_and_b32 v198, 0xffff0000, v198
    v_and_b32 v199, 0xffff0000, v199
    v_pk_mul_f32 v[8:9], v[72:73], v[192:193]
    v_pk_mul_f32 v[10:11], v[74:75], v[194:195]
    v_pk_mul_f32 v[12:13], v[104:105], v[192:193]
    v_pk_mul_f32 v[14:15], v[106:107], v[194:195]
    v_pk_fma_f32 v[8:9], v[104:105], v[196:197], v[8:9] neg_lo:[1,0,0] neg_hi:[1,0,0]
    v_pk_fma_f32 v[10:11], v[106:107], v[198:199], v[10:11] neg_lo:[1,0,0] neg_hi:[1,0,0]
    v_pk_fma_f32 v[12:13], v[72:73], v[196:197], v[12:13]
    v_pk_fma_f32 v[14:15], v[74:75], v[198:199], v[14:15]
    v_cvt_pk_bf16_f32 v18, v8, v10
    v_cvt_pk_bf16_f32 v26, v9, v11
    v_cvt_pk_bf16_f32 v34, v12, v14
    v_cvt_pk_bf16_f32 v42, v13, v15
    v_xor_b32 v50, 0x80008000, v34
    v_xor_b32 v58, 0x80008000, v42
    v_lshlrev_b32 v200, 16, v204
    v_lshlrev_b32 v201, 16, v205
    v_lshlrev_b32 v202, 16, v206
    v_lshlrev_b32 v203, 16, v207
    v_and_b32 v204, 0xffff0000, v204
    v_and_b32 v205, 0xffff0000, v205
    v_and_b32 v206, 0xffff0000, v206
    v_and_b32 v207, 0xffff0000, v207
    v_pk_mul_f32 v[8:9], v[76:77], v[200:201]
    v_pk_mul_f32 v[10:11], v[78:79], v[202:203]
    v_pk_mul_f32 v[12:13], v[108:109], v[200:201]
    v_pk_mul_f32 v[14:15], v[110:111], v[202:203]
    v_pk_fma_f32 v[8:9], v[108:109], v[204:205], v[8:9] neg_lo:[1,0,0] neg_hi:[1,0,0]
    v_pk_fma_f32 v[10:11], v[110:111], v[206:207], v[10:11] neg_lo:[1,0,0] neg_hi:[1,0,0]
    v_pk_fma_f32 v[12:13], v[76:77], v[204:205], v[12:13]
    v_pk_fma_f32 v[14:15], v[78:79], v[206:207], v[14:15]
    v_cvt_pk_bf16_f32 v19, v8, v10
    v_cvt_pk_bf16_f32 v27, v9, v11
    v_cvt_pk_bf16_f32 v35, v12, v14
    v_cvt_pk_bf16_f32 v43, v13, v15
    v_xor_b32 v51, 0x80008000, v35
    v_xor_b32 v59, 0x80008000, v43
    s_waitcnt lgkmcnt(12)
    v_lshlrev_b32 v208, 16, v212
    v_lshlrev_b32 v209, 16, v213
    v_lshlrev_b32 v210, 16, v214
    v_lshlrev_b32 v211, 16, v215
    v_and_b32 v212, 0xffff0000, v212
    v_and_b32 v213, 0xffff0000, v213
    v_and_b32 v214, 0xffff0000, v214
    v_and_b32 v215, 0xffff0000, v215
    v_pk_mul_f32 v[8:9], v[80:81], v[208:209]
    v_pk_mul_f32 v[10:11], v[82:83], v[210:211]
    v_pk_mul_f32 v[12:13], v[112:113], v[208:209]
    v_pk_mul_f32 v[14:15], v[114:115], v[210:211]
    v_pk_fma_f32 v[8:9], v[112:113], v[212:213], v[8:9] neg_lo:[1,0,0] neg_hi:[1,0,0]
    v_pk_fma_f32 v[10:11], v[114:115], v[214:215], v[10:11] neg_lo:[1,0,0] neg_hi:[1,0,0]
    v_pk_fma_f32 v[12:13], v[80:81], v[212:213], v[12:13]
    v_pk_fma_f32 v[14:15], v[82:83], v[214:215], v[14:15]
    v_cvt_pk_bf16_f32 v20, v8, v10
    v_cvt_pk_bf16_f32 v28, v9, v11
    v_cvt_pk_bf16_f32 v36, v12, v14
    v_cvt_pk_bf16_f32 v44, v13, v15
    v_xor_b32 v52, 0x80008000, v36
    v_xor_b32 v60, 0x80008000, v44
    s_waitcnt lgkmcnt(8)
    v_lshlrev_b32 v216, 16, v220
    v_lshlrev_b32 v217, 16, v221
    v_lshlrev_b32 v218, 16, v222
    v_lshlrev_b32 v219, 16, v223
    v_and_b32 v220, 0xffff0000, v220
    v_and_b32 v221, 0xffff0000, v221
    v_and_b32 v222, 0xffff0000, v222
    v_and_b32 v223, 0xffff0000, v223
    v_pk_mul_f32 v[8:9], v[84:85], v[216:217]
    v_pk_mul_f32 v[10:11], v[86:87], v[218:219]
    v_pk_mul_f32 v[12:13], v[116:117], v[216:217]
    v_pk_mul_f32 v[14:15], v[118:119], v[218:219]
    v_pk_fma_f32 v[8:9], v[116:117], v[220:221], v[8:9] neg_lo:[1,0,0] neg_hi:[1,0,0]
    v_pk_fma_f32 v[10:11], v[118:119], v[222:223], v[10:11] neg_lo:[1,0,0] neg_hi:[1,0,0]
    v_pk_fma_f32 v[12:13], v[84:85], v[220:221], v[12:13]
    v_pk_fma_f32 v[14:15], v[86:87], v[222:223], v[14:15]
    v_cvt_pk_bf16_f32 v21, v8, v10
    v_cvt_pk_bf16_f32 v29, v9, v11
    v_cvt_pk_bf16_f32 v37, v12, v14
    v_cvt_pk_bf16_f32 v45, v13, v15
    v_xor_b32 v53, 0x80008000, v37
    v_xor_b32 v61, 0x80008000, v45
    s_waitcnt lgkmcnt(4)
    v_lshlrev_b32 v224, 16, v228
    v_lshlrev_b32 v225, 16, v229
    v_lshlrev_b32 v226, 16, v230
    v_lshlrev_b32 v227, 16, v231
    v_and_b32 v228, 0xffff0000, v228
    v_and_b32 v229, 0xffff0000, v229
    v_and_b32 v230, 0xffff0000, v230
    v_and_b32 v231, 0xffff0000, v231
    v_pk_mul_f32 v[8:9], v[88:89], v[224:225]
    v_pk_mul_f32 v[10:11], v[90:91], v[226:227]
    v_pk_mul_f32 v[12:13], v[120:121], v[224:225]
    v_pk_mul_f32 v[14:15], v[122:123], v[226:227]
    v_pk_fma_f32 v[8:9], v[120:121], v[228:229], v[8:9] neg_lo:[1,0,0] neg_hi:[1,0,0]
    v_pk_fma_f32 v[10:11], v[122:123], v[230:231], v[10:11] neg_lo:[1,0,0] neg_hi:[1,0,0]
    v_pk_fma_f32 v[12:13], v[88:89], v[228:229], v[12:13]
    v_pk_fma_f32 v[14:15], v[90:91], v[230:231], v[14:15]
    v_cvt_pk_bf16_f32 v22, v8, v10
    v_cvt_pk_bf16_f32 v30, v9, v11
    v_cvt_pk_bf16_f32 v38, v12, v14
    v_cvt_pk_bf16_f32 v46, v13, v15
    v_xor_b32 v54, 0x80008000, v38
    v_xor_b32 v62, 0x80008000, v46
    s_waitcnt lgkmcnt(0)
    v_lshlrev_b32 v232, 16, v236
    v_lshlrev_b32 v233, 16, v237
    v_lshlrev_b32 v234, 16, v238
    v_lshlrev_b32 v235, 16, v239
    v_and_b32 v236, 0xffff0000, v236
    v_and_b32 v237, 0xffff0000, v237
    v_and_b32 v238, 0xffff0000, v238
    v_and_b32 v239, 0xffff0000, v239
    v_pk_mul_f32 v[8:9], v[92:93], v[232:233]
    v_pk_mul_f32 v[10:11], v[94:95], v[234:235]
    v_pk_mul_f32 v[12:13], v[124:125], v[232:233]
    v_pk_mul_f32 v[14:15], v[126:127], v[234:235]
    v_pk_fma_f32 v[8:9], v[124:125], v[236:237], v[8:9] neg_lo:[1,0,0] neg_hi:[1,0,0]
    v_pk_fma_f32 v[10:11], v[126:127], v[238:239], v[10:11] neg_lo:[1,0,0] neg_hi:[1,0,0]
    v_pk_fma_f32 v[12:13], v[92:93], v[236:237], v[12:13]
    v_pk_fma_f32 v[14:15], v[94:95], v[238:239], v[14:15]
    v_cvt_pk_bf16_f32 v23, v8, v10
    v_cvt_pk_bf16_f32 v31, v9, v11
    v_cvt_pk_bf16_f32 v39, v12, v14
    v_cvt_pk_bf16_f32 v47, v13, v15
    v_xor_b32 v55, 0x80008000, v39
    v_xor_b32 v63, 0x80008000, v47
    v_mfma_f32_32x32x16_bf16 v[64:79], v[16:19], v[144:147], 0
    ds_read_b128 v[176:179], v7 offset:28672
    ds_read_b128 v[180:183], v7 offset:29696
    v_mfma_f32_32x32x16_bf16 v[64:79], v[48:51], v[160:163], v[64:79]
    ds_read_b128 v[184:187], v7 offset:30720
    ds_read_b128 v[188:191], v7 offset:31744
    v_mfma_f32_32x32x16_bf16 v[64:79], v[20:23], v[148:151], v[64:79]
    ds_read_b128 v[192:195], v7 offset:32768
    ds_read_b128 v[196:199], v7 offset:33792
    v_mfma_f32_32x32x16_bf16 v[64:79], v[52:55], v[164:167], v[64:79]
    ds_read_b128 v[200:203], v7 offset:34816
    ds_read_b128 v[204:207], v7 offset:35840
    v_mfma_f32_32x32x16_bf16 v[80:95], v[24:27], v[152:155], 0
    ds_read_b128 v[208:211], v7 offset:36864
    ds_read_b128 v[212:215], v7 offset:37888
    v_mfma_f32_32x32x16_bf16 v[80:95], v[56:59], v[168:171], v[80:95]
    ds_read_b128 v[216:219], v7 offset:38912
    ds_read_b128 v[220:223], v7 offset:39936
    v_mfma_f32_32x32x16_bf16 v[80:95], v[28:31], v[156:159], v[80:95]
    ds_read_b128 v[224:227], v7 offset:40960
    ds_read_b128 v[228:231], v7 offset:41984
    v_mfma_f32_32x32x16_bf16 v[80:95], v[60:63], v[172:175], v[80:95]
    ds_read_b128 v[232:235], v7 offset:43008
    ds_read_b128 v[236:239], v7 offset:44032
    v_mfma_f32_32x32x16_bf16 v[96:111], v[32:35], v[144:147], 0
    v_mfma_f32_32x32x16_bf16 v[96:111], v[16:19], v[160:163], v[96:111]
    v_mfma_f32_32x32x16_bf16 v[96:111], v[36:39], v[148:151], v[96:111]
    v_mfma_f32_32x32x16_bf16 v[96:111], v[20:23], v[164:167], v[96:111]
    v_mfma_f32_32x32x16_bf16 v[112:127], v[40:43], v[152:155], 0
    v_mfma_f32_32x32x16_bf16 v[112:127], v[24:27], v[168:171], v[112:127]
    v_mfma_f32_32x32x16_bf16 v[112:127], v[44:47], v[156:159], v[112:127]
    v_mfma_f32_32x32x16_bf16 v[112:127], v[28:31], v[172:175], v[112:127]
    s_nop 1
    v_pk_add_f32 v[64:65], v[64:65], v[80:81]
    v_pk_add_f32 v[66:67], v[66:67], v[82:83]
    v_pk_add_f32 v[68:69], v[68:69], v[84:85]
    v_pk_add_f32 v[70:71], v[70:71], v[86:87]
    v_pk_add_f32 v[72:73], v[72:73], v[88:89]
    v_pk_add_f32 v[74:75], v[74:75], v[90:91]
    v_pk_add_f32 v[76:77], v[76:77], v[92:93]
    v_pk_add_f32 v[78:79], v[78:79], v[94:95]
    v_pk_fma_f32 v[80:81], v[80:81], s[64:65], v[64:65]
    v_pk_fma_f32 v[82:83], v[82:83], s[64:65], v[66:67]
    v_pk_fma_f32 v[84:85], v[84:85], s[64:65], v[68:69]
    v_pk_fma_f32 v[86:87], v[86:87], s[64:65], v[70:71]
    v_pk_fma_f32 v[88:89], v[88:89], s[64:65], v[72:73]
    v_pk_fma_f32 v[90:91], v[90:91], s[64:65], v[74:75]
    v_pk_fma_f32 v[92:93], v[92:93], s[64:65], v[76:77]
    v_pk_fma_f32 v[94:95], v[94:95], s[64:65], v[78:79]
    v_pk_add_f32 v[96:97], v[96:97], v[112:113]
    v_pk_add_f32 v[98:99], v[98:99], v[114:115]
    v_pk_add_f32 v[100:101], v[100:101], v[116:117]
    v_pk_add_f32 v[102:103], v[102:103], v[118:119]
    v_pk_add_f32 v[104:105], v[104:105], v[120:121]
    v_pk_add_f32 v[106:107], v[106:107], v[122:123]
    v_pk_add_f32 v[108:109], v[108:109], v[124:125]
    v_pk_add_f32 v[110:111], v[110:111], v[126:127]
    v_pk_fma_f32 v[112:113], v[112:113], s[64:65], v[96:97]
    v_pk_fma_f32 v[114:115], v[114:115], s[64:65], v[98:99]
    v_pk_fma_f32 v[116:117], v[116:117], s[64:65], v[100:101]
    v_pk_fma_f32 v[118:119], v[118:119], s[64:65], v[102:103]
    v_pk_fma_f32 v[120:121], v[120:121], s[64:65], v[104:105]
    v_pk_fma_f32 v[122:123], v[122:123], s[64:65], v[106:107]
    v_pk_fma_f32 v[124:125], v[124:125], s[64:65], v[108:109]
    v_pk_fma_f32 v[126:127], v[126:127], s[64:65], v[110:111]
    s_waitcnt lgkmcnt(14)
    v_pk_mul_f32 v[8:9], v[64:65], v[176:177]
    v_pk_mul_f32 v[10:11], v[66:67], v[178:179]
    v_pk_mul_f32 v[12:13], v[96:97], v[176:177]
    v_pk_mul_f32 v[14:15], v[98:99], v[178:179]
    v_pk_fma_f32 v[8:9], v[96:97], v[180:181], v[8:9] neg_lo:[1,0,0] neg_hi:[1,0,0]
    v_pk_fma_f32 v[10:11], v[98:99], v[182:183], v[10:11] neg_lo:[1,0,0] neg_hi:[1,0,0]
    v_pk_fma_f32 v[12:13], v[64:65], v[180:181], v[12:13]
    v_pk_fma_f32 v[14:15], v[66:67], v[182:183], v[14:15]
    v_cvt_pk_bf16_f32 v16, v8, v9
    v_cvt_pk_bf16_f32 v17, v10, v11
    v_cvt_pk_bf16_f32 v32, v12, v13
    v_cvt_pk_bf16_f32 v33, v14, v15
    v_xor_b32 v48, 0x80008000, v32
    v_xor_b32 v49, 0x80008000, v33
    s_waitcnt lgkmcnt(12)
    v_pk_mul_f32 v[8:9], v[68:69], v[184:185]
    v_pk_mul_f32 v[10:11], v[70:71], v[186:187]
    v_pk_mul_f32 v[12:13], v[100:101], v[184:185]
    v_pk_mul_f32 v[14:15], v[102:103], v[186:187]
    v_pk_fma_f32 v[8:9], v[100:101], v[188:189], v[8:9] neg_lo:[1,0,0] neg_hi:[1,0,0]
    v_pk_fma_f32 v[10:11], v[102:103], v[190:191], v[10:11] neg_lo:[1,0,0] neg_hi:[1,0,0]
    v_pk_fma_f32 v[12:13], v[68:69], v[188:189], v[12:13]
    v_pk_fma_f32 v[14:15], v[70:71], v[190:191], v[14:15]
    v_cvt_pk_bf16_f32 v18, v8, v9
    v_cvt_pk_bf16_f32 v19, v10, v11
    v_cvt_pk_bf16_f32 v34, v12, v13
    v_cvt_pk_bf16_f32 v35, v14, v15
    v_xor_b32 v50, 0x80008000, v34
    v_xor_b32 v51, 0x80008000, v35
    s_waitcnt lgkmcnt(10)
    v_pk_mul_f32 v[8:9], v[72:73], v[192:193]
    v_pk_mul_f32 v[10:11], v[74:75], v[194:195]
    v_pk_mul_f32 v[12:13], v[104:105], v[192:193]
    v_pk_mul_f32 v[14:15], v[106:107], v[194:195]
    v_pk_fma_f32 v[8:9], v[104:105], v[196:197], v[8:9] neg_lo:[1,0,0] neg_hi:[1,0,0]
    v_pk_fma_f32 v[10:11], v[106:107], v[198:199], v[10:11] neg_lo:[1,0,0] neg_hi:[1,0,0]
    v_pk_fma_f32 v[12:13], v[72:73], v[196:197], v[12:13]
    v_pk_fma_f32 v[14:15], v[74:75], v[198:199], v[14:15]
    v_cvt_pk_bf16_f32 v20, v8, v9
    v_cvt_pk_bf16_f32 v21, v10, v11
    v_cvt_pk_bf16_f32 v36, v12, v13
    v_cvt_pk_bf16_f32 v37, v14, v15
    v_xor_b32 v52, 0x80008000, v36
    v_xor_b32 v53, 0x80008000, v37
    s_waitcnt lgkmcnt(8)
    v_pk_mul_f32 v[8:9], v[76:77], v[200:201]
    v_pk_mul_f32 v[10:11], v[78:79], v[202:203]
    v_pk_mul_f32 v[12:13], v[108:109], v[200:201]
    v_pk_mul_f32 v[14:15], v[110:111], v[202:203]
    v_pk_fma_f32 v[8:9], v[108:109], v[204:205], v[8:9] neg_lo:[1,0,0] neg_hi:[1,0,0]
    v_pk_fma_f32 v[10:11], v[110:111], v[206:207], v[10:11] neg_lo:[1,0,0] neg_hi:[1,0,0]
    v_pk_fma_f32 v[12:13], v[76:77], v[204:205], v[12:13]
    v_pk_fma_f32 v[14:15], v[78:79], v[206:207], v[14:15]
    v_cvt_pk_bf16_f32 v22, v8, v9
    v_cvt_pk_bf16_f32 v23, v10, v11
    v_cvt_pk_bf16_f32 v38, v12, v13
    v_cvt_pk_bf16_f32 v39, v14, v15
    v_xor_b32 v54, 0x80008000, v38
    v_xor_b32 v55, 0x80008000, v39
    s_waitcnt lgkmcnt(6)
    v_pk_mul_f32 v[8:9], v[80:81], v[208:209]
    v_pk_mul_f32 v[10:11], v[82:83], v[210:211]
    v_pk_mul_f32 v[12:13], v[112:113], v[208:209]
    v_pk_mul_f32 v[14:15], v[114:115], v[210:211]
    v_pk_fma_f32 v[8:9], v[112:113], v[212:213], v[8:9] neg_lo:[1,0,0] neg_hi:[1,0,0]
    v_pk_fma_f32 v[10:11], v[114:115], v[214:215], v[10:11] neg_lo:[1,0,0] neg_hi:[1,0,0]
    v_pk_fma_f32 v[12:13], v[80:81], v[212:213], v[12:13]
    v_pk_fma_f32 v[14:15], v[82:83], v[214:215], v[14:15]
    v_cvt_pk_bf16_f32 v24, v8, v9
    v_cvt_pk_bf16_f32 v25, v10, v11
    v_cvt_pk_bf16_f32 v40, v12, v13
    v_cvt_pk_bf16_f32 v41, v14, v15
    v_xor_b32 v56, 0x80008000, v40
    v_xor_b32 v57, 0x80008000, v41
    s_waitcnt lgkmcnt(4)
    v_pk_mul_f32 v[8:9], v[84:85], v[216:217]
    v_pk_mul_f32 v[10:11], v[86:87], v[218:219]
    v_pk_mul_f32 v[12:13], v[116:117], v[216:217]
    v_pk_mul_f32 v[14:15], v[118:119], v[218:219]
    v_pk_fma_f32 v[8:9], v[116:117], v[220:221], v[8:9] neg_lo:[1,0,0] neg_hi:[1,0,0]
    v_pk_fma_f32 v[10:11], v[118:119], v[222:223], v[10:11] neg_lo:[1,0,0] neg_hi:[1,0,0]
    v_pk_fma_f32 v[12:13], v[84:85], v[220:221], v[12:13]
    v_pk_fma_f32 v[14:15], v[86:87], v[222:223], v[14:15]
    v_cvt_pk_bf16_f32 v26, v8, v9
    v_cvt_pk_bf16_f32 v27, v10, v11
    v_cvt_pk_bf16_f32 v42, v12, v13
    v_cvt_pk_bf16_f32 v43, v14, v15
    v_xor_b32 v58, 0x80008000, v42
    v_xor_b32 v59, 0x80008000, v43
    s_waitcnt lgkmcnt(2)
    v_pk_mul_f32 v[8:9], v[88:89], v[224:225]
    v_pk_mul_f32 v[10:11], v[90:91], v[226:227]
    v_pk_mul_f32 v[12:13], v[120:121], v[224:225]
    v_pk_mul_f32 v[14:15], v[122:123], v[226:227]
    v_pk_fma_f32 v[8:9], v[120:121], v[228:229], v[8:9] neg_lo:[1,0,0] neg_hi:[1,0,0]
    v_pk_fma_f32 v[10:11], v[122:123], v[230:231], v[10:11] neg_lo:[1,0,0] neg_hi:[1,0,0]
    v_pk_fma_f32 v[12:13], v[88:89], v[228:229], v[12:13]
    v_pk_fma_f32 v[14:15], v[90:91], v[230:231], v[14:15]
    v_cvt_pk_bf16_f32 v28, v8, v9
    v_cvt_pk_bf16_f32 v29, v10, v11
    v_cvt_pk_bf16_f32 v44, v12, v13
    v_cvt_pk_bf16_f32 v45, v14, v15
    v_xor_b32 v60, 0x80008000, v44
    v_xor_b32 v61, 0x80008000, v45
    s_waitcnt lgkmcnt(0)
    v_pk_mul_f32 v[8:9], v[92:93], v[232:233]
    v_pk_mul_f32 v[10:11], v[94:95], v[234:235]
    v_pk_mul_f32 v[12:13], v[124:125], v[232:233]
    v_pk_mul_f32 v[14:15], v[126:127], v[234:235]
    v_pk_fma_f32 v[8:9], v[124:125], v[236:237], v[8:9] neg_lo:[1,0,0] neg_hi:[1,0,0]
    v_pk_fma_f32 v[10:11], v[126:127], v[238:239], v[10:11] neg_lo:[1,0,0] neg_hi:[1,0,0]
    v_pk_fma_f32 v[12:13], v[92:93], v[236:237], v[12:13]
    v_pk_fma_f32 v[14:15], v[94:95], v[238:239], v[14:15]
    v_cvt_pk_bf16_f32 v30, v8, v9
    v_cvt_pk_bf16_f32 v31, v10, v11
    v_cvt_pk_bf16_f32 v46, v12, v13
    v_cvt_pk_bf16_f32 v47, v14, v15
    v_xor_b32 v62, 0x80008000, v46
    v_xor_b32 v63, 0x80008000, v47
    s_add_u32 s63, s62, 4096
    s_cmp_lg_u32 s61, 0
    s_cbranch_scc1 K2_fft_spw
    v_mfma_f32_32x32x16_bf16 v[64:79], v[16:19], v[128:131], 0
    v_mfma_f32_32x32x16_bf16 v[64:79], v[48:51], v[136:139], v[64:79]
    v_mfma_f32_32x32x16_bf16 v[64:79], v[20:23], v[132:135], v[64:79]
    v_mfma_f32_32x32x16_bf16 v[64:79], v[52:55], v[140:143], v[64:79]
    v_mfma_f32_32x32x16_bf16 v[96:111], v[32:35], v[128:131], 0
    v_mfma_f32_32x32x16_bf16 v[96:111], v[16:19], v[136:139], v[96:111]
    v_mfma_f32_32x32x16_bf16 v[96:111], v[36:39], v[132:135], v[96:111]
    v_mfma_f32_32x32x16_bf16 v[96:111], v[20:23], v[140:143], v[96:111]
    v_mfma_f32_32x32x16_bf16 v[80:95], v[24:27], v[128:131], 0
    v_mfma_f32_32x32x16_bf16 v[80:95], v[56:59], v[136:139], v[80:95]
    s_nop 9
    v_cvt_pk_bf16_f32 v176, v64, v96
    buffer_store_dword v176, v6, s[32:35], s62 offen offset:0 sc1
    v_cvt_pk_bf16_f32 v177, v65, v97
    buffer_store_dword v177, v6, s[32:35], s62 offen offset:128 sc1
    v_mfma_f32_32x32x16_bf16 v[80:95], v[28:31], v[132:135], v[80:95]
    v_cvt_pk_bf16_f32 v178, v66, v98
    buffer_store_dword v178, v6, s[32:35], s62 offen offset:256 sc1
    v_cvt_pk_bf16_f32 v179, v67, v99
    buffer_store_dword v179, v6, s[32:35], s62 offen offset:384 sc1
    v_mfma_f32_32x32x16_bf16 v[80:95], v[60:63], v[140:143], v[80:95]
    v_cvt_pk_bf16_f32 v180, v68, v100
    buffer_store_dword v180, v6, s[32:35], s62 offen offset:1024 sc1
    v_cvt_pk_bf16_f32 v181, v69, v101
    buffer_store_dword v181, v6, s[32:35], s62 offen offset:1152 sc1
    v_mfma_f32_32x32x16_bf16 v[112:127], v[40:43], v[128:131], 0
    v_cvt_pk_bf16_f32 v182, v70, v102
    buffer_store_dword v182, v6, s[32:35], s62 offen offset:1280 sc1
    v_cvt_pk_bf16_f32 v183, v71, v103
    buffer_store_dword v183, v6, s[32:35], s62 offen offset:1408 sc1
    v_mfma_f32_32x32x16_bf16 v[112:127], v[24:27], v[136:139], v[112:127]
    v_cvt_pk_bf16_f32 v184, v72, v104
    buffer_store_dword v184, v6, s[32:35], s62 offen offset:2048 sc1
    v_cvt_pk_bf16_f32 v185, v73, v105
    buffer_store_dword v185, v6, s[32:35], s62 offen offset:2176 sc1
    v_mfma_f32_32x32x16_bf16 v[112:127], v[44:47], v[132:135], v[112:127]
    v_cvt_pk_bf16_f32 v186, v74, v106
    buffer_store_dword v186, v6, s[32:35], s62 offen offset:2304 sc1
    v_cvt_pk_bf16_f32 v187, v75, v107
    buffer_store_dword v187, v6, s[32:35], s62 offen offset:2432 sc1
    v_mfma_f32_32x32x16_bf16 v[112:127], v[28:31], v[140:143], v[112:127]
    v_cvt_pk_bf16_f32 v188, v76, v108
    buffer_store_dword v188, v6, s[32:35], s62 offen offset:3072 sc1
    v_cvt_pk_bf16_f32 v189, v77, v109
    buffer_store_dword v189, v6, s[32:35], s62 offen offset:3200 sc1
    v_cvt_pk_bf16_f32 v190, v78, v110
    buffer_store_dword v190, v6, s[32:35], s62 offen offset:3328 sc1
    v_cvt_pk_bf16_f32 v191, v79, v111
    buffer_store_dword v191, v6, s[32:35], s62 offen offset:3456 sc1
    s_nop 3
    v_cvt_pk_bf16_f32 v192, v80, v112
    buffer_store_dword v192, v6, s[32:35], s63 offen offset:0 sc1
    v_cvt_pk_bf16_f32 v193, v81, v113
    buffer_store_dword v193, v6, s[32:35], s63 offen offset:128 sc1
    v_cvt_pk_bf16_f32 v194, v82, v114
    buffer_store_dword v194, v6, s[32:35], s63 offen offset:256 sc1
    v_cvt_pk_bf16_f32 v195, v83, v115
    buffer_store_dword v195, v6, s[32:35], s63 offen offset:384 sc1
    v_cvt_pk_bf16_f32 v196, v84, v116
    buffer_store_dword v196, v6, s[32:35], s63 offen offset:1024 sc1
    v_cvt_pk_bf16_f32 v197, v85, v117
    buffer_store_dword v197, v6, s[32:35], s63 offen offset:1152 sc1
    v_cvt_pk_bf16_f32 v198, v86, v118
    buffer_store_dword v198, v6, s[32:35], s63 offen offset:1280 sc1
    v_cvt_pk_bf16_f32 v199, v87, v119
    buffer_store_dword v199, v6, s[32:35], s63 offen offset:1408 sc1
    v_cvt_pk_bf16_f32 v200, v88, v120
    buffer_store_dword v200, v6, s[32:35], s63 offen offset:2048 sc1
    v_cvt_pk_bf16_f32 v201, v89, v121
    buffer_store_dword v201, v6, s[32:35], s63 offen offset:2176 sc1
    v_cvt_pk_bf16_f32 v202, v90, v122
    buffer_store_dword v202, v6, s[32:35], s63 offen offset:2304 sc1
    v_cvt_pk_bf16_f32 v203, v91, v123
    buffer_store_dword v203, v6, s[32:35], s63 offen offset:2432 sc1
    v_cvt_pk_bf16_f32 v204, v92, v124
    buffer_store_dword v204, v6, s[32:35], s63 offen offset:3072 sc1
    v_cvt_pk_bf16_f32 v205, v93, v125
    buffer_store_dword v205, v6, s[32:35], s63 offen offset:3200 sc1
    v_cvt_pk_bf16_f32 v206, v94, v126
    buffer_store_dword v206, v6, s[32:35], s63 offen offset:3328 sc1
    v_cvt_pk_bf16_f32 v207, v95, v127
    buffer_store_dword v207, v6, s[32:35], s63 offen offset:3456 sc1
    s_branch K2_fft_out
K2_fft_spw:
    s_sub_u32 s59, s61, 1
    s_lshl_b32 s59, s59, 1
    v_add_u32 v6, s59, v6
    v_mfma_f32_32x32x16_bf16 v[64:79], v[16:19], v[128:131], 0
    v_mfma_f32_32x32x16_bf16 v[64:79], v[48:51], v[136:139], v[64:79]
    v_mfma_f32_32x32x16_bf16 v[64:79], v[20:23], v[132:135], v[64:79]
    v_mfma_f32_32x32x16_bf16 v[64:79], v[52:55], v[140:143], v[64:79]
    v_mfma_f32_32x32x16_bf16 v[80:95], v[24:27], v[128:131], 0
    v_mfma_f32_32x32x16_bf16 v[80:95], v[56:59], v[136:139], v[80:95]
    v_mfma_f32_32x32x16_bf16 v[80:95], v[28:31], v[132:135], v[80:95]
    v_mfma_f32_32x32x16_bf16 v[80:95], v[60:63], v[140:143], v[80:95]
    s_nop 7
    v_cvt_pk_bf16_f32 v176, v64, v64
    buffer_store_short v176, v6, s[32:35], s62 offen offset:0 sc1
    v_cvt_pk_bf16_f32 v177, v65, v65
    buffer_store_short v177, v6, s[32:35], s62 offen offset:128 sc1
    v_cvt_pk_bf16_f32 v178, v66, v66
    buffer_store_short v178, v6, s[32:35], s62 offen offset:256 sc1
    v_cvt_pk_bf16_f32 v179, v67, v67
    buffer_store_short v179, v6, s[32:35], s62 offen offset:384 sc1
    v_cvt_pk_bf16_f32 v180, v68, v68
    buffer_store_short v180, v6, s[32:35], s62 offen offset:1024 sc1
    v_cvt_pk_bf16_f32 v181, v69, v69
    buffer_store_short v181, v6, s[32:35], s62 offen offset:1152 sc1
    v_cvt_pk_bf16_f32 v182, v70, v70
    buffer_store_short v182, v6, s[32:35], s62 offen offset:1280 sc1
    v_cvt_pk_bf16_f32 v183, v71, v71
    buffer_store_short v183, v6, s[32:35], s62 offen offset:1408 sc1
    v_cvt_pk_bf16_f32 v184, v72, v72
    buffer_store_short v184, v6, s[32:35], s62 offen offset:2048 sc1
    v_cvt_pk_bf16_f32 v185, v73, v73
    buffer_store_short v185, v6, s[32:35], s62 offen offset:2176 sc1
    v_cvt_pk_bf16_f32 v186, v74, v74
    buffer_store_short v186, v6, s[32:35], s62 offen offset:2304 sc1
    v_cvt_pk_bf16_f32 v187, v75, v75
    buffer_store_short v187, v6, s[32:35], s62 offen offset:2432 sc1
    v_cvt_pk_bf16_f32 v188, v76, v76
    buffer_store_short v188, v6, s[32:35], s62 offen offset:3072 sc1
    v_cvt_pk_bf16_f32 v189, v77, v77
    buffer_store_short v189, v6, s[32:35], s62 offen offset:3200 sc1
    v_cvt_pk_bf16_f32 v190, v78, v78
    buffer_store_short v190, v6, s[32:35], s62 offen offset:3328 sc1
    v_cvt_pk_bf16_f32 v191, v79, v79
    buffer_store_short v191, v6, s[32:35], s62 offen offset:3456 sc1
    v_cvt_pk_bf16_f32 v192, v80, v80
    buffer_store_short v192, v6, s[32:35], s63 offen offset:0 sc1
    v_cvt_pk_bf16_f32 v193, v81, v81
    buffer_store_short v193, v6, s[32:35], s63 offen offset:128 sc1
    v_cvt_pk_bf16_f32 v194, v82, v82
    buffer_store_short v194, v6, s[32:35], s63 offen offset:256 sc1
    v_cvt_pk_bf16_f32 v195, v83, v83
    buffer_store_short v195, v6, s[32:35], s63 offen offset:384 sc1
    v_cvt_pk_bf16_f32 v196, v84, v84
    buffer_store_short v196, v6, s[32:35], s63 offen offset:1024 sc1
    v_cvt_pk_bf16_f32 v197, v85, v85
    buffer_store_short v197, v6, s[32:35], s63 offen offset:1152 sc1
    v_cvt_pk_bf16_f32 v198, v86, v86
    buffer_store_short v198, v6, s[32:35], s63 offen offset:1280 sc1
    v_cvt_pk_bf16_f32 v199, v87, v87
    buffer_store_short v199, v6, s[32:35], s63 offen offset:1408 sc1
    v_cvt_pk_bf16_f32 v200, v88, v88
    buffer_store_short v200, v6, s[32:35], s63 offen offset:2048 sc1
    v_cvt_pk_bf16_f32 v201, v89, v89
    buffer_store_short v201, v6, s[32:35], s63 offen offset:2176 sc1
    v_cvt_pk_bf16_f32 v202, v90, v90
    buffer_store_short v202, v6, s[32:35], s63 offen offset:2304 sc1
    v_cvt_pk_bf16_f32 v203, v91, v91
    buffer_store_short v203, v6, s[32:35], s63 offen offset:2432 sc1
    v_cvt_pk_bf16_f32 v204, v92, v92
    buffer_store_short v204, v6, s[32:35], s63 offen offset:3072 sc1
    v_cvt_pk_bf16_f32 v205, v93, v93
    buffer_store_short v205, v6, s[32:35], s63 offen offset:3200 sc1
    v_cvt_pk_bf16_f32 v206, v94, v94
    buffer_store_short v206, v6, s[32:35], s63 offen offset:3328 sc1
    v_cvt_pk_bf16_f32 v207, v95, v95
    buffer_store_short v207, v6, s[32:35], s63 offen offset:3456 sc1
K2_fft_out:
    s_and_b32 s59, s56, 7
    s_lshl_b32 s59, s59, 7
    s_add_u32 s59, s59, 37566464
    v_mov_b32 v4, 0
    v_mov_b32 v5, 1
    s_waitcnt vmcnt(0)
    s_mov_b64 exec, 1
    buffer_atomic_add v5, v4, s[32:35], s59 offen sc1
    s_mov_b64 exec, -1
K2_end:
    s_endpgm
    s_endpgm
.fill 768, 4, 0xbf810000
code_end:
    s_endpgm
.section .rodata,"a"
.p2align 6
.amdhsa_kernel parallel_sum__spectral_gfnet__dense_activation_mish__prompt_kernel
  .amdhsa_next_free_vgpr 256
  .amdhsa_next_free_sgpr 102
  .amdhsa_accum_offset 256
  .amdhsa_group_segment_fixed_size 0
  .amdhsa_kernarg_size 80
  .amdhsa_user_sgpr_count 2
  .amdhsa_user_sgpr_kernarg_segment_ptr 1
  .amdhsa_system_sgpr_workgroup_id_x 1
  .amdhsa_float_denorm_mode_32 3
  .amdhsa_float_denorm_mode_16_64 3
.end_amdhsa_kernel
.p2align 8
.type fft_tab,@object
fft_tab:
.long 0x3f803f80,0x3f803f80,0x3f803f80,0x3f803f80,0x3f7b3f80,0x3f553f6d,0xbe48248d,0xbf0ebec4
.long 0x3f6d3f80,0x3ec43f35,0xbf6dbf80,0xbec4bf35,0x3f553f80,0xbe483ec4,0x3f0ea554,0x3f7b3f6d
.long 0x3f353f80,0xbf35248d,0x3f353f80,0xbf35248d,0x3f0e3f80,0xbf7bbec4,0xbf55248d,0xbe48bf6d
.long 0x3ec43f80,0xbf6dbf35,0xbec4bf80,0x3f6d3f35,0x3e483f80,0xbf0ebf6d,0x3f7ba554,0xbf553ec4
.long 0x248d3f80,0xa554bf80,0x248d3f80,0xa554bf80,0xbe483f80,0x3f0ebf6d,0xbf7b248d,0x3f553ec4
.long 0xbec43f80,0x3f6dbf35,0x3ec4bf80,0xbf6d3f35,0xbf0e3f80,0x3f7bbec4,0x3f55a554,0x3e48bf6d
.long 0xbf353f80,0x3f35a554,0xbf353f80,0x3f35a554,0xbf553f80,0x3e483ec4,0xbf0e248d,0xbf7b3f6d
.long 0xbf6d3f80,0xbec43f35,0x3f6dbf80,0x3ec4bf35,0xbf7b3f80,0xbf553f6d,0x3e48a554,0x3f0ebec4
.long 0xbf803f80,0xbf803f80,0xbf803f80,0xbf803f80,0xbf7b3f80,0xbf553f6d,0x3e48248d,0x3f0ebec4
.long 0xbf6d3f80,0xbec43f35,0x3f6dbf80,0x3ec4bf35,0xbf553f80,0x3e483ec4,0xbf0ea554,0xbf7b3f6d
.long 0xbf353f80,0x3f35248d,0xbf353f80,0x3f35248d,0xbf0e3f80,0x3f7bbec4,0x3f55248d,0x3e48bf6d
.long 0xbec43f80,0x3f6dbf35,0x3ec4bf80,0xbf6d3f35,0xbe483f80,0x3f0ebf6d,0xbf7ba554,0x3f553ec4
.long 0xa5543f80,0x248dbf80,0xa5543f80,0x248dbf80,0x3e483f80,0xbf0ebf6d,0x3f7b248d,0xbf553ec4
.long 0x3ec43f80,0xbf6dbf35,0xbec4bf80,0x3f6d3f35,0x3f0e3f80,0xbf7bbec4,0xbf55a554,0xbe48bf6d
.long 0x3f353f80,0xbf35a554,0x3f353f80,0xbf35a554,0x3f553f80,0xbe483ec4,0x3f0e248d,0x3f7b3f6d
.long 0x3f6d3f80,0x3ec43f35,0xbf6dbf80,0xbec4bf35,0x3f7b3f80,0x3f553f6d,0xbe48a554,0xbf0ebec4
.long 0x3f803f80,0x3f803f80,0x3f803f80,0x3f803f80,0x3f0e3f35,0x3e483ec4,0xbf55bf35,0xbf7bbf6d
.long 0xbec4248d,0xbf6dbf35,0x3ec4a554,0x3f6d3f35,0xbf7bbf35,0xbf0ebf6d,0x3e483f35,0xbf55bec4
.long 0xbf35bf80,0x3f35a554,0xbf35bf80,0x3f35a554,0x3e48bf35,0x3f553f6d,0x3f7b3f35,0xbf0e3ec4
.long 0x3f6da554,0xbec43f35,0xbf6d248d,0x3ec4bf35,0x3f553f35,0xbf7bbec4,0x3f0ebf35,0xbe483f6d
.long 0x248d3f80,0xa554bf80,0x248d3f80,0xa554bf80,0xbf553f35,0x3f7bbec4,0xbf0ebf35,0x3e483f6d
.long 0xbf6d248d,0x3ec43f35,0x3f6da554,0xbec4bf35,0xbe48bf35,0xbf553f6d,0xbf7b3f35,0x3f0e3ec4
.long 0x3f35bf80,0xbf35248d,0x3f35bf80,0xbf35248d,0x3f7bbf35,0x3f0ebf6d,0xbe483f35,0x3f55bec4
.long 0x3ec4a554,0x3f6dbf35,0xbec4248d,0xbf6d3f35,0xbf0e3f35,0xbe483ec4,0x3f55bf35,0x3f7bbf6d
.long 0xbf803f80,0xbf803f80,0xbf803f80,0xbf803f80,0xbf0e3f35,0xbe483ec4,0x3f55bf35,0x3f7bbf6d
.long 0x3ec4248d,0x3f6dbf35,0xbec4a554,0xbf6d3f35,0x3f7bbf35,0x3f0ebf6d,0xbe483f35,0x3f55bec4
.long 0x3f35bf80,0xbf35a554,0x3f35bf80,0xbf35a554,0xbe48bf35,0xbf553f6d,0xbf7b3f35,0x3f0e3ec4
.long 0xbf6da554,0x3ec43f35,0x3f6d248d,0xbec4bf35,0xbf553f35,0x3f7bbec4,0xbf0ebf35,0x3e483f6d
.long 0xa5543f80,0x248dbf80,0xa5543f80,0x248dbf80,0x3f553f35,0xbf7bbec4,0x3f0ebf35,0xbe483f6d
.long 0x3f6d248d,0xbec43f35,0xbf6da554,0x3ec4bf35,0x3e48bf35,0x3f553f6d,0x3f7b3f35,0xbf0e3ec4
.long 0xbf35bf80,0x3f35248d,0xbf35bf80,0x3f35248d,0xbf7bbf35,0xbf0ebf6d,0x3e483f35,0xbf55bec4
.long 0xbec4a554,0xbf6dbf35,0x3ec4248d,0x3f6d3f35,0x3f0e3f35,0x3e483ec4,0xbf55bf35,0xbf7bbf6d
.long 0x3f803f80,0x3f803f80,0x3f803f80,0x3f803f80,0xbf7bbf80,0xbf55bf6d,0x3e48a554,0x3f0e3ec4
.long 0x3f6d3f80,0x3ec43f35,0xbf6dbf80,0xbec4bf35,0xbf55bf80,0x3e48bec4,0xbf0e248d,0xbf7bbf6d
.long 0x3f353f80,0xbf35248d,0x3f353f80,0xbf35248d,0xbf0ebf80,0x3f7b3ec4,0x3f55a554,0x3e483f6d
.long 0x3ec43f80,0xbf6dbf35,0xbec4bf80,0x3f6d3f35,0xbe48bf80,0x3f0e3f6d,0xbf7b248d,0x3f55bec4
.long 0x248d3f80,0xa554bf80,0x248d3f80,0xa554bf80,0x3e48bf80,0xbf0e3f6d,0x3f7ba554,0xbf55bec4
.long 0xbec43f80,0x3f6dbf35,0x3ec4bf80,0xbf6d3f35,0x3f0ebf80,0xbf7b3ec4,0xbf55248d,0xbe483f6d
.long 0xbf353f80,0x3f35a554,0xbf353f80,0x3f35a554,0x3f55bf80,0xbe48bec4,0x3f0ea554,0x3f7bbf6d
.long 0xbf6d3f80,0xbec43f35,0x3f6dbf80,0x3ec4bf35,0x3f7bbf80,0x3f55bf6d,0xbe48248d,0xbf0e3ec4
.long 0xbf803f80,0xbf803f80,0xbf803f80,0xbf803f80,0x3f7bbf80,0x3f55bf6d,0xbe48a554,0xbf0e3ec4
.long 0xbf6d3f80,0xbec43f35,0x3f6dbf80,0x3ec4bf35,0x3f55bf80,0xbe48bec4,0x3f0e248d,0x3f7bbf6d
.long 0xbf353f80,0x3f35248d,0xbf353f80,0x3f35248d,0x3f0ebf80,0xbf7b3ec4,0xbf55a554,0xbe483f6d
.long 0xbec43f80,0x3f6dbf35,0x3ec4bf80,0xbf6d3f35,0x3e48bf80,0xbf0e3f6d,0x3f7b248d,0xbf55bec4
.long 0xa5543f80,0x248dbf80,0xa5543f80,0x248dbf80,0xbe48bf80,0x3f0e3f6d,0xbf7ba554,0x3f55bec4
.long 0x3ec43f80,0xbf6dbf35,0xbec4bf80,0x3f6d3f35,0xbf0ebf80,0x3f7b3ec4,0x3f55248d,0x3e483f6d
.long 0x3f353f80,0xbf35a554,0x3f353f80,0xbf35a554,0xbf55bf80,0x3e48bec4,0xbf0ea554,0xbf7bbf6d
.long 0x3f6d3f80,0x3ec43f35,0xbf6dbf80,0xbec4bf35,0xbf7bbf80,0xbf55bf6d,0x3e48248d,0x3f0e3ec4
.long 0x3f803f80,0x3f803f80,0x3f803f80,0x3f803f80,0xbf0ebf35,0xbe48bec4,0x3f553f35,0x3f7b3f6d
.long 0xbec4248d,0xbf6dbf35,0x3ec4a554,0x3f6d3f35,0x3f7b3f35,0x3f0e3f6d,0xbe48bf35,0x3f553ec4
.long 0xbf35bf80,0x3f35a554,0xbf35bf80,0x3f35a554,0xbe483f35,0xbf55bf6d,0xbf7bbf35,0x3f0ebec4
.long 0x3f6da554,0xbec43f35,0xbf6d248d,0x3ec4bf35,0xbf55bf35,0x3f7b3ec4,0xbf0e3f35,0x3e48bf6d
.long 0x248d3f80,0xa554bf80,0x248d3f80,0xa554bf80,0x3f55bf35,0xbf7b3ec4,0x3f0e3f35,0xbe48bf6d
.long 0xbf6d248d,0x3ec43f35,0x3f6da554,0xbec4bf35,0x3e483f35,0x3f55bf6d,0x3f7bbf35,0xbf0ebec4
.long 0x3f35bf80,0xbf35248d,0x3f35bf80,0xbf35248d,0xbf7b3f35,0xbf0e3f6d,0x3e48bf35,0xbf553ec4
.long 0x3ec4a554,0x3f6dbf35,0xbec4248d,0xbf6d3f35,0x3f0ebf35,0x3e48bec4,0xbf553f35,0xbf7b3f6d
.long 0xbf803f80,0xbf803f80,0xbf803f80,0xbf803f80,0x3f0ebf35,0x3e48bec4,0xbf553f35,0xbf7b3f6d
.long 0x3ec4248d,0x3f6dbf35,0xbec4a554,0xbf6d3f35,0xbf7b3f35,0xbf0e3f6d,0x3e48bf35,0xbf553ec4
.long 0x3f35bf80,0xbf35a554,0x3f35bf80,0xbf35a554,0x3e483f35,0x3f55bf6d,0x3f7bbf35,0xbf0ebec4
.long 0xbf6da554,0x3ec43f35,0x3f6d248d,0xbec4bf35,0x3f55bf35,0xbf7b3ec4,0x3f0e3f35,0xbe48bf6d
.long 0xa5543f80,0x248dbf80,0xa5543f80,0x248dbf80,0xbf55bf35,0x3f7b3ec4,0xbf0e3f35,0x3e48bf6d
.long 0x3f6d248d,0xbec43f35,0xbf6da554,0x3ec4bf35,0xbe483f35,0xbf55bf6d,0xbf7bbf35,0x3f0ebec4
.long 0xbf35bf80,0x3f35248d,0xbf35bf80,0x3f35248d,0x3f7b3f35,0x3f0e3f6d,0xbe48bf35,0x3f553ec4
.long 0xbec4a554,0xbf6dbf35,0x3ec4248d,0x3f6d3f35,0xbf0ebf35,0xbe48bec4,0x3f553f35,0x3f7b3f6d
.long 0x0,0x0,0x0,0x0,0x3e480000,0x3f0e3ec4,0x3f7b3f80,0x3f553f6d
.long 0x3ec40000,0x3f6d3f35,0xbec4250d,0xbf6dbf35,0x3f0e0000,0x3f7b3f6d,0xbf55bf80,0x3e48bec4
.long 0x3f350000,0x3f353f80,0x3f350000,0x3f353f80,0x3f550000,0x3e483f6d,0x3f0e3f80,0xbf7bbec4
.long 0x3f6d0000,0xbec43f35,0xbf6d250d,0x3ec4bf35,0x3f7b0000,0xbf553ec4,0xbe48bf80,0x3f0e3f6d
.long 0x3f800000,0xbf80250d,0x3f800000,0xbf80250d,0x3f7b0000,0xbf55bec4,0xbe483f80,0x3f0ebf6d
.long 0x3f6d0000,0xbec4bf35,0xbf6d250d,0x3ec43f35,0x3f550000,0x3e48bf6d,0x3f0ebf80,0xbf7b3ec4
.long 0x3f350000,0x3f35bf80,0x3f350000,0x3f35bf80,0x3f0e0000,0x3f7bbf6d,0xbf553f80,0x3e483ec4
.long 0x3ec40000,0x3f6dbf35,0xbec4250d,0xbf6d3f35,0x3e480000,0x3f0ebec4,0x3f7bbf80,0x3f55bf6d
.long 0x250d0000,0x250d0000,0x250d0000,0x250d0000,0xbe480000,0xbf0e3ec4,0xbf7b3f80,0xbf553f6d
.long 0xbec40000,0xbf6d3f35,0x3ec4250d,0x3f6dbf35,0xbf0e0000,0xbf7b3f6d,0x3f55bf80,0xbe48bec4
.long 0xbf350000,0xbf353f80,0xbf350000,0xbf353f80,0xbf550000,0xbe483f6d,0xbf0e3f80,0x3f7bbec4
.long 0xbf6d0000,0x3ec43f35,0x3f6d250d,0xbec4bf35,0xbf7b0000,0x3f553ec4,0x3e48bf80,0xbf0e3f6d
.long 0xbf800000,0x3f80250d,0xbf800000,0x3f80250d,0xbf7b0000,0x3f55bec4,0x3e483f80,0xbf0ebf6d
.long 0xbf6d0000,0x3ec4bf35,0x3f6d250d,0xbec43f35,0xbf550000,0xbe48bf6d,0xbf0ebf80,0x3f7b3ec4
.long 0xbf350000,0xbf35bf80,0xbf350000,0xbf35bf80,0xbf0e0000,0xbf7bbf6d,0x3f553f80,0xbe483ec4
.long 0xbec40000,0xbf6dbf35,0x3ec4250d,0x3f6d3f35,0xbe480000,0xbf0ebec4,0xbf7bbf80,0xbf55bf6d
.long 0x0,0x0,0x0,0x0,0x3f553f35,0x3f7b3f6d,0x3f0e3f35,0x3e483ec4
.long 0x3f6d3f80,0x3ec43f35,0xbf6dbf80,0xbec4bf35,0x3e483f35,0xbf55bec4,0x3f7b3f35,0x3f0e3f6d
.long 0xbf35250d,0xbf35bf80,0xbf35250d,0xbf35bf80,0xbf7bbf35,0x3f0ebec4,0x3e48bf35,0x3f553f6d
.long 0xbec4bf80,0x3f6d3f35,0x3ec43f80,0xbf6dbf35,0x3f0ebf35,0xbe483f6d,0xbf55bf35,0x3f7b3ec4
.long 0x3f800000,0xbf80250d,0x3f800000,0xbf80250d,0x3f0e3f35,0xbe48bf6d,0xbf553f35,0x3f7bbec4
.long 0xbec43f80,0x3f6dbf35,0x3ec4bf80,0xbf6d3f35,0xbf7b3f35,0x3f0e3ec4,0x3e483f35,0x3f55bf6d
.long 0xbf35250d,0xbf353f80,0xbf35250d,0xbf353f80,0x3e48bf35,0xbf553ec4,0x3f7bbf35,0x3f0ebf6d
.long 0x3f6dbf80,0x3ec4bf35,0xbf6d3f80,0xbec43f35,0x3f55bf35,0x3f7bbf6d,0x3f0ebf35,0x3e48bec4
.long 0x250d0000,0x250d0000,0x250d0000,0x250d0000,0xbf553f35,0xbf7b3f6d,0xbf0e3f35,0xbe483ec4
.long 0xbf6d3f80,0xbec43f35,0x3f6dbf80,0x3ec4bf35,0xbe483f35,0x3f55bec4,0xbf7b3f35,0xbf0e3f6d
.long 0x3f35250d,0x3f35bf80,0x3f35250d,0x3f35bf80,0x3f7bbf35,0xbf0ebec4,0xbe48bf35,0xbf553f6d
.long 0x3ec4bf80,0xbf6d3f35,0xbec43f80,0x3f6dbf35,0xbf0ebf35,0x3e483f6d,0x3f55bf35,0xbf7b3ec4
.long 0xbf800000,0x3f80250d,0xbf800000,0x3f80250d,0xbf0e3f35,0x3e48bf6d,0x3f553f35,0xbf7bbec4
.long 0x3ec43f80,0xbf6dbf35,0xbec4bf80,0x3f6d3f35,0x3f7b3f35,0xbf0e3ec4,0xbe483f35,0xbf55bf6d
.long 0x3f35250d,0x3f353f80,0x3f35250d,0x3f353f80,0xbe48bf35,0x3f553ec4,0xbf7bbf35,0xbf0ebf6d
.long 0xbf6dbf80,0xbec4bf35,0x3f6d3f80,0x3ec43f35,0xbf55bf35,0xbf7bbf6d,0xbf0ebf35,0xbe48bec4
.long 0x0,0x0,0x0,0x0,0xbe48250d,0xbf0ebec4,0xbf7bbf80,0xbf55bf6d
.long 0x3ec40000,0x3f6d3f35,0xbec4250d,0xbf6dbf35,0xbf0e250d,0xbf7bbf6d,0x3f553f80,0xbe483ec4
.long 0x3f350000,0x3f353f80,0x3f350000,0x3f353f80,0xbf55250d,0xbe48bf6d,0xbf0ebf80,0x3f7b3ec4
.long 0x3f6d0000,0xbec43f35,0xbf6d250d,0x3ec4bf35,0xbf7b250d,0x3f55bec4,0x3e483f80,0xbf0ebf6d
.long 0x3f800000,0xbf80250d,0x3f800000,0xbf80250d,0xbf7b250d,0x3f553ec4,0x3e48bf80,0xbf0e3f6d
.long 0x3f6d0000,0xbec4bf35,0xbf6d250d,0x3ec43f35,0xbf55250d,0xbe483f6d,0xbf0e3f80,0x3f7bbec4
.long 0x3f350000,0x3f35bf80,0x3f350000,0x3f35bf80,0xbf0e250d,0xbf7b3f6d,0x3f55bf80,0xbe48bec4
.long 0x3ec40000,0x3f6dbf35,0xbec4250d,0xbf6d3f35,0xbe48250d,0xbf0e3ec4,0xbf7b3f80,0xbf553f6d
.long 0x250d0000,0x250d0000,0x250d0000,0x250d0000,0x3e48250d,0x3f0ebec4,0x3f7bbf80,0x3f55bf6d
.long 0xbec40000,0xbf6d3f35,0x3ec4250d,0x3f6dbf35,0x3f0e250d,0x3f7bbf6d,0xbf553f80,0x3e483ec4
.long 0xbf350000,0xbf353f80,0xbf350000,0xbf353f80,0x3f55250d,0x3e48bf6d,0x3f0ebf80,0xbf7b3ec4
.long 0xbf6d0000,0x3ec43f35,0x3f6d250d,0xbec4bf35,0x3f7b250d,0xbf55bec4,0xbe483f80,0x3f0ebf6d
.long 0xbf800000,0x3f80250d,0xbf800000,0x3f80250d,0x3f7b250d,0xbf553ec4,0xbe48bf80,0x3f0e3f6d
.long 0xbf6d0000,0x3ec4bf35,0x3f6d250d,0xbec43f35,0x3f55250d,0x3e483f6d,0x3f0e3f80,0xbf7bbec4
.long 0xbf350000,0xbf35bf80,0xbf350000,0xbf35bf80,0x3f0e250d,0x3f7b3f6d,0xbf55bf80,0x3e48bec4
.long 0xbec40000,0xbf6dbf35,0x3ec4250d,0x3f6d3f35,0x3e48250d,0x3f0e3ec4,0x3f7b3f80,0x3f553f6d
.long 0x0,0x0,0x0,0x0,0xbf55bf35,0xbf7bbf6d,0xbf0ebf35,0xbe48bec4
.long 0x3f6d3f80,0x3ec43f35,0xbf6dbf80,0xbec4bf35,0xbe48bf35,0x3f553ec4,0xbf7bbf35,0xbf0ebf6d
.long 0xbf35250d,0xbf35bf80,0xbf35250d,0xbf35bf80,0x3f7b3f35,0xbf0e3ec4,0xbe483f35,0xbf55bf6d
.long 0xbec4bf80,0x3f6d3f35,0x3ec43f80,0xbf6dbf35,0xbf0e3f35,0x3e48bf6d,0x3f553f35,0xbf7bbec4
.long 0x3f800000,0xbf80250d,0x3f800000,0xbf80250d,0xbf0ebf35,0x3e483f6d,0x3f55bf35,0xbf7b3ec4
.long 0xbec43f80,0x3f6dbf35,0x3ec4bf80,0xbf6d3f35,0x3f7bbf35,0xbf0ebec4,0xbe48bf35,0xbf553f6d
.long 0xbf35250d,0xbf353f80,0xbf35250d,0xbf353f80,0xbe483f35,0x3f55bec4,0xbf7b3f35,0xbf0e3f6d
.long 0x3f6dbf80,0x3ec4bf35,0xbf6d3f80,0xbec43f35,0xbf553f35,0xbf7b3f6d,0xbf0e3f35,0xbe483ec4
.long 0x250d0000,0x250d0000,0x250d0000,0x250d0000,0x3f55bf35,0x3f7bbf6d,0x3f0ebf35,0x3e48bec4
.long 0xbf6d3f80,0xbec43f35,0x3f6dbf80,0x3ec4bf35,0x3e48bf35,0xbf553ec4,0x3f7bbf35,0x3f0ebf6d
.long 0x3f35250d,0x3f35bf80,0x3f35250d,0x3f35bf80,0xbf7b3f35,0x3f0e3ec4,0x3e483f35,0x3f55bf6d
.long 0x3ec4bf80,0xbf6d3f35,0xbec43f80,0x3f6dbf35,0x3f0e3f35,0xbe48bf6d,0xbf553f35,0x3f7bbec4
.long 0xbf800000,0x3f80250d,0xbf800000,0x3f80250d,0x3f0ebf35,0xbe483f6d,0xbf55bf35,0x3f7b3ec4
.long 0x3ec43f80,0xbf6dbf35,0xbec4bf80,0x3f6d3f35,0xbf7bbf35,0x3f0ebec4,0x3e48bf35,0x3f553f6d
.long 0x3f35250d,0x3f353f80,0x3f35250d,0x3f353f80,0x3e483f35,0xbf55bec4,0x3f7b3f35,0x3f0e3f6d
.long 0xbf6dbf80,0xbec4bf35,0x3f6d3f80,0x3ec43f35,0x3f553f35,0x3f7b3f6d,0x3f0e3f35,0x3e483ec4
.long 0x3f803f80,0x3f803f80,0x3f803f80,0x3f803f80,0x3f7b3f80,0x3f0e3f35,0xbe48248d,0xbf55bf35
.long 0x3f6d3f80,0xbec4248d,0xbf6dbf80,0x3ec4a554,0x3f553f80,0xbf7bbf35,0x3f0ea554,0x3e483f35
.long 0x3f353f80,0xbf35bf80,0x3f353f80,0xbf35bf80,0x3f0e3f80,0x3e48bf35,0xbf55248d,0x3f7b3f35
.long 0x3ec43f80,0x3f6da554,0xbec4bf80,0xbf6d248d,0x3e483f80,0x3f553f35,0x3f7ba554,0x3f0ebf35
.long 0x248d3f80,0x248d3f80,0x248d3f80,0x248d3f80,0xbe483f80,0xbf553f35,0xbf7b248d,0xbf0ebf35
.long 0xbec43f80,0xbf6d248d,0x3ec4bf80,0x3f6da554,0xbf0e3f80,0xbe48bf35,0x3f55a554,0xbf7b3f35
.long 0xbf353f80,0x3f35bf80,0xbf353f80,0x3f35bf80,0xbf553f80,0x3f7bbf35,0xbf0e248d,0xbe483f35
.long 0xbf6d3f80,0x3ec4a554,0x3f6dbf80,0xbec4248d,0xbf7b3f80,0xbf0e3f35,0x3e48a554,0x3f55bf35
.long 0xbf803f80,0xbf803f80,0xbf803f80,0xbf803f80,0xbf7b3f80,0xbf0e3f35,0x3e48248d,0x3f55bf35
.long 0xbf6d3f80,0x3ec4248d,0x3f6dbf80,0xbec4a554,0xbf553f80,0x3f7bbf35,0xbf0ea554,0xbe483f35
.long 0xbf353f80,0x3f35bf80,0xbf353f80,0x3f35bf80,0xbf0e3f80,0xbe48bf35,0x3f55248d,0xbf7b3f35
.long 0xbec43f80,0xbf6da554,0x3ec4bf80,0x3f6d248d,0xbe483f80,0xbf553f35,0xbf7ba554,0xbf0ebf35
.long 0xa5543f80,0xa5543f80,0xa5543f80,0xa5543f80,0x3e483f80,0x3f553f35,0x3f7b248d,0x3f0ebf35
.long 0x3ec43f80,0x3f6d248d,0xbec4bf80,0xbf6da554,0x3f0e3f80,0x3e48bf35,0xbf55a554,0x3f7b3f35
.long 0x3f353f80,0xbf35bf80,0x3f353f80,0xbf35bf80,0x3f553f80,0xbf7bbf35,0x3f0e248d,0x3e483f35
.long 0x3f6d3f80,0xbec4a554,0xbf6dbf80,0x3ec4248d,0x3f7b3f80,0x3f0e3f35,0xbe48a554,0xbf55bf35
.long 0x3f803f80,0x3f803f80,0x3f803f80,0x3f803f80,0x3f553f6d,0x3e483ec4,0xbf0ebec4,0xbf7bbf6d
.long 0x3ec43f35,0xbf6dbf35,0xbec4bf35,0x3f6d3f35,0xbe483ec4,0xbf0ebf6d,0x3f7b3f6d,0xbf55bec4
.long 0xbf35248d,0x3f35a554,0xbf35248d,0x3f35a554,0xbf7bbec4,0x3f553f6d,0xbe48bf6d,0xbf0e3ec4
.long 0xbf6dbf35,0xbec43f35,0x3f6d3f35,0x3ec4bf35,0xbf0ebf6d,0xbf7bbec4,0xbf553ec4,0xbe483f6d
.long 0xa554bf80,0xa554bf80,0xa554bf80,0xa554bf80,0x3f0ebf6d,0x3f7bbec4,0x3f553ec4,0x3e483f6d
.long 0x3f6dbf35,0x3ec43f35,0xbf6d3f35,0xbec4bf35,0x3f7bbec4,0xbf553f6d,0x3e48bf6d,0x3f0e3ec4
.long 0x3f35a554,0xbf35248d,0x3f35a554,0xbf35248d,0x3e483ec4,0x3f0ebf6d,0xbf7b3f6d,0x3f55bec4
.long 0xbec43f35,0x3f6dbf35,0x3ec4bf35,0xbf6d3f35,0xbf553f6d,0xbe483ec4,0x3f0ebec4,0x3f7bbf6d
.long 0xbf803f80,0xbf803f80,0xbf803f80,0xbf803f80,0xbf553f6d,0xbe483ec4,0x3f0ebec4,0x3f7bbf6d
.long 0xbec43f35,0x3f6dbf35,0x3ec4bf35,0xbf6d3f35,0x3e483ec4,0x3f0ebf6d,0xbf7b3f6d,0x3f55bec4
.long 0x3f35248d,0xbf35a554,0x3f35248d,0xbf35a554,0x3f7bbec4,0xbf553f6d,0x3e48bf6d,0x3f0e3ec4
.long 0x3f6dbf35,0x3ec43f35,0xbf6d3f35,0xbec4bf35,0x3f0ebf6d,0x3f7bbec4,0x3f553ec4,0x3e483f6d
.long 0x248dbf80,0x248dbf80,0x248dbf80,0x248dbf80,0xbf0ebf6d,0xbf7bbec4,0xbf553ec4,0xbe483f6d
.long 0xbf6dbf35,0xbec43f35,0x3f6d3f35,0x3ec4bf35,0xbf7bbec4,0x3f553f6d,0xbe48bf6d,0xbf0e3ec4
.long 0xbf35a554,0x3f35248d,0xbf35a554,0x3f35248d,0xbe483ec4,0xbf0ebf6d,0x3f7b3f6d,0xbf55bec4
.long 0x3ec43f35,0xbf6dbf35,0xbec4bf35,0x3f6d3f35,0x3f553f6d,0x3e483ec4,0xbf0ebec4,0xbf7bbf6d
.long 0x3f803f80,0x3f803f80,0x3f803f80,0x3f803f80,0xbf7bbf80,0xbf0ebf35,0x3e48a554,0x3f553f35
.long 0x3f6d3f80,0xbec4248d,0xbf6dbf80,0x3ec4a554,0xbf55bf80,0x3f7b3f35,0xbf0e248d,0xbe48bf35
.long 0x3f353f80,0xbf35bf80,0x3f353f80,0xbf35bf80,0xbf0ebf80,0xbe483f35,0x3f55a554,0xbf7bbf35
.long 0x3ec43f80,0x3f6da554,0xbec4bf80,0xbf6d248d,0xbe48bf80,0xbf55bf35,0xbf7b248d,0xbf0e3f35
.long 0x248d3f80,0x248d3f80,0x248d3f80,0x248d3f80,0x3e48bf80,0x3f55bf35,0x3f7ba554,0x3f0e3f35
.long 0xbec43f80,0xbf6d248d,0x3ec4bf80,0x3f6da554,0x3f0ebf80,0x3e483f35,0xbf55248d,0x3f7bbf35
.long 0xbf353f80,0x3f35bf80,0xbf353f80,0x3f35bf80,0x3f55bf80,0xbf7b3f35,0x3f0ea554,0x3e48bf35
.long 0xbf6d3f80,0x3ec4a554,0x3f6dbf80,0xbec4248d,0x3f7bbf80,0x3f0ebf35,0xbe48248d,0xbf553f35
.long 0xbf803f80,0xbf803f80,0xbf803f80,0xbf803f80,0x3f7bbf80,0x3f0ebf35,0xbe48a554,0xbf553f35
.long 0xbf6d3f80,0x3ec4248d,0x3f6dbf80,0xbec4a554,0x3f55bf80,0xbf7b3f35,0x3f0e248d,0x3e48bf35
.long 0xbf353f80,0x3f35bf80,0xbf353f80,0x3f35bf80,0x3f0ebf80,0x3e483f35,0xbf55a554,0x3f7bbf35
.long 0xbec43f80,0xbf6da554,0x3ec4bf80,0x3f6d248d,0x3e48bf80,0x3f55bf35,0x3f7b248d,0x3f0e3f35
.long 0xa5543f80,0xa5543f80,0xa5543f80,0xa5543f80,0xbe48bf80,0xbf55bf35,0xbf7ba554,0xbf0e3f35
.long 0x3ec43f80,0x3f6d248d,0xbec4bf80,0xbf6da554,0xbf0ebf80,0xbe483f35,0x3f55248d,0xbf7bbf35
.long 0x3f353f80,0xbf35bf80,0x3f353f80,0xbf35bf80,0xbf55bf80,0x3f7b3f35,0xbf0ea554,0xbe48bf35
.long 0x3f6d3f80,0xbec4a554,0xbf6dbf80,0x3ec4248d,0xbf7bbf80,0xbf0ebf35,0x3e48248d,0x3f553f35
.long 0x3f803f80,0x3f803f80,0x3f803f80,0x3f803f80,0xbf55bf6d,0xbe48bec4,0x3f0e3ec4,0x3f7b3f6d
.long 0x3ec43f35,0xbf6dbf35,0xbec4bf35,0x3f6d3f35,0x3e48bec4,0x3f0e3f6d,0xbf7bbf6d,0x3f553ec4
.long 0xbf35248d,0x3f35a554,0xbf35248d,0x3f35a554,0x3f7b3ec4,0xbf55bf6d,0x3e483f6d,0x3f0ebec4
.long 0xbf6dbf35,0xbec43f35,0x3f6d3f35,0x3ec4bf35,0x3f0e3f6d,0x3f7b3ec4,0x3f55bec4,0x3e48bf6d
.long 0xa554bf80,0xa554bf80,0xa554bf80,0xa554bf80,0xbf0e3f6d,0xbf7b3ec4,0xbf55bec4,0xbe48bf6d
.long 0x3f6dbf35,0x3ec43f35,0xbf6d3f35,0xbec4bf35,0xbf7b3ec4,0x3f55bf6d,0xbe483f6d,0xbf0ebec4
.long 0x3f35a554,0xbf35248d,0x3f35a554,0xbf35248d,0xbe48bec4,0xbf0e3f6d,0x3f7bbf6d,0xbf553ec4
.long 0xbec43f35,0x3f6dbf35,0x3ec4bf35,0xbf6d3f35,0x3f55bf6d,0x3e48bec4,0xbf0e3ec4,0xbf7b3f6d
.long 0xbf803f80,0xbf803f80,0xbf803f80,0xbf803f80,0x3f55bf6d,0x3e48bec4,0xbf0e3ec4,0xbf7b3f6d
.long 0xbec43f35,0x3f6dbf35,0x3ec4bf35,0xbf6d3f35,0xbe48bec4,0xbf0e3f6d,0x3f7bbf6d,0xbf553ec4
.long 0x3f35248d,0xbf35a554,0x3f35248d,0xbf35a554,0xbf7b3ec4,0x3f55bf6d,0xbe483f6d,0xbf0ebec4
.long 0x3f6dbf35,0x3ec43f35,0xbf6d3f35,0xbec4bf35,0xbf0e3f6d,0xbf7b3ec4,0xbf55bec4,0xbe48bf6d
.long 0x248dbf80,0x248dbf80,0x248dbf80,0x248dbf80,0x3f0e3f6d,0x3f7b3ec4,0x3f55bec4,0x3e48bf6d
.long 0xbf6dbf35,0xbec43f35,0x3f6d3f35,0x3ec4bf35,0x3f7b3ec4,0xbf55bf6d,0x3e483f6d,0x3f0ebec4
.long 0xbf35a554,0x3f35248d,0xbf35a554,0x3f35248d,0x3e48bec4,0x3f0e3f6d,0xbf7bbf6d,0x3f553ec4
.long 0x3ec43f35,0xbf6dbf35,0xbec4bf35,0x3f6d3f35,0xbf55bf6d,0xbe48bec4,0x3f0e3ec4,0x3f7b3f6d
.long 0x3f803f80,0x3f803f80,0x3f803f80,0x3f803f80,0x3f753f7f,0x3ef13f22,0xbe95bdc9,0xbf62bf46
.long 0x3f553f7b,0xbf0ebe48,0xbf55bf7b,0x3f0e3e48,0x3f223f75,0xbf7fbf62,0x3f463e95,0xbdc93ef1
.long 0x3ec43f6d,0xbec4bf6d,0x3ec43f6d,0xbec4bf6d,0x3dc93f62,0x3f22be95,0xbf7fbef1,0x3f463f75
.long 0xbe483f55,0x3f7b3f0e,0x3e48bf55,0xbf7bbf0e,0xbef13f46,0x3e953f7f,0x3f623f22,0x3f75bdc9
.long 0xbf353f35,0xbf353f35,0xbf353f35,0xbf353f35,0xbf623f22,0xbf75bdc9,0xbef1bf46,0x3e95bf7f
.long 0xbf7b3f0e,0xbe48bf55,0x3f7bbf0e,0x3e483f55,0xbf7f3ef1,0x3f46bf75,0xbdc93f62,0xbf22be95
.long 0xbf6d3ec4,0x3f6dbec4,0xbf6d3ec4,0x3f6dbec4,0xbf463e95,0x3dc93ef1,0x3f22bf75,0xbf7f3f62
.long 0xbf0e3e48,0xbf553f7b,0x3f0ebe48,0x3f55bf7b,0xbe953dc9,0xbf623f46,0xbf753f7f,0xbef13f22
.long 0xa554248d,0xa554248d,0xa554248d,0xa554248d,0x3e95bdc9,0x3f62bf46,0x3f75bf7f,0x3ef1bf22
.long 0x3f0ebe48,0x3f55bf7b,0xbf0e3e48,0xbf553f7b,0x3f46be95,0xbdc9bef1,0xbf223f75,0x3f7fbf62
.long 0x3f6dbec4,0xbf6d3ec4,0x3f6dbec4,0xbf6d3ec4,0x3f7fbef1,0xbf463f75,0x3dc9bf62,0x3f223e95
.long 0x3f7bbf0e,0x3e483f55,0xbf7b3f0e,0xbe48bf55,0x3f62bf22,0x3f753dc9,0x3ef13f46,0xbe953f7f
.long 0x3f35bf35,0x3f35bf35,0x3f35bf35,0x3f35bf35,0x3ef1bf46,0xbe95bf7f,0xbf62bf22,0xbf753dc9
.long 0x3e48bf55,0xbf7bbf0e,0xbe483f55,0x3f7b3f0e,0xbdc9bf62,0xbf223e95,0x3f7f3ef1,0xbf46bf75
.long 0xbec4bf6d,0x3ec43f6d,0xbec4bf6d,0x3ec43f6d,0xbf22bf75,0x3f7f3f62,0xbf46be95,0x3dc9bef1
.long 0xbf55bf7b,0x3f0e3e48,0x3f553f7b,0xbf0ebe48,0xbf75bf7f,0xbef1bf22,0x3e953dc9,0x3f623f46
.long 0x3f803f80,0x3f803f80,0x3f803f80,0x3f803f80,0x3f463f62,0x3dc93e95,0xbf22bef1,0xbf7fbf75
.long 0x3e483f0e,0xbf7bbf55,0xbe48bf0e,0x3f7b3f55,0xbef13dc9,0xbe95bf46,0x3f623f7f,0xbf75bf22
.long 0xbf6dbec4,0x3f6d3ec4,0xbf6dbec4,0x3f6d3ec4,0xbf75bf46,0x3ef13f7f,0x3e95bf22,0xbf62bdc9
.long 0xbf0ebf7b,0xbf553e48,0x3f0e3f7b,0x3f55be48,0x3dc9bf75,0xbf22bf62,0xbf7fbe95,0xbf463ef1
.long 0x3f35bf35,0x3f35bf35,0x3f35bf35,0x3f35bf35,0x3f7fbe95,0x3f463ef1,0x3dc93f75,0xbf223f62
.long 0x3f553e48,0xbf0e3f7b,0xbf55be48,0x3f0ebf7b,0x3e953f22,0xbf623dc9,0x3f75bf46,0xbef13f7f
.long 0xbec43f6d,0x3ec4bf6d,0xbec43f6d,0x3ec4bf6d,0xbf623f7f,0x3f75bf22,0xbef1bdc9,0xbe953f46
.long 0xbf7b3f55,0xbe483f0e,0x3f7bbf55,0x3e48bf0e,0xbf223ef1,0xbf7f3f75,0xbf463f62,0xbdc93e95
.long 0xa554248d,0xa554248d,0xa554248d,0xa554248d,0x3f22bef1,0x3f7fbf75,0x3f46bf62,0x3dc9be95
.long 0x3f7bbf55,0x3e48bf0e,0xbf7b3f55,0xbe483f0e,0x3f62bf7f,0xbf753f22,0x3ef13dc9,0x3e95bf46
.long 0x3ec4bf6d,0xbec43f6d,0x3ec4bf6d,0xbec43f6d,0xbe95bf22,0x3f62bdc9,0xbf753f46,0x3ef1bf7f
.long 0xbf55be48,0x3f0ebf7b,0x3f553e48,0xbf0e3f7b,0xbf7f3e95,0xbf46bef1,0xbdc9bf75,0x3f22bf62
.long 0xbf353f35,0xbf353f35,0xbf353f35,0xbf353f35,0xbdc93f75,0x3f223f62,0x3f7f3e95,0x3f46bef1
.long 0x3f0e3f7b,0x3f55be48,0xbf0ebf7b,0xbf553e48,0x3f753f46,0xbef1bf7f,0xbe953f22,0x3f623dc9
.long 0x3f6d3ec4,0xbf6dbec4,0x3f6d3ec4,0xbf6dbec4,0x3ef1bdc9,0x3e953f46,0xbf62bf7f,0x3f753f22
.long 0xbe48bf0e,0x3f7b3f55,0x3e483f0e,0xbf7bbf55,0xbf46bf62,0xbdc9be95,0x3f223ef1,0x3f7f3f75
.long 0x3f803f80,0x3f803f80,0x3f803f80,0x3f803f80,0xbf75bf7f,0xbef1bf22,0x3e953dc9,0x3f623f46
.long 0x3f553f7b,0xbf0ebe48,0xbf55bf7b,0x3f0e3e48,0xbf22bf75,0x3f7f3f62,0xbf46be95,0x3dc9bef1
.long 0x3ec43f6d,0xbec4bf6d,0x3ec43f6d,0xbec4bf6d,0xbdc9bf62,0xbf223e95,0x3f7f3ef1,0xbf46bf75
.long 0xbe483f55,0x3f7b3f0e,0x3e48bf55,0xbf7bbf0e,0x3ef1bf46,0xbe95bf7f,0xbf62bf22,0xbf753dc9
.long 0xbf353f35,0xbf353f35,0xbf353f35,0xbf353f35,0x3f62bf22,0x3f753dc9,0x3ef13f46,0xbe953f7f
.long 0xbf7b3f0e,0xbe48bf55,0x3f7bbf0e,0x3e483f55,0x3f7fbef1,0xbf463f75,0x3dc9bf62,0x3f223e95
.long 0xbf6d3ec4,0x3f6dbec4,0xbf6d3ec4,0x3f6dbec4,0x3f46be95,0xbdc9bef1,0xbf223f75,0x3f7fbf62
.long 0xbf0e3e48,0xbf553f7b,0x3f0ebe48,0x3f55bf7b,0x3e95bdc9,0x3f62bf46,0x3f75bf7f,0x3ef1bf22
.long 0xa554248d,0xa554248d,0xa554248d,0xa554248d,0xbe953dc9,0xbf623f46,0xbf753f7f,0xbef13f22
.long 0x3f0ebe48,0x3f55bf7b,0xbf0e3e48,0xbf553f7b,0xbf463e95,0x3dc93ef1,0x3f22bf75,0xbf7f3f62
.long 0x3f6dbec4,0xbf6d3ec4,0x3f6dbec4,0xbf6d3ec4,0xbf7f3ef1,0x3f46bf75,0xbdc93f62,0xbf22be95
.long 0x3f7bbf0e,0x3e483f55,0xbf7b3f0e,0xbe48bf55,0xbf623f22,0xbf75bdc9,0xbef1bf46,0x3e95bf7f
.long 0x3f35bf35,0x3f35bf35,0x3f35bf35,0x3f35bf35,0xbef13f46,0x3e953f7f,0x3f623f22,0x3f75bdc9
.long 0x3e48bf55,0xbf7bbf0e,0xbe483f55,0x3f7b3f0e,0x3dc93f62,0x3f22be95,0xbf7fbef1,0x3f463f75
.long 0xbec4bf6d,0x3ec43f6d,0xbec4bf6d,0x3ec43f6d,0x3f223f75,0xbf7fbf62,0x3f463e95,0xbdc93ef1
.long 0xbf55bf7b,0x3f0e3e48,0x3f553f7b,0xbf0ebe48,0x3f753f7f,0x3ef13f22,0xbe95bdc9,0xbf62bf46
.long 0x3f803f80,0x3f803f80,0x3f803f80,0x3f803f80,0xbf46bf62,0xbdc9be95,0x3f223ef1,0x3f7f3f75
.long 0x3e483f0e,0xbf7bbf55,0xbe48bf0e,0x3f7b3f55,0x3ef1bdc9,0x3e953f46,0xbf62bf7f,0x3f753f22
.long 0xbf6dbec4,0x3f6d3ec4,0xbf6dbec4,0x3f6d3ec4,0x3f753f46,0xbef1bf7f,0xbe953f22,0x3f623dc9
.long 0xbf0ebf7b,0xbf553e48,0x3f0e3f7b,0x3f55be48,0xbdc93f75,0x3f223f62,0x3f7f3e95,0x3f46bef1
.long 0x3f35bf35,0x3f35bf35,0x3f35bf35,0x3f35bf35,0xbf7f3e95,0xbf46bef1,0xbdc9bf75,0x3f22bf62
.long 0x3f553e48,0xbf0e3f7b,0xbf55be48,0x3f0ebf7b,0xbe95bf22,0x3f62bdc9,0xbf753f46,0x3ef1bf7f
.long 0xbec43f6d,0x3ec4bf6d,0xbec43f6d,0x3ec4bf6d,0x3f62bf7f,0xbf753f22,0x3ef13dc9,0x3e95bf46
.long 0xbf7b3f55,0xbe483f0e,0x3f7bbf55,0x3e48bf0e,0x3f22bef1,0x3f7fbf75,0x3f46bf62,0x3dc9be95
.long 0xa554248d,0xa554248d,0xa554248d,0xa554248d,0xbf223ef1,0xbf7f3f75,0xbf463f62,0xbdc93e95
.long 0x3f7bbf55,0x3e48bf0e,0xbf7b3f55,0xbe483f0e,0xbf623f7f,0x3f75bf22,0xbef1bdc9,0xbe953f46
.long 0x3ec4bf6d,0xbec43f6d,0x3ec4bf6d,0xbec43f6d,0x3e953f22,0xbf623dc9,0x3f75bf46,0xbef13f7f
.long 0xbf55be48,0x3f0ebf7b,0x3f553e48,0xbf0e3f7b,0x3f7fbe95,0x3f463ef1,0x3dc93f75,0xbf223f62
.long 0xbf353f35,0xbf353f35,0xbf353f35,0xbf353f35,0x3dc9bf75,0xbf22bf62,0xbf7fbe95,0xbf463ef1
.long 0x3f0e3f7b,0x3f55be48,0xbf0ebf7b,0xbf553e48,0xbf75bf46,0x3ef13f7f,0x3e95bf22,0xbf62bdc9
.long 0x3f6d3ec4,0xbf6dbec4,0x3f6d3ec4,0xbf6dbec4,0xbef13dc9,0xbe95bf46,0x3f623f7f,0xbf75bf22
.long 0xbe48bf0e,0x3f7b3f55,0x3e483f0e,0xbf7bbf55,0x3f463f62,0x3dc93e95,0xbf22bef1,0xbf7fbf75
.long 0x0,0x0,0x0,0x0,0x3e480000,0x3f553f35,0x3f7b3f80,0x3f0e3f35
.long 0x3ec40000,0x3f6d3f80,0xbec4250d,0xbf6dbf80,0x3f0e0000,0x3e483f35,0xbf55bf80,0x3f7b3f35
.long 0x3f350000,0xbf35250d,0x3f350000,0xbf35250d,0x3f550000,0xbf7bbf35,0x3f0e3f80,0x3e48bf35
.long 0x3f6d0000,0xbec4bf80,0xbf6d250d,0x3ec43f80,0x3f7b0000,0x3f0ebf35,0xbe48bf80,0xbf55bf35
.long 0x3f800000,0x3f800000,0x3f800000,0x3f800000,0x3f7b0000,0x3f0e3f35,0xbe483f80,0xbf553f35
.long 0x3f6d0000,0xbec43f80,0xbf6d250d,0x3ec4bf80,0x3f550000,0xbf7b3f35,0x3f0ebf80,0x3e483f35
.long 0x3f350000,0xbf35250d,0x3f350000,0xbf35250d,0x3f0e0000,0x3e48bf35,0xbf553f80,0x3f7bbf35
.long 0x3ec40000,0x3f6dbf80,0xbec4250d,0xbf6d3f80,0x3e480000,0x3f55bf35,0x3f7bbf80,0x3f0ebf35
.long 0x250d0000,0x250d0000,0x250d0000,0x250d0000,0xbe480000,0xbf553f35,0xbf7b3f80,0xbf0e3f35
.long 0xbec40000,0xbf6d3f80,0x3ec4250d,0x3f6dbf80,0xbf0e0000,0xbe483f35,0x3f55bf80,0xbf7b3f35
.long 0xbf350000,0x3f35250d,0xbf350000,0x3f35250d,0xbf550000,0x3f7bbf35,0xbf0e3f80,0xbe48bf35
.long 0xbf6d0000,0x3ec4bf80,0x3f6d250d,0xbec43f80,0xbf7b0000,0xbf0ebf35,0x3e48bf80,0x3f55bf35
.long 0xbf800000,0xbf800000,0xbf800000,0xbf800000,0xbf7b0000,0xbf0e3f35,0x3e483f80,0x3f553f35
.long 0xbf6d0000,0x3ec43f80,0x3f6d250d,0xbec4bf80,0xbf550000,0x3f7b3f35,0xbf0ebf80,0xbe483f35
.long 0xbf350000,0x3f35250d,0xbf350000,0x3f35250d,0xbf0e0000,0xbe48bf35,0x3f553f80,0xbf7bbf35
.long 0xbec40000,0xbf6dbf80,0x3ec4250d,0x3f6d3f80,0xbe480000,0xbf55bf35,0xbf7bbf80,0xbf0ebf35
.long 0x0,0x0,0x0,0x0,0x3f0e3ec4,0x3f7b3f6d,0x3f553f6d,0x3e483ec4
.long 0x3f6d3f35,0x3ec43f35,0xbf6dbf35,0xbec4bf35,0x3f7b3f6d,0xbf55bec4,0x3e48bec4,0x3f0e3f6d
.long 0x3f353f80,0xbf35bf80,0x3f353f80,0xbf35bf80,0x3e483f6d,0x3f0ebec4,0xbf7bbec4,0x3f553f6d
.long 0xbec43f35,0x3f6d3f35,0x3ec4bf35,0xbf6dbf35,0xbf553ec4,0xbe483f6d,0x3f0e3f6d,0x3f7b3ec4
.long 0xbf80250d,0xbf80250d,0xbf80250d,0xbf80250d,0xbf55bec4,0xbe48bf6d,0x3f0ebf6d,0x3f7bbec4
.long 0xbec4bf35,0x3f6dbf35,0x3ec43f35,0xbf6d3f35,0x3e48bf6d,0x3f0e3ec4,0xbf7b3ec4,0x3f55bf6d
.long 0x3f35bf80,0xbf353f80,0x3f35bf80,0xbf353f80,0x3f7bbf6d,0xbf553ec4,0x3e483ec4,0x3f0ebf6d
.long 0x3f6dbf35,0x3ec4bf35,0xbf6d3f35,0xbec43f35,0x3f0ebec4,0x3f7bbf6d,0x3f55bf6d,0x3e48bec4
.long 0x250d0000,0x250d0000,0x250d0000,0x250d0000,0xbf0e3ec4,0xbf7b3f6d,0xbf553f6d,0xbe483ec4
.long 0xbf6d3f35,0xbec43f35,0x3f6dbf35,0x3ec4bf35,0xbf7b3f6d,0x3f55bec4,0xbe48bec4,0xbf0e3f6d
.long 0xbf353f80,0x3f35bf80,0xbf353f80,0x3f35bf80,0xbe483f6d,0xbf0ebec4,0x3f7bbec4,0xbf553f6d
.long 0x3ec43f35,0xbf6d3f35,0xbec4bf35,0x3f6dbf35,0x3f553ec4,0x3e483f6d,0xbf0e3f6d,0xbf7b3ec4
.long 0x3f80250d,0x3f80250d,0x3f80250d,0x3f80250d,0x3f55bec4,0x3e48bf6d,0xbf0ebf6d,0xbf7bbec4
.long 0x3ec4bf35,0xbf6dbf35,0xbec43f35,0x3f6d3f35,0xbe48bf6d,0xbf0e3ec4,0x3f7b3ec4,0xbf55bf6d
.long 0xbf35bf80,0x3f353f80,0xbf35bf80,0x3f353f80,0xbf7bbf6d,0x3f553ec4,0xbe483ec4,0xbf0ebf6d
.long 0xbf6dbf35,0xbec4bf35,0x3f6d3f35,0x3ec43f35,0xbf0ebec4,0xbf7bbf6d,0xbf55bf6d,0xbe48bec4
.long 0x0,0x0,0x0,0x0,0xbe48250d,0xbf55bf35,0xbf7bbf80,0xbf0ebf35
.long 0x3ec40000,0x3f6d3f80,0xbec4250d,0xbf6dbf80,0xbf0e250d,0xbe48bf35,0x3f553f80,0xbf7bbf35
.long 0x3f350000,0xbf35250d,0x3f350000,0xbf35250d,0xbf55250d,0x3f7b3f35,0xbf0ebf80,0xbe483f35
.long 0x3f6d0000,0xbec4bf80,0xbf6d250d,0x3ec43f80,0xbf7b250d,0xbf0e3f35,0x3e483f80,0x3f553f35
.long 0x3f800000,0x3f800000,0x3f800000,0x3f800000,0xbf7b250d,0xbf0ebf35,0x3e48bf80,0x3f55bf35
.long 0x3f6d0000,0xbec43f80,0xbf6d250d,0x3ec4bf80,0xbf55250d,0x3f7bbf35,0xbf0e3f80,0xbe48bf35
.long 0x3f350000,0xbf35250d,0x3f350000,0xbf35250d,0xbf0e250d,0xbe483f35,0x3f55bf80,0xbf7b3f35
.long 0x3ec40000,0x3f6dbf80,0xbec4250d,0xbf6d3f80,0xbe48250d,0xbf553f35,0xbf7b3f80,0xbf0e3f35
.long 0x250d0000,0x250d0000,0x250d0000,0x250d0000,0x3e48250d,0x3f55bf35,0x3f7bbf80,0x3f0ebf35
.long 0xbec40000,0xbf6d3f80,0x3ec4250d,0x3f6dbf80,0x3f0e250d,0x3e48bf35,0xbf553f80,0x3f7bbf35
.long 0xbf350000,0x3f35250d,0xbf350000,0x3f35250d,0x3f55250d,0xbf7b3f35,0x3f0ebf80,0x3e483f35
.long 0xbf6d0000,0x3ec4bf80,0x3f6d250d,0xbec43f80,0x3f7b250d,0x3f0e3f35,0xbe483f80,0xbf553f35
.long 0xbf800000,0xbf800000,0xbf800000,0xbf800000,0x3f7b250d,0x3f0ebf35,0xbe48bf80,0xbf55bf35
.long 0xbf6d0000,0x3ec43f80,0x3f6d250d,0xbec4bf80,0x3f55250d,0xbf7bbf35,0x3f0e3f80,0x3e48bf35
.long 0xbf350000,0x3f35250d,0xbf350000,0x3f35250d,0x3f0e250d,0x3e483f35,0xbf55bf80,0x3f7b3f35
.long 0xbec40000,0xbf6dbf80,0x3ec4250d,0x3f6d3f80,0x3e48250d,0x3f553f35,0x3f7b3f80,0x3f0e3f35
.long 0x0,0x0,0x0,0x0,0xbf0ebec4,0xbf7bbf6d,0xbf55bf6d,0xbe48bec4
.long 0x3f6d3f35,0x3ec43f35,0xbf6dbf35,0xbec4bf35,0xbf7bbf6d,0x3f553ec4,0xbe483ec4,0xbf0ebf6d
.long 0x3f353f80,0xbf35bf80,0x3f353f80,0xbf35bf80,0xbe48bf6d,0xbf0e3ec4,0x3f7b3ec4,0xbf55bf6d
.long 0xbec43f35,0x3f6d3f35,0x3ec4bf35,0xbf6dbf35,0x3f55bec4,0x3e48bf6d,0xbf0ebf6d,0xbf7bbec4
.long 0xbf80250d,0xbf80250d,0xbf80250d,0xbf80250d,0x3f553ec4,0x3e483f6d,0xbf0e3f6d,0xbf7b3ec4
.long 0xbec4bf35,0x3f6dbf35,0x3ec43f35,0xbf6d3f35,0xbe483f6d,0xbf0ebec4,0x3f7bbec4,0xbf553f6d
.long 0x3f35bf80,0xbf353f80,0x3f35bf80,0xbf353f80,0xbf7b3f6d,0x3f55bec4,0xbe48bec4,0xbf0e3f6d
.long 0x3f6dbf35,0x3ec4bf35,0xbf6d3f35,0xbec43f35,0xbf0e3ec4,0xbf7b3f6d,0xbf553f6d,0xbe483ec4
.long 0x250d0000,0x250d0000,0x250d0000,0x250d0000,0x3f0ebec4,0x3f7bbf6d,0x3f55bf6d,0x3e48bec4
.long 0xbf6d3f35,0xbec43f35,0x3f6dbf35,0x3ec4bf35,0x3f7bbf6d,0xbf553ec4,0x3e483ec4,0x3f0ebf6d
.long 0xbf353f80,0x3f35bf80,0xbf353f80,0x3f35bf80,0x3e48bf6d,0x3f0e3ec4,0xbf7b3ec4,0x3f55bf6d
.long 0x3ec43f35,0xbf6d3f35,0xbec4bf35,0x3f6dbf35,0xbf55bec4,0xbe48bf6d,0x3f0ebf6d,0x3f7bbec4
.long 0x3f80250d,0x3f80250d,0x3f80250d,0x3f80250d,0xbf553ec4,0xbe483f6d,0x3f0e3f6d,0x3f7b3ec4
.long 0x3ec4bf35,0xbf6dbf35,0xbec43f35,0x3f6d3f35,0x3e483f6d,0x3f0ebec4,0xbf7bbec4,0x3f553f6d
.long 0xbf35bf80,0x3f353f80,0xbf35bf80,0x3f353f80,0x3f7b3f6d,0xbf55bec4,0x3e48bec4,0x3f0e3f6d
.long 0xbf6dbf35,0xbec4bf35,0x3f6d3f35,0x3ec43f35,0x3f0e3ec4,0x3f7b3f6d,0x3f553f6d,0x3e483ec4
.long 0x0,0x0,0x0,0x0,0x3e953dc9,0x3f623f46,0x3f753f7f,0x3ef13f22
.long 0x3f0e3e48,0x3f553f7b,0xbf0ebe48,0xbf55bf7b,0x3f463e95,0xbdc93ef1,0xbf22bf75,0x3f7f3f62
.long 0x3f6d3ec4,0xbf6dbec4,0x3f6d3ec4,0xbf6dbec4,0x3f7f3ef1,0xbf46bf75,0x3dc93f62,0x3f22be95
.long 0x3f7b3f0e,0x3e48bf55,0xbf7bbf0e,0xbe483f55,0x3f623f22,0x3f75bdc9,0x3ef1bf46,0xbe95bf7f
.long 0x3f353f35,0x3f353f35,0x3f353f35,0x3f353f35,0x3ef13f46,0xbe953f7f,0xbf623f22,0xbf75bdc9
.long 0x3e483f55,0xbf7b3f0e,0xbe48bf55,0x3f7bbf0e,0xbdc93f62,0xbf22be95,0x3f7fbef1,0xbf463f75
.long 0xbec43f6d,0x3ec4bf6d,0xbec43f6d,0x3ec4bf6d,0xbf223f75,0x3f7fbf62,0xbf463e95,0x3dc93ef1
.long 0xbf553f7b,0x3f0ebe48,0x3f55bf7b,0xbf0e3e48,0xbf753f7f,0xbef13f22,0x3e95bdc9,0x3f62bf46
.long 0xbf803f80,0xbf803f80,0xbf803f80,0xbf803f80,0xbf753f7f,0xbef13f22,0x3e95bdc9,0x3f62bf46
.long 0xbf553f7b,0x3f0ebe48,0x3f55bf7b,0xbf0e3e48,0xbf223f75,0x3f7fbf62,0xbf463e95,0x3dc93ef1
.long 0xbec43f6d,0x3ec4bf6d,0xbec43f6d,0x3ec4bf6d,0xbdc93f62,0xbf22be95,0x3f7fbef1,0xbf463f75
.long 0x3e483f55,0xbf7b3f0e,0xbe48bf55,0x3f7bbf0e,0x3ef13f46,0xbe953f7f,0xbf623f22,0xbf75bdc9
.long 0x3f353f35,0x3f353f35,0x3f353f35,0x3f353f35,0x3f623f22,0x3f75bdc9,0x3ef1bf46,0xbe95bf7f
.long 0x3f7b3f0e,0x3e48bf55,0xbf7bbf0e,0xbe483f55,0x3f7f3ef1,0xbf46bf75,0x3dc93f62,0x3f22be95
.long 0x3f6d3ec4,0xbf6dbec4,0x3f6d3ec4,0xbf6dbec4,0x3f463e95,0xbdc93ef1,0xbf22bf75,0x3f7f3f62
.long 0x3f0e3e48,0x3f553f7b,0xbf0ebe48,0xbf55bf7b,0x3e953dc9,0x3f623f46,0x3f753f7f,0x3ef13f22
.long 0x0,0x0,0x0,0x0,0x3f223ef1,0x3f7f3f75,0x3f463f62,0x3dc93e95
.long 0x3f7b3f55,0x3e483f0e,0xbf7bbf55,0xbe48bf0e,0x3f623f7f,0xbf75bf22,0x3ef1bdc9,0x3e953f46
.long 0x3ec43f6d,0xbec4bf6d,0x3ec43f6d,0xbec4bf6d,0xbe953f22,0x3f623dc9,0xbf75bf46,0x3ef13f7f
.long 0xbf553e48,0x3f0e3f7b,0x3f55be48,0xbf0ebf7b,0xbf7fbe95,0xbf463ef1,0xbdc93f75,0x3f223f62
.long 0xbf35bf35,0xbf35bf35,0xbf35bf35,0xbf35bf35,0xbdc9bf75,0x3f22bf62,0x3f7fbe95,0x3f463ef1
.long 0x3f0ebf7b,0x3f553e48,0xbf0e3f7b,0xbf55be48,0x3f75bf46,0xbef13f7f,0xbe95bf22,0x3f62bdc9
.long 0x3f6dbec4,0xbf6d3ec4,0x3f6dbec4,0xbf6d3ec4,0x3ef13dc9,0x3e95bf46,0xbf623f7f,0x3f75bf22
.long 0xbe483f0e,0x3f7bbf55,0x3e48bf0e,0xbf7b3f55,0xbf463f62,0xbdc93e95,0x3f22bef1,0x3f7fbf75
.long 0xbf803f80,0xbf803f80,0xbf803f80,0xbf803f80,0xbf463f62,0xbdc93e95,0x3f22bef1,0x3f7fbf75
.long 0xbe483f0e,0x3f7bbf55,0x3e48bf0e,0xbf7b3f55,0x3ef13dc9,0x3e95bf46,0xbf623f7f,0x3f75bf22
.long 0x3f6dbec4,0xbf6d3ec4,0x3f6dbec4,0xbf6d3ec4,0x3f75bf46,0xbef13f7f,0xbe95bf22,0x3f62bdc9
.long 0x3f0ebf7b,0x3f553e48,0xbf0e3f7b,0xbf55be48,0xbdc9bf75,0x3f22bf62,0x3f7fbe95,0x3f463ef1
.long 0xbf35bf35,0xbf35bf35,0xbf35bf35,0xbf35bf35,0xbf7fbe95,0xbf463ef1,0xbdc93f75,0x3f223f62
.long 0xbf553e48,0x3f0e3f7b,0x3f55be48,0xbf0ebf7b,0xbe953f22,0x3f623dc9,0xbf75bf46,0x3ef13f7f
.long 0x3ec43f6d,0xbec4bf6d,0x3ec43f6d,0xbec4bf6d,0x3f623f7f,0xbf75bf22,0x3ef1bdc9,0x3e953f46
.long 0x3f7b3f55,0x3e483f0e,0xbf7bbf55,0xbe48bf0e,0x3f223ef1,0x3f7f3f75,0x3f463f62,0x3dc93e95
.long 0x0,0x0,0x0,0x0,0xbe95bdc9,0xbf62bf46,0xbf75bf7f,0xbef1bf22
.long 0x3f0e3e48,0x3f553f7b,0xbf0ebe48,0xbf55bf7b,0xbf46be95,0x3dc9bef1,0x3f223f75,0xbf7fbf62
.long 0x3f6d3ec4,0xbf6dbec4,0x3f6d3ec4,0xbf6dbec4,0xbf7fbef1,0x3f463f75,0xbdc9bf62,0xbf223e95
.long 0x3f7b3f0e,0x3e48bf55,0xbf7bbf0e,0xbe483f55,0xbf62bf22,0xbf753dc9,0xbef13f46,0x3e953f7f
.long 0x3f353f35,0x3f353f35,0x3f353f35,0x3f353f35,0xbef1bf46,0x3e95bf7f,0x3f62bf22,0x3f753dc9
.long 0x3e483f55,0xbf7b3f0e,0xbe48bf55,0x3f7bbf0e,0x3dc9bf62,0x3f223e95,0xbf7f3ef1,0x3f46bf75
.long 0xbec43f6d,0x3ec4bf6d,0xbec43f6d,0x3ec4bf6d,0x3f22bf75,0xbf7f3f62,0x3f46be95,0xbdc9bef1
.long 0xbf553f7b,0x3f0ebe48,0x3f55bf7b,0xbf0e3e48,0x3f75bf7f,0x3ef1bf22,0xbe953dc9,0xbf623f46
.long 0xbf803f80,0xbf803f80,0xbf803f80,0xbf803f80,0x3f75bf7f,0x3ef1bf22,0xbe953dc9,0xbf623f46
.long 0xbf553f7b,0x3f0ebe48,0x3f55bf7b,0xbf0e3e48,0x3f22bf75,0xbf7f3f62,0x3f46be95,0xbdc9bef1
.long 0xbec43f6d,0x3ec4bf6d,0xbec43f6d,0x3ec4bf6d,0x3dc9bf62,0x3f223e95,0xbf7f3ef1,0x3f46bf75
.long 0x3e483f55,0xbf7b3f0e,0xbe48bf55,0x3f7bbf0e,0xbef1bf46,0x3e95bf7f,0x3f62bf22,0x3f753dc9
.long 0x3f353f35,0x3f353f35,0x3f353f35,0x3f353f35,0xbf62bf22,0xbf753dc9,0xbef13f46,0x3e953f7f
.long 0x3f7b3f0e,0x3e48bf55,0xbf7bbf0e,0xbe483f55,0xbf7fbef1,0x3f463f75,0xbdc9bf62,0xbf223e95
.long 0x3f6d3ec4,0xbf6dbec4,0x3f6d3ec4,0xbf6dbec4,0xbf46be95,0x3dc9bef1,0x3f223f75,0xbf7fbf62
.long 0x3f0e3e48,0x3f553f7b,0xbf0ebe48,0xbf55bf7b,0xbe95bdc9,0xbf62bf46,0xbf75bf7f,0xbef1bf22
.long 0x0,0x0,0x0,0x0,0xbf22bef1,0xbf7fbf75,0xbf46bf62,0xbdc9be95
.long 0x3f7b3f55,0x3e483f0e,0xbf7bbf55,0xbe48bf0e,0xbf62bf7f,0x3f753f22,0xbef13dc9,0xbe95bf46
.long 0x3ec43f6d,0xbec4bf6d,0x3ec43f6d,0xbec4bf6d,0x3e95bf22,0xbf62bdc9,0x3f753f46,0xbef1bf7f
.long 0xbf553e48,0x3f0e3f7b,0x3f55be48,0xbf0ebf7b,0x3f7f3e95,0x3f46bef1,0x3dc9bf75,0xbf22bf62
.long 0xbf35bf35,0xbf35bf35,0xbf35bf35,0xbf35bf35,0x3dc93f75,0xbf223f62,0xbf7f3e95,0xbf46bef1
.long 0x3f0ebf7b,0x3f553e48,0xbf0e3f7b,0xbf55be48,0xbf753f46,0x3ef1bf7f,0x3e953f22,0xbf623dc9
.long 0x3f6dbec4,0xbf6d3ec4,0x3f6dbec4,0xbf6d3ec4,0xbef1bdc9,0xbe953f46,0x3f62bf7f,0xbf753f22
.long 0xbe483f0e,0x3f7bbf55,0x3e48bf0e,0xbf7b3f55,0x3f46bf62,0x3dc9be95,0xbf223ef1,0xbf7f3f75
.long 0xbf803f80,0xbf803f80,0xbf803f80,0xbf803f80,0x3f46bf62,0x3dc9be95,0xbf223ef1,0xbf7f3f75
.long 0xbe483f0e,0x3f7bbf55,0x3e48bf0e,0xbf7b3f55,0xbef1bdc9,0xbe953f46,0x3f62bf7f,0xbf753f22
.long 0x3f6dbec4,0xbf6d3ec4,0x3f6dbec4,0xbf6d3ec4,0xbf753f46,0x3ef1bf7f,0x3e953f22,0xbf623dc9
.long 0x3f0ebf7b,0x3f553e48,0xbf0e3f7b,0xbf55be48,0x3dc93f75,0xbf223f62,0xbf7f3e95,0xbf46bef1
.long 0xbf35bf35,0xbf35bf35,0xbf35bf35,0xbf35bf35,0x3f7f3e95,0x3f46bef1,0x3dc9bf75,0xbf22bf62
.long 0xbf553e48,0x3f0e3f7b,0x3f55be48,0xbf0ebf7b,0x3e95bf22,0xbf62bdc9,0x3f753f46,0xbef1bf7f
.long 0x3ec43f6d,0xbec4bf6d,0x3ec43f6d,0xbec4bf6d,0xbf62bf7f,0x3f753f22,0xbef13dc9,0xbe95bf46
.long 0x3f7b3f55,0x3e483f0e,0xbf7bbf55,0xbe48bf0e,0xbf22bef1,0xbf7fbf75,0xbf46bf62,0xbdc9be95
.long 0x3f800000,0x3f800000,0x3f800000,0x3f800000,0x3f800000,0x3f7fffb1,0x3f7ffec4,0x3f7ffd39
.long 0x3f800000,0x3f7ffec4,0x3f7ffb11,0x3f7ff4e6,0x3f800000,0x3f7ffd39,0x3f7ff4e6,0x3f7fe705
.long 0x3f800000,0x3f7ffb11,0x3f7fec43,0x3f7fd397,0x3f800000,0x3f7ff84a,0x3f7fe129,0x3f7fba9e
.long 0x3f800000,0x3f7ff4e6,0x3f7fd397,0x3f7f9c18,0x3f800000,0x3f7ff0e3,0x3f7fc38f,0x3f7f7808
.long 0x3f800000,0x3f7fec43,0x3f7fb10f,0x3f7f4e6d,0x3f800000,0x3f7fe705,0x3f7f9c18,0x3f7f1f49
.long 0x3f800000,0x3f7fe129,0x3f7f84ab,0x3f7eea9d,0x3f800000,0x3f7fdaaf,0x3f7f6ac7,0x3f7eb069
.long 0x3f800000,0x3f7fd397,0x3f7f4e6d,0x3f7e70b0,0x3f800000,0x3f7fcbe2,0x3f7f2f9d,0x3f7e2b72
.long 0x3f800000,0x3f7fc38f,0x3f7f0e58,0x3f7de0b1,0x3f800000,0x3f7fba9e,0x3f7eea9d,0x3f7d906e
.long 0x3f800000,0x3f7fb10f,0x3f7ec46d,0x3f7d3aac,0x3f800000,0x3f7fa6e3,0x3f7e9bc9,0x3f7cdf6c
.long 0x3f800000,0x3f7f9c18,0x3f7e70b0,0x3f7c7eb0,0x3f800000,0x3f7f90b1,0x3f7e4323,0x3f7c187a
.long 0x3f800000,0x3f7f84ab,0x3f7e1324,0x3f7baccd,0x3f800000,0x3f7f7808,0x3f7de0b1,0x3f7b3bab
.long 0x3f800000,0x3f7f6ac7,0x3f7dabcc,0x3f7ac516,0x3f800000,0x3f7f5ce9,0x3f7d7474,0x3f7a4910
.long 0x3f800000,0x3f7f4e6d,0x3f7d3aac,0x3f79c79d,0x3f800000,0x3f7f3f54,0x3f7cfe73,0x3f7940c0
.long 0x3f800000,0x3f7f2f9d,0x3f7cbfc9,0x3f78b47b,0x3f800000,0x3f7f1f49,0x3f7c7eb0,0x3f7822d1
.long 0x3f800000,0x3f7f0e58,0x3f7c3b28,0x3f778bc5,0x3f800000,0x3f7efcc9,0x3f7bf531,0x3f76ef5b
.long 0x3f800000,0x3f7eea9d,0x3f7baccd,0x3f764d97,0x3f800000,0x3f7ed7d4,0x3f7b61fc,0x3f75a67b
.long 0x3f800000,0x3f800000,0x3f800000,0x3f800000,0x3f7ffb11,0x3f7ff84a,0x3f7ff4e6,0x3f7ff0e3
.long 0x3f7fec43,0x3f7fe129,0x3f7fd397,0x3f7fc38f,0x3f7fd397,0x3f7fba9e,0x3f7f9c18,0x3f7f7808
.long 0x3f7fb10f,0x3f7f84ab,0x3f7f4e6d,0x3f7f0e58,0x3f7f84ab,0x3f7f3f54,0x3f7eea9d,0x3f7e868b
.long 0x3f7f4e6d,0x3f7eea9d,0x3f7e70b0,0x3f7de0b1,0x3f7f0e58,0x3f7e868b,0x3f7de0b1,0x3f7d1cdd
.long 0x3f7ec46d,0x3f7e1324,0x3f7d3aac,0x3f7c3b28,0x3f7e70b0,0x3f7d906e,0x3f7c7eb0,0x3f7b3bab
.long 0x3f7e1324,0x3f7cfe73,0x3f7baccd,0x3f7a1e84,0x3f7dabcc,0x3f7c5d3a,0x3f7ac516,0x3f78e3d6
.long 0x3f7d3aac,0x3f7baccd,0x3f79c79d,0x3f778bc5,0x3f7cbfc9,0x3f7aed37,0x3f78b47b,0x3f76167a
.long 0x3f7c3b28,0x3f7a1e84,0x3f778bc5,0x3f748422,0x3f7baccd,0x3f7940c0,0x3f764d97,0x3f72d4eb
.long 0x3f7b14be,0x3f7853f8,0x3f74fa0b,0x3f710908,0x3f7a7302,0x3f77583a,0x3f73913f,0x3f6f20b0
.long 0x3f79c79d,0x3f764d97,0x3f721352,0x3f6d1c1d,0x3f791298,0x3f75341d,0x3f708066,0x3f6afb8c
.long 0x3f7853f8,0x3f740bdd,0x3f6ed89e,0x3f68bf3c,0x3f778bc5,0x3f72d4eb,0x3f6d1c1d,0x3f666771
.long 0x3f76ba07,0x3f718f57,0x3f6b4b0c,0x3f63f473,0x3f75dec6,0x3f703b37,0x3f696591,0x3f61668a
.long 0x3f74fa0b,0x3f6ed89e,0x3f676bd8,0x3f5ebe05,0x3f740bdd,0x3f6d67a1,0x3f655e0b,0x3f5bfb34
.long 0x3f731447,0x3f6be858,0x3f633c5a,0x3f591e6a,0x3f721352,0x3f6a5ad9,0x3f6106f2,0x3f5627fe
.long 0x3f710908,0x3f68bf3c,0x3f5ebe05,0x3f531849,0x3f6ff573,0x3f671599,0x3f5c61c7,0x3f4fefa8
.long 0x3f6ed89e,0x3f655e0b,0x3f59f26a,0x3f4cae79,0x3f6db293,0x3f6398ac,0x3f577026,0x3f495521
.long 0x0,0x0,0x0,0x0,0x0,0x3b490fc6,0x3bc90f88,0x3c16cb58
.long 0x0,0x3bc90f88,0x3c490e90,0x3c96c9b6,0x0,0x3c16cb58,0x3c96c9b6,0x3ce22a7a
.long 0x0,0x3c490e90,0x3cc90ab0,0x3d16c32c,0x0,0x3c7b514b,0x3cfb49ba,0x3d3c6dd5
.long 0x0,0x3c96c9b6,0x3d16c32c,0x3d621469,0x0,0x3cafea69,0x3d2fe007,0x3d83db0a
.long 0x0,0x3cc90ab0,0x3d48fb30,0x3d96a905,0x0,0x3ce22a7a,0x3d621469,0x3da973ba
.long 0x0,0x3cfb49ba,0x3d7b2b74,0x3dbc3ac3,0x0,0x3d0a342f,0x3d8a200a,0x3dcefdb7
.long 0x0,0x3d16c32c,0x3d96a905,0x3de1bc2e,0x0,0x3d2351cb,0x3da3308c,0x3df475c0
.long 0x0,0x3d2fe007,0x3dafb680,0x3e039502,0x0,0x3d3c6dd5,0x3dbc3ac3,0x3e0cec4a
.long 0x0,0x3d48fb30,0x3dc8bd36,0x3e164083,0x0,0x3d55880e,0x3dd53db9,0x3e1f917b
.long 0x0,0x3d621469,0x3de1bc2e,0x3e28defc,0x0,0x3d6ea038,0x3dee3876,0x3e3228d4
.long 0x0,0x3d7b2b74,0x3dfab273,0x3e3b6ecf,0x0,0x3d83db0a,0x3e039502,0x3e44b0b9
.long 0x0,0x3d8a200a,0x3e09cf86,0x3e4dee60,0x0,0x3d9064b4,0x3e1008b7,0x3e57278f
.long 0x0,0x3d96a905,0x3e164083,0x3e605c13,0x0,0x3d9cecf9,0x3e1c76de,0x3e698bba
.long 0x0,0x3da3308c,0x3e22abb6,0x3e72b651,0x0,0x3da973ba,0x3e28defc,0x3e7bdba4
.long 0x0,0x3dafb680,0x3e2f10a2,0x3e827dc0,0x0,0x3db5f8da,0x3e354098,0x3e870ada
.long 0x0,0x3dbc3ac3,0x3e3b6ecf,0x3e8b9507,0x0,0x3dc27c39,0x3e419b37,0x3e901c2c
.long 0x0,0x0,0x0,0x0,0x3c490e90,0x3c7b514b,0x3c96c9b6,0x3cafea69
.long 0x3cc90ab0,0x3cfb49ba,0x3d16c32c,0x3d2fe007,0x3d16c32c,0x3d3c6dd5,0x3d621469,0x3d83db0a
.long 0x3d48fb30,0x3d7b2b74,0x3d96a905,0x3dafb680,0x3d7b2b74,0x3d9cecf9,0x3dbc3ac3,0x3ddb7d37
.long 0x3d96a905,0x3dbc3ac3,0x3de1bc2e,0x3e039502,0x3dafb680,0x3ddb7d37,0x3e039502,0x3e195be0
.long 0x3dc8bd36,0x3dfab273,0x3e164083,0x3e2f10a2,0x3de1bc2e,0x3e0cec4a,0x3e28defc,0x3e44b0b9
.long 0x3dfab273,0x3e1c76de,0x3e3b6ecf,0x3e5a3997,0x3e09cf86,0x3e2bf804,0x3e4dee60,0x3e6fa8b2
.long 0x3e164083,0x3e3b6ecf,0x3e605c13,0x3e827dc0,0x3e22abb6,0x3e4ada4f,0x3e72b651,0x3e8d17c0
.long 0x3e2f10a2,0x3e5a3997,0x3e827dc0,0x3e97a117,0x3e3b6ecf,0x3e698bba,0x3e8b9507,0x3ea21887
.long 0x3e47c5c2,0x3e78cfcc,0x3e94a031,0x3eac7cd4,0x3e541501,0x3e840270,0x3e9d9e78,0x3eb6ccc3
.long 0x3e605c13,0x3e8b9507,0x3ea68f12,0x3ec1071e,0x3e6c9a7f,0x3e931f35,0x3eaf713a,0x3ecb2aae
.long 0x3e78cfcc,0x3e9aa086,0x3eb8442a,0x3ed53641,0x3e827dc0,0x3ea21887,0x3ec1071e,0x3edf28a9
.long 0x3e888e93,0x3ea986c4,0x3ec9b953,0x3ee900b7,0x3e8e9a22,0x3eb0eacb,0x3ed25a09,0x3ef2bd43
.long 0x3e94a031,0x3eb8442a,0x3edae880,0x3efc5d27,0x3e9aa086,0x3ebf926f,0x3ee363fa,0x3f02ef9f
.long 0x3ea09ae5,0x3ec6d529,0x3eebcbbb,0x3f07a136,0x3ea68f12,0x3ece0bea,0x3ef41f07,0x3f0c42c9
.long 0x3eac7cd4,0x3ed53641,0x3efc5d27,0x3f10d3cd,0x3eb263ef,0x3edc53c1,0x3f0242b1,0x3f1553b7
.long 0x3eb8442a,0x3ee363fa,0x3f064b82,0x3f19c200,0x3ebe1d4a,0x3eea6681,0x3f0a48ad,0x3f1e1e22
.long 0x3f800000,0x3f800000,0x3f800000,0x3f800000,0x3f7fec43,0x3f7fe705,0x3f7fe129,0x3f7fdaaf
.long 0x3f7fb10f,0x3f7f9c18,0x3f7f84ab,0x3f7f6ac7,0x3f7f4e6d,0x3f7f1f49,0x3f7eea9d,0x3f7eb069
.long 0x3f7ec46d,0x3f7e70b0,0x3f7e1324,0x3f7dabcc,0x3f7e1324,0x3f7d906e,0x3f7cfe73,0x3f7c5d3a
.long 0x3f7d3aac,0x3f7c7eb0,0x3f7baccd,0x3f7ac516,0x3f7c3b28,0x3f7b3bab,0x3f7a1e84,0x3f78e3d6
.long 0x3f7b14be,0x3f79c79d,0x3f7853f8,0x3f76ba07,0x3f79c79d,0x3f7822d1,0x3f764d97,0x3f74484b
.long 0x3f7853f8,0x3f764d97,0x3f740bdd,0x3f718f57,0x3f76ba07,0x3f74484b,0x3f718f57,0x3f6e8ff8
.long 0x3f74fa0b,0x3f721352,0x3f6ed89e,0x3f6b4b0c,0x3f731447,0x3f6faf1b,0x3f6be858,0x3f67c187
.long 0x3f710908,0x3f6d1c1d,0x3f68bf3c,0x3f63f473,0x3f6ed89e,0x3f6a5ad9,0x3f655e0b,0x3f5fe4e9
.long 0x3f6c835e,0x3f676bd8,0x3f61c598,0x3f5b941a,0x3f6a09a7,0x3f644fac,0x3f5df6be,0x3f570348
.long 0x3f676bd8,0x3f6106f2,0x3f59f26a,0x3f5233c6,0x3f64aa59,0x3f5d924d,0x3f55b993,0x3f4d26fd
.long 0x3f61c598,0x3f59f26a,0x3f514d3d,0x3f47de65,0x3f5ebe05,0x3f5627fe,0x3f4cae79,0x3f425b89
.long 0x3f5b941a,0x3f5233c6,0x3f47de65,0x3f3ca003,0x3f584853,0x3f4e1689,0x3f42de29,0x3f36ad7f
.long 0x3f54db31,0x3f49d112,0x3f3daef9,0x3f3085bb,0x3f514d3d,0x3f456439,0x3f385216,0x3f2a2a80
.long 0x3f4d9f02,0x3f40d0da,0x3f32c8c9,0x3f239da9,0x3f49d112,0x3f3c17d9,0x3f2d1469,0x3f1ce11f
.long 0x3f45e403,0x3f373a23,0x3f273656,0x3f15f6d9,0x3f41d870,0x3f3238aa,0x3f212ff9,0x3f0ee0db
.long 0x3f3daef9,0x3f2d1469,0x3f1b02c6,0x3f07a136,0x3f396842,0x3f27ce61,0x3f14b039,0x3f003a06
.long 0x3f800000,0x3f800000,0x3f800000,0x3f800000,0x3f7fd397,0x3f7fcbe2,0x3f7fc38f,0x3f7fba9e
.long 0x3f7f4e6d,0x3f7f2f9d,0x3f7f0e58,0x3f7eea9d,0x3f7e70b0,0x3f7e2b72,0x3f7de0b1,0x3f7d906e
.long 0x3f7d3aac,0x3f7cbfc9,0x3f7c3b28,0x3f7baccd,0x3f7baccd,0x3f7aed37,0x3f7a1e84,0x3f7940c0
.long 0x3f79c79d,0x3f78b47b,0x3f778bc5,0x3f764d97,0x3f778bc5,0x3f76167a,0x3f748422,0x3f72d4eb
.long 0x3f74fa0b,0x3f731447,0x3f710908,0x3f6ed89e,0x3f721352,0x3f6faf1b,0x3f6d1c1d,0x3f6a5ad9
.long 0x3f6ed89e,0x3f6be858,0x3f68bf3c,0x3f655e0b,0x3f6b4b0c,0x3f67c187,0x3f63f473,0x3f5fe4e9
.long 0x3f676bd8,0x3f633c5a,0x3f5ebe05,0x3f59f26a,0x3f633c5a,0x3f5e5aa6,0x3f591e6a,0x3f5389c7
.long 0x3f5ebe05,0x3f591e6a,0x3f531849,0x3f4cae79,0x3f59f26a,0x3f5389c7,0x3f4cae79,0x3f456439
.long 0x3f54db31,0x3f4d9f02,0x3f45e403,0x3f3daef9,0x3f4f7a1f,0x3f476085,0x3f3ebc1b,0x3f3592e7
.long 0x3f49d112,0x3f40d0da,0x3f373a23,0x3f2d1469,0x3f43e200,0x3f39f2ac,0x3f2f61a5,0x3f24381a
.long 0x3f3daef9,0x3f32c8c9,0x3f273656,0x3f1b02c6,0x3f373a23,0x3f2b561b,0x3f1ebc12,0x3f11796b
.long 0x3f3085bb,0x3f239da9,0x3f15f6d9,0x3f07a136,0x3f299415,0x3f1ba299,0x3f0cead0,0x3efafef7
.long 0x3f226799,0x3f13682a,0x3f039c3d,0x3ee63375,0x3f1b02c6,0x3f0af1b7,0x3ef41f07,0x3ed0eb2a
.long 0x3f13682a,0x3f0242b1,0x3ee0924f,0x3ebb31a0,0x3f0b9a6b,0x3ef2bd43,0x3ecc9b8b,0x3ea5129f
.long 0x3f039c3d,0x3ee0924f,0x3eb8442a,0x3e8e9a22,0x3ef6e0cb,0x3ece0bea,0x3ea395c5,0x3e6fa8b2
.long 0x3ee63375,0x3ebb31a0,0x3e8e9a22,0x3e419b37,0x3ed53641,0x3ea80b1f,0x3e72b651,0x3e1324ca
.long 0x0,0x0,0x0,0x0,0x3cc90ab0,0x3ce22a7a,0x3cfb49ba,0x3d0a342f
.long 0x3d48fb30,0x3d621469,0x3d7b2b74,0x3d8a200a,0x3d96a905,0x3da973ba,0x3dbc3ac3,0x3dcefdb7
.long 0x3dc8bd36,0x3de1bc2e,0x3dfab273,0x3e09cf86,0x3dfab273,0x3e0cec4a,0x3e1c76de,0x3e2bf804
.long 0x3e164083,0x3e28defc,0x3e3b6ecf,0x3e4dee60,0x3e2f10a2,0x3e44b0b9,0x3e5a3997,0x3e6fa8b2
.long 0x3e47c5c2,0x3e605c13,0x3e78cfcc,0x3e888e93,0x3e605c13,0x3e7bdba4,0x3e8b9507,0x3e9920fe
.long 0x3e78cfcc,0x3e8b9507,0x3e9aa086,0x3ea986c4,0x3e888e93,0x3e9920fe,0x3ea986c4,0x3eb9bb1e
.long 0x3e94a031,0x3ea68f12,0x3eb8442a,0x3ec9b953,0x3ea09ae5,0x3eb3dca5,0x3ec6d529,0x3ed97cb9
.long 0x3eac7cd4,0x3ec1071e,0x3ed53641,0x3ee900b7,0x3eb8442a,0x3ece0bea,0x3ee363fa,0x3ef840c8
.long 0x3ec3ef15,0x3edae880,0x3ef15aea,0x3f039c3d,0x3ecf7bca,0x3ee79a5d,0x3eff17b2,0x3f0af1b7
.long 0x3edae880,0x3ef41f07,0x3f064b82,0x3f121eb0,0x3ee63375,0x3f003a06,0x3f0cead0,0x3f19210f
.long 0x3ef15aea,0x3f064b82,0x3f13682a,0x3f1ff6cb,0x3efc5d27,0x3f0c42c9,0x3f19c200,0x3f269de3
.long 0x3f039c3d,0x3f121eb0,0x3f1ff6cb,0x3f2d1469,0x3f08f59b,0x3f17de12,0x3f26050a,0x3f33587a
.long 0x3f0e39da,0x3f1d7fd1,0x3f2beb4a,0x3f396842,0x3f13682a,0x3f2302d3,0x3f31a81d,0x3f3f41fc
.long 0x3f187fc0,0x3f286605,0x3f373a23,0x3f44e3f5,0x3f1d7fd1,0x3f2da859,0x3f3ca003,0x3f4a4c87
.long 0x3f226799,0x3f32c8c9,0x3f41d870,0x3f4f7a1f,0x3f273656,0x3f37c655,0x3f46e22a,0x3f546b3b
.long 0x3f2beb4a,0x3f3ca003,0x3f4bbbf8,0x3f591e6a,0x3f3085bb,0x3f4154e1,0x3f5064af,0x3f5d924d
.long 0x0,0x0,0x0,0x0,0x3d16c32c,0x3d2351cb,0x3d2fe007,0x3d3c6dd5
.long 0x3d96a905,0x3da3308c,0x3dafb680,0x3dbc3ac3,0x3de1bc2e,0x3df475c0,0x3e039502,0x3e0cec4a
.long 0x3e164083,0x3e22abb6,0x3e2f10a2,0x3e3b6ecf,0x3e3b6ecf,0x3e4ada4f,0x3e5a3997,0x3e698bba
.long 0x3e605c13,0x3e72b651,0x3e827dc0,0x3e8b9507,0x3e827dc0,0x3e8d17c0,0x3e97a117,0x3ea21887
.long 0x3e94a031,0x3ea09ae5,0x3eac7cd4,0x3eb8442a,0x3ea68f12,0x3eb3dca5,0x3ec1071e,0x3ece0bea
.long 0x3eb8442a,0x3ec6d529,0x3ed53641,0x3ee363fa,0x3ec9b953,0x3ed97cb9,0x3ee900b7,0x3ef840c8
.long 0x3edae880,0x3eebcbbb,0x3efc5d27,0x3f064b82,0x3eebcbbb,0x3efdbabb,0x3f07a136,0x3f102dd5
.long 0x3efc5d27,0x3f07a136,0x3f10d3cd,0x3f19c200,0x3f064b82,0x3f102dd5,0x3f19c200,0x3f2302d3
.long 0x3f0e39da,0x3f187fc0,0x3f226799,0x3f2beb4a,0x3f15f6d9,0x3f209393,0x3f2ac082,0x3f34768f
.long 0x3f1d7fd1,0x3f286605,0x3f32c8c9,0x3f3ca003,0x3f24d225,0x3f2ff3e6,0x3f3a7ca4,0x3f446337
.long 0x3f2beb4a,0x3f373a23,0x3f41d870,0x3f4bbbf8,0x3f32c8c9,0x3f3e35c5,0x3f48d8b3,0x3f52a649
.long 0x3f396842,0x3f44e3f5,0x3f4f7a1f,0x3f591e6a,0x3f3fc767,0x3f4b41fa,0x3f55b993,0x3f5f20db
.long 0x3f45e403,0x3f514d3d,0x3f5b941a,0x3f64aa59,0x3f4bbbf8,0x3f570348,0x3f6106f2,0x3f69b7e4
.long 0x3f514d3d,0x3f5c61c7,0x3f660f88,0x3f6e46be,0x3f5695e5,0x3f61668a,0x3f6aab7b,0x3f725470
.long 0x3f5b941a,0x3f660f88,0x3f6ed89e,0x3f75dec6,0x3f604621,0x3f6a5ad9,0x3f7294f8,0x3f78e3d6
.long 0x3f64aa59,0x3f6e46be,0x3f75dec6,0x3f7b61fc,0x3f68bf3c,0x3f71d19f,0x3f78b47b,0x3f7d57de
.long 0x3f800000,0x3f800000,0x3f800000,0x3f800000,0x3f7fb10f,0x3f7fa6e3,0x3f7f9c18,0x3f7f90b1
.long 0x3f7ec46d,0x3f7e9bc9,0x3f7e70b0,0x3f7e4323,0x3f7d3aac,0x3f7cdf6c,0x3f7c7eb0,0x3f7c187a
.long 0x3f7b14be,0x3f7a7302,0x3f79c79d,0x3f791298,0x3f7853f8,0x3f77583a,0x3f764d97,0x3f75341d
.long 0x3f74fa0b,0x3f73913f,0x3f721352,0x3f708066,0x3f710908,0x3f6f20b0,0x3f6d1c1d,0x3f6afb8c
.long 0x3f6c835e,0x3f6a09a7,0x3f676bd8,0x3f64aa59,0x3f676bd8,0x3f644fac,0x3f6106f2,0x3f5d924d
.long 0x3f61c598,0x3f5df6be,0x3f59f26a,0x3f55b993,0x3f5b941a,0x3f570348,0x3f5233c6,0x3f4d26fd
.long 0x3f54db31,0x3f4f7a1f,0x3f49d112,0x3f43e200,0x3f4d9f02,0x3f476085,0x3f40d0da,0x3f39f2ac
.long 0x3f45e403,0x3f3ebc1b,0x3f373a23,0x3f2f61a5,0x3f3daef9,0x3f3592e7,0x3f2d1469,0x3f24381a
.long 0x3f3504f3,0x3f2beb4a,0x3f226799,0x3f187fc0,0x3f2beb4a,0x3f21cbfb,0x3f173c07,0x3f0c42c9
.long 0x3f226799,0x3f173c07,0x3f0b9a6b,0x3eff17b2,0x3f187fc0,0x3f0c42c9,0x3eff17b2,0x3ee4cbfe
.long 0x3f0e39da,0x3f00e7e4,0x3ee63375,0x3ec9b953,0x3f039c3d,0x3eea6681,0x3ecc9b8b,0x3eadf73c
.long 0x3ef15aea,0x3ed25a09,0x3eb263ef,0x3e919ddd,0x3edae880,0x3eb9bb1e,0x3e97a117,0x3e698bba
.long 0x3ec3ef15,0x3ea09ae5,0x3e78cfcc,0x3e2f10a2,0x3eac7cd4,0x3e870ada,0x3e419b37,0x3de7fa9a
.long 0x3e94a031,0x3e5a3997,0x3e09cf86,0x3d621469,0x3e78cfcc,0x3e25c58c,0x3da3308c,0xbb490fc6
.long 0x3e47c5c2,0x3de1bc2e,0x3cc90ab0,0xbd7b2b74,0x3e164083,0x3d6ea038,0xbcfb49ba,0xbdf475c0
.long 0x3dc8bd36,0x3bc90f88,0xbdafb680,0xbe354098,0x3d48fb30,0xbd3c6dd5,0xbe1008b7,0xbe6fa8b2
.long 0x3f800000,0x3f800000,0x3f800000,0x3f800000,0x3f7f84ab,0x3f7f7808,0x3f7f6ac7,0x3f7f5ce9
.long 0x3f7e1324,0x3f7de0b1,0x3f7dabcc,0x3f7d7474,0x3f7baccd,0x3f7b3bab,0x3f7ac516,0x3f7a4910
.long 0x3f7853f8,0x3f778bc5,0x3f76ba07,0x3f75dec6,0x3f740bdd,0x3f72d4eb,0x3f718f57,0x3f703b37
.long 0x3f6ed89e,0x3f6d1c1d,0x3f6b4b0c,0x3f696591,0x3f68bf3c,0x3f666771,0x3f63f473,0x3f61668a
.long 0x3f61c598,0x3f5ebe05,0x3f5b941a,0x3f584853,0x3f59f26a,0x3f5627fe,0x3f5233c6,0x3f4e1689
.long 0x3f514d3d,0x3f4cae79,0x3f47de65,0x3f42de29,0x3f47de65,0x3f425b89,0x3f3ca003,0x3f36ad7f
.long 0x3f3daef9,0x3f373a23,0x3f3085bb,0x3f299415,0x3f32c8c9,0x3f2b561b,0x3f239da9,0x3f1ba299
.long 0x3f273656,0x3f1ebc12,0x3f15f6d9,0x3f0cead0,0x3f1b02c6,0x3f11796b,0x3f07a136,0x3efafef7
.long 0x3f0e39da,0x3f039c3d,0x3ef15aea,0x3edae880,0x3f00e7e4,0x3eea6681,0x3ed25a09,0x3eb9bb1e
.long 0x3ee63375,0x3ecc9b8b,0x3eb263ef,0x3e97a117,0x3ec9b953,0x3eadf73c,0x3e919ddd,0x3e698bba
.long 0x3eac7cd4,0x3e8e9a22,0x3e605c13,0x3e22abb6,0x3e8e9a22,0x3e5d4b1a,0x3e1c76de,0x3db5f8da
.long 0x3e605c13,0x3e1c76de,0x3dafb680,0x3c96c9b6,0x3e22abb6,0x3db5f8da,0x3c96c9b6,0xbd55880e
.long 0x3dc8bd36,0x3cc90ab0,0xbd48fb30,0xbdfab273,0x3d16c32c,0xbd2351cb,0xbdee3876,0xbe44b0b9
.long 0xbcc90ab0,0xbdd53db9,0xbe3b6ecf,0xbe8586ce,0xbdafb680,0xbe2bf804,0xbe7ee6e1,0xbea80b1f
.long 0xbe164083,0xbe6c9a7f,0xbea09ae5,0xbec9b953,0xbe541501,0xbe9620d2,0xbec1071e,0xbeea6681
.long 0xbe888e93,0xbeb554ec,0xbee0924f,0xbf04f484,0xbea68f12,0xbed3c867,0xbeff17b2,0xbf140c5f
.long 0x0,0x0,0x0,0x0,0x3d48fb30,0x3d55880e,0x3d621469,0x3d6ea038
.long 0x3dc8bd36,0x3dd53db9,0x3de1bc2e,0x3dee3876,0x3e164083,0x3e1f917b,0x3e28defc,0x3e3228d4
.long 0x3e47c5c2,0x3e541501,0x3e605c13,0x3e6c9a7f,0x3e78cfcc,0x3e840270,0x3e8b9507,0x3e931f35
.long 0x3e94a031,0x3e9d9e78,0x3ea68f12,0x3eaf713a,0x3eac7cd4,0x3eb6ccc3,0x3ec1071e,0x3ecb2aae
.long 0x3ec3ef15,0x3ecf7bca,0x3edae880,0x3ee63375,0x3edae880,0x3ee79a5d,0x3ef41f07,0x3f003a06
.long 0x3ef15aea,0x3eff17b2,0x3f064b82,0x3f0cead0,0x3f039c3d,0x3f0af1b7,0x3f121eb0,0x3f19210f
.long 0x3f0e39da,0x3f15f6d9,0x3f1d7fd1,0x3f24d225,0x3f187fc0,0x3f209393,0x3f286605,0x3f2ff3e6
.long 0x3f226799,0x3f2ac082,0x3f32c8c9,0x3f3a7ca4,0x3f2beb4a,0x3f34768f,0x3f3ca003,0x3f446337
.long 0x3f3504f3,0x3f3daef9,0x3f45e403,0x3f4d9f02,0x3f3daef9,0x3f466354,0x3f4e8d90,0x3f5627fe
.long 0x3f45e403,0x3f4e8d90,0x3f5695e5,0x3f5df6be,0x3f4d9f02,0x3f5627fe,0x3f5df6be,0x3f650479
.long 0x3f54db31,0x3f5d2d53,0x3f64aa59,0x3f6b4b0c,0x3f5b941a,0x3f6398ac,0x3f6aab7b,0x3f70c501
.long 0x3f61c598,0x3f696591,0x3f6ff573,0x3f756d97,0x3f676bd8,0x3f6e8ff8,0x3f748422,0x3f7940c0
.long 0x3f6c835e,0x3f731447,0x3f7853f8,0x3f7c3b28,0x3f710908,0x3f76ef5b,0x3f7b61fc,0x3f7e5a38
.long 0x3f74fa0b,0x3f7a1e84,0x3f7dabcc,0x3f7f9c18,0x3f7853f8,0x3f7c9f8a,0x3f7f2f9d,0x3f7fffb1
.long 0x3f7b14be,0x3f7e70b0,0x3f7fec43,0x3f7f84ab,0x3f7d3aac,0x3f7f90b1,0x3f7fe129,0x3f7e2b72
.long 0x3f7ec46d,0x3f7ffec4,0x3f7f0e58,0x3f7bf531,0x3f7fb10f,0x3f7fba9e,0x3f7d7474,0x3f78e3d6
.long 0x0,0x0,0x0,0x0,0x3d7b2b74,0x3d83db0a,0x3d8a200a,0x3d9064b4
.long 0x3dfab273,0x3e039502,0x3e09cf86,0x3e1008b7,0x3e3b6ecf,0x3e44b0b9,0x3e4dee60,0x3e57278f
.long 0x3e78cfcc,0x3e827dc0,0x3e888e93,0x3e8e9a22,0x3e9aa086,0x3ea21887,0x3ea986c4,0x3eb0eacb
.long 0x3eb8442a,0x3ec1071e,0x3ec9b953,0x3ed25a09,0x3ed53641,0x3edf28a9,0x3ee900b7,0x3ef2bd43
.long 0x3ef15aea,0x3efc5d27,0x3f039c3d,0x3f08f59b,0x3f064b82,0x3f0c42c9,0x3f121eb0,0x3f17de12
.long 0x3f13682a,0x3f19c200,0x3f1ff6cb,0x3f26050a,0x3f1ff6cb,0x3f269de3,0x3f2d1469,0x3f33587a
.long 0x3f2beb4a,0x3f32c8c9,0x3f396842,0x3f3fc767,0x3f373a23,0x3f3e35c5,0x3f44e3f5,0x3f4b41fa
.long 0x3f41d870,0x3f48d8b3,0x3f4f7a1f,0x3f55b993,0x3f4bbbf8,0x3f52a649,0x3f591e6a,0x3f5f20db
.long 0x3f54db31,0x3f5b941a,0x3f61c598,0x3f676bd8,0x3f5d2d53,0x3f6398ac,0x3f696591,0x3f6e8ff8
.long 0x3f64aa59,0x3f6aab7b,0x3f6ff573,0x3f748422,0x3f6b4b0c,0x3f70c501,0x3f756d97,0x3f7940c0
.long 0x3f710908,0x3f75dec6,0x3f79c79d,0x3f7cbfc9,0x3f75dec6,0x3f79f35e,0x3f7cfe73,0x3f7efcc9
.long 0x3f79c79d,0x3f7cfe73,0x3f7f0e58,0x3f7ff4e6,0x3f7cbfc9,0x3f7efcc9,0x3f7ff4e6,0x3f7fa6e3
.long 0x3f7ec46d,0x3f7fec43,0x3f7fb10f,0x3f7e1324,0x3f7fd397,0x3f7fcbe2,0x3f7e4323,0x3f7b3bab
.long 0x3f7fec43,0x3f7e9bc9,0x3f7baccd,0x3f772417,0x3f7f0e58,0x3f7c5d3a,0x3f77f110,0x3f71d19f
.long 0x3f7d3aac,0x3f791298,0x3f731447,0x3f6b4b0c,0x3f7a7302,0x3f74bf62,0x3f6d1c1d,0x3f6398ac
.long 0x3f76ba07,0x3f6f6830,0x3f660f88,0x3f5ac450,0x3f721352,0x3f6912ae,0x3f5df6be,0x3f50d937
.long 0x3f800000,0x3f800000,0x3f800000,0x3f800000,0x3f7f4e6d,0x3f7f3f54,0x3f7f2f9d,0x3f7f1f49
.long 0x3f7d3aac,0x3f7cfe73,0x3f7cbfc9,0x3f7c7eb0,0x3f79c79d,0x3f7940c0,0x3f78b47b,0x3f7822d1
.long 0x3f74fa0b,0x3f740bdd,0x3f731447,0x3f721352,0x3f6ed89e,0x3f6d67a1,0x3f6be858,0x3f6a5ad9
.long 0x3f676bd8,0x3f655e0b,0x3f633c5a,0x3f6106f2,0x3f5ebe05,0x3f5bfb34,0x3f591e6a,0x3f5627fe
.long 0x3f54db31,0x3f514d3d,0x3f4d9f02,0x3f49d112,0x3f49d112,0x3f456439,0x3f40d0da,0x3f3c17d9
.long 0x3f3daef9,0x3f385216,0x3f32c8c9,0x3f2d1469,0x3f3085bb,0x3f2a2a80,0x3f239da9,0x3f1ce11f
.long 0x3f226799,0x3f1b02c6,0x3f13682a,0x3f0b9a6b,0x3f13682a,0x3f0af1b7,0x3f0242b1,0x3ef2bd43
.long 0x3f039c3d,0x3ef41f07,0x3ee0924f,0x3ecc9b8b,0x3ee63375,0x3ed0eb2a,0x3ebb31a0,0x3ea5129f
.long 0x3ec3ef15,0x3eac7cd4,0x3e94a031,0x3e78cfcc,0x3ea09ae5,0x3e870ada,0x3e5a3997,0x3e25c58c
.long 0x3e78cfcc,0x3e419b37,0x3e09cf86,0x3da3308c,0x3e2f10a2,0x3de7fa9a,0x3d621469,0xbb490fc6
.long 0x3dc8bd36,0x3d16c32c,0xbcc90ab0,0xbdafb680,0x3cc90ab0,0xbd2351cb,0xbdd53db9,0xbe2bf804
.long 0xbd48fb30,0xbdee3876,0xbe3b6ecf,0xbe7ee6e1,0xbdfab273,0xbe44b0b9,0xbe8586ce,0xbea80b1f
.long 0xbe47c5c2,0xbe888e93,0xbeac7cd4,0xbecf7bca,0xbe888e93,0xbeadf73c,0xbed25a09,0xbef58035
.long 0xbeac7cd4,0xbed25a09,0xbef6e0cb,0xbf0cead0,0xbecf7bca,0xbef58035,0xbf0cead0,0xbf1e1e22
.long 0xbef15aea,0xbf0b9a6b,0xbf1d7fd1,0xbf2e3bde,0xbf08f59b,0xbf1ba299,0xbf2d1469,0xbf3d27b8
.long 0xbf187fc0,0xbf2ac082,0xbf3b8f3b,0xbf4ac77f,0xbf273656,0xbf38dd65,0xbf48d8b3,0xbf570348
.long 0x3f800000,0x3f800000,0x3f800000,0x3f800000,0x3f7f0e58,0x3f7efcc9,0x3f7eea9d,0x3f7ed7d4
.long 0x3f7c3b28,0x3f7bf531,0x3f7baccd,0x3f7b61fc,0x3f778bc5,0x3f76ef5b,0x3f764d97,0x3f75a67b
.long 0x3f710908,0x3f6ff573,0x3f6ed89e,0x3f6db293,0x3f68bf3c,0x3f671599,0x3f655e0b,0x3f6398ac
.long 0x3f5ebe05,0x3f5c61c7,0x3f59f26a,0x3f577026,0x3f531849,0x3f4fefa8,0x3f4cae79,0x3f495521
.long 0x3f45e403,0x3f41d870,0x3f3daef9,0x3f396842,0x3f373a23,0x3f3238aa,0x3f2d1469,0x3f27ce61
.long 0x3f273656,0x3f212ff9,0x3f1b02c6,0x3f14b039,0x3f15f6d9,0x3f0ee0db,0x3f07a136,0x3f003a06
.long 0x3f039c3d,0x3ef6e0cb,0x3ee63375,0x3ed53641,0x3ee0924f,0x3ece0bea,0x3ebb31a0,0x3ea80b1f
.long 0x3eb8442a,0x3ea395c5,0x3e8e9a22,0x3e72b651,0x3e8e9a22,0x3e6fa8b2,0x3e419b37,0x3e1324ca
.long 0x3e47c5c2,0x3e164083,0x3dc8bd36,0x3d48fb30,0x3de1bc2e,0x3d6ea038,0x3bc90f88,0xbd3c6dd5
.long 0x3cc90ab0,0xbcfb49ba,0xbdafb680,0xbe1008b7,0xbd7b2b74,0xbdf475c0,0xbe354098,0xbe6fa8b2
.long 0xbe164083,0xbe541501,0xbe888e93,0xbea68f12,0xbe6c9a7f,0xbe9620d2,0xbeb554ec,0xbed3c867
.long 0xbea09ae5,0xbec1071e,0xbee0924f,0xbeff17b2,0xbec9b953,0xbeea6681,0xbf04f484,0xbf140c5f
.long 0xbef15aea,0xbf08f59b,0xbf187fc0,0xbf273656,0xbf0b9a6b,0xbf1ba299,0xbf2ac082,0xbf38dd65
.long 0xbf1d7fd1,0xbf2d1469,0xbf3b8f3b,0xbf48d8b3,0xbf2e3bde,0xbf3d27b8,0xbf4ac77f,0xbf570348
.long 0xbf3daef9,0xbf4bbbf8,0xbf584853,0xbf633c5a,0xbf4bbbf8,0xbf58b3a1,0xbf63f473,0xbf6d67a1
.long 0xbf584853,0xbf63f473,0xbf6db293,0xbf756d97,0xbf633c5a,0xbf6d67a1,0xbf756d97,0xbf7b3bab
.long 0x0,0x0,0x0,0x0,0x3d96a905,0x3d9cecf9,0x3da3308c,0x3da973ba
.long 0x3e164083,0x3e1c76de,0x3e22abb6,0x3e28defc,0x3e605c13,0x3e698bba,0x3e72b651,0x3e7bdba4
.long 0x3e94a031,0x3e9aa086,0x3ea09ae5,0x3ea68f12,0x3eb8442a,0x3ebf926f,0x3ec6d529,0x3ece0bea
.long 0x3edae880,0x3ee363fa,0x3eebcbbb,0x3ef41f07,0x3efc5d27,0x3f02ef9f,0x3f07a136,0x3f0c42c9
.long 0x3f0e39da,0x3f13682a,0x3f187fc0,0x3f1d7fd1,0x3f1d7fd1,0x3f2302d3,0x3f286605,0x3f2da859
.long 0x3f2beb4a,0x3f31a81d,0x3f373a23,0x3f3ca003,0x3f396842,0x3f3f41fc,0x3f44e3f5,0x3f4a4c87
.long 0x3f45e403,0x3f4bbbf8,0x3f514d3d,0x3f5695e5,0x3f514d3d,0x3f570348,0x3f5c61c7,0x3f61668a
.long 0x3f5b941a,0x3f6106f2,0x3f660f88,0x3f6aab7b,0x3f64aa59,0x3f69b7e4,0x3f6e46be,0x3f725470
.long 0x3f6c835e,0x3f710908,0x3f74fa0b,0x3f7853f8,0x3f731447,0x3f76ef5b,0x3f7a1e84,0x3f7c9f8a
.long 0x3f7853f8,0x3f7b61fc,0x3f7dabcc,0x3f7f2f9d,0x3f7c3b28,0x3f7e5a38,0x3f7f9c18,0x3f7fffb1
.long 0x3f7ec46d,0x3f7fd397,0x3f7fec43,0x3f7f0e58,0x3f7fec43,0x3f7fcbe2,0x3f7e9bc9,0x3f7c5d3a
.long 0x3f7fb10f,0x3f7e4323,0x3f7baccd,0x3f77f110,0x3f7e1324,0x3f7b3bab,0x3f772417,0x3f71d19f
.long 0x3f7b14be,0x3f76ba07,0x3f710908,0x3f6a09a7,0x3f76ba07,0x3f70c501,0x3f696591,0x3f60a6cf
.long 0x3f710908,0x3f696591,0x3f604621,0x3f55b993,0x3f6a09a7,0x3f60a6cf,0x3f55b993,0x3f495521
.long 0x3f61c598,0x3f5695e5,0x3f49d112,0x3f3b8f3b,0x3f584853,0x3f4b41fa,0x3f3ca003,0x3f2c800f
.long 0x3f4d9f02,0x3f3ebc1b,0x3f2e3bde,0x3f1c420c,0x3f41d870,0x3f311722,0x3f1ebc12,0x3f0af1b7
.long 0x0,0x0,0x0,0x0,0x3dafb680,0x3db5f8da,0x3dbc3ac3,0x3dc27c39
.long 0x3e2f10a2,0x3e354098,0x3e3b6ecf,0x3e419b37,0x3e827dc0,0x3e870ada,0x3e8b9507,0x3e901c2c
.long 0x3eac7cd4,0x3eb263ef,0x3eb8442a,0x3ebe1d4a,0x3ed53641,0x3edc53c1,0x3ee363fa,0x3eea6681
.long 0x3efc5d27,0x3f0242b1,0x3f064b82,0x3f0a48ad,0x3f10d3cd,0x3f1553b7,0x3f19c200,0x3f1e1e22
.long 0x3f226799,0x3f273656,0x3f2beb4a,0x3f3085bb,0x3f32c8c9,0x3f37c655,0x3f3ca003,0x3f4154e1
.long 0x3f41d870,0x3f46e22a,0x3f4bbbf8,0x3f5064af,0x3f4f7a1f,0x3f546b3b,0x3f591e6a,0x3f5d924d
.long 0x3f5b941a,0x3f604621,0x3f64aa59,0x3f68bf3c,0x3f660f88,0x3f6a5ad9,0x3f6e46be,0x3f71d19f
.long 0x3f6ed89e,0x3f7294f8,0x3f75dec6,0x3f78b47b,0x3f75dec6,0x3f78e3d6,0x3f7b61fc,0x3f7d57de
.long 0x3f7b14be,0x3f7d3aac,0x3f7ec46d,0x3f7fb10f,0x3f7e70b0,0x3f7f90b1,0x3f7ffec4,0x3f7fba9e
.long 0x3f7fec43,0x3f7fe129,0x3f7f0e58,0x3f7d7474,0x3f7f84ab,0x3f7e2b72,0x3f7bf531,0x3f78e3d6
.long 0x3f7d3aac,0x3f7a7302,0x3f76ba07,0x3f721352,0x3f791298,0x3f74bf62,0x3f6f6830,0x3f6912ae
.long 0x3f731447,0x3f6d1c1d,0x3f660f88,0x3f5df6be,0x3f6b4b0c,0x3f6398ac,0x3f5ac450,0x3f50d937
.long 0x3f61c598,0x3f584853,0x3f4d9f02,0x3f41d870,0x3f5695e5,0x3f4b41fa,0x3f3ebc1b,0x3f311722
.long 0x3f49d112,0x3f3ca003,0x3f2e3bde,0x3f1ebc12,0x3f3b8f3b,0x3f2c800f,0x3f1c420c,0x3f0af1b7
.long 0x3f2beb4a,0x3f1b02c6,0x3f08f59b,0x3eebcbbb,0x3f1b02c6,0x3f084b92,0x3ee900b7,0x3ebf926f
.long 0x3f08f59b,0x3ee900b7,0x3ebe1d4a,0x3e919ddd,0x3eebcbbb,0x3ebf926f,0x3e919ddd,0x3e44b0b9
.long 0x3f800000,0x3f800000,0x3f800000,0x3f800000,0x3f7ec46d,0x3f7eb069,0x3f7e9bc9,0x3f7e868b
.long 0x3f7b14be,0x3f7ac516,0x3f7a7302,0x3f7a1e84,0x3f74fa0b,0x3f74484b,0x3f73913f,0x3f72d4eb
.long 0x3f6c835e,0x3f6b4b0c,0x3f6a09a7,0x3f68bf3c,0x3f61c598,0x3f5fe4e9,0x3f5df6be,0x3f5bfb34
.long 0x3f54db31,0x3f5233c6,0x3f4f7a1f,0x3f4cae79,0x3f45e403,0x3f425b89,0x3f3ebc1b,0x3f3b0629
.long 0x3f3504f3,0x3f3085bb,0x3f2beb4a,0x3f273656,0x3f226799,0x3f1ce11f,0x3f173c07,0x3f11796b
.long 0x3f0e39da,0x3f07a136,0x3f00e7e4,0x3ef41f07,0x3ef15aea,0x3ee1fb6a,0x3ed25a09,0x3ec27b55
.long 0x3ec3ef15,0x3eb263ef,0x3ea09ae5,0x3e8e9a22,0x3e94a031,0x3e80f8c0,0x3e5a3997,0x3e3228d4
.long 0x3e47c5c2,0x3e1c76de,0x3de1bc2e,0x3d8a200a,0x3dc8bd36,0x3d55880e,0x3bc90f88,0xbd2351cb
.long 0x248d3132,0xbd48fb30,0xbdc8bd36,0xbe164083,0xbdc8bd36,0xbe195be0,0xbe4dee60,0xbe80f8c0
.long 0xbe47c5c2,0xbe7ee6e1,0xbe9aa086,0xbeb554ec,0xbe94a031,0xbeb0eacb,0xbecc9b8b,0xbee79a5d
.long 0xbec3ef15,0xbee0924f,0xbefc5d27,0xbf0b9a6b,0xbef15aea,0xbf06f686,0xbf14b039,0xbf21cbfb
.long 0xbf0e39da,0xbf1c420c,0xbf299415,0xbf36206c,0xbf226799,0xbf2ff3e6,0xbf3ca003,0xbf485bca
.long 0xbf3504f3,0xbf41d870,0xbf4d9f02,0xbf584853,0xbf45e403,0xbf51c0c2,0xbf5c61c7,0xbf65b710
.long 0xbf54db31,0xbf5f8327,0xbf68bf3c,0xbf708066,0xbf61c598,0xbf6afb8c,0xbf7294f8,0xbf788486
.long 0xbf6c835e,0xbf740bdd,0xbf79c79d,0xbf7dabcc,0xbf74fa0b,0xbf7a9c59,0xbf7e4323,0xbf7fe705
.long 0xbf7b14be,0xbf7e9bc9,0xbf7ffb11,0xbf7f2f9d,0xbf7ec46d,0xbf7fffb1,0xbf7eea9d,0xbf7b87b2
.long 0x3f800000,0x3f800000,0x3f800000,0x3f800000,0x3f7e70b0,0x3f7e5a38,0x3f7e4323,0x3f7e2b72
.long 0x3f79c79d,0x3f796e4e,0x3f791298,0x3f78b47b,0x3f721352,0x3f714c7a,0x3f708066,0x3f6faf1b
.long 0x3f676bd8,0x3f660f88,0x3f64aa59,0x3f633c5a,0x3f59f26a,0x3f57dc7f,0x3f55b993,0x3f5389c7
.long 0x3f49d112,0x3f46e22a,0x3f43e200,0x3f40d0da,0x3f373a23,0x3f33587a,0x3f2f61a5,0x3f2b561b
.long 0x3f226799,0x3f1d7fd1,0x3f187fc0,0x3f13682a,0x3f0b9a6b,0x3f05a02c,0x3eff17b2,0x3ef2bd43
.long 0x3ee63375,0x3ed8106b,0x3ec9b953,0x3ebb31a0,0x3eb263ef,0x3ea21887,0x3e919ddd,0x3e80f8c0
.long 0x3e78cfcc,0x3e541501,0x3e2f10a2,0x3e09cf86,0x3e09cf86,0x3dc27c39,0x3d621469,0x3c7b514b
.long 0x3cc90ab0,0xbc96c9b6,0xbd7b2b74,0xbdd53db9,0xbdafb680,0xbe06b26e,0xbe354098,0xbe636c83
.long 0xbe47c5c2,0xbe78cfcc,0xbe94a031,0xbeac7cd4,0xbe9aa086,0xbeb3dca5,0xbecc9b8b,0xbee4cbfe
.long 0xbecf7bca,0xbee900b7,0xbf00e7e4,0xbf0cead0,0xbf00e7e4,0xbf0d9281,0xbf19c200,0xbf256bcb
.long 0xbf187fc0,0xbf24d225,0xbf3085bb,0xbf3b8f3b,0xbf2e3bde,0xbf39f2ac,0xbf44e3f5,0xbf4f0417
.long 0xbf41d870,0xbf4cae79,0xbf5695e5,0xbf5f8327,0xbf531849,0xbf5cc7d1,0xbf655e0b,0xbf6cd007
.long 0xbf61c598,0xbf6a09a7,0xbf710908,0xbf76ba07,0xbf6db293,0xbf74484b,0xbf796e4e,0xbf7d1cdd
.long 0xbf76ba07,0xbf7b61fc,0xbf7e70b0,0xbf7fe129,0xbf7cbfc9,0xbf7f3f54,0xbf7ffec4,0xbf7efcc9
.long 0xbf7fb10f,0xbf7fd397,0xbf7e1324,0xbf7a7302,0xbf7f84ab,0xbf7d1cdd,0xbf78b47b,0xbf725470
.long 0xbf7c3b28,0xbf772417,0xbf6ff573,0xbf66becc,0xbf75dec6,0xbf6dfcf2,0xbf63f473,0xbf57dc7f
.long 0x0,0x0,0x0,0x0,0x3dc8bd36,0x3dcefdb7,0x3dd53db9,0x3ddb7d37
.long 0x3e47c5c2,0x3e4dee60,0x3e541501,0x3e5a3997,0x3e94a031,0x3e9920fe,0x3e9d9e78,0x3ea21887
.long 0x3ec3ef15,0x3ec9b953,0x3ecf7bca,0x3ed53641,0x3ef15aea,0x3ef840c8,0x3eff17b2,0x3f02ef9f
.long 0x3f0e39da,0x3f121eb0,0x3f15f6d9,0x3f19c200,0x3f226799,0x3f269de3,0x3f2ac082,0x3f2ecef7
.long 0x3f3504f3,0x3f396842,0x3f3daef9,0x3f41d870,0x3f45e403,0x3f4a4c87,0x3f4e8d90,0x3f52a649
.long 0x3f54db31,0x3f591e6a,0x3f5d2d53,0x3f6106f2,0x3f61c598,0x3f65b710,0x3f696591,0x3f6cd007
.long 0x3f6c835e,0x3f6ff573,0x3f731447,0x3f75dec6,0x3f74fa0b,0x3f77beb7,0x3f7a1e84,0x3f7c187a
.long 0x3f7b14be,0x3f7cfe73,0x3f7e70b0,0x3f7f6ac7,0x3f7ec46d,0x3f7fa6e3,0x3f7ffec4,0x3f7fcbe2
.long 0x3f800000,0x3f7fb10f,0x3f7ec46d,0x3f7d3aac,0x3f7ec46d,0x3f7d1cdd,0x3f7ac516,0x3f77beb7
.long 0x3f7b14be,0x3f77f110,0x3f740bdd,0x3f6f6830,0x3f74fa0b,0x3f703b37,0x3f6aab7b,0x3f644fac
.long 0x3f6c835e,0x3f660f88,0x3f5ebe05,0x3f5695e5,0x3f61c598,0x3f5988ad,0x3f5064af,0x3f466354
.long 0x3f54db31,0x3f4ac77f,0x3f3fc767,0x3f33e7bc,0x3f45e403,0x3f39f2ac,0x3f2d1469,0x3f1f599f
.long 0x3f3504f3,0x3f273656,0x3f187fc0,0x3f08f59b,0x3f226799,0x3f12c39a,0x3f0242b1,0x3ee1fb6a
.long 0x3f0e39da,0x3ef9a02d,0x3ed53641,0x3eaf713a,0x3ef15aea,0x3ecb2aae,0x3ea395c5,0x3e75c35a
.long 0x3ec3ef15,0x3e9aa086,0x3e605c13,0x3e09cf86,0x3e94a031,0x3e5101f1,0x3dee3876,0x3ce22a7a
.long 0x3e47c5c2,0x3dd53db9,0x3c490e90,0xbda3308c,0x3dc8bd36,0x3b490fc6,0xbdbc3ac3,0xbe3e853e
.long 0x0,0x0,0x0,0x0,0x3de1bc2e,0x3de7fa9a,0x3dee3876,0x3df475c0
.long 0x3e605c13,0x3e667c66,0x3e6c9a7f,0x3e72b651,0x3ea68f12,0x3eab0201,0x3eaf713a,0x3eb3dca5
.long 0x3edae880,0x3ee0924f,0x3ee63375,0x3eebcbbb,0x3f064b82,0x3f099f4e,0x3f0cead0,0x3f102dd5
.long 0x3f1d7fd1,0x3f212ff9,0x3f24d225,0x3f286605,0x3f32c8c9,0x3f36ad7f,0x3f3a7ca4,0x3f3e35c5
.long 0x3f45e403,0x3f49d112,0x3f4d9f02,0x3f514d3d,0x3f5695e5,0x3f5a5ba0,0x3f5df6be,0x3f61668a
.long 0x3f64aa59,0x3f6816a8,0x3f6b4b0c,0x3f6e46be,0x3f6ff573,0x3f72d4eb,0x3f756d97,0x3f77beb7
.long 0x3f7853f8,0x3f7a7302,0x3f7c3b28,0x3f7dabcc,0x3f7dabcc,0x3f7ed7d4,0x3f7f9c18,0x3f7ff84a
.long 0x3f7fec43,0x3f7ff4e6,0x3f7f84ab,0x3f7e9bc9,0x3f7f0e58,0x3f7dc68c,0x3f7bf531,0x3f799b43
.long 0x3f7b14be,0x3f7853f8,0x3f74fa0b,0x3f710908,0x3f740bdd,0x3f6faf1b,0x3f6aab7b,0x3f650479
.long 0x3f6a09a7,0x3f63f473,0x3f5d2d53,0x3f55b993,0x3f5d2d53,0x3f554aa4,0x3f4cae79,0x3f436051
.long 0x3f4d9f02,0x3f43e200,0x3f396842,0x3f2e3bde,0x3f3b8f3b,0x3f2ff3e6,0x3f239da9,0x3f16999f
.long 0x3f273656,0x3f19c200,0x3f0b9a6b,0x3ef9a02d,0x3f10d3cd,0x3f019573,0x3ee363fa,0x3ec27b55
.long 0x3ef15aea,0x3ecf7bca,0x3eac7cd4,0x3e888e93,0x3ebe1d4a,0x3e9920fe,0x3e667c66,0x3e195be0
.long 0x3e888e93,0x3e419b37,0x3de1bc2e,0x3cfb49ba,0x3e22abb6,0x3d9cecf9,0xbbc90f88,0xbdb5f8da
.long 0x3d48fb30,0xbd16c32c,0xbdfab273,0xbe541501,0xbd7b2b74,0xbe195be0,0xbe72b651,0xbea5129f
.long 0xbe2f10a2,0xbe8586ce,0xbeb263ef,0xbeddbe79,0xbe8e9a22,0xbebca7af,0xbee900b7,0xbf099f4e
.long 0x3f800000,0x3f800000,0x3f800000,0x3f800000,0x3f7e1324,0x3f7dfa38,0x3f7de0b1,0x3f7dc68c
.long 0x3f7853f8,0x3f77f110,0x3f778bc5,0x3f772417,0x3f6ed89e,0x3f6dfcf2,0x3f6d1c1d,0x3f6c3624
.long 0x3f61c598,0x3f604621,0x3f5ebe05,0x3f5d2d53,0x3f514d3d,0x3f4f0417,0x3f4cae79,0x3f4a4c87
.long 0x3f3daef9,0x3f3a7ca4,0x3f373a23,0x3f33e7bc,0x3f273656,0x3f2302d3,0x3f1ebc12,0x3f1a6293
.long 0x3f0e39da,0x3f08f59b,0x3f039c3d,0x3efc5d27,0x3ee63375,0x3ed97cb9,0x3ecc9b8b,0x3ebf926f
.long 0x3eac7cd4,0x3e9d9e78,0x3e8e9a22,0x3e7ee6e1,0x3e605c13,0x3e3e853e,0x3e1c76de,0x3df475c0
.long 0x3dc8bd36,0x3d7b2b74,0x3cc90ab0,0xbc490e90,0xbcc90ab0,0xbd83db0a,0xbdd53db9,0xbe1324ca
.long 0xbe164083,0xbe419b37,0xbe6c9a7f,0xbe8b9507,0xbe888e93,0xbe9f1cdf,0xbeb554ec,0xbecb2aae
.long 0xbec3ef15,0xbedae880,0xbef15aea,0xbf039c3d,0xbefc5d27,0xbf099f4e,0xbf14b039,0xbf1f599f
.long 0xbf187fc0,0xbf239da9,0xbf2e3bde,0xbf385216,0xbf3085bb,0xbf3b0629,0xbf44e3f5,0xbf4e1689
.long 0xbf45e403,0xbf4f7a1f,0xbf584853,0xbf604621,0xbf584853,0xbf60a6cf,0xbf6816a8,0xbf6e8ff8
.long 0xbf676bd8,0xbf6e46be,0xbf740bdd,0xbf78b47b,0xbf731447,0xbf7822d1,0xbf7bf531,0xbf7e868b
.long 0xbf7b14be,0xbf7e1324,0xbf7fb10f,0xbf7fec43,0xbf7f4e6d,0xbf7fffb1,0xbf7f2f9d,0xbf7cdf6c
.long 0xbf7fb10f,0xbf7de0b1,0xbf7a7302,0xbf756d97,0xbf7c3b28,0xbf77beb7,0xbf718f57,0xbf69b7e4
.long 0xbf74fa0b,0xbf6db293,0xbf64aa59,0xbf59f26a,0xbf6a09a7,0xbf5fe4e9,0xbf53fac3,0xbf466354
.long 0xbf5b941a,0xbf4e8d90,0xbf3fc767,0xbf2f61a5,0xbf49d112,0xbf39f2ac,0xbf286605,0xbf1553b7
.long 0x3f800000,0x3f800000,0x3f800000,0x3f800000,0x3f7dabcc,0x3f7d906e,0x3f7d7474,0x3f7d57de
.long 0x3f76ba07,0x3f764d97,0x3f75dec6,0x3f756d97,0x3f6b4b0c,0x3f6a5ad9,0x3f696591,0x3f686b39
.long 0x3f5b941a,0x3f59f26a,0x3f584853,0x3f5695e5,0x3f47de65,0x3f456439,0x3f42de29,0x3f404c5c
.long 0x3f3085bb,0x3f2d1469,0x3f299415,0x3f26050a,0x3f15f6d9,0x3f11796b,0x3f0cead0,0x3f084b92
.long 0x3ef15aea,0x3ee63375,0x3edae880,0x3ecf7bca,0x3eb263ef,0x3ea5129f,0x3e97a117,0x3e8a11f7
.long 0x3e605c13,0x3e419b37,0x3e22abb6,0x3e039502,0x3dafb680,0x3d55880e,0x3c96c9b6,0xbc7b514b
.long 0xbd48fb30,0xbdafb680,0xbdfab273,0xbe22abb6,0xbe3b6ecf,0xbe636c83,0xbe8586ce,0xbe9920fe
.long 0xbea09ae5,0xbeb554ec,0xbec9b953,0xbeddbe79,0xbee0924f,0xbef58035,0xbf04f484,0xbf0ee0db
.long 0xbf0e39da,0xbf187fc0,0xbf226799,0xbf2beb4a,0xbf299415,0xbf33587a,0xbf3ca003,0xbf456439
.long 0xbf41d870,0xbf4ac77f,0xbf531849,0xbf5ac450,0xbf5695e5,0xbf5e5aa6,0xbf655e0b,0xbf6b99fb
.long 0xbf676bd8,0xbf6db293,0xbf731447,0xbf778bc5,0xbf740bdd,0xbf788486,0xbf7bf531,0xbf7e5a38
.long 0xbf7c3b28,0xbf7e9bc9,0xbf7fd397,0xbf7fe129,0xbf7fd397,0xbf7fdaaf,0xbf7e9bc9,0xbf7c187a
.long 0xbf7ec46d,0xbf7c3b28,0xbf7853f8,0xbf731447,0xbf791298,0xbf73ced9,0xbf6d1c1d,0xbf650479
.long 0xbf6ed89e,0xbf66becc,0xbf5d2d53,0xbf5233c6,0xbf604621,0xbf554aa4,0xbf48d8b3,0xbf3b0629
.long 0xbf4d9f02,0xbf3fc767,0xbf3085bb,0xbf1ff6cb,0xbf373a23,0xbf269de3,0xbf14b039,0xbf019573
.long 0xbf1d7fd1,0xbf0a48ad,0xbeebcbbb,0xbec1071e,0xbf00e7e4,0xbed6a399,0xbea986c4,0xbe75c35a
.long 0x0,0x0,0x0,0x0,0x3dfab273,0x3e007745,0x3e039502,0x3e06b26e
.long 0x3e78cfcc,0x3e7ee6e1,0x3e827dc0,0x3e8586ce,0x3eb8442a,0x3ebca7af,0x3ec1071e,0x3ec5625c
.long 0x3ef15aea,0x3ef6e0cb,0x3efc5d27,0x3f00e7e4,0x3f13682a,0x3f16999f,0x3f19c200,0x3f1ce11f
.long 0x3f2beb4a,0x3f2f61a5,0x3f32c8c9,0x3f36206c,0x3f41d870,0x3f456439,0x3f48d8b3,0x3f4c3578
.long 0x3f54db31,0x3f584853,0x3f5b941a,0x3f5ebe05,0x3f64aa59,0x3f67c187,0x3f6aab7b,0x3f6d67a1
.long 0x3f710908,0x3f73913f,0x3f75dec6,0x3f77f110,0x3f79c79d,0x3f7b87b2,0x3f7cfe73,0x3f7e2b72
.long 0x3f7ec46d,0x3f7f84ab,0x3f7fec43,0x3f7ffb11,0x3f7fec43,0x3f7f7808,0x3f7e9bc9,0x3f7d57de
.long 0x3f7d3aac,0x3f7b61fc,0x3f791298,0x3f764d97,0x3f76ba07,0x3f73530e,0x3f6f6830,0x3f6afb8c
.long 0x3f6c835e,0x3f676bd8,0x3f61c598,0x3f5b941a,0x3f5ebe05,0x3f57dc7f,0x3f5064af,0x3f485bca
.long 0x3f4d9f02,0x3f44e3f5,0x3f3b8f3b,0x3f31a81d,0x3f396842,0x3f2ecef7,0x3f239da9,0x3f17de12
.long 0x3f226799,0x3f15f6d9,0x3f08f59b,0x3ef6e0cb,0x3f08f59b,0x3ef58035,0x3ed8106b,0x3eb9bb1e
.long 0x3edae880,0x3ebb31a0,0x3e9aa086,0x3e72b651,0x3ea09ae5,0x3e7bdba4,0x3e354098,0x3ddb7d37
.long 0x3e47c5c2,0x3dfab273,0x3d48fb30,0xbcc90ab0,0x3d96a905,0xbb490fc6,0xbda3308c,0xbe1f917b
.long 0xbd48fb30,0xbe039502,0xbe541501,0xbe919ddd,0xbe2f10a2,0xbe80f8c0,0xbea986c4,0xbed0eb2a
.long 0xbe94a031,0xbebe1d4a,0xbee63375,0xbf064b82,0xbecf7bca,0xbef840c8,0xbf0f8784,0xbf21cbfb
.long 0xbf039c3d,0xbf173c07,0xbf299415,0xbf3a7ca4,0xbf1d7fd1,0xbf2ff3e6,0xbf40d0da,0xbf4fefa8
.long 0x0,0x0,0x0,0x0,0x3e09cf86,0x3e0cec4a,0x3e1008b7,0x3e1324ca
.long 0x3e888e93,0x3e8b9507,0x3e8e9a22,0x3e919ddd,0x3ec9b953,0x3ece0bea,0x3ed25a09,0x3ed6a399
.long 0x3f039c3d,0x3f064b82,0x3f08f59b,0x3f0b9a6b,0x3f1ff6cb,0x3f2302d3,0x3f26050a,0x3f28fd41
.long 0x3f396842,0x3f3ca003,0x3f3fc767,0x3f42de29,0x3f4f7a1f,0x3f52a649,0x3f55b993,0x3f58b3a1
.long 0x3f61c598,0x3f64aa59,0x3f676bd8,0x3f6a09a7,0x3f6ff573,0x3f725470,0x3f748422,0x3f76841b
.long 0x3f79c79d,0x3f7b61fc,0x3f7cbfc9,0x3f7de0b1,0x3f7f0e58,0x3f7fa6e3,0x3f7ff4e6,0x3f7ff84a
.long 0x3f7fb10f,0x3f7f0e58,0x3f7e1324,0x3f7cbfc9,0x3f7baccd,0x3f799b43,0x3f772417,0x3f74484b
.long 0x3f731447,0x3f6f6830,0x3f6b4b0c,0x3f66becc,0x3f660f88,0x3f60a6cf,0x3f5ac450,0x3f546b3b
.long 0x3f54db31,0x3f4d9f02,0x3f45e403,0x3f3daef9,0x3f3fc767,0x3f36ad7f,0x3f2d1469,0x3f2302d3
.long 0x3f273656,0x3f1c420c,0x3f10d3cd,0x3f04f484,0x3f0b9a6b,0x3efdbabb,0x3ee363fa,0x3ec8477c
.long 0x3edae880,0x3ebe1d4a,0x3ea09ae5,0x3e827dc0,0x3e9aa086,0x3e75c35a,0x3e354098,0x3de7fa9a
.long 0x3e2f10a2,0x3dd53db9,0x3d16c32c,0xbcfb49ba,0x3d16c32c,0xbd0a342f,0xbdd53db9,0xbe3228d4
.long 0xbdc8bd36,0xbe2f10a2,0xbe78cfcc,0xbea09ae5,0xbe6c9a7f,0xbe9c1faf,0xbec1071e,0xbee4cbfe
.long 0xbeb8442a,0xbeddbe79,0xbf00e7e4,0xbf121eb0,0xbef6e0cb,0xbf0d9281,0xbf1ebc12,0xbf2ecef7
.long 0xbf187fc0,0xbf299415,0xbf396842,0xbf47de65,0xbf32c8c9,0xbf425b89,0xbf5064af,0xbf5cc7d1
.long 0xbf49d112,0xbf577026,0xbf633c5a,0xbf6d1c1d,0xbf5d2d53,0xbf686b39,0xbf718f57,0xbf788486
.long 0x3f800000,0x3f800000,0x3f800000,0x3f800000,0x3f7d3aac,0x3f7d1cdd,0x3f7cfe73,0x3f7cdf6c
.long 0x3f74fa0b,0x3f748422,0x3f740bdd,0x3f73913f,0x3f676bd8,0x3f666771,0x3f655e0b,0x3f644fac
.long 0x3f54db31,0x3f531849,0x3f514d3d,0x3f4f7a1f,0x3f3daef9,0x3f3b0629,0x3f385216,0x3f3592e7
.long 0x3f226799,0x3f1ebc12,0x3f1b02c6,0x3f173c07,0x3f039c3d,0x3efdbabb,0x3ef41f07,0x3eea6681
.long 0x3ec3ef15,0x3eb8442a,0x3eac7cd4,0x3ea09ae5,0x3e78cfcc,0x3e5d4b1a,0x3e419b37,0x3e25c58c
.long 0x3dc8bd36,0x3d8a200a,0x3d16c32c,0x3bc90f88,0xbd48fb30,0xbda973ba,0xbdee3876,0xbe195be0
.long 0xbe47c5c2,0xbe6c9a7f,0xbe888e93,0xbe9aa086,0xbeac7cd4,0xbebf926f,0xbed25a09,0xbee4cbfe
.long 0xbef15aea,0xbf0242b1,0xbf0b9a6b,0xbf14b039,0xbf187fc0,0xbf21cbfb,0xbf2ac082,0xbf33587a
.long 0xbf3504f3,0xbf3daef9,0xbf45e403,0xbf4d9f02,0xbf4d9f02,0xbf554aa4,0xbf5c61c7,0xbf62df7b
.long 0xbf61c598,0xbf6816a8,0xbf6db293,0xbf7294f8,0xbf710908,0xbf75a67b,0xbf796e4e,0xbf7c5d3a
.long 0xbf7b14be,0xbf7dabcc,0xbf7f4e6d,0xbf7ffb11,0xbf7fb10f,0xbf7ff84a,0xbf7f2f9d,0xbf7d57de
.long 0xbf7ec46d,0xbf7c7eb0,0xbf791298,0xbf748422,0xbf7853f8,0xbf73530e,0xbf6d1c1d,0xbf65b710
.long 0xbf6c835e,0xbf64aa59,0xbf5b941a,0xbf514d3d,0xbf5b941a,0xbf50d937,0xbf44e3f5,0xbf37c655
.long 0xbf45e403,0xbf385216,0xbf299415,0xbf19c200,0xbf2beb4a,0xbf1ba299,0xbf0a48ad,0xbeeff7fb
.long 0xbf0e39da,0xbef6e0cb,0xbecf7bca,0xbea68f12,0xbedae880,0xbeb0eacb,0xbe8586ce,0xbe3228d4
.long 0xbe94a031,0xbe4dee60,0xbde1bc2e,0xbc96c9b6,0xbe164083,0xbd55880e,0x3d2fe007,0x3e0cec4a
.long 0x3f800000,0x3f800000,0x3f800000,0x3f800000,0x3f7cbfc9,0x3f7c9f8a,0x3f7c7eb0,0x3f7c5d3a
.long 0x3f731447,0x3f7294f8,0x3f721352,0x3f718f57,0x3f633c5a,0x3f62241a,0x3f6106f2,0x3f5fe4e9
.long 0x3f4d9f02,0x3f4bbbf8,0x3f49d112,0x3f47de65,0x3f32c8c9,0x3f2ff3e6,0x3f2d1469,0x3f2a2a80
.long 0x3f13682a,0x3f0f8784,0x3f0b9a6b,0x3f07a136,0x3ee0924f,0x3ed6a399,0x3ecc9b8b,0x3ec27b55
.long 0x3e94a031,0x3e888e93,0x3e78cfcc,0x3e605c13,0x3e09cf86,0x3ddb7d37,0x3da3308c,0x3d55880e
.long 0xbcc90ab0,0xbd621469,0xbdafb680,0xbdee3876,0xbe3b6ecf,0xbe5d4b1a,0xbe7ee6e1,0xbe901c2c
.long 0xbeac7cd4,0xbebe1d4a,0xbecf7bca,0xbee0924f,0xbef6e0cb,0xbf044889,0xbf0cead0,0xbf1553b7
.long 0xbf1d7fd1,0xbf26050a,0xbf2e3bde,0xbf36206c,0xbf3b8f3b,0xbf436051,0xbf4ac77f,0xbf51c0c2
.long 0xbf54db31,0xbf5b941a,0xbf61c598,0xbf676bd8,0xbf68bf3c,0xbf6dfcf2,0xbf7294f8,0xbf76841b
.long 0xbf76ba07,0xbf7a1e84,0xbf7cbfc9,0xbf7e9bc9,0xbf7e70b0,0xbf7fa6e3,0xbf7ffec4,0xbf7f7808
.long 0xbf7fb10f,0xbf7e70b0,0xbf7c3b28,0xbf791298,0xbf7a7302,0xbf76841b,0xbf718f57,0xbf6b99fb
.long 0xbf6ed89e,0xbf6816a8,0xbf604621,0xbf577026,0xbf5d2d53,0xbf5389c7,0xbf48d8b3,0xbf3d27b8
.long 0xbf45e403,0xbf396842,0xbf2beb4a,0xbf1d7fd1,0xbf299415,0xbf1a6293,0xbf0a48ad,0xbef2bd43
.long 0xbf08f59b,0xbeee9479,0xbec9b953,0xbea395c5,0xbec9b953,0xbea21887,0xbe72b651,0xbe1f917b
.long 0xbe78cfcc,0xbe22abb6,0xbd96a905,0x3c490e90,0xbdafb680,0x3b490fc6,0x3dbc3ac3,0x3e3857ec
.long 0x3d96a905,0x3e28defc,0x3e827dc0,0x3eaf713a,0x3e6c9a7f,0x3ea5129f,0x3ed25a09,0x3efdbabb
.long 0x0,0x0,0x0,0x0,0x3e164083,0x3e195be0,0x3e1c76de,0x3e1f917b
.long 0x3e94a031,0x3e97a117,0x3e9aa086,0x3e9d9e78,0x3edae880,0x3edf28a9,0x3ee363fa,0x3ee79a5d
.long 0x3f0e39da,0x3f10d3cd,0x3f13682a,0x3f15f6d9,0x3f2beb4a,0x3f2ecef7,0x3f31a81d,0x3f34768f
.long 0x3f45e403,0x3f48d8b3,0x3f4bbbf8,0x3f4e8d90,0x3f5b941a,0x3f5e5aa6,0x3f6106f2,0x3f6398ac
.long 0x3f6c835e,0x3f6ed89e,0x3f710908,0x3f731447,0x3f7853f8,0x3f79f35e,0x3f7b61fc,0x3f7c9f8a
.long 0x3f7ec46d,0x3f7f6ac7,0x3f7fd397,0x3f7ffec4,0x3f7fb10f,0x3f7f1f49,0x3f7e4323,0x3f7d1cdd
.long 0x3f7b14be,0x3f791298,0x3f76ba07,0x3f740bdd,0x3f710908,0x3f6d67a1,0x3f696591,0x3f650479
.long 0x3f61c598,0x3f5c61c7,0x3f5695e5,0x3f5064af,0x3f4d9f02,0x3f466354,0x3f3ebc1b,0x3f36ad7f
.long 0x3f3504f3,0x3f2beb4a,0x3f226799,0x3f187fc0,0x3f187fc0,0x3f0d9281,0x3f0242b1,0x3eed3063
.long 0x3ef15aea,0x3ed8106b,0x3ebe1d4a,0x3ea395c5,0x3eac7cd4,0x3e901c2c,0x3e667c66,0x3e2bf804
.long 0x3e47c5c2,0x3e09cf86,0x3d96a905,0x3c490e90,0x3d48fb30,0xbc7b514b,0xbda3308c,0xbe1324ca
.long 0xbdc8bd36,0xbe28defc,0xbe6c9a7f,0xbe97a117,0xbe78cfcc,0xbe9f1cdf,0xbec1071e,0xbee1fb6a
.long 0xbec3ef15,0xbee63375,0xbf039c3d,0xbf13682a,0xbf039c3d,0xbf140c5f,0xbf239da9,0xbf3238aa
.long 0xbf226799,0xbf31a81d,0xbf3fc767,0xbf4cae79,0xbf3daef9,0xbf4b41fa,0xbf577026,0xbf62241a
.long 0xbf54db31,0xbf604621,0xbf6a09a7,0xbf721352,0xbf676bd8,0xbf703b37,0xbf772417,0xbf7c187a
.long 0xbf74fa0b,0xbf7ac516,0xbf7e70b0,0xbf7ff4e6,0xbf7d3aac,0xbf7fa6e3,0xbf7fc38f,0xbf7d906e
.long 0x0,0x0,0x0,0x0,0x3e22abb6,0x3e25c58c,0x3e28defc,0x3e2bf804
.long 0x3ea09ae5,0x3ea395c5,0x3ea68f12,0x3ea986c4,0x3eebcbbb,0x3eeff7fb,0x3ef41f07,0x3ef840c8
.long 0x3f187fc0,0x3f1b02c6,0x3f1d7fd1,0x3f1ff6cb,0x3f373a23,0x3f39f2ac,0x3f3ca003,0x3f3f41fc
.long 0x3f514d3d,0x3f53fac3,0x3f5695e5,0x3f591e6a,0x3f660f88,0x3f686b39,0x3f6aab7b,0x3f6cd007
.long 0x3f74fa0b,0x3f76ba07,0x3f7853f8,0x3f79c79d,0x3f7dabcc,0x3f7e868b,0x3f7f2f9d,0x3f7fa6e3
.long 0x3f7fec43,0x3f7f9c18,0x3f7f0e58,0x3f7e4323,0x3f7baccd,0x3f79f35e,0x3f77f110,0x3f75a67b
.long 0x3f710908,0x3f6db293,0x3f6a09a7,0x3f660f88,0x3f604621,0x3f5b2c79,0x3f55b993,0x3f4fefa8
.long 0x3f49d112,0x3f42de29,0x3f3b8f3b,0x3f33e7bc,0x3f2e3bde,0x3f256bcb,0x3f1c420c,0x3f12c39a
.long 0x3f0e39da,0x3f039c3d,0x3ef15aea,0x3edae880,0x3ed53641,0x3ebca7af,0x3ea395c5,0x3e8a11f7
.long 0x3e888e93,0x3e5a3997,0x3e22abb6,0x3dd53db9,0x3de1bc2e,0x3d55880e,0xbbc90f88,0xbd83db0a
.long 0xbd48fb30,0xbde1bc2e,0xbe2f10a2,0xbe6c9a7f,0xbe541501,0xbe8a11f7,0xbea986c4,0xbec8477c
.long 0xbeb8442a,0xbed8106b,0xbef6e0cb,0xbf0a48ad,0xbf00e7e4,0xbf102dd5,0xbf1ebc12,0xbf2c800f
.long 0xbf226799,0xbf3085bb,0xbf3daef9,0xbf49d112,0xbf3fc767,0xbf4c3578,0xbf577026,0xbf61668a
.long 0xbf584853,0xbf628210,0xbf6b4b0c,0xbf7294f8,0xbf6b4b0c,0xbf72d4eb,0xbf78b47b,0xbf7cdf6c
.long 0xbf7853f8,0xbf7cbfc9,0xbf7f4e6d,0xbf7ffb11,0xbf7f0e58,0xbf7fffb1,0xbf7eea9d,0xbf7bd14d
.long 0xbf7f4e6d,0xbf7c7eb0,0xbf778bc5,0xbf708066,0xbf791298,0xbf725470,0xbf696591,0xbf5e5aa6
.long 0x3f800000,0x3f800000,0x3f800000,0x3f800000,0x3f7c3b28,0x3f7c187a,0x3f7bf531,0x3f7bd14d
.long 0x3f710908,0x3f708066,0x3f6ff573,0x3f6f6830,0x3f5ebe05,0x3f5d924d,0x3f5c61c7,0x3f5b2c79
.long 0x3f45e403,0x3f43e200,0x3f41d870,0x3f3fc767,0x3f273656,0x3f24381a,0x3f212ff9,0x3f1e1e22
.long 0x3f039c3d,0x3eff17b2,0x3ef6e0cb,0x3eee9479,0x3eb8442a,0x3eadf73c,0x3ea395c5,0x3e9920fe
.long 0x3e47c5c2,0x3e2f10a2,0x3e164083,0x3dfab273,0x3cc90ab0,0xbb490fc6,0xbcfb49ba,0xbd6ea038
.long 0xbe164083,0xbe354098,0xbe541501,0xbe72b651,0xbea09ae5,0xbeb0eacb,0xbec1071e,0xbed0eb2a
.long 0xbef15aea,0xbf00e7e4,0xbf08f59b,0xbf10d3cd,0xbf1d7fd1,0xbf256bcb,0xbf2d1469,0xbf34768f
.long 0xbf3daef9,0xbf44e3f5,0xbf4bbbf8,0xbf5233c6,0xbf584853,0xbf5e5aa6,0xbf63f473,0xbf6912ae
.long 0xbf6c835e,0xbf710908,0xbf74fa0b,0xbf7853f8,0xbf79c79d,0xbf7c5d3a,0xbf7e4323,0xbf7f7808
.long 0xbf7fb10f,0xbf7ffec4,0xbf7f84ab,0xbf7e4323,0xbf7e1324,0xbf7bd14d,0xbf78b47b,0xbf74bf62
.long 0xbf74fa0b,0xbf6ff573,0xbf6a09a7,0xbf633c5a,0xbf64aa59,0xbf5cc7d1,0xbf53fac3,0xbf4a4c87
.long 0xbf4d9f02,0xbf42de29,0xbf373a23,0xbf2ac082,0xbf3085bb,0xbf2302d3,0xbf14b039,0xbf05a02c
.long 0xbf0e39da,0xbefc5d27,0xbedae880,0xbeb8442a,0xbecf7bca,0xbeab0201,0xbe8586ce,0xbe3e853e
.long 0xbe78cfcc,0xbe28defc,0xbdafb680,0xbbc90f88,0xbd96a905,0x3c16cb58,0x3dbc3ac3,0x3e3228d4
.long 0x3dc8bd36,0x3e3b6ecf,0x3e888e93,0x3eb263ef,0x3e888e93,0x3eb3dca5,0x3eddbe79,0x3f02ef9f
.long 0x3edae880,0x3f0242b1,0x3f15f6d9,0x3f286605,0x3f13682a,0x3f269de3,0x3f385216,0x3f485bca
.long 0x3f800000,0x3f800000,0x3f800000,0x3f800000,0x3f7baccd,0x3f7b87b2,0x3f7b61fc,0x3f7b3bab
.long 0x3f6ed89e,0x3f6e46be,0x3f6db293,0x3f6d1c1d,0x3f59f26a,0x3f58b3a1,0x3f577026,0x3f5627fe
.long 0x3f3daef9,0x3f3b8f3b,0x3f396842,0x3f373a23,0x3f1b02c6,0x3f17de12,0x3f14b039,0x3f11796b
.long 0x3ee63375,0x3eddbe79,0x3ed53641,0x3ecc9b8b,0x3e8e9a22,0x3e840270,0x3e72b651,0x3e5d4b1a
.long 0x3dc8bd36,0x3d96a905,0x3d48fb30,0x3cc90ab0,0xbdafb680,0xbde7fa9a,0xbe1008b7,0xbe2bf804
.long 0xbe888e93,0xbe97a117,0xbea68f12,0xbeb554ec,0xbee0924f,0xbeeff7fb,0xbeff17b2,0xbf06f686
.long 0xbf187fc0,0xbf1ff6cb,0xbf273656,0xbf2e3bde,0xbf3b8f3b,0xbf425b89,0xbf48d8b3,0xbf4f0417
.long 0xbf584853,0xbf5df6be,0xbf633c5a,0xbf6816a8,0xbf6db293,0xbf71d19f,0xbf756d97,0xbf788486
.long 0xbf7b14be,0xbf7d3aac,0xbf7ec46d,0xbf7fb10f,0xbf7ffb11,0xbf7fcbe2,0xbf7eea9d,0xbf7d57de
.long 0xbf7c3b28,0xbf796e4e,0xbf75dec6,0xbf718f57,0xbf6ff573,0xbf6a5ad9,0xbf63f473,0xbf5cc7d1
.long 0xbf5b941a,0xbf531849,0xbf49d112,0xbf3fc767,0xbf3fc767,0xbf34768f,0xbf286605,0xbf1ba299
.long 0xbf1d7fd1,0xbf0f8784,0xbf00e7e4,0xbee363fa,0xbeebcbbb,0xbecb2aae,0xbea986c4,0xbe870ada
.long 0xbe94a031,0xbe605c13,0xbe164083,0xbd96a905,0xbde1bc2e,0xbd0a342f,0x3d2fe007,0x3df475c0
.long 0x3d96a905,0x3e1c76de,0x3e6c9a7f,0x3e9d9e78,0x3e827dc0,0x3eab0201,0x3ed25a09,0x3ef840c8
.long 0x3edae880,0x3f00e7e4,0x3f13682a,0x3f24d225,0x3f15f6d9,0x3f27ce61,0x3f385216,0x3f476085
.long 0x3f396842,0x3f48d8b3,0x3f5695e5,0x3f628210,0x3f5695e5,0x3f62df7b,0x3f6d1c1d,0x3f75341d
.long 0x0,0x0,0x0,0x0,0x3e2f10a2,0x3e3228d4,0x3e354098,0x3e3857ec
.long 0x3eac7cd4,0x3eaf713a,0x3eb263ef,0x3eb554ec,0x3efc5d27,0x3f003a06,0x3f0242b1,0x3f044889
.long 0x3f226799,0x3f24d225,0x3f273656,0x3f299415,0x3f41d870,0x3f446337,0x3f46e22a,0x3f495521
.long 0x3f5b941a,0x3f5df6be,0x3f604621,0x3f628210,0x3f6ed89e,0x3f70c501,0x3f7294f8,0x3f74484b
.long 0x3f7b14be,0x3f7c3b28,0x3f7d3aac,0x3f7e1324,0x3f7fec43,0x3f7fffb1,0x3f7fe129,0x3f7f90b1
.long 0x3f7d3aac,0x3f7bf531,0x3f7a7302,0x3f78b47b,0x3f731447,0x3f703b37,0x3f6d1c1d,0x3f69b7e4
.long 0x3f61c598,0x3f5d2d53,0x3f584853,0x3f531849,0x3f49d112,0x3f436051,0x3f3ca003,0x3f3592e7
.long 0x3f2beb4a,0x3f239da9,0x3f1b02c6,0x3f121eb0,0x3f08f59b,0x3efdbabb,0x3ee900b7,0x3ed3c867
.long 0x3ec3ef15,0x3eac7cd4,0x3e94a031,0x3e78cfcc,0x3e605c13,0x3e2bf804,0x3dee3876,0x3d83db0a
.long 0x3d48fb30,0xbbc90f88,0xbd7b2b74,0xbdee3876,0xbdfab273,0xbe3857ec,0xbe72b651,0xbe9620d2
.long 0xbe94a031,0xbeb263ef,0xbecf7bca,0xbeebcbbb,0xbee63375,0xbf019573,0xbf0f8784,0xbf1ce11f
.long 0xbf187fc0,0xbf26050a,0xbf32c8c9,0xbf3ebc1b,0xbf396842,0xbf456439,0xbf5064af,0xbf5a5ba0
.long 0xbf54db31,0xbf5ebe05,0xbf676bd8,0xbf6ed89e,0xbf6a09a7,0xbf714c7a,0xbf772417,0xbf7b87b2
.long 0xbf7853f8,0xbf7c7eb0,0xbf7f0e58,0xbf7ffec4,0xbf7f4e6d,0xbf7ffd39,0xbf7eea9d,0xbf7c187a
.long 0xbf7ec46d,0xbf7baccd,0xbf76ba07,0xbf6ff573,0xbf76ba07,0xbf6faf1b,0xbf66becc,0xbf5bfb34
.long 0xbf676bd8,0xbf5c61c7,0xbf4f7a1f,0xbf40d0da,0xbf514d3d,0xbf425b89,0xbf31a81d,0xbf1f599f
.long 0x0,0x0,0x0,0x0,0x3e3b6ecf,0x3e3e853e,0x3e419b37,0x3e44b0b9
.long 0x3eb8442a,0x3ebb31a0,0x3ebe1d4a,0x3ec1071e,0x3f064b82,0x3f084b92,0x3f0a48ad,0x3f0c42c9
.long 0x3f2beb4a,0x3f2e3bde,0x3f3085bb,0x3f32c8c9,0x3f4bbbf8,0x3f4e1689,0x3f5064af,0x3f52a649
.long 0x3f64aa59,0x3f66becc,0x3f68bf3c,0x3f6aab7b,0x3f75dec6,0x3f77583a,0x3f78b47b,0x3f79f35e
.long 0x3f7ec46d,0x3f7f4e6d,0x3f7fb10f,0x3f7fec43,0x3f7f0e58,0x3f7e5a38,0x3f7d7474,0x3f7c5d3a
.long 0x3f76ba07,0x3f748422,0x3f721352,0x3f6f6830,0x3f660f88,0x3f62241a,0x3f5df6be,0x3f5988ad
.long 0x3f4d9f02,0x3f47de65,0x3f41d870,0x3f3b8f3b,0x3f2e3bde,0x3f269de3,0x3f1ebc12,0x3f16999f
.long 0x3f08f59b,0x3eff17b2,0x3eebcbbb,0x3ed8106b,0x3ebe1d4a,0x3ea80b1f,0x3e919ddd,0x3e75c35a
.long 0x3e47c5c2,0x3e164083,0x3dc8bd36,0x3d48fb30,0x3c490e90,0xbd2351cb,0xbdbc3ac3,0xbe1324ca
.long 0xbe2f10a2,0xbe667c66,0xbe8e9a22,0xbea986c4,0xbeb263ef,0xbece0bea,0xbee900b7,0xbf019573
.long 0xbf039c3d,0xbf10d3cd,0xbf1d7fd1,0xbf299415,0xbf299415,0xbf3592e7,0xbf40d0da,0xbf4b41fa
.long 0xbf49d112,0xbf53fac3,0xbf5d2d53,0xbf655e0b,0xbf633c5a,0xbf6afb8c,0xbf718f57,0xbf76ef5b
.long 0xbf74fa0b,0xbf79c79d,0xbf7d3aac,0xbf7f4e6d,0xbf7e70b0,0xbf7fdaaf,0xbf7fc38f,0xbf7e2b72
.long 0xbf7f4e6d,0xbf7cfe73,0xbf791298,0xbf73913f,0xbf778bc5,0xbf714c7a,0xbf696591,0xbf5fe4e9
.long 0xbf676bd8,0xbf5d2d53,0xbf514d3d,0xbf43e200,0xbf4f7a1f,0xbf4154e1,0xbf31a81d,0xbf209393
.long 0xbf3085bb,0xbf1ebc12,0xbf0b9a6b,0xbeee9479,0xbf0b9a6b,0xbeed3063,0xbec1071e,0xbe931f35
.long 0x3f800000,0x3f800000,0x3f800000,0x3f800000,0x3f800000,0x3f7fffb1,0x3f7ffec4,0x3f7ffd39
.long 0x3f800000,0x3f7ffec4,0x3f7ffb11,0x3f7ff4e6,0x3f800000,0x3f7ffd39,0x3f7ff4e6,0x3f7fe705
.long 0x3f800000,0x3f7ffb11,0x3f7fec43,0x3f7fd397,0x3f800000,0x3f7ff84a,0x3f7fe129,0x3f7fba9e
.long 0x3f800000,0x3f7ff4e6,0x3f7fd397,0x3f7f9c18,0x3f800000,0x3f7ff0e3,0x3f7fc38f,0x3f7f7808
.long 0x3f800000,0x3f7fec43,0x3f7fb10f,0x3f7f4e6d,0x3f800000,0x3f7fe705,0x3f7f9c18,0x3f7f1f49
.long 0x3f800000,0x3f7fe129,0x3f7f84ab,0x3f7eea9d,0x3f800000,0x3f7fdaaf,0x3f7f6ac7,0x3f7eb069
.long 0x3f800000,0x3f7fd397,0x3f7f4e6d,0x3f7e70b0,0x3f800000,0x3f7fcbe2,0x3f7f2f9d,0x3f7e2b72
.long 0x3f800000,0x3f7fc38f,0x3f7f0e58,0x3f7de0b1,0x3f800000,0x3f7fba9e,0x3f7eea9d,0x3f7d906e
.long 0x3f800000,0x3f7fb10f,0x3f7ec46d,0x3f7d3aac,0x3f800000,0x3f7fa6e3,0x3f7e9bc9,0x3f7cdf6c
.long 0x3f800000,0x3f7f9c18,0x3f7e70b0,0x3f7c7eb0,0x3f800000,0x3f7f90b1,0x3f7e4323,0x3f7c187a
.long 0x3f800000,0x3f7f84ab,0x3f7e1324,0x3f7baccd,0x3f800000,0x3f7f7808,0x3f7de0b1,0x3f7b3bab
.long 0x3f800000,0x3f7f6ac7,0x3f7dabcc,0x3f7ac516,0x3f800000,0x3f7f5ce9,0x3f7d7474,0x3f7a4910
.long 0x3f800000,0x3f7f4e6d,0x3f7d3aac,0x3f79c79d,0x3f800000,0x3f7f3f54,0x3f7cfe73,0x3f7940c0
.long 0x3f800000,0x3f7f2f9d,0x3f7cbfc9,0x3f78b47b,0x3f800000,0x3f7f1f49,0x3f7c7eb0,0x3f7822d1
.long 0x3f800000,0x3f7f0e58,0x3f7c3b28,0x3f778bc5,0x3f800000,0x3f7efcc9,0x3f7bf531,0x3f76ef5b
.long 0x3f800000,0x3f7eea9d,0x3f7baccd,0x3f764d97,0x3f800000,0x3f7ed7d4,0x3f7b61fc,0x3f75a67b
.long 0x3f800000,0x3f800000,0x3f800000,0x3f800000,0x3f7ffb11,0x3f7ff84a,0x3f7ff4e6,0x3f7ff0e3
.long 0x3f7fec43,0x3f7fe129,0x3f7fd397,0x3f7fc38f,0x3f7fd397,0x3f7fba9e,0x3f7f9c18,0x3f7f7808
.long 0x3f7fb10f,0x3f7f84ab,0x3f7f4e6d,0x3f7f0e58,0x3f7f84ab,0x3f7f3f54,0x3f7eea9d,0x3f7e868b
.long 0x3f7f4e6d,0x3f7eea9d,0x3f7e70b0,0x3f7de0b1,0x3f7f0e58,0x3f7e868b,0x3f7de0b1,0x3f7d1cdd
.long 0x3f7ec46d,0x3f7e1324,0x3f7d3aac,0x3f7c3b28,0x3f7e70b0,0x3f7d906e,0x3f7c7eb0,0x3f7b3bab
.long 0x3f7e1324,0x3f7cfe73,0x3f7baccd,0x3f7a1e84,0x3f7dabcc,0x3f7c5d3a,0x3f7ac516,0x3f78e3d6
.long 0x3f7d3aac,0x3f7baccd,0x3f79c79d,0x3f778bc5,0x3f7cbfc9,0x3f7aed37,0x3f78b47b,0x3f76167a
.long 0x3f7c3b28,0x3f7a1e84,0x3f778bc5,0x3f748422,0x3f7baccd,0x3f7940c0,0x3f764d97,0x3f72d4eb
.long 0x3f7b14be,0x3f7853f8,0x3f74fa0b,0x3f710908,0x3f7a7302,0x3f77583a,0x3f73913f,0x3f6f20b0
.long 0x3f79c79d,0x3f764d97,0x3f721352,0x3f6d1c1d,0x3f791298,0x3f75341d,0x3f708066,0x3f6afb8c
.long 0x3f7853f8,0x3f740bdd,0x3f6ed89e,0x3f68bf3c,0x3f778bc5,0x3f72d4eb,0x3f6d1c1d,0x3f666771
.long 0x3f76ba07,0x3f718f57,0x3f6b4b0c,0x3f63f473,0x3f75dec6,0x3f703b37,0x3f696591,0x3f61668a
.long 0x3f74fa0b,0x3f6ed89e,0x3f676bd8,0x3f5ebe05,0x3f740bdd,0x3f6d67a1,0x3f655e0b,0x3f5bfb34
.long 0x3f731447,0x3f6be858,0x3f633c5a,0x3f591e6a,0x3f721352,0x3f6a5ad9,0x3f6106f2,0x3f5627fe
.long 0x3f710908,0x3f68bf3c,0x3f5ebe05,0x3f531849,0x3f6ff573,0x3f671599,0x3f5c61c7,0x3f4fefa8
.long 0x3f6ed89e,0x3f655e0b,0x3f59f26a,0x3f4cae79,0x3f6db293,0x3f6398ac,0x3f577026,0x3f495521
.long 0x0,0x0,0x0,0x0,0x0,0x3b490fc6,0x3bc90f88,0x3c16cb58
.long 0x0,0x3bc90f88,0x3c490e90,0x3c96c9b6,0x0,0x3c16cb58,0x3c96c9b6,0x3ce22a7a
.long 0x0,0x3c490e90,0x3cc90ab0,0x3d16c32c,0x0,0x3c7b514b,0x3cfb49ba,0x3d3c6dd5
.long 0x0,0x3c96c9b6,0x3d16c32c,0x3d621469,0x0,0x3cafea69,0x3d2fe007,0x3d83db0a
.long 0x0,0x3cc90ab0,0x3d48fb30,0x3d96a905,0x0,0x3ce22a7a,0x3d621469,0x3da973ba
.long 0x0,0x3cfb49ba,0x3d7b2b74,0x3dbc3ac3,0x0,0x3d0a342f,0x3d8a200a,0x3dcefdb7
.long 0x0,0x3d16c32c,0x3d96a905,0x3de1bc2e,0x0,0x3d2351cb,0x3da3308c,0x3df475c0
.long 0x0,0x3d2fe007,0x3dafb680,0x3e039502,0x0,0x3d3c6dd5,0x3dbc3ac3,0x3e0cec4a
.long 0x0,0x3d48fb30,0x3dc8bd36,0x3e164083,0x0,0x3d55880e,0x3dd53db9,0x3e1f917b
.long 0x0,0x3d621469,0x3de1bc2e,0x3e28defc,0x0,0x3d6ea038,0x3dee3876,0x3e3228d4
.long 0x0,0x3d7b2b74,0x3dfab273,0x3e3b6ecf,0x0,0x3d83db0a,0x3e039502,0x3e44b0b9
.long 0x0,0x3d8a200a,0x3e09cf86,0x3e4dee60,0x0,0x3d9064b4,0x3e1008b7,0x3e57278f
.long 0x0,0x3d96a905,0x3e164083,0x3e605c13,0x0,0x3d9cecf9,0x3e1c76de,0x3e698bba
.long 0x0,0x3da3308c,0x3e22abb6,0x3e72b651,0x0,0x3da973ba,0x3e28defc,0x3e7bdba4
.long 0x0,0x3dafb680,0x3e2f10a2,0x3e827dc0,0x0,0x3db5f8da,0x3e354098,0x3e870ada
.long 0x0,0x3dbc3ac3,0x3e3b6ecf,0x3e8b9507,0x0,0x3dc27c39,0x3e419b37,0x3e901c2c
.long 0x0,0x0,0x0,0x0,0x3c490e90,0x3c7b514b,0x3c96c9b6,0x3cafea69
.long 0x3cc90ab0,0x3cfb49ba,0x3d16c32c,0x3d2fe007,0x3d16c32c,0x3d3c6dd5,0x3d621469,0x3d83db0a
.long 0x3d48fb30,0x3d7b2b74,0x3d96a905,0x3dafb680,0x3d7b2b74,0x3d9cecf9,0x3dbc3ac3,0x3ddb7d37
.long 0x3d96a905,0x3dbc3ac3,0x3de1bc2e,0x3e039502,0x3dafb680,0x3ddb7d37,0x3e039502,0x3e195be0
.long 0x3dc8bd36,0x3dfab273,0x3e164083,0x3e2f10a2,0x3de1bc2e,0x3e0cec4a,0x3e28defc,0x3e44b0b9
.long 0x3dfab273,0x3e1c76de,0x3e3b6ecf,0x3e5a3997,0x3e09cf86,0x3e2bf804,0x3e4dee60,0x3e6fa8b2
.long 0x3e164083,0x3e3b6ecf,0x3e605c13,0x3e827dc0,0x3e22abb6,0x3e4ada4f,0x3e72b651,0x3e8d17c0
.long 0x3e2f10a2,0x3e5a3997,0x3e827dc0,0x3e97a117,0x3e3b6ecf,0x3e698bba,0x3e8b9507,0x3ea21887
.long 0x3e47c5c2,0x3e78cfcc,0x3e94a031,0x3eac7cd4,0x3e541501,0x3e840270,0x3e9d9e78,0x3eb6ccc3
.long 0x3e605c13,0x3e8b9507,0x3ea68f12,0x3ec1071e,0x3e6c9a7f,0x3e931f35,0x3eaf713a,0x3ecb2aae
.long 0x3e78cfcc,0x3e9aa086,0x3eb8442a,0x3ed53641,0x3e827dc0,0x3ea21887,0x3ec1071e,0x3edf28a9
.long 0x3e888e93,0x3ea986c4,0x3ec9b953,0x3ee900b7,0x3e8e9a22,0x3eb0eacb,0x3ed25a09,0x3ef2bd43
.long 0x3e94a031,0x3eb8442a,0x3edae880,0x3efc5d27,0x3e9aa086,0x3ebf926f,0x3ee363fa,0x3f02ef9f
.long 0x3ea09ae5,0x3ec6d529,0x3eebcbbb,0x3f07a136,0x3ea68f12,0x3ece0bea,0x3ef41f07,0x3f0c42c9
.long 0x3eac7cd4,0x3ed53641,0x3efc5d27,0x3f10d3cd,0x3eb263ef,0x3edc53c1,0x3f0242b1,0x3f1553b7
.long 0x3eb8442a,0x3ee363fa,0x3f064b82,0x3f19c200,0x3ebe1d4a,0x3eea6681,0x3f0a48ad,0x3f1e1e22
.long 0x3f800000,0x3f800000,0x3f800000,0x3f800000,0x3f7fec43,0x3f7fe705,0x3f7fe129,0x3f7fdaaf
.long 0x3f7fb10f,0x3f7f9c18,0x3f7f84ab,0x3f7f6ac7,0x3f7f4e6d,0x3f7f1f49,0x3f7eea9d,0x3f7eb069
.long 0x3f7ec46d,0x3f7e70b0,0x3f7e1324,0x3f7dabcc,0x3f7e1324,0x3f7d906e,0x3f7cfe73,0x3f7c5d3a
.long 0x3f7d3aac,0x3f7c7eb0,0x3f7baccd,0x3f7ac516,0x3f7c3b28,0x3f7b3bab,0x3f7a1e84,0x3f78e3d6
.long 0x3f7b14be,0x3f79c79d,0x3f7853f8,0x3f76ba07,0x3f79c79d,0x3f7822d1,0x3f764d97,0x3f74484b
.long 0x3f7853f8,0x3f764d97,0x3f740bdd,0x3f718f57,0x3f76ba07,0x3f74484b,0x3f718f57,0x3f6e8ff8
.long 0x3f74fa0b,0x3f721352,0x3f6ed89e,0x3f6b4b0c,0x3f731447,0x3f6faf1b,0x3f6be858,0x3f67c187
.long 0x3f710908,0x3f6d1c1d,0x3f68bf3c,0x3f63f473,0x3f6ed89e,0x3f6a5ad9,0x3f655e0b,0x3f5fe4e9
.long 0x3f6c835e,0x3f676bd8,0x3f61c598,0x3f5b941a,0x3f6a09a7,0x3f644fac,0x3f5df6be,0x3f570348
.long 0x3f676bd8,0x3f6106f2,0x3f59f26a,0x3f5233c6,0x3f64aa59,0x3f5d924d,0x3f55b993,0x3f4d26fd
.long 0x3f61c598,0x3f59f26a,0x3f514d3d,0x3f47de65,0x3f5ebe05,0x3f5627fe,0x3f4cae79,0x3f425b89
.long 0x3f5b941a,0x3f5233c6,0x3f47de65,0x3f3ca003,0x3f584853,0x3f4e1689,0x3f42de29,0x3f36ad7f
.long 0x3f54db31,0x3f49d112,0x3f3daef9,0x3f3085bb,0x3f514d3d,0x3f456439,0x3f385216,0x3f2a2a80
.long 0x3f4d9f02,0x3f40d0da,0x3f32c8c9,0x3f239da9,0x3f49d112,0x3f3c17d9,0x3f2d1469,0x3f1ce11f
.long 0x3f45e403,0x3f373a23,0x3f273656,0x3f15f6d9,0x3f41d870,0x3f3238aa,0x3f212ff9,0x3f0ee0db
.long 0x3f3daef9,0x3f2d1469,0x3f1b02c6,0x3f07a136,0x3f396842,0x3f27ce61,0x3f14b039,0x3f003a06
.long 0x3f800000,0x3f800000,0x3f800000,0x3f800000,0x3f7fd397,0x3f7fcbe2,0x3f7fc38f,0x3f7fba9e
.long 0x3f7f4e6d,0x3f7f2f9d,0x3f7f0e58,0x3f7eea9d,0x3f7e70b0,0x3f7e2b72,0x3f7de0b1,0x3f7d906e
.long 0x3f7d3aac,0x3f7cbfc9,0x3f7c3b28,0x3f7baccd,0x3f7baccd,0x3f7aed37,0x3f7a1e84,0x3f7940c0
.long 0x3f79c79d,0x3f78b47b,0x3f778bc5,0x3f764d97,0x3f778bc5,0x3f76167a,0x3f748422,0x3f72d4eb
.long 0x3f74fa0b,0x3f731447,0x3f710908,0x3f6ed89e,0x3f721352,0x3f6faf1b,0x3f6d1c1d,0x3f6a5ad9
.long 0x3f6ed89e,0x3f6be858,0x3f68bf3c,0x3f655e0b,0x3f6b4b0c,0x3f67c187,0x3f63f473,0x3f5fe4e9
.long 0x3f676bd8,0x3f633c5a,0x3f5ebe05,0x3f59f26a,0x3f633c5a,0x3f5e5aa6,0x3f591e6a,0x3f5389c7
.long 0x3f5ebe05,0x3f591e6a,0x3f531849,0x3f4cae79,0x3f59f26a,0x3f5389c7,0x3f4cae79,0x3f456439
.long 0x3f54db31,0x3f4d9f02,0x3f45e403,0x3f3daef9,0x3f4f7a1f,0x3f476085,0x3f3ebc1b,0x3f3592e7
.long 0x3f49d112,0x3f40d0da,0x3f373a23,0x3f2d1469,0x3f43e200,0x3f39f2ac,0x3f2f61a5,0x3f24381a
.long 0x3f3daef9,0x3f32c8c9,0x3f273656,0x3f1b02c6,0x3f373a23,0x3f2b561b,0x3f1ebc12,0x3f11796b
.long 0x3f3085bb,0x3f239da9,0x3f15f6d9,0x3f07a136,0x3f299415,0x3f1ba299,0x3f0cead0,0x3efafef7
.long 0x3f226799,0x3f13682a,0x3f039c3d,0x3ee63375,0x3f1b02c6,0x3f0af1b7,0x3ef41f07,0x3ed0eb2a
.long 0x3f13682a,0x3f0242b1,0x3ee0924f,0x3ebb31a0,0x3f0b9a6b,0x3ef2bd43,0x3ecc9b8b,0x3ea5129f
.long 0x3f039c3d,0x3ee0924f,0x3eb8442a,0x3e8e9a22,0x3ef6e0cb,0x3ece0bea,0x3ea395c5,0x3e6fa8b2
.long 0x3ee63375,0x3ebb31a0,0x3e8e9a22,0x3e419b37,0x3ed53641,0x3ea80b1f,0x3e72b651,0x3e1324ca
.long 0x0,0x0,0x0,0x0,0x3cc90ab0,0x3ce22a7a,0x3cfb49ba,0x3d0a342f
.long 0x3d48fb30,0x3d621469,0x3d7b2b74,0x3d8a200a,0x3d96a905,0x3da973ba,0x3dbc3ac3,0x3dcefdb7
.long 0x3dc8bd36,0x3de1bc2e,0x3dfab273,0x3e09cf86,0x3dfab273,0x3e0cec4a,0x3e1c76de,0x3e2bf804
.long 0x3e164083,0x3e28defc,0x3e3b6ecf,0x3e4dee60,0x3e2f10a2,0x3e44b0b9,0x3e5a3997,0x3e6fa8b2
.long 0x3e47c5c2,0x3e605c13,0x3e78cfcc,0x3e888e93,0x3e605c13,0x3e7bdba4,0x3e8b9507,0x3e9920fe
.long 0x3e78cfcc,0x3e8b9507,0x3e9aa086,0x3ea986c4,0x3e888e93,0x3e9920fe,0x3ea986c4,0x3eb9bb1e
.long 0x3e94a031,0x3ea68f12,0x3eb8442a,0x3ec9b953,0x3ea09ae5,0x3eb3dca5,0x3ec6d529,0x3ed97cb9
.long 0x3eac7cd4,0x3ec1071e,0x3ed53641,0x3ee900b7,0x3eb8442a,0x3ece0bea,0x3ee363fa,0x3ef840c8
.long 0x3ec3ef15,0x3edae880,0x3ef15aea,0x3f039c3d,0x3ecf7bca,0x3ee79a5d,0x3eff17b2,0x3f0af1b7
.long 0x3edae880,0x3ef41f07,0x3f064b82,0x3f121eb0,0x3ee63375,0x3f003a06,0x3f0cead0,0x3f19210f
.long 0x3ef15aea,0x3f064b82,0x3f13682a,0x3f1ff6cb,0x3efc5d27,0x3f0c42c9,0x3f19c200,0x3f269de3
.long 0x3f039c3d,0x3f121eb0,0x3f1ff6cb,0x3f2d1469,0x3f08f59b,0x3f17de12,0x3f26050a,0x3f33587a
.long 0x3f0e39da,0x3f1d7fd1,0x3f2beb4a,0x3f396842,0x3f13682a,0x3f2302d3,0x3f31a81d,0x3f3f41fc
.long 0x3f187fc0,0x3f286605,0x3f373a23,0x3f44e3f5,0x3f1d7fd1,0x3f2da859,0x3f3ca003,0x3f4a4c87
.long 0x3f226799,0x3f32c8c9,0x3f41d870,0x3f4f7a1f,0x3f273656,0x3f37c655,0x3f46e22a,0x3f546b3b
.long 0x3f2beb4a,0x3f3ca003,0x3f4bbbf8,0x3f591e6a,0x3f3085bb,0x3f4154e1,0x3f5064af,0x3f5d924d
.long 0x0,0x0,0x0,0x0,0x3d16c32c,0x3d2351cb,0x3d2fe007,0x3d3c6dd5
.long 0x3d96a905,0x3da3308c,0x3dafb680,0x3dbc3ac3,0x3de1bc2e,0x3df475c0,0x3e039502,0x3e0cec4a
.long 0x3e164083,0x3e22abb6,0x3e2f10a2,0x3e3b6ecf,0x3e3b6ecf,0x3e4ada4f,0x3e5a3997,0x3e698bba
.long 0x3e605c13,0x3e72b651,0x3e827dc0,0x3e8b9507,0x3e827dc0,0x3e8d17c0,0x3e97a117,0x3ea21887
.long 0x3e94a031,0x3ea09ae5,0x3eac7cd4,0x3eb8442a,0x3ea68f12,0x3eb3dca5,0x3ec1071e,0x3ece0bea
.long 0x3eb8442a,0x3ec6d529,0x3ed53641,0x3ee363fa,0x3ec9b953,0x3ed97cb9,0x3ee900b7,0x3ef840c8
.long 0x3edae880,0x3eebcbbb,0x3efc5d27,0x3f064b82,0x3eebcbbb,0x3efdbabb,0x3f07a136,0x3f102dd5
.long 0x3efc5d27,0x3f07a136,0x3f10d3cd,0x3f19c200,0x3f064b82,0x3f102dd5,0x3f19c200,0x3f2302d3
.long 0x3f0e39da,0x3f187fc0,0x3f226799,0x3f2beb4a,0x3f15f6d9,0x3f209393,0x3f2ac082,0x3f34768f
.long 0x3f1d7fd1,0x3f286605,0x3f32c8c9,0x3f3ca003,0x3f24d225,0x3f2ff3e6,0x3f3a7ca4,0x3f446337
.long 0x3f2beb4a,0x3f373a23,0x3f41d870,0x3f4bbbf8,0x3f32c8c9,0x3f3e35c5,0x3f48d8b3,0x3f52a649
.long 0x3f396842,0x3f44e3f5,0x3f4f7a1f,0x3f591e6a,0x3f3fc767,0x3f4b41fa,0x3f55b993,0x3f5f20db
.long 0x3f45e403,0x3f514d3d,0x3f5b941a,0x3f64aa59,0x3f4bbbf8,0x3f570348,0x3f6106f2,0x3f69b7e4
.long 0x3f514d3d,0x3f5c61c7,0x3f660f88,0x3f6e46be,0x3f5695e5,0x3f61668a,0x3f6aab7b,0x3f725470
.long 0x3f5b941a,0x3f660f88,0x3f6ed89e,0x3f75dec6,0x3f604621,0x3f6a5ad9,0x3f7294f8,0x3f78e3d6
.long 0x3f64aa59,0x3f6e46be,0x3f75dec6,0x3f7b61fc,0x3f68bf3c,0x3f71d19f,0x3f78b47b,0x3f7d57de
.long 0x3f800000,0x3f800000,0x3f800000,0x3f800000,0x3f7fb10f,0x3f7fa6e3,0x3f7f9c18,0x3f7f90b1
.long 0x3f7ec46d,0x3f7e9bc9,0x3f7e70b0,0x3f7e4323,0x3f7d3aac,0x3f7cdf6c,0x3f7c7eb0,0x3f7c187a
.long 0x3f7b14be,0x3f7a7302,0x3f79c79d,0x3f791298,0x3f7853f8,0x3f77583a,0x3f764d97,0x3f75341d
.long 0x3f74fa0b,0x3f73913f,0x3f721352,0x3f708066,0x3f710908,0x3f6f20b0,0x3f6d1c1d,0x3f6afb8c
.long 0x3f6c835e,0x3f6a09a7,0x3f676bd8,0x3f64aa59,0x3f676bd8,0x3f644fac,0x3f6106f2,0x3f5d924d
.long 0x3f61c598,0x3f5df6be,0x3f59f26a,0x3f55b993,0x3f5b941a,0x3f570348,0x3f5233c6,0x3f4d26fd
.long 0x3f54db31,0x3f4f7a1f,0x3f49d112,0x3f43e200,0x3f4d9f02,0x3f476085,0x3f40d0da,0x3f39f2ac
.long 0x3f45e403,0x3f3ebc1b,0x3f373a23,0x3f2f61a5,0x3f3daef9,0x3f3592e7,0x3f2d1469,0x3f24381a
.long 0x3f3504f3,0x3f2beb4a,0x3f226799,0x3f187fc0,0x3f2beb4a,0x3f21cbfb,0x3f173c07,0x3f0c42c9
.long 0x3f226799,0x3f173c07,0x3f0b9a6b,0x3eff17b2,0x3f187fc0,0x3f0c42c9,0x3eff17b2,0x3ee4cbfe
.long 0x3f0e39da,0x3f00e7e4,0x3ee63375,0x3ec9b953,0x3f039c3d,0x3eea6681,0x3ecc9b8b,0x3eadf73c
.long 0x3ef15aea,0x3ed25a09,0x3eb263ef,0x3e919ddd,0x3edae880,0x3eb9bb1e,0x3e97a117,0x3e698bba
.long 0x3ec3ef15,0x3ea09ae5,0x3e78cfcc,0x3e2f10a2,0x3eac7cd4,0x3e870ada,0x3e419b37,0x3de7fa9a
.long 0x3e94a031,0x3e5a3997,0x3e09cf86,0x3d621469,0x3e78cfcc,0x3e25c58c,0x3da3308c,0xbb490fc6
.long 0x3e47c5c2,0x3de1bc2e,0x3cc90ab0,0xbd7b2b74,0x3e164083,0x3d6ea038,0xbcfb49ba,0xbdf475c0
.long 0x3dc8bd36,0x3bc90f88,0xbdafb680,0xbe354098,0x3d48fb30,0xbd3c6dd5,0xbe1008b7,0xbe6fa8b2
.long 0x3f800000,0x3f800000,0x3f800000,0x3f800000,0x3f7f84ab,0x3f7f7808,0x3f7f6ac7,0x3f7f5ce9
.long 0x3f7e1324,0x3f7de0b1,0x3f7dabcc,0x3f7d7474,0x3f7baccd,0x3f7b3bab,0x3f7ac516,0x3f7a4910
.long 0x3f7853f8,0x3f778bc5,0x3f76ba07,0x3f75dec6,0x3f740bdd,0x3f72d4eb,0x3f718f57,0x3f703b37
.long 0x3f6ed89e,0x3f6d1c1d,0x3f6b4b0c,0x3f696591,0x3f68bf3c,0x3f666771,0x3f63f473,0x3f61668a
.long 0x3f61c598,0x3f5ebe05,0x3f5b941a,0x3f584853,0x3f59f26a,0x3f5627fe,0x3f5233c6,0x3f4e1689
.long 0x3f514d3d,0x3f4cae79,0x3f47de65,0x3f42de29,0x3f47de65,0x3f425b89,0x3f3ca003,0x3f36ad7f
.long 0x3f3daef9,0x3f373a23,0x3f3085bb,0x3f299415,0x3f32c8c9,0x3f2b561b,0x3f239da9,0x3f1ba299
.long 0x3f273656,0x3f1ebc12,0x3f15f6d9,0x3f0cead0,0x3f1b02c6,0x3f11796b,0x3f07a136,0x3efafef7
.long 0x3f0e39da,0x3f039c3d,0x3ef15aea,0x3edae880,0x3f00e7e4,0x3eea6681,0x3ed25a09,0x3eb9bb1e
.long 0x3ee63375,0x3ecc9b8b,0x3eb263ef,0x3e97a117,0x3ec9b953,0x3eadf73c,0x3e919ddd,0x3e698bba
.long 0x3eac7cd4,0x3e8e9a22,0x3e605c13,0x3e22abb6,0x3e8e9a22,0x3e5d4b1a,0x3e1c76de,0x3db5f8da
.long 0x3e605c13,0x3e1c76de,0x3dafb680,0x3c96c9b6,0x3e22abb6,0x3db5f8da,0x3c96c9b6,0xbd55880e
.long 0x3dc8bd36,0x3cc90ab0,0xbd48fb30,0xbdfab273,0x3d16c32c,0xbd2351cb,0xbdee3876,0xbe44b0b9
.long 0xbcc90ab0,0xbdd53db9,0xbe3b6ecf,0xbe8586ce,0xbdafb680,0xbe2bf804,0xbe7ee6e1,0xbea80b1f
.long 0xbe164083,0xbe6c9a7f,0xbea09ae5,0xbec9b953,0xbe541501,0xbe9620d2,0xbec1071e,0xbeea6681
.long 0xbe888e93,0xbeb554ec,0xbee0924f,0xbf04f484,0xbea68f12,0xbed3c867,0xbeff17b2,0xbf140c5f
.long 0x0,0x0,0x0,0x0,0x3d48fb30,0x3d55880e,0x3d621469,0x3d6ea038
.long 0x3dc8bd36,0x3dd53db9,0x3de1bc2e,0x3dee3876,0x3e164083,0x3e1f917b,0x3e28defc,0x3e3228d4
.long 0x3e47c5c2,0x3e541501,0x3e605c13,0x3e6c9a7f,0x3e78cfcc,0x3e840270,0x3e8b9507,0x3e931f35
.long 0x3e94a031,0x3e9d9e78,0x3ea68f12,0x3eaf713a,0x3eac7cd4,0x3eb6ccc3,0x3ec1071e,0x3ecb2aae
.long 0x3ec3ef15,0x3ecf7bca,0x3edae880,0x3ee63375,0x3edae880,0x3ee79a5d,0x3ef41f07,0x3f003a06
.long 0x3ef15aea,0x3eff17b2,0x3f064b82,0x3f0cead0,0x3f039c3d,0x3f0af1b7,0x3f121eb0,0x3f19210f
.long 0x3f0e39da,0x3f15f6d9,0x3f1d7fd1,0x3f24d225,0x3f187fc0,0x3f209393,0x3f286605,0x3f2ff3e6
.long 0x3f226799,0x3f2ac082,0x3f32c8c9,0x3f3a7ca4,0x3f2beb4a,0x3f34768f,0x3f3ca003,0x3f446337
.long 0x3f3504f3,0x3f3daef9,0x3f45e403,0x3f4d9f02,0x3f3daef9,0x3f466354,0x3f4e8d90,0x3f5627fe
.long 0x3f45e403,0x3f4e8d90,0x3f5695e5,0x3f5df6be,0x3f4d9f02,0x3f5627fe,0x3f5df6be,0x3f650479
.long 0x3f54db31,0x3f5d2d53,0x3f64aa59,0x3f6b4b0c,0x3f5b941a,0x3f6398ac,0x3f6aab7b,0x3f70c501
.long 0x3f61c598,0x3f696591,0x3f6ff573,0x3f756d97,0x3f676bd8,0x3f6e8ff8,0x3f748422,0x3f7940c0
.long 0x3f6c835e,0x3f731447,0x3f7853f8,0x3f7c3b28,0x3f710908,0x3f76ef5b,0x3f7b61fc,0x3f7e5a38
.long 0x3f74fa0b,0x3f7a1e84,0x3f7dabcc,0x3f7f9c18,0x3f7853f8,0x3f7c9f8a,0x3f7f2f9d,0x3f7fffb1
.long 0x3f7b14be,0x3f7e70b0,0x3f7fec43,0x3f7f84ab,0x3f7d3aac,0x3f7f90b1,0x3f7fe129,0x3f7e2b72
.long 0x3f7ec46d,0x3f7ffec4,0x3f7f0e58,0x3f7bf531,0x3f7fb10f,0x3f7fba9e,0x3f7d7474,0x3f78e3d6
.long 0x0,0x0,0x0,0x0,0x3d7b2b74,0x3d83db0a,0x3d8a200a,0x3d9064b4
.long 0x3dfab273,0x3e039502,0x3e09cf86,0x3e1008b7,0x3e3b6ecf,0x3e44b0b9,0x3e4dee60,0x3e57278f
.long 0x3e78cfcc,0x3e827dc0,0x3e888e93,0x3e8e9a22,0x3e9aa086,0x3ea21887,0x3ea986c4,0x3eb0eacb
.long 0x3eb8442a,0x3ec1071e,0x3ec9b953,0x3ed25a09,0x3ed53641,0x3edf28a9,0x3ee900b7,0x3ef2bd43
.long 0x3ef15aea,0x3efc5d27,0x3f039c3d,0x3f08f59b,0x3f064b82,0x3f0c42c9,0x3f121eb0,0x3f17de12
.long 0x3f13682a,0x3f19c200,0x3f1ff6cb,0x3f26050a,0x3f1ff6cb,0x3f269de3,0x3f2d1469,0x3f33587a
.long 0x3f2beb4a,0x3f32c8c9,0x3f396842,0x3f3fc767,0x3f373a23,0x3f3e35c5,0x3f44e3f5,0x3f4b41fa
.long 0x3f41d870,0x3f48d8b3,0x3f4f7a1f,0x3f55b993,0x3f4bbbf8,0x3f52a649,0x3f591e6a,0x3f5f20db
.long 0x3f54db31,0x3f5b941a,0x3f61c598,0x3f676bd8,0x3f5d2d53,0x3f6398ac,0x3f696591,0x3f6e8ff8
.long 0x3f64aa59,0x3f6aab7b,0x3f6ff573,0x3f748422,0x3f6b4b0c,0x3f70c501,0x3f756d97,0x3f7940c0
.long 0x3f710908,0x3f75dec6,0x3f79c79d,0x3f7cbfc9,0x3f75dec6,0x3f79f35e,0x3f7cfe73,0x3f7efcc9
.long 0x3f79c79d,0x3f7cfe73,0x3f7f0e58,0x3f7ff4e6,0x3f7cbfc9,0x3f7efcc9,0x3f7ff4e6,0x3f7fa6e3
.long 0x3f7ec46d,0x3f7fec43,0x3f7fb10f,0x3f7e1324,0x3f7fd397,0x3f7fcbe2,0x3f7e4323,0x3f7b3bab
.long 0x3f7fec43,0x3f7e9bc9,0x3f7baccd,0x3f772417,0x3f7f0e58,0x3f7c5d3a,0x3f77f110,0x3f71d19f
.long 0x3f7d3aac,0x3f791298,0x3f731447,0x3f6b4b0c,0x3f7a7302,0x3f74bf62,0x3f6d1c1d,0x3f6398ac
.long 0x3f76ba07,0x3f6f6830,0x3f660f88,0x3f5ac450,0x3f721352,0x3f6912ae,0x3f5df6be,0x3f50d937
.long 0x3f800000,0x3f800000,0x3f800000,0x3f800000,0x3f7f4e6d,0x3f7f3f54,0x3f7f2f9d,0x3f7f1f49
.long 0x3f7d3aac,0x3f7cfe73,0x3f7cbfc9,0x3f7c7eb0,0x3f79c79d,0x3f7940c0,0x3f78b47b,0x3f7822d1
.long 0x3f74fa0b,0x3f740bdd,0x3f731447,0x3f721352,0x3f6ed89e,0x3f6d67a1,0x3f6be858,0x3f6a5ad9
.long 0x3f676bd8,0x3f655e0b,0x3f633c5a,0x3f6106f2,0x3f5ebe05,0x3f5bfb34,0x3f591e6a,0x3f5627fe
.long 0x3f54db31,0x3f514d3d,0x3f4d9f02,0x3f49d112,0x3f49d112,0x3f456439,0x3f40d0da,0x3f3c17d9
.long 0x3f3daef9,0x3f385216,0x3f32c8c9,0x3f2d1469,0x3f3085bb,0x3f2a2a80,0x3f239da9,0x3f1ce11f
.long 0x3f226799,0x3f1b02c6,0x3f13682a,0x3f0b9a6b,0x3f13682a,0x3f0af1b7,0x3f0242b1,0x3ef2bd43
.long 0x3f039c3d,0x3ef41f07,0x3ee0924f,0x3ecc9b8b,0x3ee63375,0x3ed0eb2a,0x3ebb31a0,0x3ea5129f
.long 0x3ec3ef15,0x3eac7cd4,0x3e94a031,0x3e78cfcc,0x3ea09ae5,0x3e870ada,0x3e5a3997,0x3e25c58c
.long 0x3e78cfcc,0x3e419b37,0x3e09cf86,0x3da3308c,0x3e2f10a2,0x3de7fa9a,0x3d621469,0xbb490fc6
.long 0x3dc8bd36,0x3d16c32c,0xbcc90ab0,0xbdafb680,0x3cc90ab0,0xbd2351cb,0xbdd53db9,0xbe2bf804
.long 0xbd48fb30,0xbdee3876,0xbe3b6ecf,0xbe7ee6e1,0xbdfab273,0xbe44b0b9,0xbe8586ce,0xbea80b1f
.long 0xbe47c5c2,0xbe888e93,0xbeac7cd4,0xbecf7bca,0xbe888e93,0xbeadf73c,0xbed25a09,0xbef58035
.long 0xbeac7cd4,0xbed25a09,0xbef6e0cb,0xbf0cead0,0xbecf7bca,0xbef58035,0xbf0cead0,0xbf1e1e22
.long 0xbef15aea,0xbf0b9a6b,0xbf1d7fd1,0xbf2e3bde,0xbf08f59b,0xbf1ba299,0xbf2d1469,0xbf3d27b8
.long 0xbf187fc0,0xbf2ac082,0xbf3b8f3b,0xbf4ac77f,0xbf273656,0xbf38dd65,0xbf48d8b3,0xbf570348
.long 0x3f800000,0x3f800000,0x3f800000,0x3f800000,0x3f7f0e58,0x3f7efcc9,0x3f7eea9d,0x3f7ed7d4
.long 0x3f7c3b28,0x3f7bf531,0x3f7baccd,0x3f7b61fc,0x3f778bc5,0x3f76ef5b,0x3f764d97,0x3f75a67b
.long 0x3f710908,0x3f6ff573,0x3f6ed89e,0x3f6db293,0x3f68bf3c,0x3f671599,0x3f655e0b,0x3f6398ac
.long 0x3f5ebe05,0x3f5c61c7,0x3f59f26a,0x3f577026,0x3f531849,0x3f4fefa8,0x3f4cae79,0x3f495521
.long 0x3f45e403,0x3f41d870,0x3f3daef9,0x3f396842,0x3f373a23,0x3f3238aa,0x3f2d1469,0x3f27ce61
.long 0x3f273656,0x3f212ff9,0x3f1b02c6,0x3f14b039,0x3f15f6d9,0x3f0ee0db,0x3f07a136,0x3f003a06
.long 0x3f039c3d,0x3ef6e0cb,0x3ee63375,0x3ed53641,0x3ee0924f,0x3ece0bea,0x3ebb31a0,0x3ea80b1f
.long 0x3eb8442a,0x3ea395c5,0x3e8e9a22,0x3e72b651,0x3e8e9a22,0x3e6fa8b2,0x3e419b37,0x3e1324ca
.long 0x3e47c5c2,0x3e164083,0x3dc8bd36,0x3d48fb30,0x3de1bc2e,0x3d6ea038,0x3bc90f88,0xbd3c6dd5
.long 0x3cc90ab0,0xbcfb49ba,0xbdafb680,0xbe1008b7,0xbd7b2b74,0xbdf475c0,0xbe354098,0xbe6fa8b2
.long 0xbe164083,0xbe541501,0xbe888e93,0xbea68f12,0xbe6c9a7f,0xbe9620d2,0xbeb554ec,0xbed3c867
.long 0xbea09ae5,0xbec1071e,0xbee0924f,0xbeff17b2,0xbec9b953,0xbeea6681,0xbf04f484,0xbf140c5f
.long 0xbef15aea,0xbf08f59b,0xbf187fc0,0xbf273656,0xbf0b9a6b,0xbf1ba299,0xbf2ac082,0xbf38dd65
.long 0xbf1d7fd1,0xbf2d1469,0xbf3b8f3b,0xbf48d8b3,0xbf2e3bde,0xbf3d27b8,0xbf4ac77f,0xbf570348
.long 0xbf3daef9,0xbf4bbbf8,0xbf584853,0xbf633c5a,0xbf4bbbf8,0xbf58b3a1,0xbf63f473,0xbf6d67a1
.long 0xbf584853,0xbf63f473,0xbf6db293,0xbf756d97,0xbf633c5a,0xbf6d67a1,0xbf756d97,0xbf7b3bab
.long 0x0,0x0,0x0,0x0,0x3d96a905,0x3d9cecf9,0x3da3308c,0x3da973ba
.long 0x3e164083,0x3e1c76de,0x3e22abb6,0x3e28defc,0x3e605c13,0x3e698bba,0x3e72b651,0x3e7bdba4
.long 0x3e94a031,0x3e9aa086,0x3ea09ae5,0x3ea68f12,0x3eb8442a,0x3ebf926f,0x3ec6d529,0x3ece0bea
.long 0x3edae880,0x3ee363fa,0x3eebcbbb,0x3ef41f07,0x3efc5d27,0x3f02ef9f,0x3f07a136,0x3f0c42c9
.long 0x3f0e39da,0x3f13682a,0x3f187fc0,0x3f1d7fd1,0x3f1d7fd1,0x3f2302d3,0x3f286605,0x3f2da859
.long 0x3f2beb4a,0x3f31a81d,0x3f373a23,0x3f3ca003,0x3f396842,0x3f3f41fc,0x3f44e3f5,0x3f4a4c87
.long 0x3f45e403,0x3f4bbbf8,0x3f514d3d,0x3f5695e5,0x3f514d3d,0x3f570348,0x3f5c61c7,0x3f61668a
.long 0x3f5b941a,0x3f6106f2,0x3f660f88,0x3f6aab7b,0x3f64aa59,0x3f69b7e4,0x3f6e46be,0x3f725470
.long 0x3f6c835e,0x3f710908,0x3f74fa0b,0x3f7853f8,0x3f731447,0x3f76ef5b,0x3f7a1e84,0x3f7c9f8a
.long 0x3f7853f8,0x3f7b61fc,0x3f7dabcc,0x3f7f2f9d,0x3f7c3b28,0x3f7e5a38,0x3f7f9c18,0x3f7fffb1
.long 0x3f7ec46d,0x3f7fd397,0x3f7fec43,0x3f7f0e58,0x3f7fec43,0x3f7fcbe2,0x3f7e9bc9,0x3f7c5d3a
.long 0x3f7fb10f,0x3f7e4323,0x3f7baccd,0x3f77f110,0x3f7e1324,0x3f7b3bab,0x3f772417,0x3f71d19f
.long 0x3f7b14be,0x3f76ba07,0x3f710908,0x3f6a09a7,0x3f76ba07,0x3f70c501,0x3f696591,0x3f60a6cf
.long 0x3f710908,0x3f696591,0x3f604621,0x3f55b993,0x3f6a09a7,0x3f60a6cf,0x3f55b993,0x3f495521
.long 0x3f61c598,0x3f5695e5,0x3f49d112,0x3f3b8f3b,0x3f584853,0x3f4b41fa,0x3f3ca003,0x3f2c800f
.long 0x3f4d9f02,0x3f3ebc1b,0x3f2e3bde,0x3f1c420c,0x3f41d870,0x3f311722,0x3f1ebc12,0x3f0af1b7
.long 0x0,0x0,0x0,0x0,0x3dafb680,0x3db5f8da,0x3dbc3ac3,0x3dc27c39
.long 0x3e2f10a2,0x3e354098,0x3e3b6ecf,0x3e419b37,0x3e827dc0,0x3e870ada,0x3e8b9507,0x3e901c2c
.long 0x3eac7cd4,0x3eb263ef,0x3eb8442a,0x3ebe1d4a,0x3ed53641,0x3edc53c1,0x3ee363fa,0x3eea6681
.long 0x3efc5d27,0x3f0242b1,0x3f064b82,0x3f0a48ad,0x3f10d3cd,0x3f1553b7,0x3f19c200,0x3f1e1e22
.long 0x3f226799,0x3f273656,0x3f2beb4a,0x3f3085bb,0x3f32c8c9,0x3f37c655,0x3f3ca003,0x3f4154e1
.long 0x3f41d870,0x3f46e22a,0x3f4bbbf8,0x3f5064af,0x3f4f7a1f,0x3f546b3b,0x3f591e6a,0x3f5d924d
.long 0x3f5b941a,0x3f604621,0x3f64aa59,0x3f68bf3c,0x3f660f88,0x3f6a5ad9,0x3f6e46be,0x3f71d19f
.long 0x3f6ed89e,0x3f7294f8,0x3f75dec6,0x3f78b47b,0x3f75dec6,0x3f78e3d6,0x3f7b61fc,0x3f7d57de
.long 0x3f7b14be,0x3f7d3aac,0x3f7ec46d,0x3f7fb10f,0x3f7e70b0,0x3f7f90b1,0x3f7ffec4,0x3f7fba9e
.long 0x3f7fec43,0x3f7fe129,0x3f7f0e58,0x3f7d7474,0x3f7f84ab,0x3f7e2b72,0x3f7bf531,0x3f78e3d6
.long 0x3f7d3aac,0x3f7a7302,0x3f76ba07,0x3f721352,0x3f791298,0x3f74bf62,0x3f6f6830,0x3f6912ae
.long 0x3f731447,0x3f6d1c1d,0x3f660f88,0x3f5df6be,0x3f6b4b0c,0x3f6398ac,0x3f5ac450,0x3f50d937
.long 0x3f61c598,0x3f584853,0x3f4d9f02,0x3f41d870,0x3f5695e5,0x3f4b41fa,0x3f3ebc1b,0x3f311722
.long 0x3f49d112,0x3f3ca003,0x3f2e3bde,0x3f1ebc12,0x3f3b8f3b,0x3f2c800f,0x3f1c420c,0x3f0af1b7
.long 0x3f2beb4a,0x3f1b02c6,0x3f08f59b,0x3eebcbbb,0x3f1b02c6,0x3f084b92,0x3ee900b7,0x3ebf926f
.long 0x3f08f59b,0x3ee900b7,0x3ebe1d4a,0x3e919ddd,0x3eebcbbb,0x3ebf926f,0x3e919ddd,0x3e44b0b9
.long 0x3f800000,0x3f7ec46d,0x3f7b14be,0x3f74fa0b,0x3f800000,0x3f7eb069,0x3f7ac516,0x3f74484b
.long 0x3f800000,0x3f7e9bc9,0x3f7a7302,0x3f73913f,0x3f800000,0x3f7e868b,0x3f7a1e84,0x3f72d4eb
.long 0x3f800000,0x3f7e70b0,0x3f79c79d,0x3f721352,0x3f800000,0x3f7e5a38,0x3f796e4e,0x3f714c7a
.long 0x3f800000,0x3f7e4323,0x3f791298,0x3f708066,0x3f800000,0x3f7e2b72,0x3f78b47b,0x3f6faf1b
.long 0x3f800000,0x3f7e1324,0x3f7853f8,0x3f6ed89e,0x3f800000,0x3f7dfa38,0x3f77f110,0x3f6dfcf2
.long 0x3f800000,0x3f7de0b1,0x3f778bc5,0x3f6d1c1d,0x3f800000,0x3f7dc68c,0x3f772417,0x3f6c3624
.long 0x3f800000,0x3f7dabcc,0x3f76ba07,0x3f6b4b0c,0x3f800000,0x3f7d906e,0x3f764d97,0x3f6a5ad9
.long 0x3f800000,0x3f7d7474,0x3f75dec6,0x3f696591,0x3f800000,0x3f7d57de,0x3f756d97,0x3f686b39
.long 0x3f800000,0x3f7d3aac,0x3f74fa0b,0x3f676bd8,0x3f800000,0x3f7d1cdd,0x3f748422,0x3f666771
.long 0x3f800000,0x3f7cfe73,0x3f740bdd,0x3f655e0b,0x3f800000,0x3f7cdf6c,0x3f73913f,0x3f644fac
.long 0x3f800000,0x3f7cbfc9,0x3f731447,0x3f633c5a,0x3f800000,0x3f7c9f8a,0x3f7294f8,0x3f62241a
.long 0x3f800000,0x3f7c7eb0,0x3f721352,0x3f6106f2,0x3f800000,0x3f7c5d3a,0x3f718f57,0x3f5fe4e9
.long 0x3f800000,0x3f7c3b28,0x3f710908,0x3f5ebe05,0x3f800000,0x3f7c187a,0x3f708066,0x3f5d924d
.long 0x3f800000,0x3f7bf531,0x3f6ff573,0x3f5c61c7,0x3f800000,0x3f7bd14d,0x3f6f6830,0x3f5b2c79
.long 0x3f800000,0x3f7baccd,0x3f6ed89e,0x3f59f26a,0x3f800000,0x3f7b87b2,0x3f6e46be,0x3f58b3a1
.long 0x3f800000,0x3f7b61fc,0x3f6db293,0x3f577026,0x3f800000,0x3f7b3bab,0x3f6d1c1d,0x3f5627fe
.long 0x3f6c835e,0x3f61c598,0x3f54db31,0x3f45e403,0x3f6b4b0c,0x3f5fe4e9,0x3f5233c6,0x3f425b89
.long 0x3f6a09a7,0x3f5df6be,0x3f4f7a1f,0x3f3ebc1b,0x3f68bf3c,0x3f5bfb34,0x3f4cae79,0x3f3b0629
.long 0x3f676bd8,0x3f59f26a,0x3f49d112,0x3f373a23,0x3f660f88,0x3f57dc7f,0x3f46e22a,0x3f33587a
.long 0x3f64aa59,0x3f55b993,0x3f43e200,0x3f2f61a5,0x3f633c5a,0x3f5389c7,0x3f40d0da,0x3f2b561b
.long 0x3f61c598,0x3f514d3d,0x3f3daef9,0x3f273656,0x3f604621,0x3f4f0417,0x3f3a7ca4,0x3f2302d3
.long 0x3f5ebe05,0x3f4cae79,0x3f373a23,0x3f1ebc12,0x3f5d2d53,0x3f4a4c87,0x3f33e7bc,0x3f1a6293
.long 0x3f5b941a,0x3f47de65,0x3f3085bb,0x3f15f6d9,0x3f59f26a,0x3f456439,0x3f2d1469,0x3f11796b
.long 0x3f584853,0x3f42de29,0x3f299415,0x3f0cead0,0x3f5695e5,0x3f404c5c,0x3f26050a,0x3f084b92
.long 0x3f54db31,0x3f3daef9,0x3f226799,0x3f039c3d,0x3f531849,0x3f3b0629,0x3f1ebc12,0x3efdbabb
.long 0x3f514d3d,0x3f385216,0x3f1b02c6,0x3ef41f07,0x3f4f7a1f,0x3f3592e7,0x3f173c07,0x3eea6681
.long 0x3f4d9f02,0x3f32c8c9,0x3f13682a,0x3ee0924f,0x3f4bbbf8,0x3f2ff3e6,0x3f0f8784,0x3ed6a399
.long 0x3f49d112,0x3f2d1469,0x3f0b9a6b,0x3ecc9b8b,0x3f47de65,0x3f2a2a80,0x3f07a136,0x3ec27b55
.long 0x3f45e403,0x3f273656,0x3f039c3d,0x3eb8442a,0x3f43e200,0x3f24381a,0x3eff17b2,0x3eadf73c
.long 0x3f41d870,0x3f212ff9,0x3ef6e0cb,0x3ea395c5,0x3f3fc767,0x3f1e1e22,0x3eee9479,0x3e9920fe
.long 0x3f3daef9,0x3f1b02c6,0x3ee63375,0x3e8e9a22,0x3f3b8f3b,0x3f17de12,0x3eddbe79,0x3e840270
.long 0x3f396842,0x3f14b039,0x3ed53641,0x3e72b651,0x3f373a23,0x3f11796b,0x3ecc9b8b,0x3e5d4b1a
.long 0x0,0x3dc8bd36,0x3e47c5c2,0x3e94a031,0x0,0x3dcefdb7,0x3e4dee60,0x3e9920fe
.long 0x0,0x3dd53db9,0x3e541501,0x3e9d9e78,0x0,0x3ddb7d37,0x3e5a3997,0x3ea21887
.long 0x0,0x3de1bc2e,0x3e605c13,0x3ea68f12,0x0,0x3de7fa9a,0x3e667c66,0x3eab0201
.long 0x0,0x3dee3876,0x3e6c9a7f,0x3eaf713a,0x0,0x3df475c0,0x3e72b651,0x3eb3dca5
.long 0x0,0x3dfab273,0x3e78cfcc,0x3eb8442a,0x0,0x3e007745,0x3e7ee6e1,0x3ebca7af
.long 0x0,0x3e039502,0x3e827dc0,0x3ec1071e,0x0,0x3e06b26e,0x3e8586ce,0x3ec5625c
.long 0x0,0x3e09cf86,0x3e888e93,0x3ec9b953,0x0,0x3e0cec4a,0x3e8b9507,0x3ece0bea
.long 0x0,0x3e1008b7,0x3e8e9a22,0x3ed25a09,0x0,0x3e1324ca,0x3e919ddd,0x3ed6a399
.long 0x0,0x3e164083,0x3e94a031,0x3edae880,0x0,0x3e195be0,0x3e97a117,0x3edf28a9
.long 0x0,0x3e1c76de,0x3e9aa086,0x3ee363fa,0x0,0x3e1f917b,0x3e9d9e78,0x3ee79a5d
.long 0x0,0x3e22abb6,0x3ea09ae5,0x3eebcbbb,0x0,0x3e25c58c,0x3ea395c5,0x3eeff7fb
.long 0x0,0x3e28defc,0x3ea68f12,0x3ef41f07,0x0,0x3e2bf804,0x3ea986c4,0x3ef840c8
.long 0x0,0x3e2f10a2,0x3eac7cd4,0x3efc5d27,0x0,0x3e3228d4,0x3eaf713a,0x3f003a06
.long 0x0,0x3e354098,0x3eb263ef,0x3f0242b1,0x0,0x3e3857ec,0x3eb554ec,0x3f044889
.long 0x0,0x3e3b6ecf,0x3eb8442a,0x3f064b82,0x0,0x3e3e853e,0x3ebb31a0,0x3f084b92
.long 0x0,0x3e419b37,0x3ebe1d4a,0x3f0a48ad,0x0,0x3e44b0b9,0x3ec1071e,0x3f0c42c9
.long 0x3ec3ef15,0x3ef15aea,0x3f0e39da,0x3f226799,0x3ec9b953,0x3ef840c8,0x3f121eb0,0x3f269de3
.long 0x3ecf7bca,0x3eff17b2,0x3f15f6d9,0x3f2ac082,0x3ed53641,0x3f02ef9f,0x3f19c200,0x3f2ecef7
.long 0x3edae880,0x3f064b82,0x3f1d7fd1,0x3f32c8c9,0x3ee0924f,0x3f099f4e,0x3f212ff9,0x3f36ad7f
.long 0x3ee63375,0x3f0cead0,0x3f24d225,0x3f3a7ca4,0x3eebcbbb,0x3f102dd5,0x3f286605,0x3f3e35c5
.long 0x3ef15aea,0x3f13682a,0x3f2beb4a,0x3f41d870,0x3ef6e0cb,0x3f16999f,0x3f2f61a5,0x3f456439
.long 0x3efc5d27,0x3f19c200,0x3f32c8c9,0x3f48d8b3,0x3f00e7e4,0x3f1ce11f,0x3f36206c,0x3f4c3578
.long 0x3f039c3d,0x3f1ff6cb,0x3f396842,0x3f4f7a1f,0x3f064b82,0x3f2302d3,0x3f3ca003,0x3f52a649
.long 0x3f08f59b,0x3f26050a,0x3f3fc767,0x3f55b993,0x3f0b9a6b,0x3f28fd41,0x3f42de29,0x3f58b3a1
.long 0x3f0e39da,0x3f2beb4a,0x3f45e403,0x3f5b941a,0x3f10d3cd,0x3f2ecef7,0x3f48d8b3,0x3f5e5aa6
.long 0x3f13682a,0x3f31a81d,0x3f4bbbf8,0x3f6106f2,0x3f15f6d9,0x3f34768f,0x3f4e8d90,0x3f6398ac
.long 0x3f187fc0,0x3f373a23,0x3f514d3d,0x3f660f88,0x3f1b02c6,0x3f39f2ac,0x3f53fac3,0x3f686b39
.long 0x3f1d7fd1,0x3f3ca003,0x3f5695e5,0x3f6aab7b,0x3f1ff6cb,0x3f3f41fc,0x3f591e6a,0x3f6cd007
.long 0x3f226799,0x3f41d870,0x3f5b941a,0x3f6ed89e,0x3f24d225,0x3f446337,0x3f5df6be,0x3f70c501
.long 0x3f273656,0x3f46e22a,0x3f604621,0x3f7294f8,0x3f299415,0x3f495521,0x3f628210,0x3f74484b
.long 0x3f2beb4a,0x3f4bbbf8,0x3f64aa59,0x3f75dec6,0x3f2e3bde,0x3f4e1689,0x3f66becc,0x3f77583a
.long 0x3f3085bb,0x3f5064af,0x3f68bf3c,0x3f78b47b,0x3f32c8c9,0x3f52a649,0x3f6aab7b,0x3f79f35e
.long 0x3f3504f3,0x3f226799,0x3f0e39da,0x3ef15aea,0x3f3085bb,0x3f1ce11f,0x3f07a136,0x3ee1fb6a
.long 0x3f2beb4a,0x3f173c07,0x3f00e7e4,0x3ed25a09,0x3f273656,0x3f11796b,0x3ef41f07,0x3ec27b55
.long 0x3f226799,0x3f0b9a6b,0x3ee63375,0x3eb263ef,0x3f1d7fd1,0x3f05a02c,0x3ed8106b,0x3ea21887
.long 0x3f187fc0,0x3eff17b2,0x3ec9b953,0x3e919ddd,0x3f13682a,0x3ef2bd43,0x3ebb31a0,0x3e80f8c0
.long 0x3f0e39da,0x3ee63375,0x3eac7cd4,0x3e605c13,0x3f08f59b,0x3ed97cb9,0x3e9d9e78,0x3e3e853e
.long 0x3f039c3d,0x3ecc9b8b,0x3e8e9a22,0x3e1c76de,0x3efc5d27,0x3ebf926f,0x3e7ee6e1,0x3df475c0
.long 0x3ef15aea,0x3eb263ef,0x3e605c13,0x3dafb680,0x3ee63375,0x3ea5129f,0x3e419b37,0x3d55880e
.long 0x3edae880,0x3e97a117,0x3e22abb6,0x3c96c9b6,0x3ecf7bca,0x3e8a11f7,0x3e039502,0xbc7b514b
.long 0x3ec3ef15,0x3e78cfcc,0x3dc8bd36,0xbd48fb30,0x3eb8442a,0x3e5d4b1a,0x3d8a200a,0xbda973ba
.long 0x3eac7cd4,0x3e419b37,0x3d16c32c,0xbdee3876,0x3ea09ae5,0x3e25c58c,0x3bc90f88,0xbe195be0
.long 0x3e94a031,0x3e09cf86,0xbcc90ab0,0xbe3b6ecf,0x3e888e93,0x3ddb7d37,0xbd621469,0xbe5d4b1a
.long 0x3e78cfcc,0x3da3308c,0xbdafb680,0xbe7ee6e1,0x3e605c13,0x3d55880e,0xbdee3876,0xbe901c2c
.long 0x3e47c5c2,0x3cc90ab0,0xbe164083,0xbea09ae5,0x3e2f10a2,0xbb490fc6,0xbe354098,0xbeb0eacb
.long 0x3e164083,0xbcfb49ba,0xbe541501,0xbec1071e,0x3dfab273,0xbd6ea038,0xbe72b651,0xbed0eb2a
.long 0x3dc8bd36,0xbdafb680,0xbe888e93,0xbee0924f,0x3d96a905,0xbde7fa9a,0xbe97a117,0xbeeff7fb
.long 0x3d48fb30,0xbe1008b7,0xbea68f12,0xbeff17b2,0x3cc90ab0,0xbe2bf804,0xbeb554ec,0xbf06f686
.long 0x3ec3ef15,0x3e94a031,0x3e47c5c2,0x3dc8bd36,0x3eb263ef,0x3e80f8c0,0x3e1c76de,0x3d55880e
.long 0x3ea09ae5,0x3e5a3997,0x3de1bc2e,0x3bc90f88,0x3e8e9a22,0x3e3228d4,0x3d8a200a,0xbd2351cb
.long 0x3e78cfcc,0x3e09cf86,0x3cc90ab0,0xbdafb680,0x3e541501,0x3dc27c39,0xbc96c9b6,0xbe06b26e
.long 0x3e2f10a2,0x3d621469,0xbd7b2b74,0xbe354098,0x3e09cf86,0x3c7b514b,0xbdd53db9,0xbe636c83
.long 0x3dc8bd36,0xbcc90ab0,0xbe164083,0xbe888e93,0x3d7b2b74,0xbd83db0a,0xbe419b37,0xbe9f1cdf
.long 0x3cc90ab0,0xbdd53db9,0xbe6c9a7f,0xbeb554ec,0xbc490e90,0xbe1324ca,0xbe8b9507,0xbecb2aae
.long 0xbd48fb30,0xbe3b6ecf,0xbea09ae5,0xbee0924f,0xbdafb680,0xbe636c83,0xbeb554ec,0xbef58035
.long 0xbdfab273,0xbe8586ce,0xbec9b953,0xbf04f484,0xbe22abb6,0xbe9920fe,0xbeddbe79,0xbf0ee0db
.long 0xbe47c5c2,0xbeac7cd4,0xbef15aea,0xbf187fc0,0xbe6c9a7f,0xbebf926f,0xbf0242b1,0xbf21cbfb
.long 0xbe888e93,0xbed25a09,0xbf0b9a6b,0xbf2ac082,0xbe9aa086,0xbee4cbfe,0xbf14b039,0xbf33587a
.long 0xbeac7cd4,0xbef6e0cb,0xbf1d7fd1,0xbf3b8f3b,0xbebe1d4a,0xbf044889,0xbf26050a,0xbf436051
.long 0xbecf7bca,0xbf0cead0,0xbf2e3bde,0xbf4ac77f,0xbee0924f,0xbf1553b7,0xbf36206c,0xbf51c0c2
.long 0xbef15aea,0xbf1d7fd1,0xbf3daef9,0xbf584853,0xbf00e7e4,0xbf256bcb,0xbf44e3f5,0xbf5e5aa6
.long 0xbf08f59b,0xbf2d1469,0xbf4bbbf8,0xbf63f473,0xbf10d3cd,0xbf34768f,0xbf5233c6,0xbf6912ae
.long 0xbf187fc0,0xbf3b8f3b,0xbf584853,0xbf6db293,0xbf1ff6cb,0xbf425b89,0xbf5df6be,0xbf71d19f
.long 0xbf273656,0xbf48d8b3,0xbf633c5a,0xbf756d97,0xbf2e3bde,0xbf4f0417,0xbf6816a8,0xbf788486
.long 0x3f3504f3,0x3f45e403,0x3f54db31,0x3f61c598,0x3f396842,0x3f4a4c87,0x3f591e6a,0x3f65b710
.long 0x3f3daef9,0x3f4e8d90,0x3f5d2d53,0x3f696591,0x3f41d870,0x3f52a649,0x3f6106f2,0x3f6cd007
.long 0x3f45e403,0x3f5695e5,0x3f64aa59,0x3f6ff573,0x3f49d112,0x3f5a5ba0,0x3f6816a8,0x3f72d4eb
.long 0x3f4d9f02,0x3f5df6be,0x3f6b4b0c,0x3f756d97,0x3f514d3d,0x3f61668a,0x3f6e46be,0x3f77beb7
.long 0x3f54db31,0x3f64aa59,0x3f710908,0x3f79c79d,0x3f584853,0x3f67c187,0x3f73913f,0x3f7b87b2
.long 0x3f5b941a,0x3f6aab7b,0x3f75dec6,0x3f7cfe73,0x3f5ebe05,0x3f6d67a1,0x3f77f110,0x3f7e2b72
.long 0x3f61c598,0x3f6ff573,0x3f79c79d,0x3f7f0e58,0x3f64aa59,0x3f725470,0x3f7b61fc,0x3f7fa6e3
.long 0x3f676bd8,0x3f748422,0x3f7cbfc9,0x3f7ff4e6,0x3f6a09a7,0x3f76841b,0x3f7de0b1,0x3f7ff84a
.long 0x3f6c835e,0x3f7853f8,0x3f7ec46d,0x3f7fb10f,0x3f6ed89e,0x3f79f35e,0x3f7f6ac7,0x3f7f1f49
.long 0x3f710908,0x3f7b61fc,0x3f7fd397,0x3f7e4323,0x3f731447,0x3f7c9f8a,0x3f7ffec4,0x3f7d1cdd
.long 0x3f74fa0b,0x3f7dabcc,0x3f7fec43,0x3f7baccd,0x3f76ba07,0x3f7e868b,0x3f7f9c18,0x3f79f35e
.long 0x3f7853f8,0x3f7f2f9d,0x3f7f0e58,0x3f77f110,0x3f79c79d,0x3f7fa6e3,0x3f7e4323,0x3f75a67b
.long 0x3f7b14be,0x3f7fec43,0x3f7d3aac,0x3f731447,0x3f7c3b28,0x3f7fffb1,0x3f7bf531,0x3f703b37
.long 0x3f7d3aac,0x3f7fe129,0x3f7a7302,0x3f6d1c1d,0x3f7e1324,0x3f7f90b1,0x3f78b47b,0x3f69b7e4
.long 0x3f7ec46d,0x3f7f0e58,0x3f76ba07,0x3f660f88,0x3f7f4e6d,0x3f7e5a38,0x3f748422,0x3f62241a
.long 0x3f7fb10f,0x3f7d7474,0x3f721352,0x3f5df6be,0x3f7fec43,0x3f7c5d3a,0x3f6f6830,0x3f5988ad
.long 0x3f6c835e,0x3f74fa0b,0x3f7b14be,0x3f7ec46d,0x3f6ff573,0x3f77beb7,0x3f7cfe73,0x3f7fa6e3
.long 0x3f731447,0x3f7a1e84,0x3f7e70b0,0x3f7ffec4,0x3f75dec6,0x3f7c187a,0x3f7f6ac7,0x3f7fcbe2
.long 0x3f7853f8,0x3f7dabcc,0x3f7fec43,0x3f7f0e58,0x3f7a7302,0x3f7ed7d4,0x3f7ff4e6,0x3f7dc68c
.long 0x3f7c3b28,0x3f7f9c18,0x3f7f84ab,0x3f7bf531,0x3f7dabcc,0x3f7ff84a,0x3f7e9bc9,0x3f799b43
.long 0x3f7ec46d,0x3f7fec43,0x3f7d3aac,0x3f76ba07,0x3f7f84ab,0x3f7f7808,0x3f7b61fc,0x3f73530e
.long 0x3f7fec43,0x3f7e9bc9,0x3f791298,0x3f6f6830,0x3f7ffb11,0x3f7d57de,0x3f764d97,0x3f6afb8c
.long 0x3f7fb10f,0x3f7baccd,0x3f731447,0x3f660f88,0x3f7f0e58,0x3f799b43,0x3f6f6830,0x3f60a6cf
.long 0x3f7e1324,0x3f772417,0x3f6b4b0c,0x3f5ac450,0x3f7cbfc9,0x3f74484b,0x3f66becc,0x3f546b3b
.long 0x3f7b14be,0x3f710908,0x3f61c598,0x3f4d9f02,0x3f791298,0x3f6d67a1,0x3f5c61c7,0x3f466354
.long 0x3f76ba07,0x3f696591,0x3f5695e5,0x3f3ebc1b,0x3f740bdd,0x3f650479,0x3f5064af,0x3f36ad7f
.long 0x3f710908,0x3f604621,0x3f49d112,0x3f2e3bde,0x3f6db293,0x3f5b2c79,0x3f42de29,0x3f256bcb
.long 0x3f6a09a7,0x3f55b993,0x3f3b8f3b,0x3f1c420c,0x3f660f88,0x3f4fefa8,0x3f33e7bc,0x3f12c39a
.long 0x3f61c598,0x3f49d112,0x3f2beb4a,0x3f08f59b,0x3f5d2d53,0x3f436051,0x3f239da9,0x3efdbabb
.long 0x3f584853,0x3f3ca003,0x3f1b02c6,0x3ee900b7,0x3f531849,0x3f3592e7,0x3f121eb0,0x3ed3c867
.long 0x3f4d9f02,0x3f2e3bde,0x3f08f59b,0x3ebe1d4a,0x3f47de65,0x3f269de3,0x3eff17b2,0x3ea80b1f
.long 0x3f41d870,0x3f1ebc12,0x3eebcbbb,0x3e919ddd,0x3f3b8f3b,0x3f16999f,0x3ed8106b,0x3e75c35a
.long 0x248d3132,0xbdc8bd36,0xbe47c5c2,0xbe94a031,0xbd48fb30,0xbe195be0,0xbe7ee6e1,0xbeb0eacb
.long 0xbdc8bd36,0xbe4dee60,0xbe9aa086,0xbecc9b8b,0xbe164083,0xbe80f8c0,0xbeb554ec,0xbee79a5d
.long 0xbe47c5c2,0xbe9aa086,0xbecf7bca,0xbf00e7e4,0xbe78cfcc,0xbeb3dca5,0xbee900b7,0xbf0d9281
.long 0xbe94a031,0xbecc9b8b,0xbf00e7e4,0xbf19c200,0xbeac7cd4,0xbee4cbfe,0xbf0cead0,0xbf256bcb
.long 0xbec3ef15,0xbefc5d27,0xbf187fc0,0xbf3085bb,0xbedae880,0xbf099f4e,0xbf239da9,0xbf3b0629
.long 0xbef15aea,0xbf14b039,0xbf2e3bde,0xbf44e3f5,0xbf039c3d,0xbf1f599f,0xbf385216,0xbf4e1689
.long 0xbf0e39da,0xbf299415,0xbf41d870,0xbf5695e5,0xbf187fc0,0xbf33587a,0xbf4ac77f,0xbf5e5aa6
.long 0xbf226799,0xbf3ca003,0xbf531849,0xbf655e0b,0xbf2beb4a,0xbf456439,0xbf5ac450,0xbf6b99fb
.long 0xbf3504f3,0xbf4d9f02,0xbf61c598,0xbf710908,0xbf3daef9,0xbf554aa4,0xbf6816a8,0xbf75a67b
.long 0xbf45e403,0xbf5c61c7,0xbf6db293,0xbf796e4e,0xbf4d9f02,0xbf62df7b,0xbf7294f8,0xbf7c5d3a
.long 0xbf54db31,0xbf68bf3c,0xbf76ba07,0xbf7e70b0,0xbf5b941a,0xbf6dfcf2,0xbf7a1e84,0xbf7fa6e3
.long 0xbf61c598,0xbf7294f8,0xbf7cbfc9,0xbf7ffec4,0xbf676bd8,0xbf76841b,0xbf7e9bc9,0xbf7f7808
.long 0xbf6c835e,0xbf79c79d,0xbf7fb10f,0xbf7e1324,0xbf710908,0xbf7c5d3a,0xbf7ffec4,0xbf7bd14d
.long 0xbf74fa0b,0xbf7e4323,0xbf7f84ab,0xbf78b47b,0xbf7853f8,0xbf7f7808,0xbf7e4323,0xbf74bf62
.long 0xbf7b14be,0xbf7ffb11,0xbf7c3b28,0xbf6ff573,0xbf7d3aac,0xbf7fcbe2,0xbf796e4e,0xbf6a5ad9
.long 0xbf7ec46d,0xbf7eea9d,0xbf75dec6,0xbf63f473,0xbf7fb10f,0xbf7d57de,0xbf718f57,0xbf5cc7d1
.long 0xbec3ef15,0xbef15aea,0xbf0e39da,0xbf226799,0xbee0924f,0xbf06f686,0xbf1c420c,0xbf2ff3e6
.long 0xbefc5d27,0xbf14b039,0xbf299415,0xbf3ca003,0xbf0b9a6b,0xbf21cbfb,0xbf36206c,0xbf485bca
.long 0xbf187fc0,0xbf2e3bde,0xbf41d870,0xbf531849,0xbf24d225,0xbf39f2ac,0xbf4cae79,0xbf5cc7d1
.long 0xbf3085bb,0xbf44e3f5,0xbf5695e5,0xbf655e0b,0xbf3b8f3b,0xbf4f0417,0xbf5f8327,0xbf6cd007
.long 0xbf45e403,0xbf584853,0xbf676bd8,0xbf731447,0xbf4f7a1f,0xbf60a6cf,0xbf6e46be,0xbf7822d1
.long 0xbf584853,0xbf6816a8,0xbf740bdd,0xbf7bf531,0xbf604621,0xbf6e8ff8,0xbf78b47b,0xbf7e868b
.long 0xbf676bd8,0xbf740bdd,0xbf7c3b28,0xbf7fd397,0xbf6db293,0xbf788486,0xbf7e9bc9,0xbf7fdaaf
.long 0xbf731447,0xbf7bf531,0xbf7fd397,0xbf7e9bc9,0xbf778bc5,0xbf7e5a38,0xbf7fe129,0xbf7c187a
.long 0xbf7b14be,0xbf7fb10f,0xbf7ec46d,0xbf7853f8,0xbf7dabcc,0xbf7ff84a,0xbf7c7eb0,0xbf73530e
.long 0xbf7f4e6d,0xbf7f2f9d,0xbf791298,0xbf6d1c1d,0xbf7ffb11,0xbf7d57de,0xbf748422,0xbf65b710
.long 0xbf7fb10f,0xbf7a7302,0xbf6ed89e,0xbf5d2d53,0xbf7e70b0,0xbf76841b,0xbf6816a8,0xbf5389c7
.long 0xbf7c3b28,0xbf718f57,0xbf604621,0xbf48d8b3,0xbf791298,0xbf6b99fb,0xbf577026,0xbf3d27b8
.long 0xbf74fa0b,0xbf64aa59,0xbf4d9f02,0xbf3085bb,0xbf6ff573,0xbf5cc7d1,0xbf42de29,0xbf2302d3
.long 0xbf6a09a7,0xbf53fac3,0xbf373a23,0xbf14b039,0xbf633c5a,0xbf4a4c87,0xbf2ac082,0xbf05a02c
.long 0xbf5b941a,0xbf3fc767,0xbf1d7fd1,0xbeebcbbb,0xbf531849,0xbf34768f,0xbf0f8784,0xbecb2aae
.long 0xbf49d112,0xbf286605,0xbf00e7e4,0xbea986c4,0xbf3fc767,0xbf1ba299,0xbee363fa,0xbe870ada
.long 0x3f800000,0x3f7ec46d,0x3f7b14be,0x3f74fa0b,0x3f7fb10f,0x3f7d1cdd,0x3f77f110,0x3f703b37
.long 0x3f7ec46d,0x3f7ac516,0x3f740bdd,0x3f6aab7b,0x3f7d3aac,0x3f77beb7,0x3f6f6830,0x3f644fac
.long 0x3f7b14be,0x3f740bdd,0x3f6a09a7,0x3f5d2d53,0x3f7853f8,0x3f6faf1b,0x3f63f473,0x3f554aa4
.long 0x3f74fa0b,0x3f6aab7b,0x3f5d2d53,0x3f4cae79,0x3f710908,0x3f650479,0x3f55b993,0x3f436051
.long 0x3f6c835e,0x3f5ebe05,0x3f4d9f02,0x3f396842,0x3f676bd8,0x3f57dc7f,0x3f44e3f5,0x3f2ecef7
.long 0x3f61c598,0x3f5064af,0x3f3b8f3b,0x3f239da9,0x3f5b941a,0x3f485bca,0x3f31a81d,0x3f17de12
.long 0x3f54db31,0x3f3fc767,0x3f273656,0x3f0b9a6b,0x3f4d9f02,0x3f36ad7f,0x3f1c420c,0x3efdbabb
.long 0x3f45e403,0x3f2d1469,0x3f10d3cd,0x3ee363fa,0x3f3daef9,0x3f2302d3,0x3f04f484,0x3ec8477c
.long 0x3f3504f3,0x3f187fc0,0x3ef15aea,0x3eac7cd4,0x3f2beb4a,0x3f0d9281,0x3ed8106b,0x3e901c2c
.long 0x3f226799,0x3f0242b1,0x3ebe1d4a,0x3e667c66,0x3f187fc0,0x3eed3063,0x3ea395c5,0x3e2bf804
.long 0x3f0e39da,0x3ed53641,0x3e888e93,0x3de1bc2e,0x3f039c3d,0x3ebca7af,0x3e5a3997,0x3d55880e
.long 0x3ef15aea,0x3ea395c5,0x3e22abb6,0xbbc90f88,0x3edae880,0x3e8a11f7,0x3dd53db9,0xbd83db0a
.long 0x3ec3ef15,0x3e605c13,0x3d48fb30,0xbdfab273,0x3eac7cd4,0x3e2bf804,0xbbc90f88,0xbe3857ec
.long 0x3e94a031,0x3dee3876,0xbd7b2b74,0xbe72b651,0x3e78cfcc,0x3d83db0a,0xbdee3876,0xbe9620d2
.long 0x3e47c5c2,0x3c490e90,0xbe2f10a2,0xbeb263ef,0x3e164083,0xbd2351cb,0xbe667c66,0xbece0bea
.long 0x3dc8bd36,0xbdbc3ac3,0xbe8e9a22,0xbee900b7,0x3d48fb30,0xbe1324ca,0xbea986c4,0xbf019573
.long 0x3f6c835e,0x3f61c598,0x3f54db31,0x3f45e403,0x3f660f88,0x3f5988ad,0x3f4ac77f,0x3f39f2ac
.long 0x3f5ebe05,0x3f5064af,0x3f3fc767,0x3f2d1469,0x3f5695e5,0x3f466354,0x3f33e7bc,0x3f1f599f
.long 0x3f4d9f02,0x3f3b8f3b,0x3f273656,0x3f10d3cd,0x3f43e200,0x3f2ff3e6,0x3f19c200,0x3f019573
.long 0x3f396842,0x3f239da9,0x3f0b9a6b,0x3ee363fa,0x3f2e3bde,0x3f16999f,0x3ef9a02d,0x3ec27b55
.long 0x3f226799,0x3f08f59b,0x3edae880,0x3ea09ae5,0x3f15f6d9,0x3ef58035,0x3ebb31a0,0x3e7bdba4
.long 0x3f08f59b,0x3ed8106b,0x3e9aa086,0x3e354098,0x3ef6e0cb,0x3eb9bb1e,0x3e72b651,0x3ddb7d37
.long 0x3edae880,0x3e9aa086,0x3e2f10a2,0x3d16c32c,0x3ebe1d4a,0x3e75c35a,0x3dd53db9,0xbd0a342f
.long 0x3ea09ae5,0x3e354098,0x3d16c32c,0xbdd53db9,0x3e827dc0,0x3de7fa9a,0xbcfb49ba,0xbe3228d4
.long 0x3e47c5c2,0x3d48fb30,0xbdc8bd36,0xbe78cfcc,0x3e09cf86,0xbc7b514b,0xbe28defc,0xbe9f1cdf
.long 0x3d96a905,0xbda3308c,0xbe6c9a7f,0xbec1071e,0x3c490e90,0xbe1324ca,0xbe97a117,0xbee1fb6a
.long 0xbd48fb30,0xbe541501,0xbeb8442a,0xbf00e7e4,0xbde1bc2e,0xbe8a11f7,0xbed8106b,0xbf102dd5
.long 0xbe2f10a2,0xbea986c4,0xbef6e0cb,0xbf1ebc12,0xbe6c9a7f,0xbec8477c,0xbf0a48ad,0xbf2c800f
.long 0xbe94a031,0xbee63375,0xbf187fc0,0xbf396842,0xbeb263ef,0xbf019573,0xbf26050a,0xbf456439
.long 0xbecf7bca,0xbf0f8784,0xbf32c8c9,0xbf5064af,0xbeebcbbb,0xbf1ce11f,0xbf3ebc1b,0xbf5a5ba0
.long 0xbf039c3d,0xbf299415,0xbf49d112,0xbf633c5a,0xbf10d3cd,0xbf3592e7,0xbf53fac3,0xbf6afb8c
.long 0xbf1d7fd1,0xbf40d0da,0xbf5d2d53,0xbf718f57,0xbf299415,0xbf4b41fa,0xbf655e0b,0xbf76ef5b
.long 0xbf3504f3,0xbf45e403,0xbf54db31,0xbf61c598,0xbf41d870,0xbf51c0c2,0xbf5f8327,0xbf6afb8c
.long 0xbf4d9f02,0xbf5c61c7,0xbf68bf3c,0xbf7294f8,0xbf584853,0xbf65b710,0xbf708066,0xbf788486
.long 0xbf61c598,0xbf6db293,0xbf76ba07,0xbf7cbfc9,0xbf6a09a7,0xbf74484b,0xbf7b61fc,0xbf7f3f54
.long 0xbf710908,0xbf796e4e,0xbf7e70b0,0xbf7ffec4,0xbf76ba07,0xbf7d1cdd,0xbf7fe129,0xbf7efcc9
.long 0xbf7b14be,0xbf7f4e6d,0xbf7fb10f,0xbf7c3b28,0xbf7e1324,0xbf7fffb1,0xbf7de0b1,0xbf77beb7
.long 0xbf7fb10f,0xbf7f2f9d,0xbf7a7302,0xbf718f57,0xbf7fec43,0xbf7cdf6c,0xbf756d97,0xbf69b7e4
.long 0xbf7ec46d,0xbf791298,0xbf6ed89e,0xbf604621,0xbf7c3b28,0xbf73ced9,0xbf66becc,0xbf554aa4
.long 0xbf7853f8,0xbf6d1c1d,0xbf5d2d53,0xbf48d8b3,0xbf731447,0xbf650479,0xbf5233c6,0xbf3b0629
.long 0xbf6c835e,0xbf5b941a,0xbf45e403,0xbf2beb4a,0xbf64aa59,0xbf50d937,0xbf385216,0xbf1ba299
.long 0xbf5b941a,0xbf44e3f5,0xbf299415,0xbf0a48ad,0xbf514d3d,0xbf37c655,0xbf19c200,0xbeeff7fb
.long 0xbf45e403,0xbf299415,0xbf08f59b,0xbec9b953,0xbf396842,0xbf1a6293,0xbeee9479,0xbea21887
.long 0xbf2beb4a,0xbf0a48ad,0xbec9b953,0xbe72b651,0xbf1d7fd1,0xbef2bd43,0xbea395c5,0xbe1f917b
.long 0xbf0e39da,0xbecf7bca,0xbe78cfcc,0xbd96a905,0xbefc5d27,0xbeab0201,0xbe28defc,0x3c16cb58
.long 0xbedae880,0xbe8586ce,0xbdafb680,0x3dbc3ac3,0xbeb8442a,0xbe3e853e,0xbbc90f88,0x3e3228d4
.long 0xbe94a031,0xbde1bc2e,0x3d96a905,0x3e827dc0,0xbe605c13,0xbd0a342f,0x3e1c76de,0x3eab0201
.long 0xbe164083,0x3d2fe007,0x3e6c9a7f,0x3ed25a09,0xbd96a905,0x3df475c0,0x3e9d9e78,0x3ef840c8
.long 0xbf6c835e,0xbf74fa0b,0xbf7b14be,0xbf7ec46d,0xbf740bdd,0xbf7a9c59,0xbf7e9bc9,0xbf7fffb1
.long 0xbf79c79d,0xbf7e4323,0xbf7ffb11,0xbf7eea9d,0xbf7dabcc,0xbf7fe705,0xbf7f2f9d,0xbf7b87b2
.long 0xbf7fb10f,0xbf7f84ab,0xbf7c3b28,0xbf75dec6,0xbf7fd397,0xbf7d1cdd,0xbf772417,0xbf6dfcf2
.long 0xbf7e1324,0xbf78b47b,0xbf6ff573,0xbf63f473,0xbf7a7302,0xbf725470,0xbf66becc,0xbf57dc7f
.long 0xbf74fa0b,0xbf6a09a7,0xbf5b941a,0xbf49d112,0xbf6db293,0xbf5fe4e9,0xbf4e8d90,0xbf39f2ac
.long 0xbf64aa59,0xbf53fac3,0xbf3fc767,0xbf286605,0xbf59f26a,0xbf466354,0xbf2f61a5,0xbf1553b7
.long 0xbf4d9f02,0xbf373a23,0xbf1d7fd1,0xbf00e7e4,0xbf3fc767,0xbf269de3,0xbf0a48ad,0xbed6a399
.long 0xbf3085bb,0xbf14b039,0xbeebcbbb,0xbea986c4,0xbf1ff6cb,0xbf019573,0xbec1071e,0xbe75c35a
.long 0xbf0e39da,0xbedae880,0xbe94a031,0xbe164083,0xbef6e0cb,0xbeb0eacb,0xbe4dee60,0xbd55880e
.long 0xbecf7bca,0xbe8586ce,0xbde1bc2e,0x3d2fe007,0xbea68f12,0xbe3228d4,0xbc96c9b6,0x3e0cec4a
.long 0xbe78cfcc,0xbdafb680,0x3d96a905,0x3e6c9a7f,0xbe22abb6,0x3b490fc6,0x3e28defc,0x3ea5129f
.long 0xbd96a905,0x3dbc3ac3,0x3e827dc0,0x3ed25a09,0x3c490e90,0x3e3857ec,0x3eaf713a,0x3efdbabb
.long 0x3dc8bd36,0x3e888e93,0x3edae880,0x3f13682a,0x3e3b6ecf,0x3eb3dca5,0x3f0242b1,0x3f269de3
.long 0x3e888e93,0x3eddbe79,0x3f15f6d9,0x3f385216,0x3eb263ef,0x3f02ef9f,0x3f286605,0x3f485bca
.long 0x3edae880,0x3f15f6d9,0x3f396842,0x3f5695e5,0x3f00e7e4,0x3f27ce61,0x3f48d8b3,0x3f62df7b
.long 0x3f13682a,0x3f385216,0x3f5695e5,0x3f6d1c1d,0x3f24d225,0x3f476085,0x3f628210,0x3f75341d
.long 0x3f3504f3,0x3f226799,0x3f0e39da,0x3ef15aea,0x3f273656,0x3f12c39a,0x3ef9a02d,0x3ecb2aae
.long 0x3f187fc0,0x3f0242b1,0x3ed53641,0x3ea395c5,0x3f08f59b,0x3ee1fb6a,0x3eaf713a,0x3e75c35a
.long 0x3ef15aea,0x3ebe1d4a,0x3e888e93,0x3e22abb6,0x3ecf7bca,0x3e9920fe,0x3e419b37,0x3d9cecf9
.long 0x3eac7cd4,0x3e667c66,0x3de1bc2e,0xbbc90f88,0x3e888e93,0x3e195be0,0x3cfb49ba,0xbdb5f8da
.long 0x3e47c5c2,0x3d96a905,0xbd48fb30,0xbe2f10a2,0x3dfab273,0xbb490fc6,0xbe039502,0xbe80f8c0
.long 0x3d48fb30,0xbda3308c,0xbe541501,0xbea986c4,0xbcc90ab0,0xbe1f917b,0xbe919ddd,0xbed0eb2a
.long 0xbdc8bd36,0xbe6c9a7f,0xbeb8442a,0xbef6e0cb,0xbe2f10a2,0xbe9c1faf,0xbeddbe79,0xbf0d9281
.long 0xbe78cfcc,0xbec1071e,0xbf00e7e4,0xbf1ebc12,0xbea09ae5,0xbee4cbfe,0xbf121eb0,0xbf2ecef7
.long 0xbec3ef15,0xbf039c3d,0xbf226799,0xbf3daef9,0xbee63375,0xbf140c5f,0xbf31a81d,0xbf4b41fa
.long 0xbf039c3d,0xbf239da9,0xbf3fc767,0xbf577026,0xbf13682a,0xbf3238aa,0xbf4cae79,0xbf62241a
.long 0xbf226799,0xbf3fc767,0xbf584853,0xbf6b4b0c,0xbf3085bb,0xbf4c3578,0xbf628210,0xbf72d4eb
.long 0xbf3daef9,0xbf577026,0xbf6b4b0c,0xbf78b47b,0xbf49d112,0xbf61668a,0xbf7294f8,0xbf7cdf6c
.long 0xbf54db31,0xbf6a09a7,0xbf7853f8,0xbf7f4e6d,0xbf5ebe05,0xbf714c7a,0xbf7c7eb0,0xbf7ffd39
.long 0xbf676bd8,0xbf772417,0xbf7f0e58,0xbf7eea9d,0xbf6ed89e,0xbf7b87b2,0xbf7ffec4,0xbf7c187a
.long 0xbf74fa0b,0xbf7e70b0,0xbf7f4e6d,0xbf778bc5,0xbf79c79d,0xbf7fdaaf,0xbf7cfe73,0xbf714c7a
.long 0xbf7d3aac,0xbf7fc38f,0xbf791298,0xbf696591,0xbf7f4e6d,0xbf7e2b72,0xbf73913f,0xbf5fe4e9
.long 0x3ec3ef15,0x3e94a031,0x3e47c5c2,0x3dc8bd36,0x3e9aa086,0x3e5101f1,0x3dd53db9,0x3b490fc6
.long 0x3e605c13,0x3dee3876,0x3c490e90,0xbdbc3ac3,0x3e09cf86,0x3ce22a7a,0xbda3308c,0xbe3e853e
.long 0x3d48fb30,0xbd7b2b74,0xbe2f10a2,0xbe8e9a22,0xbd16c32c,0xbe195be0,0xbe8586ce,0xbebca7af
.long 0xbdfab273,0xbe72b651,0xbeb263ef,0xbee900b7,0xbe541501,0xbea5129f,0xbeddbe79,0xbf099f4e
.long 0xbe94a031,0xbecf7bca,0xbf039c3d,0xbf1d7fd1,0xbebe1d4a,0xbef840c8,0xbf173c07,0xbf2ff3e6
.long 0xbee63375,0xbf0f8784,0xbf299415,0xbf40d0da,0xbf064b82,0xbf21cbfb,0xbf3a7ca4,0xbf4fefa8
.long 0xbf187fc0,0xbf32c8c9,0xbf49d112,0xbf5d2d53,0xbf299415,0xbf425b89,0xbf577026,0xbf686b39
.long 0xbf396842,0xbf5064af,0xbf633c5a,0xbf718f57,0xbf47de65,0xbf5cc7d1,0xbf6d1c1d,0xbf788486
.long 0xbf54db31,0xbf676bd8,0xbf74fa0b,0xbf7d3aac,0xbf604621,0xbf703b37,0xbf7ac516,0xbf7fa6e3
.long 0xbf6a09a7,0xbf772417,0xbf7e70b0,0xbf7fc38f,0xbf721352,0xbf7c187a,0xbf7ff4e6,0xbf7d906e
.long 0xbf7853f8,0xbf7f0e58,0xbf7f4e6d,0xbf791298,0xbf7cbfc9,0xbf7fffb1,0xbf7c7eb0,0xbf725470
.long 0xbf7f4e6d,0xbf7eea9d,0xbf778bc5,0xbf696591,0xbf7ffb11,0xbf7bd14d,0xbf708066,0xbf5e5aa6
.long 0xbf7ec46d,0xbf76ba07,0xbf676bd8,0xbf514d3d,0xbf7baccd,0xbf6faf1b,0xbf5c61c7,0xbf425b89
.long 0xbf76ba07,0xbf66becc,0xbf4f7a1f,0xbf31a81d,0xbf6ff573,0xbf5bfb34,0xbf40d0da,0xbf1f599f
.long 0xbf676bd8,0xbf4f7a1f,0xbf3085bb,0xbf0b9a6b,0xbf5d2d53,0xbf4154e1,0xbf1ebc12,0xbeed3063
.long 0xbf514d3d,0xbf31a81d,0xbf0b9a6b,0xbec1071e,0xbf43e200,0xbf209393,0xbeee9479,0xbe931f35
```
